```python
import torch

def _softmax(x, axis=-1):
    return torch.softmax(x, dim=axis)
def _gelu(x):
    return torch.nn.functional.gelu(x, approximate="tanh")
def _silu(x):
    return torch.nn.functional.silu(x)
def _sigmoid(x):
    return torch.sigmoid(x)
def _layernorm(x, axis=-1, eps=1e-5):
    m = x.mean(dim=axis, keepdim=True)
    v = x.var(dim=axis, keepdim=True, unbiased=False)
    return (x - m) / torch.sqrt(v + eps)
def _scatter_add(tgt, idx, src, axis=0):
    return tgt.clone().index_add_(axis, idx, src)
def _segment_sum(src, seg, n):
    out = torch.zeros((n,) + src.shape[1:], dtype=src.dtype)
    return out.index_add_(0, seg, src)
def _pad(x, pw):
    flat = tuple(v for pair in reversed(pw) for v in pair)
    return torch.nn.functional.pad(x, flat)

kernel_name = 'standalone__mha_block_cached__near_ridge'

def setup_inputs():

    _w = (lambda a: (lambda t: t.to(torch.bfloat16) if t.is_floating_point() else t)(torch.as_tensor(a)))
    B, Sq, D = 8, 240, 512
    H, Sk, Dh = 32, 1024, 128
    return {
        "x": _w((lambda *s: torch.randn(*s, dtype=torch.bfloat16) * 0.8)(B, Sq, D)),
        "k_cache": _w((lambda *s: torch.randn(*s, dtype=torch.bfloat16) * 0.8)(B, H, Sk, Dh)),
        "v_cache": _w((lambda *s: torch.randn(*s, dtype=torch.bfloat16) * 0.05)(B, H, Sk, Dh)),
        "wq": _w((lambda *s: torch.randn(*s, dtype=torch.bfloat16) * 0.8)(D, H * Dh) * (D ** -0.5)),
        "wo": _w((lambda *s: torch.randn(*s, dtype=torch.bfloat16) * 0.05)(H * Dh, D) * ((H * Dh) ** -0.5)),
    }

def reference(x, k_cache, v_cache, wq, wo):
    B, Sq, D = x.shape
    H, Dh = 32, 128
    q = (lambda x, *d: x.permute(*d))((x @ wq).reshape(B, Sq, H, Dh), 0, 2, 1, 3)
    scores = torch.einsum("bhqd,bhkd->bhqk", q, k_cache) * (Dh ** -0.5)
    p = _softmax(scores, axis=-1)
    o = torch.einsum("bhqk,bhkd->bhqd", p, v_cache)
    return (lambda x, *d: x.permute(*d))(o, 0, 2, 1, 3).reshape(B, Sq, H * Dh) @ wo
```

```asm
; @launch grid=(256,1,1) block=(256,1,1) lds=152128
.amdgcn_target "amdgcn-amd-amdhsa--gfx950"
.text
.globl standalone__mha_block_cached__near_ridge_kernel
.p2align 8
.type standalone__mha_block_cached__near_ridge_kernel,@function
standalone__mha_block_cached__near_ridge_kernel:
  s_cmp_ge_u32 s2, 256
  s_cbranch_scc1 L_k1_done
  s_load_dwordx4 s[4:7], s[0:1], 0
  s_load_dwordx4 s[40:43], s[0:1], 16
  s_load_dwordx2 s[44:45], s[0:1], 56
  s_load_dwordx4 s[56:59], s[0:1], 32
  s_load_dwordx2 s[100:101], s[0:1], 48
  s_getpc_b64 s[54:55]
L_pc:
  v_cmp_gt_u32 vcc, 64, v0
  s_and_saveexec_b64 s[34:35], vcc
  s_cbranch_execz L_cpf
  s_lshr_b32 s33, s2, 3
  s_mul_i32 s33, s33, 0x900
  v_lshrrev_b32 v2, 5, v0
  v_mul_u32_u24 v2, s33, v2
  v_lshl_add_u32 v1, v0, 7, v2
  v_min_u32 v1, 0x125c8, v1
  global_load_dword v231, v1, s[54:55]
L_cpf:
  s_mov_b64 exec, s[34:35]
  v_lshrrev_b32 v1, 6, v0
  v_and_b32 v239, 63, v0
  v_readfirstlane_b32 s3, v1
  s_and_b32 s33, s2, 7
  s_lshr_b32 s34, s2, 3
  s_and_b32 s28, s33, 1
  s_lshl_b32 s28, s28, 2
  s_and_b32 s35, s34, 3
  s_add_u32 s28, s28, s35
  s_lshr_b32 s29, s33, 1
  s_lshl_b32 s29, s29, 3
  s_lshr_b32 s34, s34, 2
  s_add_u32 s29, s29, s34
  s_lshl_b32 s35, s35, 1
  s_add_u32 s30, s29, s35
  s_lshr_b32 s35, s35, 1
  s_add_u32 s30, s29, s35
  s_and_b32 s30, s30, 3
  s_mul_i32 s30, s30, 2
  s_mul_i32 s32, s3, 4224
  s_lshl_b32 s31, s32, 1
  s_add_u32 s31, s31, 50688
  v_and_b32 v1, 15, v239
  v_lshrrev_b32 v2, 4, v239
  v_bfe_u32 v3, v239, 2, 2
  v_and_b32 v4, 3, v239
  v_lshrrev_b32 v5, 5, v239
  v_lshlrev_b32 v5, 15, v5
  v_bfe_u32 v6, v239, 3, 2
  v_lshl_add_u32 v5, v6, 12, v5
  v_and_b32 v6, 7, v239
  v_lshl_add_u32 v5, v6, 4, v5
  s_lshl_b32 s33, s3, 16
  s_add_u32 s33, s33, 128
  v_add_u32 v244, s33, v5
  v_subrev_u32 v245, 32, v244
  v_subrev_u32 v246, 64, v244
  v_subrev_u32 v247, 96, v244
  s_and_b32 s33, s3, 1
  s_lshl_b32 s33, s33, 16
  s_lshr_b32 s34, s3, 1
  s_lshl_b32 s34, s34, 15
  s_add_u32 s33, s33, s34
  v_lshlrev_b32 v5, 17, v2
  v_lshl_add_u32 v5, v1, 4, v5
  v_add_u32 v248, s33, v5
  v_add_u32 v249, 7136, v248
  v_add_u32 v250, 14272, v248
  v_add_u32 v251, 21408, v248
  s_mul_i32 s33, s28, 245760
  s_lshl_b32 s34, s29, 8
  s_sub_u32 s35, 0x400000, s34
  s_waitcnt lgkmcnt(0)
  s_add_u32 s8, s4, s33
  s_addc_u32 s9, s5, 0
  s_sub_u32 s8, s8, 128
  s_subb_u32 s9, s9, 0
  s_mov_b32 s10, 245888
  s_mov_b32 s11, 0x20000
  s_add_u32 s12, s42, s34
  s_addc_u32 s13, s43, 0
  s_mov_b32 s14, s35
  s_mov_b32 s15, 0x20000
  s_add_u32 s33, s30, 0
  s_and_b32 s33, s33, 7
  s_lshl_b32 s36, s33, 7
  s_lshl_b32 s38, s33, 19
  s_add_u32 s37, s36, 16384
  s_add_u32 m0, s31, 0
  s_nop 0
  buffer_load_dwordx4 v244, s[8:11], s36 offen offset:0 lds
  buffer_load_dwordx4 v245, s[8:11], s36 offen offset:1056 lds
  buffer_load_dwordx4 v246, s[8:11], s36 offen offset:2112 lds
  buffer_load_dwordx4 v247, s[8:11], s36 offen offset:3168 lds
  s_add_u32 m0, s31, 4224
  s_nop 0
  buffer_load_dwordx4 v244, s[8:11], s37 offen offset:0 lds
  buffer_load_dwordx4 v245, s[8:11], s37 offen offset:1056 lds
  buffer_load_dwordx4 v246, s[8:11], s37 offen offset:2112 lds
  buffer_load_dwordx4 v247, s[8:11], s37 offen offset:3168 lds
  s_add_u32 m0, s32, 118272
  s_nop 0
  buffer_load_dwordx4 v248, s[12:15], s38 offen offset:0 lds
  buffer_load_dwordx4 v249, s[12:15], s38 offen offset:1056 lds
  buffer_load_dwordx4 v250, s[12:15], s38 offen offset:2112 lds
  buffer_load_dwordx4 v251, s[12:15], s38 offen offset:3168 lds
  s_mov_b32 s53, 0x3e0293ee
  s_mov_b32 s52, 0
  s_lshl_b32 s33, s3, 12
  s_add_u32 s33, s33, 128
  v_lshlrev_b32 v238, 4, v239
  v_add_u32 v240, s33, v238
  v_subrev_u32 v241, 32, v240
  v_subrev_u32 v242, 64, v240
  v_subrev_u32 v243, 96, v240
  s_mov_b32 s33, 1056
  v_and_b32 v5, 7, v1
  v_mul_u32_u24 v5, s33, v5
  v_lshrrev_b32 v6, 3, v1
  v_lshl_add_u32 v5, v6, 8, v5
  v_lshl_add_u32 v234, v2, 4, v5
  v_mov_b32 v232, v234
  v_and_b32 v5, 1, v2
  v_lshl_add_u32 v5, v5, 2, v3
  v_mul_u32_u24 v5, s33, v5
  v_lshrrev_b32 v6, 1, v2
  v_lshl_add_u32 v5, v6, 8, v5
  v_lshl_add_u32 v5, v4, 3, v5
  v_add_u32 v235, 16896, v5
  v_mov_b32 v233, v235
  v_add_u32 v237, 118272, v5
  v_mul_u32_u24 v5, s33, v4
  v_lshl_add_u32 v5, v3, 7, v5
  v_lshl_add_u32 v5, v2, 4, v5
  v_add_u32 v236, s31, v5
  v_mov_b32 v212, 0xff800000
  v_mov_b32 v213, 0xff800000
  v_mov_b32 v214, 0xff800000
  v_mov_b32 v215, 0xff800000
  v_lshrrev_b32 v5, 1, v2
  v_lshlrev_b32 v5, 15, v5
  v_and_b32 v6, 1, v2
  v_lshl_add_u32 v5, v6, 13, v5
  v_lshl_add_u32 v5, v1, 4, v5
  s_lshr_b32 s33, s3, 1
  s_lshl_b32 s33, s33, 14
  s_and_b32 s34, s3, 1
  s_lshl_b32 s34, s34, 12
  s_add_u32 s33, s33, s34
  v_add_u32 v5, s33, v5
  v_add_u32 v252, 128, v5
  v_add_u32 v253, 96, v5
  v_add_u32 v254, 64, v5
  v_add_u32 v255, 32, v5
  s_lshl_b32 s33, s28, 5
  s_add_u32 s33, s33, s29
  s_lshl_b32 s33, s33, 18
  s_add_u32 s16, s6, s33
  s_addc_u32 s17, s7, 0
  s_sub_u32 s16, s16, 128
  s_subb_u32 s17, s17, 0
  s_mov_b32 s18, 262272
  s_mov_b32 s19, 0x20000
  s_add_u32 s20, s40, s33
  s_addc_u32 s21, s41, 0
  s_sub_u32 s20, s20, 128
  s_subb_u32 s21, s21, 0
  s_mov_b32 s22, 262272
  s_mov_b32 s23, 0x20000
  s_lshl_b32 s33, s28, 21
  s_lshr_b32 s34, s3, 1
  s_lshl_b32 s34, s34, 20
  s_add_u32 s33, s33, s34
  s_lshl_b32 s34, s29, 15
  s_add_u32 s33, s33, s34
  s_and_b32 s34, s3, 1
  s_lshl_b32 s34, s34, 12
  s_add_u32 s33, s33, s34
  s_add_u32 s24, s44, s33
  s_addc_u32 s25, s45, 0
  s_mov_b32 s26, 28672
  s_mov_b32 s27, 0x20000
  s_add_u32 s33, s30, 1
  s_and_b32 s33, s33, 7
  s_lshl_b32 s36, s33, 7
  s_lshl_b32 s38, s33, 19
  s_add_u32 s37, s36, 16384
  s_add_u32 m0, s31, 33792
  s_nop 0
  buffer_load_dwordx4 v244, s[8:11], s36 offen offset:0 lds
  buffer_load_dwordx4 v245, s[8:11], s36 offen offset:1056 lds
  buffer_load_dwordx4 v246, s[8:11], s36 offen offset:2112 lds
  buffer_load_dwordx4 v247, s[8:11], s36 offen offset:3168 lds
  s_add_u32 m0, s31, 38016
  s_nop 0
  buffer_load_dwordx4 v244, s[8:11], s37 offen offset:0 lds
  buffer_load_dwordx4 v245, s[8:11], s37 offen offset:1056 lds
  buffer_load_dwordx4 v246, s[8:11], s37 offen offset:2112 lds
  buffer_load_dwordx4 v247, s[8:11], s37 offen offset:3168 lds
  s_add_u32 m0, s32, 135168
  s_nop 0
  buffer_load_dwordx4 v248, s[12:15], s38 offen offset:0 lds
  buffer_load_dwordx4 v249, s[12:15], s38 offen offset:1056 lds
  buffer_load_dwordx4 v250, s[12:15], s38 offen offset:2112 lds
  buffer_load_dwordx4 v251, s[12:15], s38 offen offset:3168 lds
  s_cmp_eq_u32 s3, 3
  s_cbranch_scc1 L_w3
L_w012:
  s_waitcnt vmcnt(12)
  s_barrier
  ds_read_b128 a[64:67], v236 offset:0
  ds_read_b128 a[68:71], v236 offset:4224
  ds_read_b128 a[72:75], v236 offset:512
  ds_read_b128 a[76:79], v236 offset:4736
  ds_read_b128 a[80:83], v236 offset:64
  ds_read_b128 a[84:87], v236 offset:4288
  ds_read_b128 a[88:91], v236 offset:576
  ds_read_b128 a[92:95], v236 offset:4800
  ds_read_b64_tr_b16 a[0:1], v237 offset:0
  ds_read_b64_tr_b16 a[2:3], v237 offset:8448
  ds_read_b64_tr_b16 a[32:33], v237 offset:512
  ds_read_b64_tr_b16 a[34:35], v237 offset:8960
  ds_read_b64_tr_b16 a[4:5], v237 offset:32
  ds_read_b64_tr_b16 a[6:7], v237 offset:8480
  ds_read_b64_tr_b16 a[36:37], v237 offset:544
  ds_read_b64_tr_b16 a[38:39], v237 offset:8992
  ds_read_b64_tr_b16 a[8:9], v237 offset:64
  s_waitcnt lgkmcnt(7)
  ds_read_b64_tr_b16 a[10:11], v237 offset:8512
  v_mfma_f32_16x16x32_bf16 v[0:3], a[0:3], a[64:67], 0
  ds_read_b64_tr_b16 a[40:41], v237 offset:576
  s_waitcnt lgkmcnt(7)
  ds_read_b64_tr_b16 a[42:43], v237 offset:9024
  v_mfma_f32_16x16x32_bf16 v[0:3], a[32:35], a[80:83], v[0:3]
  ds_read_b64_tr_b16 a[12:13], v237 offset:96
  ds_read_b64_tr_b16 a[14:15], v237 offset:8544
  v_mfma_f32_16x16x32_bf16 v[32:35], a[0:3], a[68:71], 0
  ds_read_b64_tr_b16 a[44:45], v237 offset:608
  ds_read_b64_tr_b16 a[46:47], v237 offset:9056
  v_mfma_f32_16x16x32_bf16 v[32:35], a[32:35], a[84:87], v[32:35]
  ds_read_b64_tr_b16 a[16:17], v237 offset:128
  ds_read_b64_tr_b16 a[18:19], v237 offset:8576
  v_mfma_f32_16x16x32_bf16 v[64:67], a[0:3], a[72:75], 0
  ds_read_b64_tr_b16 a[48:49], v237 offset:640
  ds_read_b64_tr_b16 a[50:51], v237 offset:9088
  v_mfma_f32_16x16x32_bf16 v[64:67], a[32:35], a[88:91], v[64:67]
  ds_read_b64_tr_b16 a[20:21], v237 offset:160
  v_mfma_f32_16x16x32_bf16 v[96:99], a[0:3], a[76:79], 0
  ds_read_b64_tr_b16 a[22:23], v237 offset:8608
  ds_read_b64_tr_b16 a[52:53], v237 offset:672
  v_mfma_f32_16x16x32_bf16 v[96:99], a[32:35], a[92:95], v[96:99]
  ds_read_b64_tr_b16 a[54:55], v237 offset:9120
  s_waitcnt lgkmcnt(9)
  ds_read_b64_tr_b16 a[24:25], v237 offset:192
  v_mfma_f32_16x16x32_bf16 v[4:7], a[4:7], a[64:67], 0
  ds_read_b64_tr_b16 a[26:27], v237 offset:8640
  ds_read_b64_tr_b16 a[56:57], v237 offset:704
  v_mfma_f32_16x16x32_bf16 v[4:7], a[36:39], a[80:83], v[4:7]
  s_mov_b32 s34, 0
  ds_read_b64_tr_b16 a[58:59], v237 offset:9152
  ds_read_b64_tr_b16 a[28:29], v237 offset:224
  v_mfma_f32_16x16x32_bf16 v[36:39], a[4:7], a[68:71], 0
  s_add_u32 m0, s32, 0
  s_add_u32 s33, s30, 2
  s_and_b32 s33, s33, 7
  ds_read_b64_tr_b16 a[30:31], v237 offset:8672
  ds_read_b64_tr_b16 a[60:61], v237 offset:736
  v_mfma_f32_16x16x32_bf16 v[36:39], a[36:39], a[84:87], v[36:39]
  s_lshl_b32 s36, s33, 7
  buffer_load_dwordx4 v240, s[16:19], s34 offen offset:0 nt lds
  ds_read_b64_tr_b16 a[62:63], v237 offset:9184
  v_mfma_f32_16x16x32_bf16 v[68:71], a[4:7], a[72:75], 0
  s_lshl_b32 s38, s33, 19
  buffer_load_dwordx4 v241, s[16:19], s34 offen offset:1056 nt lds
  v_mfma_f32_16x16x32_bf16 v[68:71], a[36:39], a[88:91], v[68:71]
  s_waitcnt lgkmcnt(0)
  s_waitcnt vmcnt(2)
  s_add_u32 s37, s36, 16384
  v_mfma_f32_16x16x32_bf16 v[100:103], a[4:7], a[76:79], 0
  s_barrier
  s_add_u32 m0, s31, 0
  v_mfma_f32_16x16x32_bf16 v[100:103], a[36:39], a[92:95], v[100:103]
  buffer_load_dwordx4 v244, s[8:11], s36 offen offset:0 lds
  ds_read_b128 a[160:163], v236 offset:33792
  v_mfma_f32_16x16x32_bf16 v[8:11], a[8:11], a[64:67], 0
  ds_read_b128 a[164:167], v236 offset:38016
  v_mfma_f32_16x16x32_bf16 v[8:11], a[40:43], a[80:83], v[8:11]
  buffer_load_dwordx4 v245, s[8:11], s36 offen offset:1056 lds
  v_mfma_f32_16x16x32_bf16 v[40:43], a[8:11], a[68:71], 0
  ds_read_b128 a[168:171], v236 offset:34304
  v_mfma_f32_16x16x32_bf16 v[40:43], a[40:43], a[84:87], v[40:43]
  buffer_load_dwordx4 v246, s[8:11], s36 offen offset:2112 lds
  v_mfma_f32_16x16x32_bf16 v[72:75], a[8:11], a[72:75], 0
  ds_read_b128 a[172:175], v236 offset:38528
  v_mfma_f32_16x16x32_bf16 v[72:75], a[40:43], a[88:91], v[72:75]
  buffer_load_dwordx4 v247, s[8:11], s36 offen offset:3168 lds
  v_mfma_f32_16x16x32_bf16 v[104:107], a[8:11], a[76:79], 0
  s_add_u32 m0, s31, 4224
  ds_read_b128 a[176:179], v236 offset:33856
  v_mfma_f32_16x16x32_bf16 v[104:107], a[40:43], a[92:95], v[104:107]
  buffer_load_dwordx4 v244, s[8:11], s37 offen offset:0 lds
  v_mfma_f32_16x16x32_bf16 v[12:15], a[12:15], a[64:67], 0
  buffer_load_dwordx4 v245, s[8:11], s37 offen offset:1056 lds
  ds_read_b128 a[180:183], v236 offset:38080
  v_mfma_f32_16x16x32_bf16 v[12:15], a[44:47], a[80:83], v[12:15]
  ds_read_b128 a[184:187], v236 offset:34368
  v_mfma_f32_16x16x32_bf16 v[44:47], a[12:15], a[68:71], 0
  buffer_load_dwordx4 v246, s[8:11], s37 offen offset:2112 lds
  v_mfma_f32_16x16x32_bf16 v[44:47], a[44:47], a[84:87], v[44:47]
  ds_read_b128 a[188:191], v236 offset:38592
  v_mfma_f32_16x16x32_bf16 v[76:79], a[12:15], a[72:75], 0
  ds_read_b64_tr_b16 a[96:97], v237 offset:16896
  v_mfma_f32_16x16x32_bf16 v[76:79], a[44:47], a[88:91], v[76:79]
  buffer_load_dwordx4 v247, s[8:11], s37 offen offset:3168 lds
  v_mfma_f32_16x16x32_bf16 v[108:111], a[12:15], a[76:79], 0
  s_add_u32 m0, s32, 118272
  ds_read_b64_tr_b16 a[98:99], v237 offset:25344
  v_mfma_f32_16x16x32_bf16 v[108:111], a[44:47], a[92:95], v[108:111]
  buffer_load_dwordx4 v248, s[12:15], s38 offen offset:0 lds
  v_mfma_f32_16x16x32_bf16 v[16:19], a[16:19], a[64:67], 0
  ds_read_b64_tr_b16 a[128:129], v237 offset:17408
  v_mfma_f32_16x16x32_bf16 v[16:19], a[48:51], a[80:83], v[16:19]
  buffer_load_dwordx4 v249, s[12:15], s38 offen offset:1056 lds
  ds_read_b64_tr_b16 a[130:131], v237 offset:25856
  v_mfma_f32_16x16x32_bf16 v[48:51], a[16:19], a[68:71], 0
  buffer_load_dwordx4 v250, s[12:15], s38 offen offset:2112 lds
  v_mfma_f32_16x16x32_bf16 v[48:51], a[48:51], a[84:87], v[48:51]
  ds_read_b64_tr_b16 a[100:101], v237 offset:16928
  v_mfma_f32_16x16x32_bf16 v[80:83], a[16:19], a[72:75], 0
  buffer_load_dwordx4 v251, s[12:15], s38 offen offset:3168 lds
  v_mfma_f32_16x16x32_bf16 v[80:83], a[48:51], a[88:91], v[80:83]
  ds_read_b64_tr_b16 a[102:103], v237 offset:25376
  v_mfma_f32_16x16x32_bf16 v[112:115], a[16:19], a[76:79], 0
  ds_read_b64_tr_b16 a[132:133], v237 offset:17440
  v_mfma_f32_16x16x32_bf16 v[112:115], a[48:51], a[92:95], v[112:115]
  ds_read_b64_tr_b16 a[134:135], v237 offset:25888
  v_mfma_f32_16x16x32_bf16 v[20:23], a[20:23], a[64:67], 0
  ds_read_b64_tr_b16 a[104:105], v237 offset:16960
  v_mfma_f32_16x16x32_bf16 v[20:23], a[52:55], a[80:83], v[20:23]
  ds_read_b64_tr_b16 a[106:107], v237 offset:25408
  v_mfma_f32_16x16x32_bf16 v[52:55], a[20:23], a[68:71], 0
  ds_read_b64_tr_b16 a[136:137], v237 offset:17472
  v_mfma_f32_16x16x32_bf16 v[52:55], a[52:55], a[84:87], v[52:55]
  ds_read_b64_tr_b16 a[138:139], v237 offset:25920
  ds_read_b64_tr_b16 a[108:109], v237 offset:16992
  v_mfma_f32_16x16x32_bf16 v[84:87], a[20:23], a[72:75], 0
  ds_read_b64_tr_b16 a[110:111], v237 offset:25440
  v_mfma_f32_16x16x32_bf16 v[84:87], a[52:55], a[88:91], v[84:87]
  ds_read_b64_tr_b16 a[140:141], v237 offset:17504
  v_mfma_f32_16x16x32_bf16 v[116:119], a[20:23], a[76:79], 0
  ds_read_b64_tr_b16 a[142:143], v237 offset:25952
  v_mfma_f32_16x16x32_bf16 v[116:119], a[52:55], a[92:95], v[116:119]
  ds_read_b64_tr_b16 a[112:113], v237 offset:17024
  v_mfma_f32_16x16x32_bf16 v[24:27], a[24:27], a[64:67], 0
  ds_read_b64_tr_b16 a[114:115], v237 offset:25472
  v_mfma_f32_16x16x32_bf16 v[24:27], a[56:59], a[80:83], v[24:27]
  ds_read_b64_tr_b16 a[144:145], v237 offset:17536
  v_mfma_f32_16x16x32_bf16 v[56:59], a[24:27], a[68:71], 0
  ds_read_b64_tr_b16 a[146:147], v237 offset:25984
  v_mfma_f32_16x16x32_bf16 v[56:59], a[56:59], a[84:87], v[56:59]
  ds_read_b64_tr_b16 a[116:117], v237 offset:17056
  v_mfma_f32_16x16x32_bf16 v[88:91], a[24:27], a[72:75], 0
  ds_read_b64_tr_b16 a[118:119], v237 offset:25504
  ds_read_b64_tr_b16 a[148:149], v237 offset:17568
  v_mfma_f32_16x16x32_bf16 v[88:91], a[56:59], a[88:91], v[88:91]
  ds_read_b64_tr_b16 a[150:151], v237 offset:26016
  v_mfma_f32_16x16x32_bf16 v[120:123], a[24:27], a[76:79], 0
  ds_read_b64_tr_b16 a[120:121], v237 offset:17088
  v_mfma_f32_16x16x32_bf16 v[120:123], a[56:59], a[92:95], v[120:123]
  ds_read_b64_tr_b16 a[122:123], v237 offset:25536
  v_mfma_f32_16x16x32_bf16 v[28:31], a[28:31], a[64:67], 0
  ds_read_b64_tr_b16 a[152:153], v237 offset:17600
  v_mfma_f32_16x16x32_bf16 v[28:31], a[60:63], a[80:83], v[28:31]
  ds_read_b64_tr_b16 a[154:155], v237 offset:26048
  v_mfma_f32_16x16x32_bf16 v[60:63], a[28:31], a[68:71], 0
  ds_read_b64_tr_b16 a[124:125], v237 offset:17120
  v_mfma_f32_16x16x32_bf16 v[60:63], a[60:63], a[84:87], v[60:63]
  ds_read_b64_tr_b16 a[126:127], v237 offset:25568
  v_mfma_f32_16x16x32_bf16 v[92:95], a[28:31], a[72:75], 0
  ds_read_b64_tr_b16 a[156:157], v237 offset:17632
  v_mfma_f32_16x16x32_bf16 v[92:95], a[60:63], a[88:91], v[92:95]
  ds_read_b64_tr_b16 a[158:159], v237 offset:26080
  v_mfma_f32_16x16x32_bf16 v[124:127], a[28:31], a[76:79], 0
  v_mfma_f32_16x16x32_bf16 v[124:127], a[60:63], a[92:95], v[124:127]
  s_waitcnt lgkmcnt(0)
  s_add_u32 s33, s30, 3
  s_and_b32 s33, s33, 7
  s_lshl_b32 s36, s33, 7
  s_lshl_b32 s38, s33, 19
  v_mfma_f32_16x16x32_bf16 v[0:3], a[96:99], a[160:163], v[0:3]
  s_waitcnt vmcnt(0)
  s_add_u32 s37, s36, 16384
  v_mfma_f32_16x16x32_bf16 v[0:3], a[128:131], a[176:179], v[0:3]
  s_barrier
  s_add_u32 m0, s31, 33792
  v_mfma_f32_16x16x32_bf16 v[32:35], a[96:99], a[164:167], v[32:35]
  buffer_load_dwordx4 v244, s[8:11], s36 offen offset:0 lds
  ds_read_b128 a[64:67], v236 offset:0
  v_mfma_f32_16x16x32_bf16 v[32:35], a[128:131], a[180:183], v[32:35]
  buffer_load_dwordx4 v245, s[8:11], s36 offen offset:1056 lds
  v_mfma_f32_16x16x32_bf16 v[64:67], a[96:99], a[168:171], v[64:67]
  ds_read_b128 a[68:71], v236 offset:4224
  v_mfma_f32_16x16x32_bf16 v[64:67], a[128:131], a[184:187], v[64:67]
  buffer_load_dwordx4 v246, s[8:11], s36 offen offset:2112 lds
  v_mfma_f32_16x16x32_bf16 v[96:99], a[96:99], a[172:175], v[96:99]
  ds_read_b128 a[72:75], v236 offset:512
  v_mfma_f32_16x16x32_bf16 v[96:99], a[128:131], a[188:191], v[96:99]
  buffer_load_dwordx4 v247, s[8:11], s36 offen offset:3168 lds
  v_mfma_f32_16x16x32_bf16 v[4:7], a[100:103], a[160:163], v[4:7]
  s_add_u32 m0, s31, 38016
  ds_read_b128 a[76:79], v236 offset:4736
  v_mfma_f32_16x16x32_bf16 v[4:7], a[132:135], a[176:179], v[4:7]
  buffer_load_dwordx4 v244, s[8:11], s37 offen offset:0 lds
  v_mfma_f32_16x16x32_bf16 v[36:39], a[100:103], a[164:167], v[36:39]
  ds_read_b128 a[80:83], v236 offset:64
  v_mfma_f32_16x16x32_bf16 v[36:39], a[132:135], a[180:183], v[36:39]
  buffer_load_dwordx4 v245, s[8:11], s37 offen offset:1056 lds
  v_mfma_f32_16x16x32_bf16 v[68:71], a[100:103], a[168:171], v[68:71]
  ds_read_b128 a[84:87], v236 offset:4288
  v_mfma_f32_16x16x32_bf16 v[68:71], a[132:135], a[184:187], v[68:71]
  buffer_load_dwordx4 v246, s[8:11], s37 offen offset:2112 lds
  ds_read_b128 a[88:91], v236 offset:576
  v_mfma_f32_16x16x32_bf16 v[100:103], a[100:103], a[172:175], v[100:103]
  buffer_load_dwordx4 v247, s[8:11], s37 offen offset:3168 lds
  v_mfma_f32_16x16x32_bf16 v[100:103], a[132:135], a[188:191], v[100:103]
  s_add_u32 m0, s32, 135168
  ds_read_b128 a[92:95], v236 offset:4800
  v_mfma_f32_16x16x32_bf16 v[8:11], a[104:107], a[160:163], v[8:11]
  buffer_load_dwordx4 v248, s[12:15], s38 offen offset:0 lds
  v_mfma_f32_16x16x32_bf16 v[8:11], a[136:139], a[176:179], v[8:11]
  ds_read_b64_tr_b16 a[0:1], v237 offset:0
  v_mfma_f32_16x16x32_bf16 v[40:43], a[104:107], a[164:167], v[40:43]
  s_add_u32 s33, s30, 4
  buffer_load_dwordx4 v249, s[12:15], s38 offen offset:1056 lds
  v_mfma_f32_16x16x32_bf16 v[40:43], a[136:139], a[180:183], v[40:43]
  s_and_b32 s33, s33, 7
  ds_read_b64_tr_b16 a[2:3], v237 offset:8448
  v_mfma_f32_16x16x32_bf16 v[72:75], a[104:107], a[168:171], v[72:75]
  s_lshl_b32 s36, s33, 7
  buffer_load_dwordx4 v250, s[12:15], s38 offen offset:2112 lds
  v_mfma_f32_16x16x32_bf16 v[72:75], a[136:139], a[184:187], v[72:75]
  ds_read_b64_tr_b16 a[32:33], v237 offset:512
  v_mfma_f32_16x16x32_bf16 v[104:107], a[104:107], a[172:175], v[104:107]
  buffer_load_dwordx4 v251, s[12:15], s38 offen offset:3168 lds
  s_lshl_b32 s38, s33, 19
  s_add_u32 s37, s36, 16384
  v_mfma_f32_16x16x32_bf16 v[104:107], a[136:139], a[188:191], v[104:107]
  ds_read_b64_tr_b16 a[34:35], v237 offset:8960
  s_waitcnt lgkmcnt(4)
  s_add_u32 m0, s31, 0
  v_mfma_f32_16x16x32_bf16 v[12:15], a[108:111], a[160:163], v[12:15]
  buffer_load_dwordx4 v244, s[8:11], s36 offen offset:0 lds
  ds_read_b64_tr_b16 a[4:5], v237 offset:32
  v_mfma_f32_16x16x32_bf16 v[12:15], a[140:143], a[176:179], v[12:15]
  ds_read_b64_tr_b16 a[6:7], v237 offset:8480
  v_mfma_f32_16x16x32_bf16 v[44:47], a[108:111], a[164:167], v[44:47]
  ds_read_b64_tr_b16 a[36:37], v237 offset:544
  v_mfma_f32_16x16x32_bf16 v[44:47], a[140:143], a[180:183], v[44:47]
  ds_read_b64_tr_b16 a[38:39], v237 offset:8992
  v_mfma_f32_16x16x32_bf16 v[76:79], a[108:111], a[168:171], v[76:79]
  buffer_load_dwordx4 v245, s[8:11], s36 offen offset:1056 lds
  v_mfma_f32_16x16x32_bf16 v[76:79], a[140:143], a[184:187], v[76:79]
  ds_read_b64_tr_b16 a[8:9], v237 offset:64
  v_mfma_f32_16x16x32_bf16 v[108:111], a[108:111], a[172:175], v[108:111]
  ds_read_b64_tr_b16 a[10:11], v237 offset:8512
  v_mfma_f32_16x16x32_bf16 v[108:111], a[140:143], a[188:191], v[108:111]
  ds_read_b64_tr_b16 a[40:41], v237 offset:576
  v_mfma_f32_16x16x32_bf16 v[16:19], a[112:115], a[160:163], v[16:19]
  buffer_load_dwordx4 v246, s[8:11], s36 offen offset:2112 lds
  v_mfma_f32_16x16x32_bf16 v[16:19], a[144:147], a[176:179], v[16:19]
  ds_read_b64_tr_b16 a[42:43], v237 offset:9024
  v_mfma_f32_16x16x32_bf16 v[48:51], a[112:115], a[164:167], v[48:51]
  ds_read_b64_tr_b16 a[12:13], v237 offset:96
  v_mfma_f32_16x16x32_bf16 v[48:51], a[144:147], a[180:183], v[48:51]
  ds_read_b64_tr_b16 a[14:15], v237 offset:8544
  ds_read_b64_tr_b16 a[44:45], v237 offset:608
  v_mfma_f32_16x16x32_bf16 v[80:83], a[112:115], a[168:171], v[80:83]
  buffer_load_dwordx4 v247, s[8:11], s36 offen offset:3168 lds
  v_mfma_f32_16x16x32_bf16 v[80:83], a[144:147], a[184:187], v[80:83]
  ds_read_b64_tr_b16 a[46:47], v237 offset:9056
  v_mfma_f32_16x16x32_bf16 v[112:115], a[112:115], a[172:175], v[112:115]
  ds_read_b64_tr_b16 a[16:17], v237 offset:128
  v_mfma_f32_16x16x32_bf16 v[112:115], a[144:147], a[188:191], v[112:115]
  s_add_u32 m0, s31, 4224
  ds_read_b64_tr_b16 a[18:19], v237 offset:8576
  v_mfma_f32_16x16x32_bf16 v[20:23], a[116:119], a[160:163], v[20:23]
  buffer_load_dwordx4 v244, s[8:11], s37 offen offset:0 lds
  v_mfma_f32_16x16x32_bf16 v[20:23], a[148:151], a[176:179], v[20:23]
  ds_read_b64_tr_b16 a[48:49], v237 offset:640
  v_mfma_f32_16x16x32_bf16 v[52:55], a[116:119], a[164:167], v[52:55]
  ds_read_b64_tr_b16 a[50:51], v237 offset:9088
  v_mfma_f32_16x16x32_bf16 v[52:55], a[148:151], a[180:183], v[52:55]
  ds_read_b64_tr_b16 a[20:21], v237 offset:160
  v_mfma_f32_16x16x32_bf16 v[84:87], a[116:119], a[168:171], v[84:87]
  ds_read_b64_tr_b16 a[22:23], v237 offset:8608
  v_mfma_f32_16x16x32_bf16 v[84:87], a[148:151], a[184:187], v[84:87]
  buffer_load_dwordx4 v245, s[8:11], s37 offen offset:1056 lds
  v_mfma_f32_16x16x32_bf16 v[116:119], a[116:119], a[172:175], v[116:119]
  ds_read_b64_tr_b16 a[52:53], v237 offset:672
  ds_read_b64_tr_b16 a[54:55], v237 offset:9120
  v_mfma_f32_16x16x32_bf16 v[116:119], a[148:151], a[188:191], v[116:119]
  ds_read_b64_tr_b16 a[24:25], v237 offset:192
  v_mfma_f32_16x16x32_bf16 v[24:27], a[120:123], a[160:163], v[24:27]
  buffer_load_dwordx4 v246, s[8:11], s37 offen offset:2112 lds
  v_mfma_f32_16x16x32_bf16 v[24:27], a[152:155], a[176:179], v[24:27]
  ds_read_b64_tr_b16 a[26:27], v237 offset:8640
  v_mfma_f32_16x16x32_bf16 v[56:59], a[120:123], a[164:167], v[56:59]
  ds_read_b64_tr_b16 a[56:57], v237 offset:704
  v_mfma_f32_16x16x32_bf16 v[56:59], a[152:155], a[180:183], v[56:59]
  ds_read_b64_tr_b16 a[58:59], v237 offset:9152
  v_mfma_f32_16x16x32_bf16 v[88:91], a[120:123], a[168:171], v[88:91]
  ds_read_b64_tr_b16 a[28:29], v237 offset:224
  v_mfma_f32_16x16x32_bf16 v[88:91], a[152:155], a[184:187], v[88:91]
  buffer_load_dwordx4 v247, s[8:11], s37 offen offset:3168 lds
  v_mfma_f32_16x16x32_bf16 v[120:123], a[120:123], a[172:175], v[120:123]
  ds_read_b64_tr_b16 a[30:31], v237 offset:8672
  v_mfma_f32_16x16x32_bf16 v[120:123], a[152:155], a[188:191], v[120:123]
  ds_read_b64_tr_b16 a[60:61], v237 offset:736
  v_mfma_f32_16x16x32_bf16 v[28:31], a[124:127], a[160:163], v[28:31]
  ds_read_b64_tr_b16 a[62:63], v237 offset:9184
  v_mfma_f32_16x16x32_bf16 v[28:31], a[156:159], a[176:179], v[28:31]
  v_mfma_f32_16x16x32_bf16 v[60:63], a[124:127], a[164:167], v[60:63]
  s_waitcnt lgkmcnt(0)
  v_mfma_f32_16x16x32_bf16 v[60:63], a[156:159], a[180:183], v[60:63]
  s_barrier
  s_add_u32 m0, s32, 118272
  v_mfma_f32_16x16x32_bf16 v[92:95], a[124:127], a[168:171], v[92:95]
  buffer_load_dwordx4 v248, s[12:15], s38 offen offset:0 lds
  v_mfma_f32_16x16x32_bf16 v[92:95], a[156:159], a[184:187], v[92:95]
  buffer_load_dwordx4 v249, s[12:15], s38 offen offset:1056 lds
  v_mfma_f32_16x16x32_bf16 v[124:127], a[124:127], a[172:175], v[124:127]
  buffer_load_dwordx4 v250, s[12:15], s38 offen offset:2112 lds
  v_mfma_f32_16x16x32_bf16 v[124:127], a[156:159], a[188:191], v[124:127]
  buffer_load_dwordx4 v251, s[12:15], s38 offen offset:3168 lds
  v_mfma_f32_16x16x32_bf16 v[0:3], a[0:3], a[64:67], v[0:3]
  s_waitcnt vmcnt(12)
  v_mfma_f32_16x16x32_bf16 v[0:3], a[32:35], a[80:83], v[0:3]
  s_barrier
  s_mov_b32 s34, 0
  s_add_u32 m0, s32, 0
  v_mfma_f32_16x16x32_bf16 v[32:35], a[0:3], a[68:71], v[32:35]
  buffer_load_dwordx4 v242, s[16:19], s34 offen offset:2112 nt lds
  v_mfma_f32_16x16x32_bf16 v[32:35], a[32:35], a[84:87], v[32:35]
  ds_read_b128 a[160:163], v236 offset:33792
  v_mfma_f32_16x16x32_bf16 v[64:67], a[0:3], a[72:75], v[64:67]
  ds_read_b128 a[164:167], v236 offset:38016
  v_mfma_f32_16x16x32_bf16 v[64:67], a[32:35], a[88:91], v[64:67]
  ds_read_b128 a[168:171], v236 offset:34304
  v_mfma_f32_16x16x32_bf16 v[96:99], a[0:3], a[76:79], v[96:99]
  ds_read_b128 a[172:175], v236 offset:38528
  v_mfma_f32_16x16x32_bf16 v[96:99], a[32:35], a[92:95], v[96:99]
  ds_read_b128 a[176:179], v236 offset:33856
  v_mfma_f32_16x16x32_bf16 v[4:7], a[4:7], a[64:67], v[4:7]
  ds_read_b128 a[180:183], v236 offset:38080
  v_mfma_f32_16x16x32_bf16 v[4:7], a[36:39], a[80:83], v[4:7]
  buffer_load_dwordx4 v243, s[16:19], s34 offen offset:3168 nt lds
  v_mfma_f32_16x16x32_bf16 v[36:39], a[4:7], a[68:71], v[36:39]
  ds_read_b128 a[184:187], v236 offset:34368
  v_mfma_f32_16x16x32_bf16 v[36:39], a[36:39], a[84:87], v[36:39]
  s_add_u32 s33, s30, 5
  ds_read_b128 a[188:191], v236 offset:38592
  v_mfma_f32_16x16x32_bf16 v[68:71], a[4:7], a[72:75], v[68:71]
  s_and_b32 s33, s33, 7
  v_mfma_f32_16x16x32_bf16 v[68:71], a[36:39], a[88:91], v[68:71]
  s_lshl_b32 s36, s33, 7
  ds_read_b64_tr_b16 a[96:97], v237 offset:16896
  v_mfma_f32_16x16x32_bf16 v[100:103], a[4:7], a[76:79], v[100:103]
  s_lshl_b32 s38, s33, 19
  ds_read_b64_tr_b16 a[98:99], v237 offset:25344
  v_mfma_f32_16x16x32_bf16 v[100:103], a[36:39], a[92:95], v[100:103]
  s_add_u32 s37, s36, 16384
  ds_read_b64_tr_b16 a[128:129], v237 offset:17408
  v_mfma_f32_16x16x32_bf16 v[8:11], a[8:11], a[64:67], v[8:11]
  ds_read_b64_tr_b16 a[130:131], v237 offset:25856
  s_waitcnt lgkmcnt(4)
  s_add_u32 m0, s31, 33792
  v_mfma_f32_16x16x32_bf16 v[8:11], a[40:43], a[80:83], v[8:11]
  buffer_load_dwordx4 v244, s[8:11], s36 offen offset:0 lds
  v_mfma_f32_16x16x32_bf16 v[40:43], a[8:11], a[68:71], v[40:43]
  ds_read_b64_tr_b16 a[100:101], v237 offset:16928
  v_mfma_f32_16x16x32_bf16 v[40:43], a[40:43], a[84:87], v[40:43]
  ds_read_b64_tr_b16 a[102:103], v237 offset:25376
  v_mfma_f32_16x16x32_bf16 v[72:75], a[8:11], a[72:75], v[72:75]
  ds_read_b64_tr_b16 a[132:133], v237 offset:17440
  v_mfma_f32_16x16x32_bf16 v[72:75], a[40:43], a[88:91], v[72:75]
  ds_read_b64_tr_b16 a[134:135], v237 offset:25888
  v_mfma_f32_16x16x32_bf16 v[104:107], a[8:11], a[76:79], v[104:107]
  buffer_load_dwordx4 v245, s[8:11], s36 offen offset:1056 lds
  v_mfma_f32_16x16x32_bf16 v[104:107], a[40:43], a[92:95], v[104:107]
  v_mfma_f32_16x16x32_bf16 v[12:15], a[12:15], a[64:67], v[12:15]
  ds_read_b64_tr_b16 a[104:105], v237 offset:16960
  v_mfma_f32_16x16x32_bf16 v[12:15], a[44:47], a[80:83], v[12:15]
  ds_read_b64_tr_b16 a[106:107], v237 offset:25408
  v_mfma_f32_16x16x32_bf16 v[44:47], a[12:15], a[68:71], v[44:47]
  ds_read_b64_tr_b16 a[136:137], v237 offset:17472
  v_mfma_f32_16x16x32_bf16 v[44:47], a[44:47], a[84:87], v[44:47]
  buffer_load_dwordx4 v246, s[8:11], s36 offen offset:2112 lds
  v_mfma_f32_16x16x32_bf16 v[76:79], a[12:15], a[72:75], v[76:79]
  ds_read_b64_tr_b16 a[138:139], v237 offset:25920
  v_mfma_f32_16x16x32_bf16 v[76:79], a[44:47], a[88:91], v[76:79]
  ds_read_b64_tr_b16 a[108:109], v237 offset:16992
  v_mfma_f32_16x16x32_bf16 v[108:111], a[12:15], a[76:79], v[108:111]
  ds_read_b64_tr_b16 a[110:111], v237 offset:25440
  v_mfma_f32_16x16x32_bf16 v[108:111], a[44:47], a[92:95], v[108:111]
  ds_read_b64_tr_b16 a[140:141], v237 offset:17504
  v_mfma_f32_16x16x32_bf16 v[16:19], a[16:19], a[64:67], v[16:19]
  buffer_load_dwordx4 v247, s[8:11], s36 offen offset:3168 lds
  v_mfma_f32_16x16x32_bf16 v[16:19], a[48:51], a[80:83], v[16:19]
  ds_read_b64_tr_b16 a[142:143], v237 offset:25952
  v_mfma_f32_16x16x32_bf16 v[48:51], a[16:19], a[68:71], v[48:51]
  v_mfma_f32_16x16x32_bf16 v[48:51], a[48:51], a[84:87], v[48:51]
  ds_read_b64_tr_b16 a[112:113], v237 offset:17024
  v_mfma_f32_16x16x32_bf16 v[80:83], a[16:19], a[72:75], v[80:83]
  s_add_u32 m0, s31, 38016
  ds_read_b64_tr_b16 a[114:115], v237 offset:25472
  v_mfma_f32_16x16x32_bf16 v[80:83], a[48:51], a[88:91], v[80:83]
  buffer_load_dwordx4 v244, s[8:11], s37 offen offset:0 lds
  v_mfma_f32_16x16x32_bf16 v[112:115], a[16:19], a[76:79], v[112:115]
  ds_read_b64_tr_b16 a[144:145], v237 offset:17536
  v_mfma_f32_16x16x32_bf16 v[112:115], a[48:51], a[92:95], v[112:115]
  ds_read_b64_tr_b16 a[146:147], v237 offset:25984
  v_mfma_f32_16x16x32_bf16 v[20:23], a[20:23], a[64:67], v[20:23]
  ds_read_b64_tr_b16 a[116:117], v237 offset:17056
  v_mfma_f32_16x16x32_bf16 v[20:23], a[52:55], a[80:83], v[20:23]
  ds_read_b64_tr_b16 a[118:119], v237 offset:25504
  v_mfma_f32_16x16x32_bf16 v[52:55], a[20:23], a[68:71], v[52:55]
  buffer_load_dwordx4 v245, s[8:11], s37 offen offset:1056 lds
  v_mfma_f32_16x16x32_bf16 v[52:55], a[52:55], a[84:87], v[52:55]
  ds_read_b64_tr_b16 a[148:149], v237 offset:17568
  v_mfma_f32_16x16x32_bf16 v[84:87], a[20:23], a[72:75], v[84:87]
  ds_read_b64_tr_b16 a[150:151], v237 offset:26016
  v_mfma_f32_16x16x32_bf16 v[84:87], a[52:55], a[88:91], v[84:87]
  v_mfma_f32_16x16x32_bf16 v[116:119], a[20:23], a[76:79], v[116:119]
  ds_read_b64_tr_b16 a[120:121], v237 offset:17088
  v_mfma_f32_16x16x32_bf16 v[116:119], a[52:55], a[92:95], v[116:119]
  buffer_load_dwordx4 v246, s[8:11], s37 offen offset:2112 lds
  v_mfma_f32_16x16x32_bf16 v[24:27], a[24:27], a[64:67], v[24:27]
  ds_read_b64_tr_b16 a[122:123], v237 offset:25536
  v_mfma_f32_16x16x32_bf16 v[24:27], a[56:59], a[80:83], v[24:27]
  ds_read_b64_tr_b16 a[152:153], v237 offset:17600
  v_mfma_f32_16x16x32_bf16 v[56:59], a[24:27], a[68:71], v[56:59]
  ds_read_b64_tr_b16 a[154:155], v237 offset:26048
  v_mfma_f32_16x16x32_bf16 v[56:59], a[56:59], a[84:87], v[56:59]
  ds_read_b64_tr_b16 a[124:125], v237 offset:17120
  v_mfma_f32_16x16x32_bf16 v[88:91], a[24:27], a[72:75], v[88:91]
  buffer_load_dwordx4 v247, s[8:11], s37 offen offset:3168 lds
  v_mfma_f32_16x16x32_bf16 v[88:91], a[56:59], a[88:91], v[88:91]
  ds_read_b64_tr_b16 a[126:127], v237 offset:25568
  v_mfma_f32_16x16x32_bf16 v[120:123], a[24:27], a[76:79], v[120:123]
  ds_read_b64_tr_b16 a[156:157], v237 offset:17632
  v_mfma_f32_16x16x32_bf16 v[120:123], a[56:59], a[92:95], v[120:123]
  ds_read_b64_tr_b16 a[158:159], v237 offset:26080
  v_mfma_f32_16x16x32_bf16 v[28:31], a[28:31], a[64:67], v[28:31]
  v_mfma_f32_16x16x32_bf16 v[28:31], a[60:63], a[80:83], v[28:31]
  v_mfma_f32_16x16x32_bf16 v[60:63], a[28:31], a[68:71], v[60:63]
  s_waitcnt lgkmcnt(0)
  v_mfma_f32_16x16x32_bf16 v[60:63], a[60:63], a[84:87], v[60:63]
  s_barrier
  s_add_u32 m0, s32, 135168
  v_mfma_f32_16x16x32_bf16 v[92:95], a[28:31], a[72:75], v[92:95]
  buffer_load_dwordx4 v248, s[12:15], s38 offen offset:0 lds
  v_mfma_f32_16x16x32_bf16 v[92:95], a[60:63], a[88:91], v[92:95]
  buffer_load_dwordx4 v249, s[12:15], s38 offen offset:1056 lds
  v_mfma_f32_16x16x32_bf16 v[124:127], a[28:31], a[76:79], v[124:127]
  buffer_load_dwordx4 v250, s[12:15], s38 offen offset:2112 lds
  v_mfma_f32_16x16x32_bf16 v[124:127], a[60:63], a[92:95], v[124:127]
  buffer_load_dwordx4 v251, s[12:15], s38 offen offset:3168 lds
  v_mfma_f32_16x16x32_bf16 v[0:3], a[96:99], a[160:163], v[0:3]
  s_waitcnt vmcnt(14)
  v_mfma_f32_16x16x32_bf16 v[0:3], a[128:131], a[176:179], v[0:3]
  s_barrier
  s_mov_b32 s34, 0
  s_add_u32 m0, s32, 16896
  v_mfma_f32_16x16x32_bf16 v[32:35], a[96:99], a[164:167], v[32:35]
  buffer_load_dwordx4 v240, s[20:23], s34 offen offset:0 nt lds
  v_mfma_f32_16x16x32_bf16 v[32:35], a[128:131], a[180:183], v[32:35]
  ds_read_b128 a[64:67], v236 offset:0
  v_mfma_f32_16x16x32_bf16 v[64:67], a[96:99], a[168:171], v[64:67]
  ds_read_b128 a[68:71], v236 offset:4224
  v_mfma_f32_16x16x32_bf16 v[64:67], a[128:131], a[184:187], v[64:67]
  ds_read_b128 a[72:75], v236 offset:512
  v_mfma_f32_16x16x32_bf16 v[96:99], a[96:99], a[172:175], v[96:99]
  ds_read_b128 a[76:79], v236 offset:4736
  v_mfma_f32_16x16x32_bf16 v[96:99], a[128:131], a[188:191], v[96:99]
  ds_read_b128 a[80:83], v236 offset:64
  v_mfma_f32_16x16x32_bf16 v[4:7], a[100:103], a[160:163], v[4:7]
  ds_read_b128 a[84:87], v236 offset:4288
  v_mfma_f32_16x16x32_bf16 v[4:7], a[132:135], a[176:179], v[4:7]
  buffer_load_dwordx4 v241, s[20:23], s34 offen offset:1056 nt lds
  v_mfma_f32_16x16x32_bf16 v[36:39], a[100:103], a[164:167], v[36:39]
  ds_read_b128 a[88:91], v236 offset:576
  v_mfma_f32_16x16x32_bf16 v[36:39], a[132:135], a[180:183], v[36:39]
  s_add_u32 s33, s30, 6
  ds_read_b128 a[92:95], v236 offset:4800
  v_mfma_f32_16x16x32_bf16 v[68:71], a[100:103], a[168:171], v[68:71]
  s_and_b32 s33, s33, 7
  v_mfma_f32_16x16x32_bf16 v[68:71], a[132:135], a[184:187], v[68:71]
  s_lshl_b32 s36, s33, 7
  ds_read_b64_tr_b16 a[0:1], v237 offset:0
  v_mfma_f32_16x16x32_bf16 v[100:103], a[100:103], a[172:175], v[100:103]
  s_lshl_b32 s38, s33, 19
  ds_read_b64_tr_b16 a[2:3], v237 offset:8448
  v_mfma_f32_16x16x32_bf16 v[100:103], a[132:135], a[188:191], v[100:103]
  s_add_u32 s37, s36, 16384
  ds_read_b64_tr_b16 a[32:33], v237 offset:512
  v_mfma_f32_16x16x32_bf16 v[8:11], a[104:107], a[160:163], v[8:11]
  ds_read_b64_tr_b16 a[34:35], v237 offset:8960
  s_waitcnt lgkmcnt(4)
  s_add_u32 m0, s31, 0
  v_mfma_f32_16x16x32_bf16 v[8:11], a[136:139], a[176:179], v[8:11]
  buffer_load_dwordx4 v244, s[8:11], s36 offen offset:0 lds
  v_mfma_f32_16x16x32_bf16 v[40:43], a[104:107], a[164:167], v[40:43]
  ds_read_b64_tr_b16 a[4:5], v237 offset:32
  v_mfma_f32_16x16x32_bf16 v[40:43], a[136:139], a[180:183], v[40:43]
  ds_read_b64_tr_b16 a[6:7], v237 offset:8480
  v_mfma_f32_16x16x32_bf16 v[72:75], a[104:107], a[168:171], v[72:75]
  ds_read_b64_tr_b16 a[36:37], v237 offset:544
  v_mfma_f32_16x16x32_bf16 v[72:75], a[136:139], a[184:187], v[72:75]
  ds_read_b64_tr_b16 a[38:39], v237 offset:8992
  v_mfma_f32_16x16x32_bf16 v[104:107], a[104:107], a[172:175], v[104:107]
  buffer_load_dwordx4 v245, s[8:11], s36 offen offset:1056 lds
  v_mfma_f32_16x16x32_bf16 v[104:107], a[136:139], a[188:191], v[104:107]
  v_mfma_f32_16x16x32_bf16 v[12:15], a[108:111], a[160:163], v[12:15]
  ds_read_b64_tr_b16 a[8:9], v237 offset:64
  v_mfma_f32_16x16x32_bf16 v[12:15], a[140:143], a[176:179], v[12:15]
  ds_read_b64_tr_b16 a[10:11], v237 offset:8512
  v_mfma_f32_16x16x32_bf16 v[44:47], a[108:111], a[164:167], v[44:47]
  ds_read_b64_tr_b16 a[40:41], v237 offset:576
  v_mfma_f32_16x16x32_bf16 v[44:47], a[140:143], a[180:183], v[44:47]
  buffer_load_dwordx4 v246, s[8:11], s36 offen offset:2112 lds
  v_mfma_f32_16x16x32_bf16 v[76:79], a[108:111], a[168:171], v[76:79]
  ds_read_b64_tr_b16 a[42:43], v237 offset:9024
  v_mfma_f32_16x16x32_bf16 v[76:79], a[140:143], a[184:187], v[76:79]
  ds_read_b64_tr_b16 a[12:13], v237 offset:96
  v_mfma_f32_16x16x32_bf16 v[108:111], a[108:111], a[172:175], v[108:111]
  ds_read_b64_tr_b16 a[14:15], v237 offset:8544
  v_mfma_f32_16x16x32_bf16 v[108:111], a[140:143], a[188:191], v[108:111]
  ds_read_b64_tr_b16 a[44:45], v237 offset:608
  v_mfma_f32_16x16x32_bf16 v[16:19], a[112:115], a[160:163], v[16:19]
  buffer_load_dwordx4 v247, s[8:11], s36 offen offset:3168 lds
  v_mfma_f32_16x16x32_bf16 v[16:19], a[144:147], a[176:179], v[16:19]
  ds_read_b64_tr_b16 a[46:47], v237 offset:9056
  v_mfma_f32_16x16x32_bf16 v[48:51], a[112:115], a[164:167], v[48:51]
  v_mfma_f32_16x16x32_bf16 v[48:51], a[144:147], a[180:183], v[48:51]
  ds_read_b64_tr_b16 a[16:17], v237 offset:128
  v_mfma_f32_16x16x32_bf16 v[80:83], a[112:115], a[168:171], v[80:83]
  s_add_u32 m0, s31, 4224
  ds_read_b64_tr_b16 a[18:19], v237 offset:8576
  v_mfma_f32_16x16x32_bf16 v[80:83], a[144:147], a[184:187], v[80:83]
  buffer_load_dwordx4 v244, s[8:11], s37 offen offset:0 lds
  v_mfma_f32_16x16x32_bf16 v[112:115], a[112:115], a[172:175], v[112:115]
  ds_read_b64_tr_b16 a[48:49], v237 offset:640
  v_mfma_f32_16x16x32_bf16 v[112:115], a[144:147], a[188:191], v[112:115]
  ds_read_b64_tr_b16 a[50:51], v237 offset:9088
  v_mfma_f32_16x16x32_bf16 v[20:23], a[116:119], a[160:163], v[20:23]
  ds_read_b64_tr_b16 a[20:21], v237 offset:160
  v_mfma_f32_16x16x32_bf16 v[20:23], a[148:151], a[176:179], v[20:23]
  ds_read_b64_tr_b16 a[22:23], v237 offset:8608
  v_mfma_f32_16x16x32_bf16 v[52:55], a[116:119], a[164:167], v[52:55]
  buffer_load_dwordx4 v245, s[8:11], s37 offen offset:1056 lds
  v_mfma_f32_16x16x32_bf16 v[52:55], a[148:151], a[180:183], v[52:55]
  ds_read_b64_tr_b16 a[52:53], v237 offset:672
  v_mfma_f32_16x16x32_bf16 v[84:87], a[116:119], a[168:171], v[84:87]
  ds_read_b64_tr_b16 a[54:55], v237 offset:9120
  v_mfma_f32_16x16x32_bf16 v[84:87], a[148:151], a[184:187], v[84:87]
  v_mfma_f32_16x16x32_bf16 v[116:119], a[116:119], a[172:175], v[116:119]
  ds_read_b64_tr_b16 a[24:25], v237 offset:192
  v_mfma_f32_16x16x32_bf16 v[116:119], a[148:151], a[188:191], v[116:119]
  buffer_load_dwordx4 v246, s[8:11], s37 offen offset:2112 lds
  v_mfma_f32_16x16x32_bf16 v[24:27], a[120:123], a[160:163], v[24:27]
  ds_read_b64_tr_b16 a[26:27], v237 offset:8640
  v_mfma_f32_16x16x32_bf16 v[24:27], a[152:155], a[176:179], v[24:27]
  ds_read_b64_tr_b16 a[56:57], v237 offset:704
  v_mfma_f32_16x16x32_bf16 v[56:59], a[120:123], a[164:167], v[56:59]
  ds_read_b64_tr_b16 a[58:59], v237 offset:9152
  v_mfma_f32_16x16x32_bf16 v[56:59], a[152:155], a[180:183], v[56:59]
  ds_read_b64_tr_b16 a[28:29], v237 offset:224
  v_mfma_f32_16x16x32_bf16 v[88:91], a[120:123], a[168:171], v[88:91]
  buffer_load_dwordx4 v247, s[8:11], s37 offen offset:3168 lds
  v_mfma_f32_16x16x32_bf16 v[88:91], a[152:155], a[184:187], v[88:91]
  ds_read_b64_tr_b16 a[30:31], v237 offset:8672
  v_mfma_f32_16x16x32_bf16 v[120:123], a[120:123], a[172:175], v[120:123]
  ds_read_b64_tr_b16 a[60:61], v237 offset:736
  v_mfma_f32_16x16x32_bf16 v[120:123], a[152:155], a[188:191], v[120:123]
  ds_read_b64_tr_b16 a[62:63], v237 offset:9184
  v_mfma_f32_16x16x32_bf16 v[28:31], a[124:127], a[160:163], v[28:31]
  v_mfma_f32_16x16x32_bf16 v[28:31], a[156:159], a[176:179], v[28:31]
  v_mfma_f32_16x16x32_bf16 v[60:63], a[124:127], a[164:167], v[60:63]
  s_waitcnt lgkmcnt(0)
  v_mfma_f32_16x16x32_bf16 v[60:63], a[156:159], a[180:183], v[60:63]
  s_barrier
  s_add_u32 m0, s32, 118272
  v_mfma_f32_16x16x32_bf16 v[92:95], a[124:127], a[168:171], v[92:95]
  buffer_load_dwordx4 v248, s[12:15], s38 offen offset:0 lds
  v_mfma_f32_16x16x32_bf16 v[92:95], a[156:159], a[184:187], v[92:95]
  buffer_load_dwordx4 v249, s[12:15], s38 offen offset:1056 lds
  v_mfma_f32_16x16x32_bf16 v[124:127], a[124:127], a[172:175], v[124:127]
  buffer_load_dwordx4 v250, s[12:15], s38 offen offset:2112 lds
  v_mfma_f32_16x16x32_bf16 v[124:127], a[156:159], a[188:191], v[124:127]
  buffer_load_dwordx4 v251, s[12:15], s38 offen offset:3168 lds
  v_mfma_f32_16x16x32_bf16 v[0:3], a[0:3], a[64:67], v[0:3]
  s_waitcnt vmcnt(14)
  v_mfma_f32_16x16x32_bf16 v[0:3], a[32:35], a[80:83], v[0:3]
  s_barrier
  s_mov_b32 s34, 0
  s_add_u32 m0, s32, 16896
  v_mfma_f32_16x16x32_bf16 v[32:35], a[0:3], a[68:71], v[32:35]
  buffer_load_dwordx4 v242, s[20:23], s34 offen offset:2112 nt lds
  v_mfma_f32_16x16x32_bf16 v[32:35], a[32:35], a[84:87], v[32:35]
  ds_read_b128 a[160:163], v236 offset:33792
  v_mfma_f32_16x16x32_bf16 v[64:67], a[0:3], a[72:75], v[64:67]
  ds_read_b128 a[164:167], v236 offset:38016
  v_mfma_f32_16x16x32_bf16 v[64:67], a[32:35], a[88:91], v[64:67]
  ds_read_b128 a[168:171], v236 offset:34304
  v_mfma_f32_16x16x32_bf16 v[96:99], a[0:3], a[76:79], v[96:99]
  ds_read_b128 a[172:175], v236 offset:38528
  v_mfma_f32_16x16x32_bf16 v[96:99], a[32:35], a[92:95], v[96:99]
  ds_read_b128 a[176:179], v236 offset:33856
  v_mfma_f32_16x16x32_bf16 v[4:7], a[4:7], a[64:67], v[4:7]
  ds_read_b128 a[180:183], v236 offset:38080
  v_mfma_f32_16x16x32_bf16 v[4:7], a[36:39], a[80:83], v[4:7]
  buffer_load_dwordx4 v243, s[20:23], s34 offen offset:3168 nt lds
  v_mfma_f32_16x16x32_bf16 v[36:39], a[4:7], a[68:71], v[36:39]
  ds_read_b128 a[184:187], v236 offset:34368
  v_mfma_f32_16x16x32_bf16 v[36:39], a[36:39], a[84:87], v[36:39]
  s_add_u32 s33, s30, 7
  ds_read_b128 a[188:191], v236 offset:38592
  v_mfma_f32_16x16x32_bf16 v[68:71], a[4:7], a[72:75], v[68:71]
  s_and_b32 s33, s33, 7
  v_mfma_f32_16x16x32_bf16 v[68:71], a[36:39], a[88:91], v[68:71]
  s_lshl_b32 s36, s33, 7
  ds_read_b64_tr_b16 a[96:97], v237 offset:16896
  v_mfma_f32_16x16x32_bf16 v[100:103], a[4:7], a[76:79], v[100:103]
  s_lshl_b32 s38, s33, 19
  ds_read_b64_tr_b16 a[98:99], v237 offset:25344
  v_mfma_f32_16x16x32_bf16 v[100:103], a[36:39], a[92:95], v[100:103]
  s_add_u32 s37, s36, 16384
  ds_read_b64_tr_b16 a[128:129], v237 offset:17408
  v_mfma_f32_16x16x32_bf16 v[8:11], a[8:11], a[64:67], v[8:11]
  ds_read_b64_tr_b16 a[130:131], v237 offset:25856
  s_waitcnt lgkmcnt(4)
  s_add_u32 m0, s31, 33792
  v_mfma_f32_16x16x32_bf16 v[8:11], a[40:43], a[80:83], v[8:11]
  buffer_load_dwordx4 v244, s[8:11], s36 offen offset:0 lds
  v_mfma_f32_16x16x32_bf16 v[40:43], a[8:11], a[68:71], v[40:43]
  ds_read_b64_tr_b16 a[100:101], v237 offset:16928
  v_mfma_f32_16x16x32_bf16 v[40:43], a[40:43], a[84:87], v[40:43]
  ds_read_b64_tr_b16 a[102:103], v237 offset:25376
  v_mfma_f32_16x16x32_bf16 v[72:75], a[8:11], a[72:75], v[72:75]
  ds_read_b64_tr_b16 a[132:133], v237 offset:17440
  v_mfma_f32_16x16x32_bf16 v[72:75], a[40:43], a[88:91], v[72:75]
  ds_read_b64_tr_b16 a[134:135], v237 offset:25888
  v_mfma_f32_16x16x32_bf16 v[104:107], a[8:11], a[76:79], v[104:107]
  buffer_load_dwordx4 v245, s[8:11], s36 offen offset:1056 lds
  v_mfma_f32_16x16x32_bf16 v[104:107], a[40:43], a[92:95], v[104:107]
  v_mfma_f32_16x16x32_bf16 v[12:15], a[12:15], a[64:67], v[12:15]
  ds_read_b64_tr_b16 a[104:105], v237 offset:16960
  v_mfma_f32_16x16x32_bf16 v[12:15], a[44:47], a[80:83], v[12:15]
  ds_read_b64_tr_b16 a[106:107], v237 offset:25408
  v_mfma_f32_16x16x32_bf16 v[44:47], a[12:15], a[68:71], v[44:47]
  ds_read_b64_tr_b16 a[136:137], v237 offset:17472
  v_mfma_f32_16x16x32_bf16 v[44:47], a[44:47], a[84:87], v[44:47]
  buffer_load_dwordx4 v246, s[8:11], s36 offen offset:2112 lds
  v_mfma_f32_16x16x32_bf16 v[76:79], a[12:15], a[72:75], v[76:79]
  ds_read_b64_tr_b16 a[138:139], v237 offset:25920
  v_mfma_f32_16x16x32_bf16 v[76:79], a[44:47], a[88:91], v[76:79]
  ds_read_b64_tr_b16 a[108:109], v237 offset:16992
  v_mfma_f32_16x16x32_bf16 v[108:111], a[12:15], a[76:79], v[108:111]
  ds_read_b64_tr_b16 a[110:111], v237 offset:25440
  v_mfma_f32_16x16x32_bf16 v[108:111], a[44:47], a[92:95], v[108:111]
  ds_read_b64_tr_b16 a[140:141], v237 offset:17504
  v_mfma_f32_16x16x32_bf16 v[16:19], a[16:19], a[64:67], v[16:19]
  buffer_load_dwordx4 v247, s[8:11], s36 offen offset:3168 lds
  v_mfma_f32_16x16x32_bf16 v[16:19], a[48:51], a[80:83], v[16:19]
  ds_read_b64_tr_b16 a[142:143], v237 offset:25952
  v_mfma_f32_16x16x32_bf16 v[48:51], a[16:19], a[68:71], v[48:51]
  v_mfma_f32_16x16x32_bf16 v[48:51], a[48:51], a[84:87], v[48:51]
  ds_read_b64_tr_b16 a[112:113], v237 offset:17024
  v_mfma_f32_16x16x32_bf16 v[80:83], a[16:19], a[72:75], v[80:83]
  s_add_u32 m0, s31, 38016
  ds_read_b64_tr_b16 a[114:115], v237 offset:25472
  v_mfma_f32_16x16x32_bf16 v[80:83], a[48:51], a[88:91], v[80:83]
  buffer_load_dwordx4 v244, s[8:11], s37 offen offset:0 lds
  v_mfma_f32_16x16x32_bf16 v[112:115], a[16:19], a[76:79], v[112:115]
  ds_read_b64_tr_b16 a[144:145], v237 offset:17536
  v_mfma_f32_16x16x32_bf16 v[112:115], a[48:51], a[92:95], v[112:115]
  ds_read_b64_tr_b16 a[146:147], v237 offset:25984
  v_mfma_f32_16x16x32_bf16 v[20:23], a[20:23], a[64:67], v[20:23]
  ds_read_b64_tr_b16 a[116:117], v237 offset:17056
  v_mfma_f32_16x16x32_bf16 v[20:23], a[52:55], a[80:83], v[20:23]
  ds_read_b64_tr_b16 a[118:119], v237 offset:25504
  v_mfma_f32_16x16x32_bf16 v[52:55], a[20:23], a[68:71], v[52:55]
  buffer_load_dwordx4 v245, s[8:11], s37 offen offset:1056 lds
  v_mfma_f32_16x16x32_bf16 v[52:55], a[52:55], a[84:87], v[52:55]
  ds_read_b64_tr_b16 a[148:149], v237 offset:17568
  v_mfma_f32_16x16x32_bf16 v[84:87], a[20:23], a[72:75], v[84:87]
  ds_read_b64_tr_b16 a[150:151], v237 offset:26016
  v_mfma_f32_16x16x32_bf16 v[84:87], a[52:55], a[88:91], v[84:87]
  v_mfma_f32_16x16x32_bf16 v[116:119], a[20:23], a[76:79], v[116:119]
  ds_read_b64_tr_b16 a[120:121], v237 offset:17088
  v_mfma_f32_16x16x32_bf16 v[116:119], a[52:55], a[92:95], v[116:119]
  buffer_load_dwordx4 v246, s[8:11], s37 offen offset:2112 lds
  v_mfma_f32_16x16x32_bf16 v[24:27], a[24:27], a[64:67], v[24:27]
  ds_read_b64_tr_b16 a[122:123], v237 offset:25536
  v_mfma_f32_16x16x32_bf16 v[24:27], a[56:59], a[80:83], v[24:27]
  ds_read_b64_tr_b16 a[152:153], v237 offset:17600
  v_mfma_f32_16x16x32_bf16 v[56:59], a[24:27], a[68:71], v[56:59]
  ds_read_b64_tr_b16 a[154:155], v237 offset:26048
  v_mfma_f32_16x16x32_bf16 v[56:59], a[56:59], a[84:87], v[56:59]
  ds_read_b64_tr_b16 a[124:125], v237 offset:17120
  v_mfma_f32_16x16x32_bf16 v[88:91], a[24:27], a[72:75], v[88:91]
  buffer_load_dwordx4 v247, s[8:11], s37 offen offset:3168 lds
  v_mfma_f32_16x16x32_bf16 v[88:91], a[56:59], a[88:91], v[88:91]
  ds_read_b64_tr_b16 a[126:127], v237 offset:25568
  v_mfma_f32_16x16x32_bf16 v[120:123], a[24:27], a[76:79], v[120:123]
  ds_read_b64_tr_b16 a[156:157], v237 offset:17632
  v_mfma_f32_16x16x32_bf16 v[120:123], a[56:59], a[92:95], v[120:123]
  ds_read_b64_tr_b16 a[158:159], v237 offset:26080
  v_mfma_f32_16x16x32_bf16 v[28:31], a[28:31], a[64:67], v[28:31]
  v_mfma_f32_16x16x32_bf16 v[28:31], a[60:63], a[80:83], v[28:31]
  v_mfma_f32_16x16x32_bf16 v[60:63], a[28:31], a[68:71], v[60:63]
  s_waitcnt lgkmcnt(0)
  v_mfma_f32_16x16x32_bf16 v[60:63], a[60:63], a[84:87], v[60:63]
  s_barrier
  s_add_u32 m0, s32, 135168
  v_mfma_f32_16x16x32_bf16 v[92:95], a[28:31], a[72:75], v[92:95]
  buffer_load_dwordx4 v248, s[12:15], s38 offen offset:0 lds
  v_mfma_f32_16x16x32_bf16 v[92:95], a[60:63], a[88:91], v[92:95]
  buffer_load_dwordx4 v249, s[12:15], s38 offen offset:1056 lds
  v_mfma_f32_16x16x32_bf16 v[124:127], a[28:31], a[76:79], v[124:127]
  buffer_load_dwordx4 v250, s[12:15], s38 offen offset:2112 lds
  v_mfma_f32_16x16x32_bf16 v[124:127], a[60:63], a[92:95], v[124:127]
  buffer_load_dwordx4 v251, s[12:15], s38 offen offset:3168 lds
  v_mfma_f32_16x16x32_bf16 v[0:3], a[96:99], a[160:163], v[0:3]
  s_waitcnt vmcnt(14)
  v_mfma_f32_16x16x32_bf16 v[0:3], a[128:131], a[176:179], v[0:3]
  s_barrier
  s_mov_b32 s34, 16384
  s_add_u32 m0, s32, 33792
  v_mfma_f32_16x16x32_bf16 v[32:35], a[96:99], a[164:167], v[32:35]
  buffer_load_dwordx4 v240, s[16:19], s34 offen offset:0 nt lds
  v_mfma_f32_16x16x32_bf16 v[32:35], a[128:131], a[180:183], v[32:35]
  ds_read_b128 a[64:67], v236 offset:0
  v_mfma_f32_16x16x32_bf16 v[64:67], a[96:99], a[168:171], v[64:67]
  ds_read_b128 a[68:71], v236 offset:4224
  v_mfma_f32_16x16x32_bf16 v[64:67], a[128:131], a[184:187], v[64:67]
  ds_read_b128 a[72:75], v236 offset:512
  v_mfma_f32_16x16x32_bf16 v[96:99], a[96:99], a[172:175], v[96:99]
  v_mfma_f32_16x16x32_bf16 v[96:99], a[128:131], a[188:191], v[96:99]
  ds_read_b128 a[76:79], v236 offset:4736
  v_mfma_f32_16x16x32_bf16 v[4:7], a[100:103], a[160:163], v[4:7]
  ds_read_b128 a[80:83], v236 offset:64
  v_mfma_f32_16x16x32_bf16 v[4:7], a[132:135], a[176:179], v[4:7]
  ds_read_b128 a[84:87], v236 offset:4288
  v_mfma_f32_16x16x32_bf16 v[36:39], a[100:103], a[164:167], v[36:39]
  v_mfma_f32_16x16x32_bf16 v[36:39], a[132:135], a[180:183], v[36:39]
  ds_read_b128 a[88:91], v236 offset:576
  v_mfma_f32_16x16x32_bf16 v[68:71], a[100:103], a[168:171], v[68:71]
  ds_read_b128 a[92:95], v236 offset:4800
  v_mfma_f32_16x16x32_bf16 v[68:71], a[132:135], a[184:187], v[68:71]
  ds_read_b64_tr_b16 a[0:1], v237 offset:0
  v_mfma_f32_16x16x32_bf16 v[100:103], a[100:103], a[172:175], v[100:103]
  ds_read_b64_tr_b16 a[2:3], v237 offset:8448
  v_mfma_f32_16x16x32_bf16 v[100:103], a[132:135], a[188:191], v[100:103]
  v_mfma_f32_16x16x32_bf16 v[8:11], a[104:107], a[160:163], v[8:11]
  buffer_load_dwordx4 v241, s[16:19], s34 offen offset:1056 nt lds
  v_mfma_f32_16x16x32_bf16 v[8:11], a[136:139], a[176:179], v[8:11]
  ds_read_b64_tr_b16 a[32:33], v237 offset:512
  v_mfma_f32_16x16x32_bf16 v[40:43], a[104:107], a[164:167], v[40:43]
  ds_read_b64_tr_b16 a[34:35], v237 offset:8960
  v_mfma_f32_16x16x32_bf16 v[40:43], a[136:139], a[180:183], v[40:43]
  v_mfma_f32_16x16x32_bf16 v[72:75], a[104:107], a[168:171], v[72:75]
  ds_read_b64_tr_b16 a[4:5], v237 offset:32
  v_mfma_f32_16x16x32_bf16 v[72:75], a[136:139], a[184:187], v[72:75]
  ds_read_b64_tr_b16 a[6:7], v237 offset:8480
  v_mfma_f32_16x16x32_bf16 v[104:107], a[104:107], a[172:175], v[104:107]
  ds_read_b64_tr_b16 a[36:37], v237 offset:544
  v_mfma_f32_16x16x32_bf16 v[104:107], a[136:139], a[188:191], v[104:107]
  v_mfma_f32_16x16x32_bf16 v[12:15], a[108:111], a[160:163], v[12:15]
  ds_read_b64_tr_b16 a[38:39], v237 offset:8992
  v_mfma_f32_16x16x32_bf16 v[12:15], a[140:143], a[176:179], v[12:15]
  ds_read_b64_tr_b16 a[8:9], v237 offset:64
  v_mfma_f32_16x16x32_bf16 v[44:47], a[108:111], a[164:167], v[44:47]
  ds_read_b64_tr_b16 a[10:11], v237 offset:8512
  v_mfma_f32_16x16x32_bf16 v[44:47], a[140:143], a[180:183], v[44:47]
  ds_read_b64_tr_b16 a[40:41], v237 offset:576
  v_mfma_f32_16x16x32_bf16 v[76:79], a[108:111], a[168:171], v[76:79]
  v_mfma_f32_16x16x32_bf16 v[76:79], a[140:143], a[184:187], v[76:79]
  ds_read_b64_tr_b16 a[42:43], v237 offset:9024
  v_mfma_f32_16x16x32_bf16 v[108:111], a[108:111], a[172:175], v[108:111]
  buffer_load_dwordx4 v242, s[16:19], s34 offen offset:2112 nt lds
  v_mfma_f32_16x16x32_bf16 v[108:111], a[140:143], a[188:191], v[108:111]
  ds_read_b64_tr_b16 a[12:13], v237 offset:96
  v_mfma_f32_16x16x32_bf16 v[16:19], a[112:115], a[160:163], v[16:19]
  v_mfma_f32_16x16x32_bf16 v[16:19], a[144:147], a[176:179], v[16:19]
  ds_read_b64_tr_b16 a[14:15], v237 offset:8544
  v_mfma_f32_16x16x32_bf16 v[48:51], a[112:115], a[164:167], v[48:51]
  ds_read_b64_tr_b16 a[44:45], v237 offset:608
  v_mfma_f32_16x16x32_bf16 v[48:51], a[144:147], a[180:183], v[48:51]
  ds_read_b64_tr_b16 a[46:47], v237 offset:9056
  v_mfma_f32_16x16x32_bf16 v[80:83], a[112:115], a[168:171], v[80:83]
  ds_read_b64_tr_b16 a[16:17], v237 offset:128
  v_mfma_f32_16x16x32_bf16 v[80:83], a[144:147], a[184:187], v[80:83]
  v_mfma_f32_16x16x32_bf16 v[112:115], a[112:115], a[172:175], v[112:115]
  ds_read_b64_tr_b16 a[18:19], v237 offset:8576
  v_mfma_f32_16x16x32_bf16 v[112:115], a[144:147], a[188:191], v[112:115]
  ds_read_b64_tr_b16 a[48:49], v237 offset:640
  v_mfma_f32_16x16x32_bf16 v[20:23], a[116:119], a[160:163], v[20:23]
  ds_read_b64_tr_b16 a[50:51], v237 offset:9088
  v_mfma_f32_16x16x32_bf16 v[20:23], a[148:151], a[176:179], v[20:23]
  v_mfma_f32_16x16x32_bf16 v[52:55], a[116:119], a[164:167], v[52:55]
  ds_read_b64_tr_b16 a[20:21], v237 offset:160
  v_mfma_f32_16x16x32_bf16 v[52:55], a[148:151], a[180:183], v[52:55]
  ds_read_b64_tr_b16 a[22:23], v237 offset:8608
  v_mfma_f32_16x16x32_bf16 v[84:87], a[116:119], a[168:171], v[84:87]
  buffer_load_dwordx4 v243, s[16:19], s34 offen offset:3168 nt lds
  v_mfma_f32_16x16x32_bf16 v[84:87], a[148:151], a[184:187], v[84:87]
  v_mfma_f32_16x16x32_bf16 v[116:119], a[116:119], a[172:175], v[116:119]
  ds_read_b64_tr_b16 a[52:53], v237 offset:672
  v_mfma_f32_16x16x32_bf16 v[116:119], a[148:151], a[188:191], v[116:119]
  ds_read_b64_tr_b16 a[54:55], v237 offset:9120
  v_mfma_f32_16x16x32_bf16 v[24:27], a[120:123], a[160:163], v[24:27]
  ds_read_b64_tr_b16 a[24:25], v237 offset:192
  v_mfma_f32_16x16x32_bf16 v[24:27], a[152:155], a[176:179], v[24:27]
  ds_read_b64_tr_b16 a[26:27], v237 offset:8640
  v_mfma_f32_16x16x32_bf16 v[56:59], a[120:123], a[164:167], v[56:59]
  v_mfma_f32_16x16x32_bf16 v[56:59], a[152:155], a[180:183], v[56:59]
  ds_read_b64_tr_b16 a[56:57], v237 offset:704
  v_mfma_f32_16x16x32_bf16 v[88:91], a[120:123], a[168:171], v[88:91]
  ds_read_b64_tr_b16 a[58:59], v237 offset:9152
  v_mfma_f32_16x16x32_bf16 v[88:91], a[152:155], a[184:187], v[88:91]
  ds_read_b64_tr_b16 a[28:29], v237 offset:224
  v_mfma_f32_16x16x32_bf16 v[120:123], a[120:123], a[172:175], v[120:123]
  v_mfma_f32_16x16x32_bf16 v[120:123], a[152:155], a[188:191], v[120:123]
  ds_read_b64_tr_b16 a[30:31], v237 offset:8672
  v_mfma_f32_16x16x32_bf16 v[28:31], a[124:127], a[160:163], v[28:31]
  ds_read_b64_tr_b16 a[60:61], v237 offset:736
  v_mfma_f32_16x16x32_bf16 v[28:31], a[156:159], a[176:179], v[28:31]
  ds_read_b64_tr_b16 a[62:63], v237 offset:9184
  v_mfma_f32_16x16x32_bf16 v[60:63], a[124:127], a[164:167], v[60:63]
  v_mfma_f32_16x16x32_bf16 v[60:63], a[156:159], a[180:183], v[60:63]
  v_mfma_f32_16x16x32_bf16 v[92:95], a[124:127], a[168:171], v[92:95]
  v_mfma_f32_16x16x32_bf16 v[92:95], a[156:159], a[184:187], v[92:95]
  v_mfma_f32_16x16x32_bf16 v[124:127], a[124:127], a[172:175], v[124:127]
  v_mfma_f32_16x16x32_bf16 v[124:127], a[156:159], a[188:191], v[124:127]
  s_waitcnt lgkmcnt(0)
  v_mfma_f32_16x16x32_bf16 v[0:3], a[0:3], a[64:67], v[0:3]
  s_waitcnt vmcnt(4)
  v_mfma_f32_16x16x32_bf16 v[0:3], a[32:35], a[80:83], v[0:3]
  s_barrier
  s_mov_b32 s34, 32768
  s_add_u32 m0, s32, 67584
  v_mfma_f32_16x16x32_bf16 v[32:35], a[0:3], a[68:71], v[32:35]
  buffer_load_dwordx4 v240, s[16:19], s34 offen offset:0 nt lds
  v_mfma_f32_16x16x32_bf16 v[32:35], a[32:35], a[84:87], v[32:35]
  ds_read_b128 a[160:163], v236 offset:33792
  v_mfma_f32_16x16x32_bf16 v[64:67], a[0:3], a[72:75], v[64:67]
  ds_read_b128 a[164:167], v236 offset:38016
  v_mfma_f32_16x16x32_bf16 v[64:67], a[32:35], a[88:91], v[64:67]
  ds_read_b128 a[168:171], v236 offset:34304
  v_mfma_f32_16x16x32_bf16 v[96:99], a[0:3], a[76:79], v[96:99]
  ds_read_b128 a[172:175], v236 offset:38528
  v_mfma_f32_16x16x32_bf16 v[96:99], a[32:35], a[92:95], v[96:99]
  ds_read_b128 a[176:179], v236 offset:33856
  v_mfma_f32_16x16x32_bf16 v[4:7], a[4:7], a[64:67], v[4:7]
  v_mfma_f32_16x16x32_bf16 v[4:7], a[36:39], a[80:83], v[4:7]
  buffer_load_dwordx4 v241, s[16:19], s34 offen offset:1056 nt lds
  v_mfma_f32_16x16x32_bf16 v[36:39], a[4:7], a[68:71], v[36:39]
  ds_read_b128 a[180:183], v236 offset:38080
  v_mfma_f32_16x16x32_bf16 v[36:39], a[36:39], a[84:87], v[36:39]
  ds_read_b128 a[184:187], v236 offset:34368
  v_mfma_f32_16x16x32_bf16 v[68:71], a[4:7], a[72:75], v[68:71]
  ds_read_b128 a[188:191], v236 offset:38592
  v_mfma_f32_16x16x32_bf16 v[68:71], a[36:39], a[88:91], v[68:71]
  ds_read_b64_tr_b16 a[96:97], v237 offset:16896
  v_mfma_f32_16x16x32_bf16 v[100:103], a[4:7], a[76:79], v[100:103]
  v_mfma_f32_16x16x32_bf16 v[100:103], a[36:39], a[92:95], v[100:103]
  ds_read_b64_tr_b16 a[98:99], v237 offset:25344
  v_mfma_f32_16x16x32_bf16 v[8:11], a[8:11], a[64:67], v[8:11]
  buffer_load_dwordx4 v242, s[16:19], s34 offen offset:2112 nt lds
  v_mfma_f32_16x16x32_bf16 v[8:11], a[40:43], a[80:83], v[8:11]
  ds_read_b64_tr_b16 a[128:129], v237 offset:17408
  v_mfma_f32_16x16x32_bf16 v[40:43], a[8:11], a[68:71], v[40:43]
  ds_read_b64_tr_b16 a[130:131], v237 offset:25856
  v_mfma_f32_16x16x32_bf16 v[40:43], a[40:43], a[84:87], v[40:43]
  ds_read_b64_tr_b16 a[100:101], v237 offset:16928
  v_mfma_f32_16x16x32_bf16 v[72:75], a[8:11], a[72:75], v[72:75]
  v_mfma_f32_16x16x32_bf16 v[72:75], a[40:43], a[88:91], v[72:75]
  ds_read_b64_tr_b16 a[102:103], v237 offset:25376
  v_mfma_f32_16x16x32_bf16 v[104:107], a[8:11], a[76:79], v[104:107]
  ds_read_b64_tr_b16 a[132:133], v237 offset:17440
  v_mfma_f32_16x16x32_bf16 v[104:107], a[40:43], a[92:95], v[104:107]
  buffer_load_dwordx4 v243, s[16:19], s34 offen offset:3168 nt lds
  v_mfma_f32_16x16x32_bf16 v[12:15], a[12:15], a[64:67], v[12:15]
  ds_read_b64_tr_b16 a[134:135], v237 offset:25888
  v_mfma_f32_16x16x32_bf16 v[12:15], a[44:47], a[80:83], v[12:15]
  ds_read_b64_tr_b16 a[104:105], v237 offset:16960
  v_mfma_f32_16x16x32_bf16 v[44:47], a[12:15], a[68:71], v[44:47]
  ds_read_b64_tr_b16 a[106:107], v237 offset:25408
  v_mfma_f32_16x16x32_bf16 v[44:47], a[44:47], a[84:87], v[44:47]
  v_mfma_f32_16x16x32_bf16 v[76:79], a[12:15], a[72:75], v[76:79]
  s_mov_b32 s34, 16384
  ds_read_b64_tr_b16 a[136:137], v237 offset:17472
  v_mfma_f32_16x16x32_bf16 v[76:79], a[44:47], a[88:91], v[76:79]
  s_add_u32 m0, s32, 50688
  ds_read_b64_tr_b16 a[138:139], v237 offset:25920
  v_mfma_f32_16x16x32_bf16 v[108:111], a[12:15], a[76:79], v[108:111]
  buffer_load_dwordx4 v240, s[20:23], s34 offen offset:0 nt lds
  v_mfma_f32_16x16x32_bf16 v[108:111], a[44:47], a[92:95], v[108:111]
  ds_read_b64_tr_b16 a[108:109], v237 offset:16992
  v_mfma_f32_16x16x32_bf16 v[16:19], a[16:19], a[64:67], v[16:19]
  ds_read_b64_tr_b16 a[110:111], v237 offset:25440
  v_mfma_f32_16x16x32_bf16 v[16:19], a[48:51], a[80:83], v[16:19]
  v_mfma_f32_16x16x32_bf16 v[48:51], a[16:19], a[68:71], v[48:51]
  ds_read_b64_tr_b16 a[140:141], v237 offset:17504
  v_mfma_f32_16x16x32_bf16 v[48:51], a[48:51], a[84:87], v[48:51]
  ds_read_b64_tr_b16 a[142:143], v237 offset:25952
  v_mfma_f32_16x16x32_bf16 v[80:83], a[16:19], a[72:75], v[80:83]
  ds_read_b64_tr_b16 a[112:113], v237 offset:17024
  v_mfma_f32_16x16x32_bf16 v[80:83], a[48:51], a[88:91], v[80:83]
  buffer_load_dwordx4 v241, s[20:23], s34 offen offset:1056 nt lds
  v_mfma_f32_16x16x32_bf16 v[112:115], a[16:19], a[76:79], v[112:115]
  ds_read_b64_tr_b16 a[114:115], v237 offset:25472
  v_mfma_f32_16x16x32_bf16 v[112:115], a[48:51], a[92:95], v[112:115]
  v_mfma_f32_16x16x32_bf16 v[20:23], a[20:23], a[64:67], v[20:23]
  ds_read_b64_tr_b16 a[144:145], v237 offset:17536
  v_mfma_f32_16x16x32_bf16 v[20:23], a[52:55], a[80:83], v[20:23]
  ds_read_b64_tr_b16 a[146:147], v237 offset:25984
  v_mfma_f32_16x16x32_bf16 v[52:55], a[20:23], a[68:71], v[52:55]
  ds_read_b64_tr_b16 a[116:117], v237 offset:17056
  v_mfma_f32_16x16x32_bf16 v[52:55], a[52:55], a[84:87], v[52:55]
  ds_read_b64_tr_b16 a[118:119], v237 offset:25504
  v_mfma_f32_16x16x32_bf16 v[84:87], a[20:23], a[72:75], v[84:87]
  buffer_load_dwordx4 v242, s[20:23], s34 offen offset:2112 nt lds
  v_mfma_f32_16x16x32_bf16 v[84:87], a[52:55], a[88:91], v[84:87]
  ds_read_b64_tr_b16 a[148:149], v237 offset:17568
  v_mfma_f32_16x16x32_bf16 v[116:119], a[20:23], a[76:79], v[116:119]
  v_mfma_f32_16x16x32_bf16 v[116:119], a[52:55], a[92:95], v[116:119]
  ds_read_b64_tr_b16 a[150:151], v237 offset:26016
  v_mfma_f32_16x16x32_bf16 v[24:27], a[24:27], a[64:67], v[24:27]
  ds_read_b64_tr_b16 a[120:121], v237 offset:17088
  v_mfma_f32_16x16x32_bf16 v[24:27], a[56:59], a[80:83], v[24:27]
  ds_read_b64_tr_b16 a[122:123], v237 offset:25536
  v_mfma_f32_16x16x32_bf16 v[56:59], a[24:27], a[68:71], v[56:59]
  ds_read_b64_tr_b16 a[152:153], v237 offset:17600
  v_mfma_f32_16x16x32_bf16 v[56:59], a[56:59], a[84:87], v[56:59]
  buffer_load_dwordx4 v243, s[20:23], s34 offen offset:3168 nt lds
  v_mfma_f32_16x16x32_bf16 v[88:91], a[24:27], a[72:75], v[88:91]
  v_mfma_f32_16x16x32_bf16 v[88:91], a[56:59], a[88:91], v[88:91]
  ds_read_b64_tr_b16 a[154:155], v237 offset:26048
  v_mfma_f32_16x16x32_bf16 v[120:123], a[24:27], a[76:79], v[120:123]
  ds_read_b64_tr_b16 a[124:125], v237 offset:17120
  v_mfma_f32_16x16x32_bf16 v[120:123], a[56:59], a[92:95], v[120:123]
  ds_read_b64_tr_b16 a[126:127], v237 offset:25568
  v_mfma_f32_16x16x32_bf16 v[28:31], a[28:31], a[64:67], v[28:31]
  ds_read_b64_tr_b16 a[156:157], v237 offset:17632
  v_mfma_f32_16x16x32_bf16 v[28:31], a[60:63], a[80:83], v[28:31]
  ds_read_b64_tr_b16 a[158:159], v237 offset:26080
  v_mfma_f32_16x16x32_bf16 v[60:63], a[28:31], a[68:71], v[60:63]
  v_mfma_f32_16x16x32_bf16 v[60:63], a[60:63], a[84:87], v[60:63]
  v_mfma_f32_16x16x32_bf16 v[92:95], a[28:31], a[72:75], v[92:95]
  v_mfma_f32_16x16x32_bf16 v[92:95], a[60:63], a[88:91], v[92:95]
  v_mfma_f32_16x16x32_bf16 v[124:127], a[28:31], a[76:79], v[124:127]
  v_mfma_f32_16x16x32_bf16 v[124:127], a[60:63], a[92:95], v[124:127]
  s_waitcnt lgkmcnt(0)
  v_mfma_f32_16x16x32_bf16 v[0:3], a[96:99], a[160:163], v[0:3]
  v_mfma_f32_16x16x32_bf16 v[0:3], a[128:131], a[176:179], v[0:3]
  v_mfma_f32_16x16x32_bf16 v[4:7], a[100:103], a[160:163], v[4:7]
  v_mfma_f32_16x16x32_bf16 v[4:7], a[132:135], a[176:179], v[4:7]
  v_mfma_f32_16x16x32_bf16 v[8:11], a[104:107], a[160:163], v[8:11]
  v_mfma_f32_16x16x32_bf16 v[8:11], a[136:139], a[176:179], v[8:11]
  v_mfma_f32_16x16x32_bf16 v[12:15], a[108:111], a[160:163], v[12:15]
  v_mfma_f32_16x16x32_bf16 v[12:15], a[140:143], a[176:179], v[12:15]
  v_mfma_f32_16x16x32_bf16 v[16:19], a[112:115], a[160:163], v[16:19]
  v_mfma_f32_16x16x32_bf16 v[16:19], a[144:147], a[176:179], v[16:19]
  v_mfma_f32_16x16x32_bf16 v[20:23], a[116:119], a[160:163], v[20:23]
  s_waitcnt vmcnt(52)
  v_mfma_f32_16x16x32_bf16 v[20:23], a[148:151], a[176:179], v[20:23]
  s_barrier
  v_mfma_f32_16x16x32_bf16 v[24:27], a[120:123], a[160:163], v[24:27]
  s_mov_b32 s34, 49152
  ds_read_b128 a[192:195], v232 offset:0
  v_mfma_f32_16x16x32_bf16 v[24:27], a[152:155], a[176:179], v[24:27]
  s_add_u32 m0, s32, 101376
  ds_read_b128 a[196:199], v232 offset:64
  v_mfma_f32_16x16x32_bf16 v[28:31], a[124:127], a[160:163], v[28:31]
  buffer_load_dwordx4 v240, s[16:19], s34 offen offset:0 nt lds
  v_mfma_f32_16x16x32_bf16 v[28:31], a[156:159], a[176:179], v[28:31]
  ds_read_b128 a[200:203], v232 offset:128
  v_mfma_f32_16x16x32_bf16 v[32:35], a[96:99], a[164:167], v[32:35]
  buffer_load_dwordx4 v241, s[16:19], s34 offen offset:1056 nt lds
  v_mfma_f32_16x16x32_bf16 v[32:35], a[128:131], a[180:183], v[32:35]
  ds_read_b128 a[204:207], v232 offset:192
  v_mul_f32 v0, s53, v0
  v_mfma_f32_16x16x32_bf16 v[36:39], a[100:103], a[164:167], v[36:39]
  ds_read_b128 a[208:211], v232 offset:512
  v_mul_f32 v1, s53, v1
  v_mul_f32 v2, s53, v2
  v_mul_f32 v3, s53, v3
  v_mfma_f32_16x16x32_bf16 v[36:39], a[132:135], a[180:183], v[36:39]
  buffer_load_dwordx4 v242, s[16:19], s34 offen offset:2112 nt lds
  v_cvt_pk_bf16_f32 v128, v0, v1
  v_mfma_f32_16x16x32_bf16 v[40:43], a[104:107], a[164:167], v[40:43]
  ds_read_b128 a[212:215], v232 offset:576
  v_cvt_pk_bf16_f32 v129, v2, v3
  v_mul_f32 v4, s53, v4
  v_mul_f32 v5, s53, v5
  v_mfma_f32_16x16x32_bf16 v[40:43], a[136:139], a[180:183], v[40:43]
  ds_read_b128 a[216:219], v232 offset:640
  v_mul_f32 v6, s53, v6
  v_mul_f32 v7, s53, v7
  v_cvt_pk_bf16_f32 v130, v4, v5
  v_mfma_f32_16x16x32_bf16 v[44:47], a[108:111], a[164:167], v[44:47]
  ds_read_b128 a[220:223], v232 offset:704
  v_cvt_pk_bf16_f32 v131, v6, v7
  v_permlane32_swap_b32 v128, v130
  v_mul_f32 v8, s53, v8
  v_mfma_f32_16x16x32_bf16 v[44:47], a[140:143], a[180:183], v[44:47]
  buffer_load_dwordx4 v243, s[16:19], s34 offen offset:3168 nt lds
  v_permlane32_swap_b32 v129, v131
  v_mfma_f32_16x16x32_bf16 v[48:51], a[112:115], a[164:167], v[48:51]
  s_lshl_b32 s35, s28, 4
  v_permlane16_swap_b32 v128, v130
  v_permlane16_swap_b32 v129, v131
  v_mul_f32 v9, s53, v9
  v_mul_f32 v10, s53, v10
  v_mfma_f32_16x16x32_bf16 v[48:51], a[144:147], a[180:183], v[48:51]
  v_mul_f32 v11, s53, v11
  v_mov_b32 v228, s35
  v_cvt_pk_bf16_f32 v132, v8, v9
  v_cvt_pk_bf16_f32 v133, v10, v11
  v_mfma_f32_16x16x32_bf16 v[52:55], a[116:119], a[164:167], v[52:55]
  v_mul_f32 v12, s53, v12
  v_mul_f32 v13, s53, v13
  v_mul_f32 v14, s53, v14
  v_mul_f32 v15, s53, v15
  v_mfma_f32_16x16x32_bf16 v[52:55], a[148:151], a[180:183], v[52:55]
  s_lshr_b32 s97, s29, 3
  global_load_dwordx4 v[224:227], v228, s[100:101] sc1
  v_cvt_pk_bf16_f32 v134, v12, v13
  v_mfma_f32_16x16x32_bf16 v[56:59], a[120:123], a[164:167], v[56:59]
  s_lshl_b32 s97, s97, 2
  v_cvt_pk_bf16_f32 v135, v14, v15
  v_permlane32_swap_b32 v132, v134
  v_mul_f32 v16, s53, v16
  v_permlane32_swap_b32 v133, v135
  v_mfma_f32_16x16x32_bf16 v[56:59], a[152:155], a[180:183], v[56:59]
  s_add_u32 s35, s35, s97
  v_permlane16_swap_b32 v132, v134
  v_permlane16_swap_b32 v133, v135
  v_mul_f32 v17, s53, v17
  v_mul_f32 v18, s53, v18
  v_mfma_f32_16x16x32_bf16 v[60:63], a[124:127], a[164:167], v[60:63]
  v_mul_f32 v19, s53, v19
  v_cvt_pk_bf16_f32 v136, v16, v17
  v_mov_b32 v228, s35
  v_cvt_pk_bf16_f32 v137, v18, v19
  v_mfma_f32_16x16x32_bf16 v[60:63], a[156:159], a[180:183], v[60:63]
  v_mul_f32 v20, s53, v20
  v_mul_f32 v21, s53, v21
  v_mul_f32 v22, s53, v22
  v_mul_f32 v23, s53, v23
  v_mfma_f32_16x16x32_bf16 v[64:67], a[96:99], a[168:171], v[64:67]
  global_load_dword v229, v228, s[100:101] sc1
  v_cvt_pk_bf16_f32 v138, v20, v21
  v_mfma_f32_16x16x32_bf16 v[64:67], a[128:131], a[184:187], v[64:67]
  v_cvt_pk_bf16_f32 v139, v22, v23
  v_permlane32_swap_b32 v136, v138
  v_mul_f32 v24, s53, v24
  v_permlane32_swap_b32 v137, v139
  v_mfma_f32_16x16x32_bf16 v[68:71], a[100:103], a[168:171], v[68:71]
  v_permlane16_swap_b32 v136, v138
  v_permlane16_swap_b32 v137, v139
  v_mul_f32 v25, s53, v25
  v_mul_f32 v26, s53, v26
  v_mfma_f32_16x16x32_bf16 v[68:71], a[132:135], a[184:187], v[68:71]
  v_mul_f32 v27, s53, v27
  v_cvt_pk_bf16_f32 v140, v24, v25
  v_cvt_pk_bf16_f32 v141, v26, v27
  v_mul_f32 v32, s53, v32
  v_mfma_f32_16x16x32_bf16 v[72:75], a[104:107], a[168:171], v[72:75]
  v_mul_f32 v28, s53, v28
  v_mul_f32 v33, s53, v33
  v_mul_f32 v29, s53, v29
  v_mul_f32 v34, s53, v34
  v_mfma_f32_16x16x32_bf16 v[72:75], a[136:139], a[184:187], v[72:75]
  v_mul_f32 v30, s53, v30
  v_mul_f32 v35, s53, v35
  v_mul_f32 v31, s53, v31
  v_cvt_pk_bf16_f32 v144, v32, v33
  v_mfma_f32_16x16x32_bf16 v[76:79], a[108:111], a[168:171], v[76:79]
  v_cvt_pk_bf16_f32 v142, v28, v29
  v_cvt_pk_bf16_f32 v145, v34, v35
  v_cvt_pk_bf16_f32 v143, v30, v31
  v_mul_f32 v36, s53, v36
  v_mfma_f32_16x16x32_bf16 v[76:79], a[140:143], a[184:187], v[76:79]
  v_permlane32_swap_b32 v140, v142
  v_mul_f32 v37, s53, v37
  v_permlane32_swap_b32 v141, v143
  v_mul_f32 v38, s53, v38
  v_mfma_f32_16x16x32_bf16 v[80:83], a[112:115], a[168:171], v[80:83]
  v_permlane16_swap_b32 v140, v142
  v_mul_f32 v39, s53, v39
  v_permlane16_swap_b32 v141, v143
  v_cvt_pk_bf16_f32 v146, v36, v37
  v_mfma_f32_16x16x32_bf16 v[80:83], a[144:147], a[184:187], v[80:83]
  v_cvt_pk_bf16_f32 v147, v38, v39
  v_permlane32_swap_b32 v144, v146
  v_mul_f32 v40, s53, v40
  v_permlane32_swap_b32 v145, v147
  v_mfma_f32_16x16x32_bf16 v[84:87], a[116:119], a[168:171], v[84:87]
  v_permlane16_swap_b32 v144, v146
  v_permlane16_swap_b32 v145, v147
  v_mul_f32 v41, s53, v41
  v_mul_f32 v42, s53, v42
  v_mfma_f32_16x16x32_bf16 v[84:87], a[148:151], a[184:187], v[84:87]
  v_mul_f32 v43, s53, v43
  v_cvt_pk_bf16_f32 v148, v40, v41
  v_cvt_pk_bf16_f32 v149, v42, v43
  v_mul_f32 v44, s53, v44
  v_mfma_f32_16x16x32_bf16 v[88:91], a[120:123], a[168:171], v[88:91]
  v_mul_f32 v45, s53, v45
  v_mul_f32 v46, s53, v46
  v_mul_f32 v47, s53, v47
  v_cvt_pk_bf16_f32 v150, v44, v45
  v_mfma_f32_16x16x32_bf16 v[88:91], a[152:155], a[184:187], v[88:91]
  v_cvt_pk_bf16_f32 v151, v46, v47
  v_permlane32_swap_b32 v148, v150
  v_mul_f32 v48, s53, v48
  v_permlane32_swap_b32 v149, v151
  v_mfma_f32_16x16x32_bf16 v[92:95], a[124:127], a[168:171], v[92:95]
  v_permlane16_swap_b32 v148, v150
  v_permlane16_swap_b32 v149, v151
  v_mul_f32 v49, s53, v49
  v_mul_f32 v50, s53, v50
  v_mfma_f32_16x16x32_bf16 v[92:95], a[156:159], a[184:187], v[92:95]
  v_mul_f32 v51, s53, v51
  v_cvt_pk_bf16_f32 v152, v48, v49
  v_cvt_pk_bf16_f32 v153, v50, v51
  v_mul_f32 v52, s53, v52
  v_mfma_f32_16x16x32_bf16 v[96:99], a[96:99], a[172:175], v[96:99]
  v_mul_f32 v53, s53, v53
  v_mul_f32 v54, s53, v54
  v_mul_f32 v55, s53, v55
  v_cvt_pk_bf16_f32 v154, v52, v53
  v_mfma_f32_16x16x32_bf16 v[96:99], a[128:131], a[188:191], v[96:99]
  v_cvt_pk_bf16_f32 v155, v54, v55
  v_permlane32_swap_b32 v152, v154
  v_mul_f32 v56, s53, v56
  v_permlane32_swap_b32 v153, v155
  v_mfma_f32_16x16x32_bf16 v[100:103], a[100:103], a[172:175], v[100:103]
  v_permlane16_swap_b32 v152, v154
  v_permlane16_swap_b32 v153, v155
  v_mul_f32 v57, s53, v57
  v_mul_f32 v58, s53, v58
  v_mfma_f32_16x16x32_bf16 v[100:103], a[132:135], a[188:191], v[100:103]
  v_mul_f32 v59, s53, v59
  v_cvt_pk_bf16_f32 v156, v56, v57
  v_cvt_pk_bf16_f32 v157, v58, v59
  v_mul_f32 v64, s53, v64
  v_mfma_f32_16x16x32_bf16 v[104:107], a[104:107], a[172:175], v[104:107]
  v_mul_f32 v60, s53, v60
  v_mul_f32 v65, s53, v65
  v_mul_f32 v61, s53, v61
  v_mul_f32 v66, s53, v66
  v_mfma_f32_16x16x32_bf16 v[104:107], a[136:139], a[188:191], v[104:107]
  v_mul_f32 v62, s53, v62
  v_mul_f32 v67, s53, v67
  v_mul_f32 v63, s53, v63
  v_cvt_pk_bf16_f32 v160, v64, v65
  v_mfma_f32_16x16x32_bf16 v[108:111], a[108:111], a[172:175], v[108:111]
  v_cvt_pk_bf16_f32 v158, v60, v61
  v_cvt_pk_bf16_f32 v161, v66, v67
  v_cvt_pk_bf16_f32 v159, v62, v63
  v_mul_f32 v68, s53, v68
  v_mfma_f32_16x16x32_bf16 v[108:111], a[140:143], a[188:191], v[108:111]
  v_permlane32_swap_b32 v156, v158
  v_mul_f32 v69, s53, v69
  v_permlane32_swap_b32 v157, v159
  v_mul_f32 v70, s53, v70
  v_mfma_f32_16x16x32_bf16 v[112:115], a[112:115], a[172:175], v[112:115]
  v_permlane16_swap_b32 v156, v158
  v_mul_f32 v71, s53, v71
  v_permlane16_swap_b32 v157, v159
  v_cvt_pk_bf16_f32 v162, v68, v69
  v_mfma_f32_16x16x32_bf16 v[112:115], a[144:147], a[188:191], v[112:115]
  v_cvt_pk_bf16_f32 v163, v70, v71
  v_permlane32_swap_b32 v160, v162
  v_mul_f32 v72, s53, v72
  v_permlane32_swap_b32 v161, v163
  v_mfma_f32_16x16x32_bf16 v[116:119], a[116:119], a[172:175], v[116:119]
  s_mov_b32 s34, 32768
  v_permlane16_swap_b32 v160, v162
  v_permlane16_swap_b32 v161, v163
  v_mul_f32 v73, s53, v73
  v_mul_f32 v74, s53, v74
  v_mfma_f32_16x16x32_bf16 v[116:119], a[148:151], a[188:191], v[116:119]
  s_add_u32 m0, s32, 84480
  v_mul_f32 v75, s53, v75
  v_cvt_pk_bf16_f32 v164, v72, v73
  v_cvt_pk_bf16_f32 v165, v74, v75
  v_mul_f32 v76, s53, v76
  v_mfma_f32_16x16x32_bf16 v[120:123], a[120:123], a[172:175], v[120:123]
  v_mul_f32 v77, s53, v77
  v_mul_f32 v78, s53, v78
  v_mul_f32 v79, s53, v79
  v_cvt_pk_bf16_f32 v166, v76, v77
  v_mfma_f32_16x16x32_bf16 v[120:123], a[152:155], a[188:191], v[120:123]
  v_cvt_pk_bf16_f32 v167, v78, v79
  v_permlane32_swap_b32 v164, v166
  v_mul_f32 v80, s53, v80
  v_permlane32_swap_b32 v165, v167
  v_mfma_f32_16x16x32_bf16 v[124:127], a[124:127], a[172:175], v[124:127]
  v_permlane16_swap_b32 v164, v166
  v_permlane16_swap_b32 v165, v167
  v_mul_f32 v81, s53, v81
  v_mul_f32 v82, s53, v82
  v_mfma_f32_16x16x32_bf16 v[124:127], a[156:159], a[188:191], v[124:127]
  s_waitcnt lgkmcnt(0)
  v_mul_f32 v83, s53, v83
  v_cvt_pk_bf16_f32 v168, v80, v81
  v_cvt_pk_bf16_f32 v169, v82, v83
  v_mul_f32 v84, s53, v84
  v_mfma_f32_16x16x32_bf16 v[0:3], a[192:195], v[128:131], 0
  v_mul_f32 v85, s53, v85
  v_mul_f32 v86, s53, v86
  v_mul_f32 v87, s53, v87
  v_cvt_pk_bf16_f32 v170, v84, v85
  v_mfma_f32_16x16x32_bf16 v[0:3], a[196:199], v[132:135], v[0:3]
  v_cvt_pk_bf16_f32 v171, v86, v87
  v_permlane32_swap_b32 v168, v170
  v_mul_f32 v88, s53, v88
  v_permlane32_swap_b32 v169, v171
  v_mfma_f32_16x16x32_bf16 v[0:3], a[200:203], v[136:139], v[0:3]
  v_permlane16_swap_b32 v168, v170
  v_permlane16_swap_b32 v169, v171
  v_mul_f32 v89, s53, v89
  v_mul_f32 v90, s53, v90
  v_mfma_f32_16x16x32_bf16 v[0:3], a[204:207], v[140:143], v[0:3]
  buffer_load_dwordx4 v240, s[20:23], s34 offen offset:0 nt lds
  v_mul_f32 v91, s53, v91
  v_mfma_f32_16x16x32_bf16 v[4:7], a[208:211], v[128:131], 0
  v_cvt_pk_bf16_f32 v172, v88, v89
  v_cvt_pk_bf16_f32 v173, v90, v91
  v_mul_f32 v96, s53, v96
  v_mul_f32 v92, s53, v92
  v_mfma_f32_16x16x32_bf16 v[4:7], a[212:215], v[132:135], v[4:7]
  v_mul_f32 v97, s53, v97
  v_mul_f32 v93, s53, v93
  v_mul_f32 v98, s53, v98
  v_mul_f32 v94, s53, v94
  v_mfma_f32_16x16x32_bf16 v[4:7], a[216:219], v[136:139], v[4:7]
  v_mul_f32 v99, s53, v99
  v_mul_f32 v95, s53, v95
  v_cvt_pk_bf16_f32 v176, v96, v97
  v_cvt_pk_bf16_f32 v174, v92, v93
  v_mfma_f32_16x16x32_bf16 v[4:7], a[220:223], v[140:143], v[4:7]
  v_cvt_pk_bf16_f32 v177, v98, v99
  v_cvt_pk_bf16_f32 v175, v94, v95
  v_mul_f32 v100, s53, v100
  v_permlane32_swap_b32 v172, v174
  v_mfma_f32_16x16x32_bf16 v[8:11], a[192:195], v[144:147], 0
  v_mul_f32 v101, s53, v101
  v_permlane32_swap_b32 v173, v175
  v_mul_f32 v102, s53, v102
  v_permlane16_swap_b32 v172, v174
  v_mfma_f32_16x16x32_bf16 v[8:11], a[196:199], v[148:151], v[8:11]
  v_mul_f32 v103, s53, v103
  v_permlane16_swap_b32 v173, v175
  v_cvt_pk_bf16_f32 v178, v100, v101
  v_cvt_pk_bf16_f32 v179, v102, v103
  v_mfma_f32_16x16x32_bf16 v[8:11], a[200:203], v[152:155], v[8:11]
  s_mov_b32 s98, 0
  v_permlane32_swap_b32 v176, v178
  v_permlane32_swap_b32 v177, v179
  v_mul_f32 v104, s53, v104
  v_permlane16_swap_b32 v176, v178
  v_mfma_f32_16x16x32_bf16 v[8:11], a[204:207], v[156:159], v[8:11]
  s_mov_b32 s47, 49152
  v_permlane16_swap_b32 v177, v179
  v_mov_b32 v233, v235
  v_mul_f32 v105, s53, v105
  v_mul_f32 v106, s53, v106
  v_mfma_f32_16x16x32_bf16 v[12:15], a[208:211], v[144:147], 0
  s_mov_b32 s46, 53248
  v_mul_f32 v107, s53, v107
  v_cvt_pk_bf16_f32 v180, v104, v105
  v_cvt_pk_bf16_f32 v181, v106, v107
  v_mul_f32 v108, s53, v108
  v_mfma_f32_16x16x32_bf16 v[12:15], a[212:215], v[148:151], v[12:15]
  s_mov_b32 s48, 33792
  v_mul_f32 v109, s53, v109
  v_max3_f32 v216, v0, v1, v212
  v_mov_b32 v208, 0
  v_mul_f32 v110, s53, v110
  v_mfma_f32_16x16x32_bf16 v[12:15], a[216:219], v[152:155], v[12:15]
  s_mov_b32 s49, 67584
  buffer_load_dwordx4 v241, s[20:23], s34 offen offset:1056 nt lds
  v_mul_f32 v111, s53, v111
  v_max3_f32 v216, v2, v3, v216
  v_cvt_pk_bf16_f32 v182, v108, v109
  v_max3_f32 v216, v4, v5, v216
  v_mfma_f32_16x16x32_bf16 v[12:15], a[220:223], v[156:159], v[12:15]
  s_mov_b32 s50, 101376
  v_cvt_pk_bf16_f32 v183, v110, v111
  v_permlane32_swap_b32 v180, v182
  v_max3_f32 v216, v6, v7, v216
  v_permlane32_swap_b32 v181, v183
  v_permlane16_swap_b32 v180, v182
  v_mov_b32 v217, v216
  v_mfma_f32_16x16x32_bf16 v[16:19], a[192:195], v[160:163], 0
  s_mov_b32 s51, 0
  v_permlane16_swap_b32 v181, v183
  v_permlane16_swap_b32 v216, v217
  v_mul_f32 v112, s53, v112
  v_mul_f32 v113, s53, v113
  v_max_f32 v216, v216, v217
  v_mfma_f32_16x16x32_bf16 v[16:19], a[196:199], v[164:167], v[16:19]
  s_mov_b32 s40, 0
  v_mul_f32 v114, s53, v114
  v_mul_f32 v115, s53, v115
  v_mov_b32 v217, v216
  v_cvt_pk_bf16_f32 v184, v112, v113
  v_mfma_f32_16x16x32_bf16 v[16:19], a[200:203], v[168:171], v[16:19]
  s_mov_b32 s41, 33792
  v_permlane32_swap_b32 v216, v217
  v_cvt_pk_bf16_f32 v185, v114, v115
  v_mul_f32 v116, s53, v116
  v_max_f32 v216, v216, v217
  v_mul_f32 v117, s53, v117
  v_mul_f32 v118, s53, v118
  v_sub_f32 v192, 0, v216
  v_mfma_f32_16x16x32_bf16 v[16:19], a[204:207], v[172:175], v[16:19]
  s_mov_b32 s42, 67584
  v_mul_f32 v119, s53, v119
  v_sub_f32 v193, 0, v216
  v_cvt_pk_bf16_f32 v186, v116, v117
  v_cvt_pk_bf16_f32 v187, v118, v119
  v_sub_f32 v194, 0, v216
  v_mfma_f32_16x16x32_bf16 v[20:23], a[208:211], v[160:163], 0
  s_mov_b32 s43, 101376
  v_permlane32_swap_b32 v184, v186
  v_permlane32_swap_b32 v185, v187
  v_sub_f32 v195, 0, v216
  v_permlane16_swap_b32 v184, v186
  v_sub_f32 v0, v0, v216
  v_mfma_f32_16x16x32_bf16 v[20:23], a[212:215], v[164:167], v[20:23]
  s_mov_b32 s7, 118272
  v_permlane16_swap_b32 v185, v187
  v_mul_f32 v120, s53, v120
  v_sub_f32 v1, v1, v216
  v_mul_f32 v121, s53, v121
  v_mul_f32 v122, s53, v122
  v_sub_f32 v2, v2, v216
  v_max3_f32 v218, v8, v9, v213
  v_mov_b32 v209, 0
  v_mfma_f32_16x16x32_bf16 v[20:23], a[216:219], v[168:171], v[20:23]
  buffer_load_dwordx4 v242, s[20:23], s34 offen offset:2112 nt lds
  v_mul_f32 v123, s53, v123
  v_sub_f32 v3, v3, v216
  v_max3_f32 v218, v10, v11, v218
  v_cvt_pk_bf16_f32 v188, v120, v121
  v_cvt_pk_bf16_f32 v189, v122, v123
  v_sub_f32 v4, v4, v216
  v_max3_f32 v218, v12, v13, v218
  v_mfma_f32_16x16x32_bf16 v[20:23], a[220:223], v[172:175], v[20:23]
  v_mul_f32 v124, s53, v124
  v_mul_f32 v125, s53, v125
  v_sub_f32 v5, v5, v216
  v_max3_f32 v218, v14, v15, v218
  v_mul_f32 v126, s53, v126
  v_sub_f32 v6, v6, v216
  v_mov_b32 v219, v218
  v_mfma_f32_16x16x32_bf16 v[24:27], a[192:195], v[176:179], 0
  ds_read_b128 a[192:195], v232 offset:8448
  v_mul_f32 v127, s53, v127
  v_cvt_pk_bf16_f32 v190, v124, v125
  v_sub_f32 v7, v7, v216
  v_permlane16_swap_b32 v218, v219
  v_cvt_pk_bf16_f32 v191, v126, v127
  v_permlane32_swap_b32 v188, v190
  v_max_f32 v218, v218, v219
  v_mfma_f32_16x16x32_bf16 v[24:27], a[196:199], v[180:183], v[24:27]
  ds_read_b128 a[196:199], v232 offset:8512
  v_permlane32_swap_b32 v189, v191
  v_mov_b32 v219, v218
  v_permlane16_swap_b32 v188, v190
  v_permlane16_swap_b32 v189, v191
  v_permlane32_swap_b32 v218, v219
  v_mfma_f32_16x16x32_bf16 v[24:27], a[200:203], v[184:187], v[24:27]
  ds_read_b128 a[200:203], v232 offset:8576
  v_max_f32 v218, v218, v219
  v_sub_f32 v196, 0, v218
  v_sub_f32 v197, 0, v218
  v_mfma_f32_16x16x32_bf16 v[24:27], a[204:207], v[188:191], v[24:27]
  ds_read_b128 a[204:207], v232 offset:8640
  v_sub_f32 v198, 0, v218
  v_sub_f32 v199, 0, v218
  v_sub_f32 v8, v8, v218
  v_mfma_f32_16x16x32_bf16 v[28:31], a[208:211], v[176:179], 0
  ds_read_b128 a[208:211], v232 offset:8960
  v_sub_f32 v9, v9, v218
  v_sub_f32 v10, v10, v218
  v_max3_f32 v220, v16, v17, v214
  v_mfma_f32_16x16x32_bf16 v[28:31], a[212:215], v[180:183], v[28:31]
  buffer_load_dwordx4 v243, s[20:23], s34 offen offset:3168 nt lds
  v_mov_b32 v210, 0
  v_mfma_f32_16x16x32_bf16 v[28:31], a[216:219], v[184:187], v[28:31]
  ds_read_b128 a[212:215], v232 offset:9024
  v_sub_f32 v11, v11, v218
  v_max3_f32 v220, v18, v19, v220
  v_sub_f32 v12, v12, v218
  v_max3_f32 v220, v20, v21, v220
  v_mfma_f32_16x16x32_bf16 v[28:31], a[220:223], v[188:191], v[28:31]
  s_waitcnt lgkmcnt(1)
  ds_read_b128 a[216:219], v232 offset:9088
  v_sub_f32 v13, v13, v218
  v_max3_f32 v220, v22, v23, v220
  v_sub_f32 v14, v14, v218
  v_mov_b32 v221, v220
  v_mfma_f32_16x16x32_bf16 v[32:35], a[192:195], v[128:131], v[192:195]
  ds_read_b128 a[220:223], v232 offset:9152
  v_sub_f32 v15, v15, v218
  v_permlane16_swap_b32 v220, v221
  v_max_f32 v220, v220, v221
  v_mfma_f32_16x16x32_bf16 v[32:35], a[196:199], v[132:135], v[32:35]
  v_mov_b32 v221, v220
  v_mov_b32 v96, 0x3f803f80
  v_accvgpr_write_b32 a128, v96
  v_permlane32_swap_b32 v220, v221
  v_mfma_f32_16x16x32_bf16 v[32:35], a[200:203], v[136:139], v[32:35]
  v_max_f32 v220, v220, v221
  v_sub_f32 v200, 0, v220
  v_sub_f32 v201, 0, v220
  v_sub_f32 v202, 0, v220
  v_mfma_f32_16x16x32_bf16 v[32:35], a[204:207], v[140:143], v[32:35]
  v_sub_f32 v203, 0, v220
  v_sub_f32 v16, v16, v220
  v_accvgpr_write_b32 a129, v96
  v_accvgpr_write_b32 a130, v96
  v_mfma_f32_16x16x32_bf16 v[36:39], a[208:211], v[128:131], v[192:195]
  s_waitcnt lgkmcnt(0)
  v_accvgpr_write_b32 a131, v96
  v_sub_f32 v17, v17, v220
  v_sub_f32 v18, v18, v220
  v_max3_f32 v222, v24, v25, v215
  v_mfma_f32_16x16x32_bf16 v[36:39], a[212:215], v[132:135], v[36:39]
  v_mov_b32 v211, 0
  v_exp_f32 v0, v0
  v_sub_f32 v19, v19, v220
  v_exp_f32 v1, v1
  v_mfma_f32_16x16x32_bf16 v[36:39], a[216:219], v[136:139], v[36:39]
  v_max3_f32 v222, v26, v27, v222
  v_sub_f32 v20, v20, v220
  v_max3_f32 v222, v28, v29, v222
  v_cvt_pk_bf16_f32 v64, v0, v1
  v_exp_f32 v2, v2
  v_mfma_f32_16x16x32_bf16 v[36:39], a[220:223], v[140:143], v[36:39]
  v_sub_f32 v21, v21, v220
  v_max3_f32 v222, v30, v31, v222
  v_sub_f32 v22, v22, v220
  v_mov_b32 v223, v222
  v_exp_f32 v3, v3
  v_mfma_f32_16x16x32_bf16 v[40:43], a[192:195], v[144:147], v[196:199]
  v_sub_f32 v23, v23, v220
  v_permlane16_swap_b32 v222, v223
  v_max_f32 v222, v222, v223
  v_cvt_pk_bf16_f32 v65, v2, v3
  v_exp_f32 v4, v4
  v_mfma_f32_16x16x32_bf16 v[40:43], a[196:199], v[148:151], v[40:43]
  v_mov_b32 v223, v222
  v_exp_f32 v5, v5
  v_mfma_f32_16x16x32_bf16 v[40:43], a[200:203], v[152:155], v[40:43]
  v_permlane32_swap_b32 v222, v223
  v_max_f32 v222, v222, v223
  v_sub_f32 v204, 0, v222
  v_cvt_pk_bf16_f32 v66, v4, v5
  v_exp_f32 v6, v6
  v_mfma_f32_16x16x32_bf16 v[40:43], a[204:207], v[156:159], v[40:43]
  v_sub_f32 v205, 0, v222
  v_sub_f32 v206, 0, v222
  v_exp_f32 v7, v7
  v_mfma_f32_16x16x32_bf16 v[44:47], a[208:211], v[144:147], v[196:199]
  v_sub_f32 v207, 0, v222
  v_sub_f32 v24, v24, v222
  v_cvt_pk_bf16_f32 v67, v6, v7
  v_sub_f32 v25, v25, v222
  v_exp_f32 v8, v8
  v_mfma_f32_16x16x32_bf16 v[44:47], a[212:215], v[148:151], v[44:47]
  v_sub_f32 v26, v26, v222
  v_add_f32 v209, v209, v8
  v_exp_f32 v9, v9
  v_mfma_f32_16x16x32_bf16 v[44:47], a[216:219], v[152:155], v[44:47]
  v_sub_f32 v27, v27, v222
  v_sub_f32 v28, v28, v222
  v_add_f32 v209, v209, v9
  v_cvt_pk_bf16_f32 v68, v8, v9
  v_exp_f32 v10, v10
  v_exp_f32 v11, v11
  v_mfma_f32_16x16x32_bf16 v[44:47], a[220:223], v[156:159], v[44:47]
  v_sub_f32 v29, v29, v222
  v_sub_f32 v30, v30, v222
  v_add_f32 v209, v209, v10
  v_add_f32 v209, v209, v11
  v_cvt_pk_bf16_f32 v69, v10, v11
  v_exp_f32 v12, v12
  v_mfma_f32_16x16x32_bf16 v[48:51], a[192:195], v[160:163], v[200:203]
  v_sub_f32 v31, v31, v222
  v_add_f32 v209, v209, v12
  v_exp_f32 v13, v13
  v_mfma_f32_16x16x32_bf16 v[48:51], a[196:199], v[164:167], v[48:51]
  v_add_f32 v209, v209, v13
  v_cvt_pk_bf16_f32 v70, v12, v13
  v_exp_f32 v14, v14
  v_mfma_f32_16x16x32_bf16 v[48:51], a[200:203], v[168:171], v[48:51]
  v_add_f32 v209, v209, v14
  v_exp_f32 v15, v15
  v_mfma_f32_16x16x32_bf16 v[48:51], a[204:207], v[172:175], v[48:51]
  v_add_f32 v209, v209, v15
  v_cvt_pk_bf16_f32 v71, v14, v15
  v_exp_f32 v16, v16
  v_mfma_f32_16x16x32_bf16 v[52:55], a[208:211], v[160:163], v[200:203]
  v_add_f32 v210, v210, v16
  v_exp_f32 v17, v17
  v_mfma_f32_16x16x32_bf16 v[52:55], a[212:215], v[164:167], v[52:55]
  v_add_f32 v210, v210, v17
  v_cvt_pk_bf16_f32 v72, v16, v17
  v_exp_f32 v18, v18
  v_mfma_f32_16x16x32_bf16 v[52:55], a[216:219], v[168:171], v[52:55]
  v_add_f32 v210, v210, v18
  v_exp_f32 v19, v19
  v_mfma_f32_16x16x32_bf16 v[52:55], a[220:223], v[172:175], v[52:55]
  v_add_f32 v210, v210, v19
  v_cvt_pk_bf16_f32 v73, v18, v19
  v_exp_f32 v20, v20
  v_exp_f32 v21, v21
  v_mfma_f32_16x16x32_bf16 v[56:59], a[192:195], v[176:179], v[204:207]
  v_add_f32 v210, v210, v20
  v_add_f32 v210, v210, v21
  v_cvt_pk_bf16_f32 v74, v20, v21
  v_exp_f32 v22, v22
  v_mfma_f32_16x16x32_bf16 v[56:59], a[196:199], v[180:183], v[56:59]
  v_add_f32 v210, v210, v22
  v_exp_f32 v23, v23
  v_mfma_f32_16x16x32_bf16 v[56:59], a[200:203], v[184:187], v[56:59]
  v_add_f32 v210, v210, v23
  v_cvt_pk_bf16_f32 v75, v22, v23
  v_exp_f32 v24, v24
  v_mfma_f32_16x16x32_bf16 v[56:59], a[204:207], v[188:191], v[56:59]
  v_add_f32 v211, v211, v24
  v_exp_f32 v25, v25
  v_mfma_f32_16x16x32_bf16 v[60:63], a[208:211], v[176:179], v[204:207]
  v_add_f32 v211, v211, v25
  v_cvt_pk_bf16_f32 v76, v24, v25
  v_exp_f32 v26, v26
  v_mfma_f32_16x16x32_bf16 v[60:63], a[212:215], v[180:183], v[60:63]
  s_waitcnt vmcnt(4)
  v_add_f32 v211, v211, v26
  v_exp_f32 v27, v27
  v_add_u32 v232, 33792, v234
  v_mfma_f32_16x16x32_bf16 v[60:63], a[216:219], v[184:187], v[60:63]
  s_barrier
  ds_read_b128 a[192:195], v232 offset:0
  v_add_f32 v211, v211, v27
  v_cvt_pk_bf16_f32 v77, v26, v27
  v_exp_f32 v28, v28
  v_mfma_f32_16x16x32_bf16 v[60:63], a[220:223], v[188:191], v[60:63]
  ds_read_b128 a[196:199], v232 offset:64
  v_add_f32 v211, v211, v28
  v_exp_f32 v29, v29
  s_nop 0
  v_add_f32 v211, v211, v29
  v_cvt_pk_bf16_f32 v78, v28, v29
  v_exp_f32 v30, v30
  s_nop 0
  v_add_f32 v211, v211, v30
  v_exp_f32 v31, v31
  s_nop 0
  v_add_f32 v211, v211, v31
  v_cvt_pk_bf16_f32 v79, v30, v31
  ds_read_b128 a[200:203], v232 offset:128
  ds_read_b128 a[204:207], v232 offset:192
  ds_read_b128 a[208:211], v232 offset:512
  ds_read_b128 a[212:215], v232 offset:576
  ds_read_b128 a[216:219], v232 offset:640
  ds_read_b128 a[220:223], v232 offset:704
L_w012_join:
  s_waitcnt lgkmcnt(6)
  v_mfma_f32_16x16x32_bf16 v[0:3], a[192:195], v[128:131], v[192:195]
  v_exp_f32 v32, v32
  v_mfma_f32_16x16x32_bf16 v[0:3], a[196:199], v[132:135], v[0:3]
  s_waitcnt lgkmcnt(5)
  ds_read_b64_tr_b16 a[224:225], v233 offset:0
  v_mfma_f32_16x16x32_bf16 v[0:3], a[200:203], v[136:139], v[0:3]
  s_waitcnt lgkmcnt(5)
  v_exp_f32 v33, v33
  v_mfma_f32_16x16x32_bf16 v[0:3], a[204:207], v[140:143], v[0:3]
  s_waitcnt lgkmcnt(4)
  ds_read_b64_tr_b16 a[226:227], v233 offset:512
  v_and_b32 v224, v224, v225
  v_mfma_f32_16x16x32_bf16 v[4:7], a[208:211], v[128:131], v[192:195]
  s_waitcnt lgkmcnt(2)
  v_exp_f32 v40, v40
  v_mfma_f32_16x16x32_bf16 v[4:7], a[212:215], v[132:135], v[4:7]
  ds_read_b64_tr_b16 a[228:229], v233 offset:32
  v_cvt_pk_bf16_f32 v80, v32, v33
  v_mfma_f32_16x16x32_bf16 v[4:7], a[216:219], v[136:139], v[4:7]
  v_exp_f32 v41, v41
  v_mfma_f32_16x16x32_bf16 v[4:7], a[220:223], v[140:143], v[4:7]
  ds_read_b64_tr_b16 a[230:231], v233 offset:544
  v_and_b32 v226, v226, v227
  v_add_f32 v209, v209, v40
  v_mfma_f32_16x16x32_bf16 v[8:11], a[192:195], v[144:147], v[196:199]
  v_exp_f32 v34, v34
  v_mfma_f32_16x16x32_bf16 v[8:11], a[196:199], v[148:151], v[8:11]
  ds_read_b64_tr_b16 a[232:233], v233 offset:64
  v_and_b32 v224, v224, v226
  v_mfma_f32_16x16x32_bf16 v[8:11], a[200:203], v[152:155], v[8:11]
  v_exp_f32 v35, v35
  v_mfma_f32_16x16x32_bf16 v[8:11], a[204:207], v[156:159], v[8:11]
  ds_read_b64_tr_b16 a[234:235], v233 offset:576
  v_add_f32 v209, v209, v41
  v_cvt_pk_bf16_f32 v84, v40, v41
  v_mfma_f32_16x16x32_bf16 v[12:15], a[208:211], v[144:147], v[196:199]
  v_exp_f32 v42, v42
  v_mfma_f32_16x16x32_bf16 v[12:15], a[212:215], v[148:151], v[12:15]
  ds_read_b64_tr_b16 a[236:237], v233 offset:96
  v_readfirstlane_b32 s97, v224
  v_mfma_f32_16x16x32_bf16 v[12:15], a[216:219], v[152:155], v[12:15]
  v_exp_f32 v43, v43
  v_mfma_f32_16x16x32_bf16 v[12:15], a[220:223], v[156:159], v[12:15]
  ds_read_b64_tr_b16 a[238:239], v233 offset:608
  v_readfirstlane_b32 s39, v229
  s_and_b32 s97, s97, 8
  s_getreg_b32 s55, hwreg(HW_REG_XCC_ID, 0, 4)
  v_cvt_pk_bf16_f32 v81, v34, v35
  v_mfma_f32_16x16x32_bf16 v[16:19], a[192:195], v[160:163], v[200:203]
  v_exp_f32 v36, v36
  v_mfma_f32_16x16x32_bf16 v[16:19], a[196:199], v[164:167], v[16:19]
  s_mul_i32 s54, s55, s55
  ds_read_b64_tr_b16 a[240:241], v233 offset:128
  v_add_f32 v209, v209, v42
  v_mfma_f32_16x16x32_bf16 v[16:19], a[200:203], v[168:171], v[16:19]
  v_exp_f32 v37, v37
  v_mfma_f32_16x16x32_bf16 v[16:19], a[204:207], v[172:175], v[16:19]
  s_lshl_b32 s54, s54, 8
  ds_read_b64_tr_b16 a[242:243], v233 offset:640
  v_add_f32 v209, v209, v43
  v_mfma_f32_16x16x32_bf16 v[20:23], a[208:211], v[160:163], v[200:203]
  v_exp_f32 v44, v44
  v_mfma_f32_16x16x32_bf16 v[20:23], a[212:215], v[164:167], v[20:23]
  s_add_u32 s54, s54, s55
  ds_read_b64_tr_b16 a[244:245], v233 offset:160
  v_cvt_pk_bf16_f32 v85, v42, v43
  v_mfma_f32_16x16x32_bf16 v[20:23], a[216:219], v[168:171], v[20:23]
  v_exp_f32 v45, v45
  v_mfma_f32_16x16x32_bf16 v[20:23], a[220:223], v[172:175], v[20:23]
  s_lshl_b32 s54, s54, 8
  ds_read_b64_tr_b16 a[246:247], v233 offset:672
  v_cvt_pk_bf16_f32 v82, v36, v37
  v_mfma_f32_16x16x32_bf16 v[24:27], a[192:195], v[176:179], v[204:207]
  v_exp_f32 v38, v38
  v_mfma_f32_16x16x32_bf16 v[24:27], a[196:199], v[180:183], v[24:27]
  s_add_u32 s54, s54, 1
  ds_read_b64_tr_b16 a[248:249], v233 offset:192
  v_add_f32 v209, v209, v44
  v_mfma_f32_16x16x32_bf16 v[24:27], a[200:203], v[184:187], v[24:27]
  v_exp_f32 v39, v39
  v_mfma_f32_16x16x32_bf16 v[24:27], a[204:207], v[188:191], v[24:27]
  s_lshl_b32 s54, s54, 3
  ds_read_b64_tr_b16 a[250:251], v233 offset:704
  v_add_f32 v209, v209, v45
  v_mfma_f32_16x16x32_bf16 v[28:31], a[208:211], v[176:179], v[204:207]
  v_exp_f32 v46, v46
  v_mfma_f32_16x16x32_bf16 v[28:31], a[212:215], v[180:183], v[28:31]
  s_cmp_eq_u32 s39, s54
  s_cselect_b32 s39, 1, 0
  ds_read_b64_tr_b16 a[252:253], v233 offset:224
  v_cvt_pk_bf16_f32 v86, v44, v45
  v_mfma_f32_16x16x32_bf16 v[28:31], a[216:219], v[184:187], v[28:31]
  v_exp_f32 v47, v47
  v_mfma_f32_16x16x32_bf16 v[28:31], a[220:223], v[188:191], v[28:31]
  s_waitcnt lgkmcnt(2)
  ds_read_b64_tr_b16 a[254:255], v233 offset:736
  v_cvt_pk_bf16_f32 v83, v38, v39
  v_mfma_f32_16x16x32_bf16 a[0:3], a[224:227], v[64:67], 0
  v_exp_f32 v48, v48
  v_mfma_f32_16x16x32_bf16 a[32:35], a[224:227], v[68:71], 0
  s_lshr_b32 s36, s29, 3
  ds_read_b128 a[192:195], v232 offset:8448
  v_add_f32 v209, v209, v46
  v_mfma_f32_16x16x32_bf16 a[64:67], a[224:227], v[72:75], 0
  v_exp_f32 v49, v49
  v_mfma_f32_16x16x32_bf16 a[96:99], a[224:227], v[76:79], 0
  s_bfe_u32 s37, s29, 0x10002
  v_add_f32 v209, v209, v47
  v_cvt_pk_bf16_f32 v87, v46, v47
  v_mfma_f32_16x16x32_bf16 a[4:7], a[228:231], v[64:67], 0
  v_exp_f32 v50, v50
  v_mfma_f32_16x16x32_bf16 a[36:39], a[228:231], v[68:71], 0
  s_and_b32 s38, s29, 3
  ds_read_b128 a[196:199], v232 offset:8512
  v_add_f32 v210, v210, v48
  v_mfma_f32_16x16x32_bf16 a[68:71], a[228:231], v[72:75], 0
  v_exp_f32 v51, v51
  v_mfma_f32_16x16x32_bf16 a[100:103], a[228:231], v[76:79], 0
  s_lshl_b32 s31, s28, 2
  v_add_f32 v210, v210, v49
  v_cvt_pk_bf16_f32 v88, v48, v49
  v_mfma_f32_16x16x32_bf16 a[8:11], a[232:235], v[64:67], 0
  v_exp_f32 v52, v52
  v_mfma_f32_16x16x32_bf16 a[40:43], a[232:235], v[68:71], 0
  s_add_u32 s31, s31, s36
  ds_read_b128 a[200:203], v232 offset:8576
  v_add_f32 v210, v210, v50
  v_mfma_f32_16x16x32_bf16 a[72:75], a[232:235], v[72:75], 0
  v_exp_f32 v53, v53
  v_mfma_f32_16x16x32_bf16 a[104:107], a[232:235], v[76:79], 0
  s_lshl_b32 s31, s31, 7
  v_add_f32 v210, v210, v51
  v_cvt_pk_bf16_f32 v89, v50, v51
  v_mfma_f32_16x16x32_bf16 a[12:15], a[236:239], v[64:67], 0
  v_exp_f32 v54, v54
  v_mfma_f32_16x16x32_bf16 a[44:47], a[236:239], v[68:71], 0
  s_add_u32 s33, s43, s32
  ds_read_b128 a[204:207], v232 offset:8640
  v_add_f32 v210, v210, v52
  v_mfma_f32_16x16x32_bf16 a[76:79], a[236:239], v[72:75], 0
  s_add_u32 m0, s33, 16896
  v_exp_f32 v55, v55
  v_mfma_f32_16x16x32_bf16 a[108:111], a[236:239], v[76:79], 0
  s_add_u32 s31, s31, 0x3000000
  buffer_load_dwordx4 v240, s[20:23], s47 offen offset:0 nt lds
  v_mfma_f32_16x16x32_bf16 a[16:19], a[240:243], v[64:67], 0
  s_lshl_b32 s30, s28, 3
  v_exp_f32 v56, v56
  v_mfma_f32_16x16x32_bf16 a[48:51], a[240:243], v[68:71], 0
  s_and_b32 s92, s29, 7
  buffer_load_dwordx4 v241, s[20:23], s47 offen offset:1056 nt lds
  v_mfma_f32_16x16x32_bf16 a[80:83], a[240:243], v[72:75], 0
  v_exp_f32 v57, v57
  v_mfma_f32_16x16x32_bf16 a[112:115], a[240:243], v[76:79], 0
  s_add_u32 s30, s30, s92
  buffer_load_dwordx4 v242, s[20:23], s47 offen offset:2112 nt lds
  v_mfma_f32_16x16x32_bf16 a[20:23], a[244:247], v[64:67], 0
  v_exp_f32 v58, v58
  v_mfma_f32_16x16x32_bf16 a[52:55], a[244:247], v[68:71], 0
  s_lshl_b32 s30, s30, 9
  buffer_load_dwordx4 v243, s[20:23], s47 offen offset:3168 nt lds
  v_mfma_f32_16x16x32_bf16 a[84:87], a[244:247], v[72:75], 0
  v_exp_f32 v59, v59
  v_mfma_f32_16x16x32_bf16 a[116:119], a[244:247], v[76:79], 0
  s_add_u32 s30, s30, 0x3001000
  s_waitcnt lgkmcnt(0)
  ds_read_b128 a[208:211], v232 offset:8960
  v_add_f32 v210, v210, v53
  v_cvt_pk_bf16_f32 v90, v52, v53
  v_mfma_f32_16x16x32_bf16 a[24:27], a[248:251], v[64:67], 0
  v_exp_f32 v60, v60
  v_mfma_f32_16x16x32_bf16 a[56:59], a[248:251], v[68:71], 0
  s_lshl_b32 s94, s92, 1
  ds_read_b128 a[212:215], v232 offset:9024
  v_add_f32 v210, v210, v54
  v_add_f32 v210, v210, v55
  v_mfma_f32_16x16x32_bf16 a[88:91], a[248:251], v[72:75], 0
  v_exp_f32 v61, v61
  v_mfma_f32_16x16x32_bf16 a[120:123], a[248:251], v[76:79], 0
  s_lshl_b32 s92, s36, 20
  ds_read_b128 a[216:219], v232 offset:9088
  v_cvt_pk_bf16_f32 v91, v54, v55
  v_add_f32 v211, v211, v56
  v_mfma_f32_16x16x32_bf16 a[28:31], a[252:255], v[64:67], 0
  v_exp_f32 v62, v62
  v_mfma_f32_16x16x32_bf16 a[60:63], a[252:255], v[68:71], 0
  s_lshl_b32 s93, s38, 8
  ds_read_b128 a[220:223], v232 offset:9152
  v_add_f32 v211, v211, v57
  v_cvt_pk_bf16_f32 v92, v56, v57
  v_mfma_f32_16x16x32_bf16 a[92:95], a[252:255], v[72:75], 0
  v_exp_f32 v63, v63
  v_mfma_f32_16x16x32_bf16 a[124:127], a[252:255], v[76:79], 0
  s_add_u32 s92, s92, s93
  v_add_f32 v211, v211, v58
  v_add_f32 v211, v211, v59
  v_cvt_pk_bf16_f32 v93, v58, v59
  v_mfma_f32_16x16x32_bf16 v[96:99], a[128:131], v[64:67], 0
  v_add_f32 v211, v211, v60
  v_add_f32 v211, v211, v61
  v_cvt_pk_bf16_f32 v94, v60, v61
  v_mfma_f32_16x16x32_bf16 v[32:35], a[192:195], v[128:131], v[192:195]
  s_sub_u32 s93, 1048704, s93
  v_exp_f32 v0, v0
  v_mfma_f32_16x16x32_bf16 v[32:35], a[196:199], v[132:135], v[32:35]
  ds_read_b64_tr_b16 a[224:225], v233 offset:8448
  v_add_f32 v211, v211, v62
  v_mfma_f32_16x16x32_bf16 v[32:35], a[200:203], v[136:139], v[32:35]
  s_add_u32 s12, s56, s92
  s_addc_u32 s13, s57, 0
  v_exp_f32 v1, v1
  v_mfma_f32_16x16x32_bf16 v[32:35], a[204:207], v[140:143], v[32:35]
  s_waitcnt lgkmcnt(1)
  ds_read_b64_tr_b16 a[226:227], v233 offset:8960
  v_add_f32 v211, v211, v63
  v_mfma_f32_16x16x32_bf16 v[36:39], a[208:211], v[128:131], v[192:195]
  v_exp_f32 v8, v8
  v_mfma_f32_16x16x32_bf16 v[36:39], a[212:215], v[132:135], v[36:39]
  ds_read_b64_tr_b16 a[228:229], v233 offset:8480
  v_cvt_pk_bf16_f32 v95, v62, v63
  v_mfma_f32_16x16x32_bf16 v[36:39], a[216:219], v[136:139], v[36:39]
  s_sub_u32 s12, s12, 128
  s_subb_u32 s13, s13, 0
  v_exp_f32 v9, v9
  v_mfma_f32_16x16x32_bf16 v[36:39], a[220:223], v[140:143], v[36:39]
  ds_read_b64_tr_b16 a[230:231], v233 offset:8992
  v_cvt_pk_bf16_f32 v64, v0, v1
  v_mfma_f32_16x16x32_bf16 v[40:43], a[192:195], v[144:147], v[196:199]
  v_exp_f32 v2, v2
  v_mfma_f32_16x16x32_bf16 v[40:43], a[196:199], v[148:151], v[40:43]
  ds_read_b64_tr_b16 a[232:233], v233 offset:8512
  v_add_f32 v209, v209, v8
  v_mfma_f32_16x16x32_bf16 v[40:43], a[200:203], v[152:155], v[40:43]
  s_mov_b32 s14, s93
  v_exp_f32 v3, v3
  v_mfma_f32_16x16x32_bf16 v[40:43], a[204:207], v[156:159], v[40:43]
  ds_read_b64_tr_b16 a[234:235], v233 offset:9024
  v_add_f32 v209, v209, v9
  v_mfma_f32_16x16x32_bf16 v[44:47], a[208:211], v[144:147], v[196:199]
  s_mov_b32 s15, 0x20000
  v_exp_f32 v10, v10
  v_mfma_f32_16x16x32_bf16 v[44:47], a[212:215], v[148:151], v[44:47]
  ds_read_b64_tr_b16 a[236:237], v233 offset:8544
  v_cvt_pk_bf16_f32 v68, v8, v9
  v_mfma_f32_16x16x32_bf16 v[44:47], a[216:219], v[152:155], v[44:47]
  v_exp_f32 v11, v11
  v_mfma_f32_16x16x32_bf16 v[44:47], a[220:223], v[156:159], v[44:47]
  ds_read_b64_tr_b16 a[238:239], v233 offset:9056
  v_cvt_pk_bf16_f32 v65, v2, v3
  v_mfma_f32_16x16x32_bf16 v[48:51], a[192:195], v[160:163], v[200:203]
  v_exp_f32 v4, v4
  v_mfma_f32_16x16x32_bf16 v[48:51], a[196:199], v[164:167], v[48:51]
  ds_read_b64_tr_b16 a[240:241], v233 offset:8576
  v_add_f32 v209, v209, v10
  v_mfma_f32_16x16x32_bf16 v[48:51], a[200:203], v[168:171], v[48:51]
  v_exp_f32 v5, v5
  v_mfma_f32_16x16x32_bf16 v[48:51], a[204:207], v[172:175], v[48:51]
  ds_read_b64_tr_b16 a[242:243], v233 offset:9088
  v_add_f32 v209, v209, v11
  v_mfma_f32_16x16x32_bf16 v[52:55], a[208:211], v[160:163], v[200:203]
  v_exp_f32 v12, v12
  v_mfma_f32_16x16x32_bf16 v[52:55], a[212:215], v[164:167], v[52:55]
  ds_read_b64_tr_b16 a[244:245], v233 offset:8608
  v_cvt_pk_bf16_f32 v69, v10, v11
  v_mfma_f32_16x16x32_bf16 v[52:55], a[216:219], v[168:171], v[52:55]
  v_exp_f32 v13, v13
  v_mfma_f32_16x16x32_bf16 v[52:55], a[220:223], v[172:175], v[52:55]
  ds_read_b64_tr_b16 a[246:247], v233 offset:9120
  v_cvt_pk_bf16_f32 v66, v4, v5
  v_mfma_f32_16x16x32_bf16 v[56:59], a[192:195], v[176:179], v[204:207]
  v_exp_f32 v6, v6
  v_mfma_f32_16x16x32_bf16 v[56:59], a[196:199], v[180:183], v[56:59]
  ds_read_b64_tr_b16 a[248:249], v233 offset:8640
  v_add_f32 v209, v209, v12
  v_mfma_f32_16x16x32_bf16 v[56:59], a[200:203], v[184:187], v[56:59]
  v_exp_f32 v7, v7
  v_mfma_f32_16x16x32_bf16 v[56:59], a[204:207], v[188:191], v[56:59]
  ds_read_b64_tr_b16 a[250:251], v233 offset:9152
  v_add_f32 v209, v209, v13
  v_mfma_f32_16x16x32_bf16 v[60:63], a[208:211], v[176:179], v[204:207]
  s_add_u32 s47, s47, 16384
  v_exp_f32 v14, v14
  v_mfma_f32_16x16x32_bf16 v[60:63], a[212:215], v[180:183], v[60:63]
  s_waitcnt vmcnt(14)
  ds_read_b64_tr_b16 a[252:253], v233 offset:8672
  v_cvt_pk_bf16_f32 v70, v12, v13
  v_mfma_f32_16x16x32_bf16 v[60:63], a[216:219], v[184:187], v[60:63]
  s_barrier
  v_exp_f32 v15, v15
  v_mfma_f32_16x16x32_bf16 v[60:63], a[220:223], v[188:191], v[60:63]
  s_waitcnt lgkmcnt(1)
  ds_read_b64_tr_b16 a[254:255], v233 offset:9184
  v_cvt_pk_bf16_f32 v67, v6, v7
  v_add_u32 v232, s49, v234
  v_mfma_f32_16x16x32_bf16 a[0:3], a[224:227], v[80:83], a[0:3]
  v_exp_f32 v16, v16
  v_mfma_f32_16x16x32_bf16 a[32:35], a[224:227], v[84:87], a[32:35]
  ds_read_b128 a[192:195], v232 offset:0
  v_add_f32 v209, v209, v14
  v_mfma_f32_16x16x32_bf16 a[64:67], a[224:227], v[88:91], a[64:67]
  v_exp_f32 v17, v17
  v_mfma_f32_16x16x32_bf16 a[96:99], a[224:227], v[92:95], a[96:99]
  v_add_f32 v209, v209, v15
  v_cvt_pk_bf16_f32 v71, v14, v15
  v_add_f32 v210, v210, v16
  v_mfma_f32_16x16x32_bf16 a[4:7], a[228:231], v[80:83], a[4:7]
  v_exp_f32 v18, v18
  v_mfma_f32_16x16x32_bf16 a[36:39], a[228:231], v[84:87], a[36:39]
  ds_read_b128 a[196:199], v232 offset:64
  v_add_u32 v233, s41, v235
  v_mfma_f32_16x16x32_bf16 a[68:71], a[228:231], v[88:91], a[68:71]
  v_exp_f32 v19, v19
  v_mfma_f32_16x16x32_bf16 a[100:103], a[228:231], v[92:95], a[100:103]
  v_add_f32 v210, v210, v17
  v_cvt_pk_bf16_f32 v72, v16, v17
  v_mfma_f32_16x16x32_bf16 a[8:11], a[232:235], v[80:83], a[8:11]
  v_exp_f32 v20, v20
  v_mfma_f32_16x16x32_bf16 a[40:43], a[232:235], v[84:87], a[40:43]
  ds_read_b128 a[200:203], v232 offset:128
  v_add_f32 v210, v210, v18
  v_mfma_f32_16x16x32_bf16 a[72:75], a[232:235], v[88:91], a[72:75]
  v_exp_f32 v21, v21
  v_mfma_f32_16x16x32_bf16 a[104:107], a[232:235], v[92:95], a[104:107]
  v_add_f32 v210, v210, v19
  v_cvt_pk_bf16_f32 v73, v18, v19
  v_mfma_f32_16x16x32_bf16 a[12:15], a[236:239], v[80:83], a[12:15]
  v_exp_f32 v22, v22
  v_mfma_f32_16x16x32_bf16 a[44:47], a[236:239], v[84:87], a[44:47]
  ds_read_b128 a[204:207], v232 offset:192
  v_add_f32 v210, v210, v20
  v_mfma_f32_16x16x32_bf16 a[76:79], a[236:239], v[88:91], a[76:79]
  v_exp_f32 v23, v23
  v_mfma_f32_16x16x32_bf16 a[108:111], a[236:239], v[92:95], a[108:111]
  s_mov_b32 s35, s40
  ds_read_b128 a[208:211], v232 offset:512
  v_add_f32 v210, v210, v21
  v_cvt_pk_bf16_f32 v74, v20, v21
  v_mfma_f32_16x16x32_bf16 a[16:19], a[240:243], v[80:83], a[16:19]
  s_mov_b32 s40, s41
  v_exp_f32 v24, v24
  v_mfma_f32_16x16x32_bf16 a[48:51], a[240:243], v[84:87], a[48:51]
  s_mov_b32 s41, s42
  v_add_f32 v210, v210, v22
  v_add_f32 v210, v210, v23
  v_mfma_f32_16x16x32_bf16 a[80:83], a[240:243], v[88:91], a[80:83]
  s_mov_b32 s42, s43
  v_exp_f32 v25, v25
  v_mfma_f32_16x16x32_bf16 a[112:115], a[240:243], v[92:95], a[112:115]
  s_mov_b32 s43, s7
  ds_read_b128 a[212:215], v232 offset:576
  v_cvt_pk_bf16_f32 v75, v22, v23
  v_mfma_f32_16x16x32_bf16 a[20:23], a[244:247], v[80:83], a[20:23]
  s_mov_b32 s7, s35
  v_exp_f32 v26, v26
  v_mfma_f32_16x16x32_bf16 a[52:55], a[244:247], v[84:87], a[52:55]
  v_add_f32 v211, v211, v24
  v_add_f32 v211, v211, v25
  v_mfma_f32_16x16x32_bf16 a[84:87], a[244:247], v[88:91], a[84:87]
  v_exp_f32 v27, v27
  v_mfma_f32_16x16x32_bf16 a[116:119], a[244:247], v[92:95], a[116:119]
  ds_read_b128 a[216:219], v232 offset:640
  v_cvt_pk_bf16_f32 v76, v24, v25
  v_mfma_f32_16x16x32_bf16 a[24:27], a[248:251], v[80:83], a[24:27]
  s_mov_b32 s98, s48
  v_exp_f32 v28, v28
  v_mfma_f32_16x16x32_bf16 a[56:59], a[248:251], v[84:87], a[56:59]
  s_mov_b32 s48, s49
  v_add_f32 v211, v211, v26
  v_add_f32 v211, v211, v27
  v_mfma_f32_16x16x32_bf16 a[88:91], a[248:251], v[88:91], a[88:91]
  s_mov_b32 s49, s50
  v_exp_f32 v29, v29
  v_mfma_f32_16x16x32_bf16 a[120:123], a[248:251], v[92:95], a[120:123]
  s_add_u32 s50, s50, 33792
  s_waitcnt lgkmcnt(0)
  ds_read_b128 a[220:223], v232 offset:704
  v_cvt_pk_bf16_f32 v77, v26, v27
  v_mfma_f32_16x16x32_bf16 a[28:31], a[252:255], v[80:83], a[28:31]
  s_cmp_eq_u32 s50, 135168
  s_cselect_b32 s50, 0, s50
  v_exp_f32 v30, v30
  v_mfma_f32_16x16x32_bf16 a[60:63], a[252:255], v[84:87], a[60:63]
  v_add_f32 v211, v211, v28
  v_add_f32 v211, v211, v29
  v_mfma_f32_16x16x32_bf16 a[92:95], a[252:255], v[88:91], a[92:95]
  s_add_u32 s51, s51, 1
  v_exp_f32 v31, v31
  v_mfma_f32_16x16x32_bf16 a[124:127], a[252:255], v[92:95], a[124:127]
  s_cmp_lt_u32 s51, 12
  v_cvt_pk_bf16_f32 v78, v28, v29
  v_add_f32 v211, v211, v30
  v_mfma_f32_16x16x32_bf16 v[96:99], a[128:131], v[80:83], v[96:99]
  v_add_f32 v211, v211, v31
  v_cvt_pk_bf16_f32 v79, v30, v31
L_w012_loop:
  v_mfma_f32_16x16x32_bf16 v[0:3], a[192:195], v[128:131], v[192:195]
  v_exp_f32 v32, v32
  v_mfma_f32_16x16x32_bf16 v[0:3], a[196:199], v[132:135], v[0:3]
  ds_read_b64_tr_b16 a[224:225], v233 offset:0
  v_mfma_f32_16x16x32_bf16 v[0:3], a[200:203], v[136:139], v[0:3]
  v_exp_f32 v33, v33
  v_mfma_f32_16x16x32_bf16 v[0:3], a[204:207], v[140:143], v[0:3]
  ds_read_b64_tr_b16 a[226:227], v233 offset:512
  v_cvt_pk_bf16_f32 v80, v32, v33
  v_mfma_f32_16x16x32_bf16 v[4:7], a[208:211], v[128:131], v[192:195]
  s_waitcnt lgkmcnt(2)
  v_exp_f32 v40, v40
  v_mfma_f32_16x16x32_bf16 v[4:7], a[212:215], v[132:135], v[4:7]
  ds_read_b64_tr_b16 a[228:229], v233 offset:32
  v_add_f32 v209, v209, v40
  v_mfma_f32_16x16x32_bf16 v[4:7], a[216:219], v[136:139], v[4:7]
  v_exp_f32 v41, v41
  v_mfma_f32_16x16x32_bf16 v[4:7], a[220:223], v[140:143], v[4:7]
  ds_read_b64_tr_b16 a[230:231], v233 offset:544
  v_add_f32 v209, v209, v41
  v_mfma_f32_16x16x32_bf16 v[8:11], a[192:195], v[144:147], v[196:199]
  v_exp_f32 v34, v34
  v_mfma_f32_16x16x32_bf16 v[8:11], a[196:199], v[148:151], v[8:11]
  ds_read_b64_tr_b16 a[232:233], v233 offset:64
  v_cvt_pk_bf16_f32 v84, v40, v41
  v_mfma_f32_16x16x32_bf16 v[8:11], a[200:203], v[152:155], v[8:11]
  v_exp_f32 v35, v35
  v_mfma_f32_16x16x32_bf16 v[8:11], a[204:207], v[156:159], v[8:11]
  ds_read_b64_tr_b16 a[234:235], v233 offset:576
  v_cvt_pk_bf16_f32 v81, v34, v35
  v_mfma_f32_16x16x32_bf16 v[12:15], a[208:211], v[144:147], v[196:199]
  v_exp_f32 v42, v42
  v_mfma_f32_16x16x32_bf16 v[12:15], a[212:215], v[148:151], v[12:15]
  ds_read_b64_tr_b16 a[236:237], v233 offset:96
  v_add_f32 v209, v209, v42
  v_mfma_f32_16x16x32_bf16 v[12:15], a[216:219], v[152:155], v[12:15]
  v_exp_f32 v43, v43
  v_mfma_f32_16x16x32_bf16 v[12:15], a[220:223], v[156:159], v[12:15]
  ds_read_b64_tr_b16 a[238:239], v233 offset:608
  v_add_f32 v209, v209, v43
  v_mfma_f32_16x16x32_bf16 v[16:19], a[192:195], v[160:163], v[200:203]
  v_exp_f32 v36, v36
  v_mfma_f32_16x16x32_bf16 v[16:19], a[196:199], v[164:167], v[16:19]
  ds_read_b64_tr_b16 a[240:241], v233 offset:128
  v_cvt_pk_bf16_f32 v85, v42, v43
  v_mfma_f32_16x16x32_bf16 v[16:19], a[200:203], v[168:171], v[16:19]
  v_exp_f32 v37, v37
  v_mfma_f32_16x16x32_bf16 v[16:19], a[204:207], v[172:175], v[16:19]
  ds_read_b64_tr_b16 a[242:243], v233 offset:640
  v_cvt_pk_bf16_f32 v82, v36, v37
  v_mfma_f32_16x16x32_bf16 v[20:23], a[208:211], v[160:163], v[200:203]
  v_exp_f32 v44, v44
  v_mfma_f32_16x16x32_bf16 v[20:23], a[212:215], v[164:167], v[20:23]
  ds_read_b64_tr_b16 a[244:245], v233 offset:160
  v_add_f32 v209, v209, v44
  v_mfma_f32_16x16x32_bf16 v[20:23], a[216:219], v[168:171], v[20:23]
  v_exp_f32 v45, v45
  v_mfma_f32_16x16x32_bf16 v[20:23], a[220:223], v[172:175], v[20:23]
  ds_read_b64_tr_b16 a[246:247], v233 offset:672
  v_add_f32 v209, v209, v45
  v_mfma_f32_16x16x32_bf16 v[24:27], a[192:195], v[176:179], v[204:207]
  v_exp_f32 v38, v38
  v_mfma_f32_16x16x32_bf16 v[24:27], a[196:199], v[180:183], v[24:27]
  ds_read_b64_tr_b16 a[248:249], v233 offset:192
  v_cvt_pk_bf16_f32 v86, v44, v45
  v_mfma_f32_16x16x32_bf16 v[24:27], a[200:203], v[184:187], v[24:27]
  v_exp_f32 v39, v39
  v_mfma_f32_16x16x32_bf16 v[24:27], a[204:207], v[188:191], v[24:27]
  ds_read_b64_tr_b16 a[250:251], v233 offset:704
  v_cvt_pk_bf16_f32 v83, v38, v39
  v_mfma_f32_16x16x32_bf16 v[28:31], a[208:211], v[176:179], v[204:207]
  v_exp_f32 v46, v46
  v_mfma_f32_16x16x32_bf16 v[28:31], a[212:215], v[180:183], v[28:31]
  ds_read_b64_tr_b16 a[252:253], v233 offset:224
  v_add_f32 v209, v209, v46
  v_mfma_f32_16x16x32_bf16 v[28:31], a[216:219], v[184:187], v[28:31]
  v_exp_f32 v47, v47
  v_mfma_f32_16x16x32_bf16 v[28:31], a[220:223], v[188:191], v[28:31]
  s_waitcnt lgkmcnt(2)
  ds_read_b64_tr_b16 a[254:255], v233 offset:736
  v_add_f32 v209, v209, v47
  v_mfma_f32_16x16x32_bf16 a[0:3], a[224:227], v[64:67], a[0:3]
  v_exp_f32 v48, v48
  v_mfma_f32_16x16x32_bf16 a[32:35], a[224:227], v[68:71], a[32:35]
  ds_read_b128 a[192:195], v232 offset:8448
  v_cvt_pk_bf16_f32 v87, v46, v47
  v_mfma_f32_16x16x32_bf16 a[64:67], a[224:227], v[72:75], a[64:67]
  v_exp_f32 v49, v49
  v_mfma_f32_16x16x32_bf16 a[96:99], a[224:227], v[76:79], a[96:99]
  v_add_f32 v210, v210, v48
  v_add_f32 v210, v210, v49
  v_mfma_f32_16x16x32_bf16 a[4:7], a[228:231], v[64:67], a[4:7]
  v_exp_f32 v50, v50
  v_mfma_f32_16x16x32_bf16 a[36:39], a[228:231], v[68:71], a[36:39]
  ds_read_b128 a[196:199], v232 offset:8512
  v_cvt_pk_bf16_f32 v88, v48, v49
  v_mfma_f32_16x16x32_bf16 a[68:71], a[228:231], v[72:75], a[68:71]
  v_exp_f32 v51, v51
  v_mfma_f32_16x16x32_bf16 a[100:103], a[228:231], v[76:79], a[100:103]
  v_add_f32 v210, v210, v50
  v_add_f32 v210, v210, v51
  v_mfma_f32_16x16x32_bf16 a[8:11], a[232:235], v[64:67], a[8:11]
  v_exp_f32 v52, v52
  v_mfma_f32_16x16x32_bf16 a[40:43], a[232:235], v[68:71], a[40:43]
  ds_read_b128 a[200:203], v232 offset:8576
  v_cvt_pk_bf16_f32 v89, v50, v51
  v_mfma_f32_16x16x32_bf16 a[72:75], a[232:235], v[72:75], a[72:75]
  v_exp_f32 v53, v53
  v_mfma_f32_16x16x32_bf16 a[104:107], a[232:235], v[76:79], a[104:107]
  v_add_f32 v210, v210, v52
  v_add_f32 v210, v210, v53
  v_mfma_f32_16x16x32_bf16 a[12:15], a[236:239], v[64:67], a[12:15]
  v_exp_f32 v54, v54
  v_mfma_f32_16x16x32_bf16 a[44:47], a[236:239], v[68:71], a[44:47]
  s_add_u32 s33, s43, s32
  ds_read_b128 a[204:207], v232 offset:8640
  v_cvt_pk_bf16_f32 v90, v52, v53
  v_mfma_f32_16x16x32_bf16 a[76:79], a[236:239], v[72:75], a[76:79]
  s_add_u32 m0, s33, 16896
  v_exp_f32 v55, v55
  v_mfma_f32_16x16x32_bf16 a[108:111], a[236:239], v[76:79], a[108:111]
  buffer_load_dwordx4 v240, s[20:23], s47 offen offset:0 nt lds
  v_mfma_f32_16x16x32_bf16 a[16:19], a[240:243], v[64:67], a[16:19]
  v_exp_f32 v56, v56
  v_mfma_f32_16x16x32_bf16 a[48:51], a[240:243], v[68:71], a[48:51]
  buffer_load_dwordx4 v241, s[20:23], s47 offen offset:1056 nt lds
  v_mfma_f32_16x16x32_bf16 a[80:83], a[240:243], v[72:75], a[80:83]
  v_exp_f32 v57, v57
  v_mfma_f32_16x16x32_bf16 a[112:115], a[240:243], v[76:79], a[112:115]
  buffer_load_dwordx4 v242, s[20:23], s47 offen offset:2112 nt lds
  v_mfma_f32_16x16x32_bf16 a[20:23], a[244:247], v[64:67], a[20:23]
  v_exp_f32 v58, v58
  v_mfma_f32_16x16x32_bf16 a[52:55], a[244:247], v[68:71], a[52:55]
  buffer_load_dwordx4 v243, s[20:23], s47 offen offset:3168 nt lds
  v_mfma_f32_16x16x32_bf16 a[84:87], a[244:247], v[72:75], a[84:87]
  v_exp_f32 v59, v59
  v_mfma_f32_16x16x32_bf16 a[116:119], a[244:247], v[76:79], a[116:119]
  s_waitcnt lgkmcnt(0)
  ds_read_b128 a[208:211], v232 offset:8960
  v_add_f32 v210, v210, v54
  v_add_f32 v210, v210, v55
  v_mfma_f32_16x16x32_bf16 a[24:27], a[248:251], v[64:67], a[24:27]
  v_exp_f32 v60, v60
  v_mfma_f32_16x16x32_bf16 a[56:59], a[248:251], v[68:71], a[56:59]
  ds_read_b128 a[212:215], v232 offset:9024
  v_cvt_pk_bf16_f32 v91, v54, v55
  v_add_f32 v211, v211, v56
  v_mfma_f32_16x16x32_bf16 a[88:91], a[248:251], v[72:75], a[88:91]
  v_exp_f32 v61, v61
  v_mfma_f32_16x16x32_bf16 a[120:123], a[248:251], v[76:79], a[120:123]
  ds_read_b128 a[216:219], v232 offset:9088
  v_add_f32 v211, v211, v57
  v_cvt_pk_bf16_f32 v92, v56, v57
  v_mfma_f32_16x16x32_bf16 a[28:31], a[252:255], v[64:67], a[28:31]
  v_exp_f32 v62, v62
  v_mfma_f32_16x16x32_bf16 a[60:63], a[252:255], v[68:71], a[60:63]
  ds_read_b128 a[220:223], v232 offset:9152
  v_add_f32 v211, v211, v58
  v_add_f32 v211, v211, v59
  v_mfma_f32_16x16x32_bf16 a[92:95], a[252:255], v[72:75], a[92:95]
  v_exp_f32 v63, v63
  v_mfma_f32_16x16x32_bf16 a[124:127], a[252:255], v[76:79], a[124:127]
  v_cvt_pk_bf16_f32 v93, v58, v59
  v_add_f32 v211, v211, v60
  v_add_f32 v211, v211, v61
  v_mfma_f32_16x16x32_bf16 v[96:99], a[128:131], v[64:67], v[96:99]
  v_cvt_pk_bf16_f32 v94, v60, v61
  v_add_f32 v211, v211, v62
  v_mfma_f32_16x16x32_bf16 v[32:35], a[192:195], v[128:131], v[192:195]
  v_exp_f32 v0, v0
  v_mfma_f32_16x16x32_bf16 v[32:35], a[196:199], v[132:135], v[32:35]
  ds_read_b64_tr_b16 a[224:225], v233 offset:8448
  v_add_f32 v211, v211, v63
  v_mfma_f32_16x16x32_bf16 v[32:35], a[200:203], v[136:139], v[32:35]
  v_exp_f32 v1, v1
  v_mfma_f32_16x16x32_bf16 v[32:35], a[204:207], v[140:143], v[32:35]
  s_waitcnt lgkmcnt(1)
  ds_read_b64_tr_b16 a[226:227], v233 offset:8960
  v_cvt_pk_bf16_f32 v95, v62, v63
  v_mfma_f32_16x16x32_bf16 v[36:39], a[208:211], v[128:131], v[192:195]
  v_exp_f32 v8, v8
  v_mfma_f32_16x16x32_bf16 v[36:39], a[212:215], v[132:135], v[36:39]
  ds_read_b64_tr_b16 a[228:229], v233 offset:8480
  v_cvt_pk_bf16_f32 v64, v0, v1
  v_mfma_f32_16x16x32_bf16 v[36:39], a[216:219], v[136:139], v[36:39]
  v_exp_f32 v9, v9
  v_mfma_f32_16x16x32_bf16 v[36:39], a[220:223], v[140:143], v[36:39]
  ds_read_b64_tr_b16 a[230:231], v233 offset:8992
  v_add_f32 v209, v209, v8
  v_mfma_f32_16x16x32_bf16 v[40:43], a[192:195], v[144:147], v[196:199]
  v_exp_f32 v2, v2
  v_mfma_f32_16x16x32_bf16 v[40:43], a[196:199], v[148:151], v[40:43]
  ds_read_b64_tr_b16 a[232:233], v233 offset:8512
  v_add_f32 v209, v209, v9
  v_mfma_f32_16x16x32_bf16 v[40:43], a[200:203], v[152:155], v[40:43]
  v_exp_f32 v3, v3
  v_mfma_f32_16x16x32_bf16 v[40:43], a[204:207], v[156:159], v[40:43]
  ds_read_b64_tr_b16 a[234:235], v233 offset:9024
  v_cvt_pk_bf16_f32 v68, v8, v9
  v_mfma_f32_16x16x32_bf16 v[44:47], a[208:211], v[144:147], v[196:199]
  v_exp_f32 v10, v10
  v_mfma_f32_16x16x32_bf16 v[44:47], a[212:215], v[148:151], v[44:47]
  ds_read_b64_tr_b16 a[236:237], v233 offset:8544
  v_cvt_pk_bf16_f32 v65, v2, v3
  v_mfma_f32_16x16x32_bf16 v[44:47], a[216:219], v[152:155], v[44:47]
  v_exp_f32 v11, v11
  v_mfma_f32_16x16x32_bf16 v[44:47], a[220:223], v[156:159], v[44:47]
  ds_read_b64_tr_b16 a[238:239], v233 offset:9056
  v_add_f32 v209, v209, v10
  v_mfma_f32_16x16x32_bf16 v[48:51], a[192:195], v[160:163], v[200:203]
  v_exp_f32 v4, v4
  v_mfma_f32_16x16x32_bf16 v[48:51], a[196:199], v[164:167], v[48:51]
  ds_read_b64_tr_b16 a[240:241], v233 offset:8576
  v_add_f32 v209, v209, v11
  v_mfma_f32_16x16x32_bf16 v[48:51], a[200:203], v[168:171], v[48:51]
  v_exp_f32 v5, v5
  v_mfma_f32_16x16x32_bf16 v[48:51], a[204:207], v[172:175], v[48:51]
  ds_read_b64_tr_b16 a[242:243], v233 offset:9088
  v_cvt_pk_bf16_f32 v69, v10, v11
  v_mfma_f32_16x16x32_bf16 v[52:55], a[208:211], v[160:163], v[200:203]
  v_exp_f32 v12, v12
  v_mfma_f32_16x16x32_bf16 v[52:55], a[212:215], v[164:167], v[52:55]
  ds_read_b64_tr_b16 a[244:245], v233 offset:8608
  v_cvt_pk_bf16_f32 v66, v4, v5
  v_mfma_f32_16x16x32_bf16 v[52:55], a[216:219], v[168:171], v[52:55]
  v_exp_f32 v13, v13
  v_mfma_f32_16x16x32_bf16 v[52:55], a[220:223], v[172:175], v[52:55]
  ds_read_b64_tr_b16 a[246:247], v233 offset:9120
  v_add_f32 v209, v209, v12
  v_mfma_f32_16x16x32_bf16 v[56:59], a[192:195], v[176:179], v[204:207]
  v_exp_f32 v6, v6
  v_mfma_f32_16x16x32_bf16 v[56:59], a[196:199], v[180:183], v[56:59]
  ds_read_b64_tr_b16 a[248:249], v233 offset:8640
  v_add_f32 v209, v209, v13
  v_mfma_f32_16x16x32_bf16 v[56:59], a[200:203], v[184:187], v[56:59]
  v_exp_f32 v7, v7
  v_mfma_f32_16x16x32_bf16 v[56:59], a[204:207], v[188:191], v[56:59]
  ds_read_b64_tr_b16 a[250:251], v233 offset:9152
  v_cvt_pk_bf16_f32 v70, v12, v13
  v_mfma_f32_16x16x32_bf16 v[60:63], a[208:211], v[176:179], v[204:207]
  s_add_u32 s47, s47, 16384
  v_exp_f32 v14, v14
  v_mfma_f32_16x16x32_bf16 v[60:63], a[212:215], v[180:183], v[60:63]
  s_waitcnt vmcnt(8)
  ds_read_b64_tr_b16 a[252:253], v233 offset:8672
  v_cvt_pk_bf16_f32 v67, v6, v7
  v_mfma_f32_16x16x32_bf16 v[60:63], a[216:219], v[184:187], v[60:63]
  s_barrier
  v_exp_f32 v15, v15
  v_mfma_f32_16x16x32_bf16 v[60:63], a[220:223], v[188:191], v[60:63]
  s_waitcnt lgkmcnt(2)
  ds_read_b64_tr_b16 a[254:255], v233 offset:9184
  v_add_u32 v232, s49, v234
  v_mfma_f32_16x16x32_bf16 a[0:3], a[224:227], v[80:83], a[0:3]
  v_exp_f32 v16, v16
  v_mfma_f32_16x16x32_bf16 a[32:35], a[224:227], v[84:87], a[32:35]
  ds_read_b128 a[192:195], v232 offset:0
  v_add_f32 v209, v209, v14
  v_mfma_f32_16x16x32_bf16 a[64:67], a[224:227], v[88:91], a[64:67]
  v_exp_f32 v17, v17
  v_mfma_f32_16x16x32_bf16 a[96:99], a[224:227], v[92:95], a[96:99]
  v_add_f32 v209, v209, v15
  v_cvt_pk_bf16_f32 v71, v14, v15
  v_add_f32 v210, v210, v16
  v_mfma_f32_16x16x32_bf16 a[4:7], a[228:231], v[80:83], a[4:7]
  v_exp_f32 v18, v18
  v_mfma_f32_16x16x32_bf16 a[36:39], a[228:231], v[84:87], a[36:39]
  ds_read_b128 a[196:199], v232 offset:64
  v_add_u32 v233, s41, v235
  v_mfma_f32_16x16x32_bf16 a[68:71], a[228:231], v[88:91], a[68:71]
  v_exp_f32 v19, v19
  v_mfma_f32_16x16x32_bf16 a[100:103], a[228:231], v[92:95], a[100:103]
  v_add_f32 v210, v210, v17
  v_cvt_pk_bf16_f32 v72, v16, v17
  v_mfma_f32_16x16x32_bf16 a[8:11], a[232:235], v[80:83], a[8:11]
  v_exp_f32 v20, v20
  v_mfma_f32_16x16x32_bf16 a[40:43], a[232:235], v[84:87], a[40:43]
  ds_read_b128 a[200:203], v232 offset:128
  v_add_f32 v210, v210, v18
  v_mfma_f32_16x16x32_bf16 a[72:75], a[232:235], v[88:91], a[72:75]
  v_exp_f32 v21, v21
  v_mfma_f32_16x16x32_bf16 a[104:107], a[232:235], v[92:95], a[104:107]
  v_add_f32 v210, v210, v19
  v_cvt_pk_bf16_f32 v73, v18, v19
  v_mfma_f32_16x16x32_bf16 a[12:15], a[236:239], v[80:83], a[12:15]
  v_exp_f32 v22, v22
  v_mfma_f32_16x16x32_bf16 a[44:47], a[236:239], v[84:87], a[44:47]
  ds_read_b128 a[204:207], v232 offset:192
  v_add_f32 v210, v210, v20
  v_mfma_f32_16x16x32_bf16 a[76:79], a[236:239], v[88:91], a[76:79]
  v_exp_f32 v23, v23
  v_mfma_f32_16x16x32_bf16 a[108:111], a[236:239], v[92:95], a[108:111]
  s_mov_b32 s35, s40
  ds_read_b128 a[208:211], v232 offset:512
  v_add_f32 v210, v210, v21
  v_cvt_pk_bf16_f32 v74, v20, v21
  v_mfma_f32_16x16x32_bf16 a[16:19], a[240:243], v[80:83], a[16:19]
  s_mov_b32 s40, s41
  v_exp_f32 v24, v24
  v_mfma_f32_16x16x32_bf16 a[48:51], a[240:243], v[84:87], a[48:51]
  s_mov_b32 s41, s42
  v_add_f32 v210, v210, v22
  v_add_f32 v210, v210, v23
  v_mfma_f32_16x16x32_bf16 a[80:83], a[240:243], v[88:91], a[80:83]
  s_mov_b32 s42, s43
  v_exp_f32 v25, v25
  v_mfma_f32_16x16x32_bf16 a[112:115], a[240:243], v[92:95], a[112:115]
  s_mov_b32 s43, s7
  ds_read_b128 a[212:215], v232 offset:576
  v_cvt_pk_bf16_f32 v75, v22, v23
  v_mfma_f32_16x16x32_bf16 a[20:23], a[244:247], v[80:83], a[20:23]
  s_mov_b32 s7, s35
  v_exp_f32 v26, v26
  v_mfma_f32_16x16x32_bf16 a[52:55], a[244:247], v[84:87], a[52:55]
  v_add_f32 v211, v211, v24
  v_add_f32 v211, v211, v25
  v_mfma_f32_16x16x32_bf16 a[84:87], a[244:247], v[88:91], a[84:87]
  v_exp_f32 v27, v27
  v_mfma_f32_16x16x32_bf16 a[116:119], a[244:247], v[92:95], a[116:119]
  s_waitcnt lgkmcnt(1)
  ds_read_b128 a[216:219], v232 offset:640
  v_cvt_pk_bf16_f32 v76, v24, v25
  v_mfma_f32_16x16x32_bf16 a[24:27], a[248:251], v[80:83], a[24:27]
  s_mov_b32 s98, s48
  v_exp_f32 v28, v28
  v_mfma_f32_16x16x32_bf16 a[56:59], a[248:251], v[84:87], a[56:59]
  s_mov_b32 s48, s49
  v_add_f32 v211, v211, v26
  v_add_f32 v211, v211, v27
  v_mfma_f32_16x16x32_bf16 a[88:91], a[248:251], v[88:91], a[88:91]
  s_mov_b32 s49, s50
  v_exp_f32 v29, v29
  v_mfma_f32_16x16x32_bf16 a[120:123], a[248:251], v[92:95], a[120:123]
  s_add_u32 s50, s50, 33792
  ds_read_b128 a[220:223], v232 offset:704
  v_cvt_pk_bf16_f32 v77, v26, v27
  v_mfma_f32_16x16x32_bf16 a[28:31], a[252:255], v[80:83], a[28:31]
  s_cmp_eq_u32 s50, 135168
  s_cselect_b32 s50, 0, s50
  v_exp_f32 v30, v30
  v_mfma_f32_16x16x32_bf16 a[60:63], a[252:255], v[84:87], a[60:63]
  v_add_f32 v211, v211, v28
  v_add_f32 v211, v211, v29
  v_mfma_f32_16x16x32_bf16 a[92:95], a[252:255], v[88:91], a[92:95]
  s_add_u32 s51, s51, 1
  v_exp_f32 v31, v31
  v_mfma_f32_16x16x32_bf16 a[124:127], a[252:255], v[92:95], a[124:127]
  s_cmp_lt_u32 s51, 12
  v_cvt_pk_bf16_f32 v78, v28, v29
  v_add_f32 v211, v211, v30
  v_mfma_f32_16x16x32_bf16 v[96:99], a[128:131], v[80:83], v[96:99]
  v_add_f32 v211, v211, v31
  v_cvt_pk_bf16_f32 v79, v30, v31
  s_cbranch_scc1 L_w012_loop
  s_add_u32 s93, s94, 0
  v_mfma_f32_16x16x32_bf16 v[0:3], a[192:195], v[128:131], v[192:195]
  s_and_b32 s93, s93, 15
  v_exp_f32 v32, v32
  v_mfma_f32_16x16x32_bf16 v[0:3], a[196:199], v[132:135], v[0:3]
  s_lshl_b32 s93, s93, 16
  ds_read_b64_tr_b16 a[224:225], v233 offset:0
  v_mfma_f32_16x16x32_bf16 v[0:3], a[200:203], v[136:139], v[0:3]
  s_add_u32 m0, s32, 0
  v_exp_f32 v33, v33
  v_mfma_f32_16x16x32_bf16 v[0:3], a[204:207], v[140:143], v[0:3]
  buffer_load_dwordx4 v252, s[12:15], s93 offen offset:0 lds
  v_mfma_f32_16x16x32_bf16 v[4:7], a[208:211], v[128:131], v[192:195]
  s_waitcnt lgkmcnt(1)
  v_exp_f32 v40, v40
  v_mfma_f32_16x16x32_bf16 v[4:7], a[212:215], v[132:135], v[4:7]
  ds_read_b64_tr_b16 a[226:227], v233 offset:512
  v_cvt_pk_bf16_f32 v80, v32, v33
  v_mfma_f32_16x16x32_bf16 v[4:7], a[216:219], v[136:139], v[4:7]
  v_exp_f32 v41, v41
  v_mfma_f32_16x16x32_bf16 v[4:7], a[220:223], v[140:143], v[4:7]
  ds_read_b64_tr_b16 a[228:229], v233 offset:32
  v_add_f32 v209, v209, v40
  v_mfma_f32_16x16x32_bf16 v[8:11], a[192:195], v[144:147], v[196:199]
  v_exp_f32 v34, v34
  v_mfma_f32_16x16x32_bf16 v[8:11], a[196:199], v[148:151], v[8:11]
  ds_read_b64_tr_b16 a[230:231], v233 offset:544
  v_add_f32 v209, v209, v41
  v_mfma_f32_16x16x32_bf16 v[8:11], a[200:203], v[152:155], v[8:11]
  v_exp_f32 v35, v35
  v_mfma_f32_16x16x32_bf16 v[8:11], a[204:207], v[156:159], v[8:11]
  ds_read_b64_tr_b16 a[232:233], v233 offset:64
  v_cvt_pk_bf16_f32 v84, v40, v41
  v_mfma_f32_16x16x32_bf16 v[12:15], a[208:211], v[144:147], v[196:199]
  v_exp_f32 v42, v42
  v_mfma_f32_16x16x32_bf16 v[12:15], a[212:215], v[148:151], v[12:15]
  ds_read_b64_tr_b16 a[234:235], v233 offset:576
  v_cvt_pk_bf16_f32 v81, v34, v35
  v_mfma_f32_16x16x32_bf16 v[12:15], a[216:219], v[152:155], v[12:15]
  v_exp_f32 v43, v43
  v_mfma_f32_16x16x32_bf16 v[12:15], a[220:223], v[156:159], v[12:15]
  ds_read_b64_tr_b16 a[236:237], v233 offset:96
  v_add_f32 v209, v209, v42
  v_mfma_f32_16x16x32_bf16 v[16:19], a[192:195], v[160:163], v[200:203]
  v_exp_f32 v36, v36
  v_mfma_f32_16x16x32_bf16 v[16:19], a[196:199], v[164:167], v[16:19]
  ds_read_b64_tr_b16 a[238:239], v233 offset:608
  v_add_f32 v209, v209, v43
  v_mfma_f32_16x16x32_bf16 v[16:19], a[200:203], v[168:171], v[16:19]
  v_exp_f32 v37, v37
  v_mfma_f32_16x16x32_bf16 v[16:19], a[204:207], v[172:175], v[16:19]
  ds_read_b64_tr_b16 a[240:241], v233 offset:128
  v_cvt_pk_bf16_f32 v85, v42, v43
  v_mfma_f32_16x16x32_bf16 v[20:23], a[208:211], v[160:163], v[200:203]
  v_exp_f32 v44, v44
  v_mfma_f32_16x16x32_bf16 v[20:23], a[212:215], v[164:167], v[20:23]
  ds_read_b64_tr_b16 a[242:243], v233 offset:640
  v_cvt_pk_bf16_f32 v82, v36, v37
  v_mfma_f32_16x16x32_bf16 v[20:23], a[216:219], v[168:171], v[20:23]
  v_exp_f32 v45, v45
  v_mfma_f32_16x16x32_bf16 v[20:23], a[220:223], v[172:175], v[20:23]
  ds_read_b64_tr_b16 a[244:245], v233 offset:160
  v_add_f32 v209, v209, v44
  v_mfma_f32_16x16x32_bf16 v[24:27], a[192:195], v[176:179], v[204:207]
  v_exp_f32 v38, v38
  v_mfma_f32_16x16x32_bf16 v[24:27], a[196:199], v[180:183], v[24:27]
  buffer_load_dwordx4 v253, s[12:15], s93 offen offset:1056 lds
  v_mfma_f32_16x16x32_bf16 v[24:27], a[200:203], v[184:187], v[24:27]
  v_exp_f32 v39, v39
  v_mfma_f32_16x16x32_bf16 v[24:27], a[204:207], v[188:191], v[24:27]
  ds_read_b64_tr_b16 a[246:247], v233 offset:672
  v_add_f32 v209, v209, v45
  v_mfma_f32_16x16x32_bf16 v[28:31], a[208:211], v[176:179], v[204:207]
  v_exp_f32 v46, v46
  v_mfma_f32_16x16x32_bf16 v[28:31], a[212:215], v[180:183], v[28:31]
  ds_read_b64_tr_b16 a[248:249], v233 offset:192
  v_cvt_pk_bf16_f32 v86, v44, v45
  v_mfma_f32_16x16x32_bf16 v[28:31], a[216:219], v[184:187], v[28:31]
  v_exp_f32 v47, v47
  v_mfma_f32_16x16x32_bf16 v[28:31], a[220:223], v[188:191], v[28:31]
  s_waitcnt lgkmcnt(2)
  ds_read_b64_tr_b16 a[250:251], v233 offset:704
  v_cvt_pk_bf16_f32 v83, v38, v39
  v_mfma_f32_16x16x32_bf16 a[0:3], a[224:227], v[64:67], a[0:3]
  v_exp_f32 v48, v48
  v_mfma_f32_16x16x32_bf16 a[32:35], a[224:227], v[68:71], a[32:35]
  ds_read_b64_tr_b16 a[252:253], v233 offset:224
  v_add_f32 v209, v209, v46
  v_mfma_f32_16x16x32_bf16 a[64:67], a[224:227], v[72:75], a[64:67]
  v_exp_f32 v49, v49
  v_mfma_f32_16x16x32_bf16 a[96:99], a[224:227], v[76:79], a[96:99]
  ds_read_b64_tr_b16 a[254:255], v233 offset:736
  v_add_f32 v209, v209, v47
  v_cvt_pk_bf16_f32 v87, v46, v47
  v_mfma_f32_16x16x32_bf16 a[4:7], a[228:231], v[64:67], a[4:7]
  v_exp_f32 v50, v50
  v_mfma_f32_16x16x32_bf16 a[36:39], a[228:231], v[68:71], a[36:39]
  ds_read_b128 a[192:195], v232 offset:8448
  v_add_f32 v210, v210, v48
  v_mfma_f32_16x16x32_bf16 a[68:71], a[228:231], v[72:75], a[68:71]
  v_exp_f32 v51, v51
  v_mfma_f32_16x16x32_bf16 a[100:103], a[228:231], v[76:79], a[100:103]
  ds_read_b128 a[196:199], v232 offset:8512
  v_add_f32 v210, v210, v49
  v_cvt_pk_bf16_f32 v88, v48, v49
  v_mfma_f32_16x16x32_bf16 a[8:11], a[232:235], v[64:67], a[8:11]
  v_exp_f32 v52, v52
  v_mfma_f32_16x16x32_bf16 a[40:43], a[232:235], v[68:71], a[40:43]
  ds_read_b128 a[200:203], v232 offset:8576
  v_add_f32 v210, v210, v50
  v_mfma_f32_16x16x32_bf16 a[72:75], a[232:235], v[72:75], a[72:75]
  v_exp_f32 v53, v53
  v_mfma_f32_16x16x32_bf16 a[104:107], a[232:235], v[76:79], a[104:107]
  v_add_f32 v210, v210, v51
  v_cvt_pk_bf16_f32 v89, v50, v51
  v_mfma_f32_16x16x32_bf16 a[12:15], a[236:239], v[64:67], a[12:15]
  v_exp_f32 v54, v54
  v_mfma_f32_16x16x32_bf16 a[44:47], a[236:239], v[68:71], a[44:47]
  ds_read_b128 a[204:207], v232 offset:8640
  v_add_f32 v210, v210, v52
  v_mfma_f32_16x16x32_bf16 a[76:79], a[236:239], v[72:75], a[76:79]
  v_exp_f32 v55, v55
  v_mfma_f32_16x16x32_bf16 a[108:111], a[236:239], v[76:79], a[108:111]
  buffer_load_dwordx4 v254, s[12:15], s93 offen offset:2112 lds
  s_mov_b32 s95, 245760
  v_mfma_f32_16x16x32_bf16 a[16:19], a[240:243], v[64:67], a[16:19]
  s_add_u32 m0, s32, 16896
  v_exp_f32 v56, v56
  v_mfma_f32_16x16x32_bf16 a[48:51], a[240:243], v[68:71], a[48:51]
  buffer_load_dwordx4 v240, s[20:23], s95 offen offset:0 nt lds
  v_mfma_f32_16x16x32_bf16 a[80:83], a[240:243], v[72:75], a[80:83]
  v_exp_f32 v57, v57
  v_mfma_f32_16x16x32_bf16 a[112:115], a[240:243], v[76:79], a[112:115]
  buffer_load_dwordx4 v241, s[20:23], s95 offen offset:1056 nt lds
  s_waitcnt lgkmcnt(0)
  v_mfma_f32_16x16x32_bf16 a[20:23], a[244:247], v[64:67], a[20:23]
  v_exp_f32 v58, v58
  v_mfma_f32_16x16x32_bf16 a[52:55], a[244:247], v[68:71], a[52:55]
  buffer_load_dwordx4 v242, s[20:23], s95 offen offset:2112 nt lds
  v_mfma_f32_16x16x32_bf16 a[84:87], a[244:247], v[72:75], a[84:87]
  v_exp_f32 v59, v59
  v_mfma_f32_16x16x32_bf16 a[116:119], a[244:247], v[76:79], a[116:119]
  buffer_load_dwordx4 v243, s[20:23], s95 offen offset:3168 nt lds
  v_mfma_f32_16x16x32_bf16 a[24:27], a[248:251], v[64:67], a[24:27]
  v_exp_f32 v60, v60
  v_mfma_f32_16x16x32_bf16 a[56:59], a[248:251], v[68:71], a[56:59]
  ds_read_b128 a[208:211], v232 offset:8960
  v_add_f32 v210, v210, v53
  v_cvt_pk_bf16_f32 v90, v52, v53
  v_mfma_f32_16x16x32_bf16 a[88:91], a[248:251], v[72:75], a[88:91]
  v_exp_f32 v61, v61
  v_mfma_f32_16x16x32_bf16 a[120:123], a[248:251], v[76:79], a[120:123]
  ds_read_b128 a[212:215], v232 offset:9024
  v_add_f32 v210, v210, v54
  v_add_f32 v210, v210, v55
  v_mfma_f32_16x16x32_bf16 a[28:31], a[252:255], v[64:67], a[28:31]
  v_exp_f32 v62, v62
  v_mfma_f32_16x16x32_bf16 a[60:63], a[252:255], v[68:71], a[60:63]
  ds_read_b128 a[216:219], v232 offset:9088
  v_cvt_pk_bf16_f32 v91, v54, v55
  v_add_f32 v211, v211, v56
  v_mfma_f32_16x16x32_bf16 a[92:95], a[252:255], v[72:75], a[92:95]
  v_exp_f32 v63, v63
  v_mfma_f32_16x16x32_bf16 a[124:127], a[252:255], v[76:79], a[124:127]
  ds_read_b128 a[220:223], v232 offset:9152
  v_add_f32 v211, v211, v57
  v_cvt_pk_bf16_f32 v92, v56, v57
  v_mfma_f32_16x16x32_bf16 v[96:99], a[128:131], v[64:67], v[96:99]
  v_add_f32 v211, v211, v58
  v_add_f32 v211, v211, v59
  v_cvt_pk_bf16_f32 v93, v58, v59
  v_mfma_f32_16x16x32_bf16 v[32:35], a[192:195], v[128:131], v[192:195]
  v_exp_f32 v0, v0
  v_mfma_f32_16x16x32_bf16 v[32:35], a[196:199], v[132:135], v[32:35]
  ds_read_b64_tr_b16 a[224:225], v233 offset:8448
  v_add_f32 v211, v211, v60
  v_add_f32 v211, v211, v61
  v_mfma_f32_16x16x32_bf16 v[32:35], a[200:203], v[136:139], v[32:35]
  s_add_u32 m0, s32, 0
  v_exp_f32 v1, v1
  v_mfma_f32_16x16x32_bf16 v[32:35], a[204:207], v[140:143], v[32:35]
  buffer_load_dwordx4 v255, s[12:15], s93 offen offset:3168 lds
  s_waitcnt lgkmcnt(1)
  v_mfma_f32_16x16x32_bf16 v[36:39], a[208:211], v[128:131], v[192:195]
  v_exp_f32 v8, v8
  v_mfma_f32_16x16x32_bf16 v[36:39], a[212:215], v[132:135], v[36:39]
  ds_read_b64_tr_b16 a[226:227], v233 offset:8960
  v_cvt_pk_bf16_f32 v94, v60, v61
  v_add_f32 v211, v211, v62
  v_mfma_f32_16x16x32_bf16 v[36:39], a[216:219], v[136:139], v[36:39]
  v_exp_f32 v9, v9
  v_mfma_f32_16x16x32_bf16 v[36:39], a[220:223], v[140:143], v[36:39]
  ds_read_b64_tr_b16 a[228:229], v233 offset:8480
  v_add_f32 v211, v211, v63
  v_cvt_pk_bf16_f32 v95, v62, v63
  v_mfma_f32_16x16x32_bf16 v[40:43], a[192:195], v[144:147], v[196:199]
  v_exp_f32 v2, v2
  v_mfma_f32_16x16x32_bf16 v[40:43], a[196:199], v[148:151], v[40:43]
  ds_read_b64_tr_b16 a[230:231], v233 offset:8992
  v_cvt_pk_bf16_f32 v64, v0, v1
  v_mfma_f32_16x16x32_bf16 v[40:43], a[200:203], v[152:155], v[40:43]
  v_exp_f32 v3, v3
  v_mfma_f32_16x16x32_bf16 v[40:43], a[204:207], v[156:159], v[40:43]
  ds_read_b64_tr_b16 a[232:233], v233 offset:8512
  v_add_f32 v209, v209, v8
  v_mfma_f32_16x16x32_bf16 v[44:47], a[208:211], v[144:147], v[196:199]
  v_exp_f32 v10, v10
  v_mfma_f32_16x16x32_bf16 v[44:47], a[212:215], v[148:151], v[44:47]
  ds_read_b64_tr_b16 a[234:235], v233 offset:9024
  v_add_f32 v209, v209, v9
  v_mfma_f32_16x16x32_bf16 v[44:47], a[216:219], v[152:155], v[44:47]
  v_exp_f32 v11, v11
  v_mfma_f32_16x16x32_bf16 v[44:47], a[220:223], v[156:159], v[44:47]
  ds_read_b64_tr_b16 a[236:237], v233 offset:8544
  v_cvt_pk_bf16_f32 v68, v8, v9
  v_cvt_pk_bf16_f32 v65, v2, v3
  v_mfma_f32_16x16x32_bf16 v[48:51], a[192:195], v[160:163], v[200:203]
  v_exp_f32 v4, v4
  v_mfma_f32_16x16x32_bf16 v[48:51], a[196:199], v[164:167], v[48:51]
  ds_read_b64_tr_b16 a[238:239], v233 offset:9056
  v_add_f32 v209, v209, v10
  v_mfma_f32_16x16x32_bf16 v[48:51], a[200:203], v[168:171], v[48:51]
  v_exp_f32 v5, v5
  v_mfma_f32_16x16x32_bf16 v[48:51], a[204:207], v[172:175], v[48:51]
  ds_read_b64_tr_b16 a[240:241], v233 offset:8576
  v_add_f32 v209, v209, v11
  v_mfma_f32_16x16x32_bf16 v[52:55], a[208:211], v[160:163], v[200:203]
  v_exp_f32 v12, v12
  v_mfma_f32_16x16x32_bf16 v[52:55], a[212:215], v[164:167], v[52:55]
  ds_read_b64_tr_b16 a[242:243], v233 offset:9088
  v_cvt_pk_bf16_f32 v69, v10, v11
  v_mfma_f32_16x16x32_bf16 v[52:55], a[216:219], v[168:171], v[52:55]
  v_exp_f32 v13, v13
  v_mfma_f32_16x16x32_bf16 v[52:55], a[220:223], v[172:175], v[52:55]
  ds_read_b64_tr_b16 a[244:245], v233 offset:8608
  v_cvt_pk_bf16_f32 v66, v4, v5
  v_mfma_f32_16x16x32_bf16 v[56:59], a[192:195], v[176:179], v[204:207]
  v_exp_f32 v6, v6
  v_mfma_f32_16x16x32_bf16 v[56:59], a[196:199], v[180:183], v[56:59]
  ds_read_b64_tr_b16 a[246:247], v233 offset:9120
  v_add_f32 v209, v209, v12
  v_mfma_f32_16x16x32_bf16 v[56:59], a[200:203], v[184:187], v[56:59]
  v_exp_f32 v7, v7
  v_mfma_f32_16x16x32_bf16 v[56:59], a[204:207], v[188:191], v[56:59]
  ds_read_b64_tr_b16 a[248:249], v233 offset:8640
  v_add_f32 v209, v209, v13
  v_mfma_f32_16x16x32_bf16 v[60:63], a[208:211], v[176:179], v[204:207]
  v_exp_f32 v14, v14
  v_mfma_f32_16x16x32_bf16 v[60:63], a[212:215], v[180:183], v[60:63]
  s_waitcnt vmcnt(12)
  ds_read_b64_tr_b16 a[250:251], v233 offset:9152
  v_cvt_pk_bf16_f32 v70, v12, v13
  v_mfma_f32_16x16x32_bf16 v[60:63], a[216:219], v[184:187], v[60:63]
  s_barrier
  v_exp_f32 v15, v15
  v_mfma_f32_16x16x32_bf16 v[60:63], a[220:223], v[188:191], v[60:63]
  s_add_u32 s93, s94, 1
  s_waitcnt lgkmcnt(1)
  ds_read_b64_tr_b16 a[252:253], v233 offset:8672
  v_cvt_pk_bf16_f32 v67, v6, v7
  v_add_u32 v232, 67584, v234
  v_mfma_f32_16x16x32_bf16 a[0:3], a[224:227], v[80:83], a[0:3]
  s_and_b32 s93, s93, 15
  v_exp_f32 v16, v16
  v_mfma_f32_16x16x32_bf16 a[32:35], a[224:227], v[84:87], a[32:35]
  s_lshl_b32 s93, s93, 16
  ds_read_b64_tr_b16 a[254:255], v233 offset:9184
  v_add_f32 v209, v209, v14
  v_mfma_f32_16x16x32_bf16 a[64:67], a[224:227], v[88:91], a[64:67]
  s_add_u32 m0, s32, 33792
  v_exp_f32 v17, v17
  v_mfma_f32_16x16x32_bf16 a[96:99], a[224:227], v[92:95], a[96:99]
  buffer_load_dwordx4 v252, s[12:15], s93 offen offset:0 lds
  v_mfma_f32_16x16x32_bf16 a[4:7], a[228:231], v[80:83], a[4:7]
  v_exp_f32 v18, v18
  v_mfma_f32_16x16x32_bf16 a[36:39], a[228:231], v[84:87], a[36:39]
  ds_read_b128 a[192:195], v232 offset:0
  v_add_f32 v209, v209, v15
  v_cvt_pk_bf16_f32 v71, v14, v15
  v_mfma_f32_16x16x32_bf16 a[68:71], a[228:231], v[88:91], a[68:71]
  v_exp_f32 v19, v19
  v_mfma_f32_16x16x32_bf16 a[100:103], a[228:231], v[92:95], a[100:103]
  ds_read_b128 a[196:199], v232 offset:64
  v_add_u32 v233, 101376, v235
  v_add_f32 v210, v210, v16
  v_mfma_f32_16x16x32_bf16 a[8:11], a[232:235], v[80:83], a[8:11]
  v_exp_f32 v20, v20
  v_mfma_f32_16x16x32_bf16 a[40:43], a[232:235], v[84:87], a[40:43]
  buffer_load_dwordx4 v253, s[12:15], s93 offen offset:1056 lds
  v_mfma_f32_16x16x32_bf16 a[72:75], a[232:235], v[88:91], a[72:75]
  v_exp_f32 v21, v21
  v_mfma_f32_16x16x32_bf16 a[104:107], a[232:235], v[92:95], a[104:107]
  ds_read_b128 a[200:203], v232 offset:128
  v_add_f32 v210, v210, v17
  v_cvt_pk_bf16_f32 v72, v16, v17
  v_mfma_f32_16x16x32_bf16 a[12:15], a[236:239], v[80:83], a[12:15]
  v_exp_f32 v22, v22
  v_mfma_f32_16x16x32_bf16 a[44:47], a[236:239], v[84:87], a[44:47]
  ds_read_b128 a[204:207], v232 offset:192
  v_add_f32 v210, v210, v18
  v_add_f32 v210, v210, v19
  v_mfma_f32_16x16x32_bf16 a[76:79], a[236:239], v[88:91], a[76:79]
  v_exp_f32 v23, v23
  v_mfma_f32_16x16x32_bf16 a[108:111], a[236:239], v[92:95], a[108:111]
  buffer_load_dwordx4 v254, s[12:15], s93 offen offset:2112 lds
  v_mfma_f32_16x16x32_bf16 a[16:19], a[240:243], v[80:83], a[16:19]
  v_exp_f32 v24, v24
  v_mfma_f32_16x16x32_bf16 a[48:51], a[240:243], v[84:87], a[48:51]
  ds_read_b128 a[208:211], v232 offset:512
  v_cvt_pk_bf16_f32 v73, v18, v19
  v_add_f32 v210, v210, v20
  v_mfma_f32_16x16x32_bf16 a[80:83], a[240:243], v[88:91], a[80:83]
  v_exp_f32 v25, v25
  v_mfma_f32_16x16x32_bf16 a[112:115], a[240:243], v[92:95], a[112:115]
  ds_read_b128 a[212:215], v232 offset:576
  v_add_f32 v210, v210, v21
  v_cvt_pk_bf16_f32 v74, v20, v21
  v_mfma_f32_16x16x32_bf16 a[20:23], a[244:247], v[80:83], a[20:23]
  v_exp_f32 v26, v26
  v_mfma_f32_16x16x32_bf16 a[52:55], a[244:247], v[84:87], a[52:55]
  v_add_f32 v210, v210, v22
  v_add_f32 v210, v210, v23
  v_cvt_pk_bf16_f32 v75, v22, v23
  v_mfma_f32_16x16x32_bf16 a[84:87], a[244:247], v[88:91], a[84:87]
  v_exp_f32 v27, v27
  v_mfma_f32_16x16x32_bf16 a[116:119], a[244:247], v[92:95], a[116:119]
  buffer_load_dwordx4 v255, s[12:15], s93 offen offset:3168 lds
  s_waitcnt lgkmcnt(1)
  v_mfma_f32_16x16x32_bf16 a[24:27], a[248:251], v[80:83], a[24:27]
  v_exp_f32 v28, v28
  v_mfma_f32_16x16x32_bf16 a[56:59], a[248:251], v[84:87], a[56:59]
  ds_read_b128 a[216:219], v232 offset:640
  v_add_f32 v211, v211, v24
  v_add_f32 v211, v211, v25
  v_mfma_f32_16x16x32_bf16 a[88:91], a[248:251], v[88:91], a[88:91]
  v_exp_f32 v29, v29
  v_mfma_f32_16x16x32_bf16 a[120:123], a[248:251], v[92:95], a[120:123]
  ds_read_b128 a[220:223], v232 offset:704
  v_cvt_pk_bf16_f32 v76, v24, v25
  v_add_f32 v211, v211, v26
  v_mfma_f32_16x16x32_bf16 a[28:31], a[252:255], v[80:83], a[28:31]
  v_exp_f32 v30, v30
  v_mfma_f32_16x16x32_bf16 a[60:63], a[252:255], v[84:87], a[60:63]
  v_add_f32 v211, v211, v27
  v_cvt_pk_bf16_f32 v77, v26, v27
  v_add_f32 v211, v211, v28
  v_mfma_f32_16x16x32_bf16 a[92:95], a[252:255], v[88:91], a[92:95]
  v_exp_f32 v31, v31
  v_mfma_f32_16x16x32_bf16 a[124:127], a[252:255], v[92:95], a[124:127]
  v_add_f32 v211, v211, v29
  v_cvt_pk_bf16_f32 v78, v28, v29
  v_mfma_f32_16x16x32_bf16 v[96:99], a[128:131], v[80:83], v[96:99]
  v_add_f32 v211, v211, v30
  v_add_f32 v211, v211, v31
  v_cvt_pk_bf16_f32 v79, v30, v31
  v_mfma_f32_16x16x32_bf16 v[0:3], a[192:195], v[128:131], v[192:195]
  v_exp_f32 v32, v32
  v_mfma_f32_16x16x32_bf16 v[0:3], a[196:199], v[132:135], v[0:3]
  ds_read_b64_tr_b16 a[224:225], v233 offset:0
  v_mfma_f32_16x16x32_bf16 v[0:3], a[200:203], v[136:139], v[0:3]
  v_exp_f32 v33, v33
  v_mfma_f32_16x16x32_bf16 v[0:3], a[204:207], v[140:143], v[0:3]
  s_add_u32 s93, s94, 2
  ds_read_b64_tr_b16 a[226:227], v233 offset:512
  v_cvt_pk_bf16_f32 v80, v32, v33
  v_mfma_f32_16x16x32_bf16 v[4:7], a[208:211], v[128:131], v[192:195]
  s_and_b32 s93, s93, 15
  s_waitcnt lgkmcnt(2)
  v_exp_f32 v40, v40
  v_mfma_f32_16x16x32_bf16 v[4:7], a[212:215], v[132:135], v[4:7]
  s_lshl_b32 s93, s93, 16
  ds_read_b64_tr_b16 a[228:229], v233 offset:32
  v_add_f32 v209, v209, v40
  v_mfma_f32_16x16x32_bf16 v[4:7], a[216:219], v[136:139], v[4:7]
  s_add_u32 m0, s32, 50688
  v_exp_f32 v41, v41
  v_mfma_f32_16x16x32_bf16 v[4:7], a[220:223], v[140:143], v[4:7]
  buffer_load_dwordx4 v252, s[12:15], s93 offen offset:0 lds
  v_mfma_f32_16x16x32_bf16 v[8:11], a[192:195], v[144:147], v[196:199]
  v_exp_f32 v34, v34
  v_mfma_f32_16x16x32_bf16 v[8:11], a[196:199], v[148:151], v[8:11]
  ds_read_b64_tr_b16 a[230:231], v233 offset:544
  v_add_f32 v209, v209, v41
  v_mfma_f32_16x16x32_bf16 v[8:11], a[200:203], v[152:155], v[8:11]
  v_exp_f32 v35, v35
  v_mfma_f32_16x16x32_bf16 v[8:11], a[204:207], v[156:159], v[8:11]
  ds_read_b64_tr_b16 a[232:233], v233 offset:64
  v_cvt_pk_bf16_f32 v84, v40, v41
  v_mfma_f32_16x16x32_bf16 v[12:15], a[208:211], v[144:147], v[196:199]
  v_exp_f32 v42, v42
  v_mfma_f32_16x16x32_bf16 v[12:15], a[212:215], v[148:151], v[12:15]
  ds_read_b64_tr_b16 a[234:235], v233 offset:576
  v_cvt_pk_bf16_f32 v81, v34, v35
  v_mfma_f32_16x16x32_bf16 v[12:15], a[216:219], v[152:155], v[12:15]
  v_exp_f32 v43, v43
  v_mfma_f32_16x16x32_bf16 v[12:15], a[220:223], v[156:159], v[12:15]
  ds_read_b64_tr_b16 a[236:237], v233 offset:96
  v_add_f32 v209, v209, v42
  v_mfma_f32_16x16x32_bf16 v[16:19], a[192:195], v[160:163], v[200:203]
  v_exp_f32 v36, v36
  v_mfma_f32_16x16x32_bf16 v[16:19], a[196:199], v[164:167], v[16:19]
  ds_read_b64_tr_b16 a[238:239], v233 offset:608
  v_add_f32 v209, v209, v43
  v_mfma_f32_16x16x32_bf16 v[16:19], a[200:203], v[168:171], v[16:19]
  v_exp_f32 v37, v37
  v_mfma_f32_16x16x32_bf16 v[16:19], a[204:207], v[172:175], v[16:19]
  ds_read_b64_tr_b16 a[240:241], v233 offset:128
  v_cvt_pk_bf16_f32 v85, v42, v43
  v_mfma_f32_16x16x32_bf16 v[20:23], a[208:211], v[160:163], v[200:203]
  v_exp_f32 v44, v44
  v_mfma_f32_16x16x32_bf16 v[20:23], a[212:215], v[164:167], v[20:23]
  ds_read_b64_tr_b16 a[242:243], v233 offset:640
  v_cvt_pk_bf16_f32 v82, v36, v37
  v_mfma_f32_16x16x32_bf16 v[20:23], a[216:219], v[168:171], v[20:23]
  v_exp_f32 v45, v45
  v_mfma_f32_16x16x32_bf16 v[20:23], a[220:223], v[172:175], v[20:23]
  ds_read_b64_tr_b16 a[244:245], v233 offset:160
  v_add_f32 v209, v209, v44
  v_mfma_f32_16x16x32_bf16 v[24:27], a[192:195], v[176:179], v[204:207]
  v_exp_f32 v38, v38
  v_mfma_f32_16x16x32_bf16 v[24:27], a[196:199], v[180:183], v[24:27]
  ds_read_b64_tr_b16 a[246:247], v233 offset:672
  v_add_f32 v209, v209, v45
  v_mfma_f32_16x16x32_bf16 v[24:27], a[200:203], v[184:187], v[24:27]
  v_exp_f32 v39, v39
  v_mfma_f32_16x16x32_bf16 v[24:27], a[204:207], v[188:191], v[24:27]
  buffer_load_dwordx4 v253, s[12:15], s93 offen offset:1056 lds
  v_mfma_f32_16x16x32_bf16 v[28:31], a[208:211], v[176:179], v[204:207]
  v_exp_f32 v46, v46
  v_mfma_f32_16x16x32_bf16 v[28:31], a[212:215], v[180:183], v[28:31]
  ds_read_b64_tr_b16 a[248:249], v233 offset:192
  v_cvt_pk_bf16_f32 v86, v44, v45
  v_mfma_f32_16x16x32_bf16 v[28:31], a[216:219], v[184:187], v[28:31]
  v_exp_f32 v47, v47
  v_mfma_f32_16x16x32_bf16 v[28:31], a[220:223], v[188:191], v[28:31]
  s_waitcnt lgkmcnt(1)
  ds_read_b64_tr_b16 a[250:251], v233 offset:704
  v_cvt_pk_bf16_f32 v83, v38, v39
  v_mfma_f32_16x16x32_bf16 a[0:3], a[224:227], v[64:67], a[0:3]
  v_exp_f32 v48, v48
  v_mfma_f32_16x16x32_bf16 a[32:35], a[224:227], v[68:71], a[32:35]
  ds_read_b64_tr_b16 a[252:253], v233 offset:224
  v_add_f32 v209, v209, v46
  v_mfma_f32_16x16x32_bf16 a[64:67], a[224:227], v[72:75], a[64:67]
  v_exp_f32 v49, v49
  v_mfma_f32_16x16x32_bf16 a[96:99], a[224:227], v[76:79], a[96:99]
  ds_read_b64_tr_b16 a[254:255], v233 offset:736
  v_add_f32 v209, v209, v47
  v_cvt_pk_bf16_f32 v87, v46, v47
  v_mfma_f32_16x16x32_bf16 a[4:7], a[228:231], v[64:67], a[4:7]
  v_exp_f32 v50, v50
  v_mfma_f32_16x16x32_bf16 a[36:39], a[228:231], v[68:71], a[36:39]
  ds_read_b128 a[192:195], v232 offset:8448
  v_add_f32 v210, v210, v48
  v_mfma_f32_16x16x32_bf16 a[68:71], a[228:231], v[72:75], a[68:71]
  v_exp_f32 v51, v51
  v_mfma_f32_16x16x32_bf16 a[100:103], a[228:231], v[76:79], a[100:103]
  ds_read_b128 a[196:199], v232 offset:8512
  v_add_f32 v210, v210, v49
  v_cvt_pk_bf16_f32 v88, v48, v49
  v_mfma_f32_16x16x32_bf16 a[8:11], a[232:235], v[64:67], a[8:11]
  v_exp_f32 v52, v52
  v_mfma_f32_16x16x32_bf16 a[40:43], a[232:235], v[68:71], a[40:43]
  ds_read_b128 a[200:203], v232 offset:8576
  v_add_f32 v210, v210, v50
  v_mfma_f32_16x16x32_bf16 a[72:75], a[232:235], v[72:75], a[72:75]
  v_exp_f32 v53, v53
  v_mfma_f32_16x16x32_bf16 a[104:107], a[232:235], v[76:79], a[104:107]
  v_add_f32 v210, v210, v51
  v_cvt_pk_bf16_f32 v89, v50, v51
  v_mfma_f32_16x16x32_bf16 a[12:15], a[236:239], v[64:67], a[12:15]
  v_exp_f32 v54, v54
  v_mfma_f32_16x16x32_bf16 a[44:47], a[236:239], v[68:71], a[44:47]
  ds_read_b128 a[204:207], v232 offset:8640
  v_add_f32 v210, v210, v52
  v_mfma_f32_16x16x32_bf16 a[76:79], a[236:239], v[72:75], a[76:79]
  v_exp_f32 v55, v55
  v_mfma_f32_16x16x32_bf16 a[108:111], a[236:239], v[76:79], a[108:111]
  buffer_load_dwordx4 v254, s[12:15], s93 offen offset:2112 lds
  v_mfma_f32_16x16x32_bf16 a[16:19], a[240:243], v[64:67], a[16:19]
  v_exp_f32 v56, v56
  v_mfma_f32_16x16x32_bf16 a[48:51], a[240:243], v[68:71], a[48:51]
  ds_read_b128 a[208:211], v232 offset:8960
  v_add_f32 v210, v210, v53
  v_cvt_pk_bf16_f32 v90, v52, v53
  v_mfma_f32_16x16x32_bf16 a[80:83], a[240:243], v[72:75], a[80:83]
  v_exp_f32 v57, v57
  v_mfma_f32_16x16x32_bf16 a[112:115], a[240:243], v[76:79], a[112:115]
  ds_read_b128 a[212:215], v232 offset:9024
  v_add_f32 v210, v210, v54
  v_add_f32 v210, v210, v55
  v_mfma_f32_16x16x32_bf16 a[20:23], a[244:247], v[64:67], a[20:23]
  v_exp_f32 v58, v58
  v_mfma_f32_16x16x32_bf16 a[52:55], a[244:247], v[68:71], a[52:55]
  v_cvt_pk_bf16_f32 v91, v54, v55
  v_add_f32 v211, v211, v56
  v_mfma_f32_16x16x32_bf16 a[84:87], a[244:247], v[72:75], a[84:87]
  v_exp_f32 v59, v59
  v_mfma_f32_16x16x32_bf16 a[116:119], a[244:247], v[76:79], a[116:119]
  s_waitcnt lgkmcnt(1)
  ds_read_b128 a[216:219], v232 offset:9088
  v_add_f32 v211, v211, v57
  v_cvt_pk_bf16_f32 v92, v56, v57
  v_mfma_f32_16x16x32_bf16 a[24:27], a[248:251], v[64:67], a[24:27]
  v_exp_f32 v60, v60
  v_mfma_f32_16x16x32_bf16 a[56:59], a[248:251], v[68:71], a[56:59]
  v_add_f32 v211, v211, v58
  v_add_f32 v211, v211, v59
  v_mfma_f32_16x16x32_bf16 a[88:91], a[248:251], v[72:75], a[88:91]
  v_exp_f32 v61, v61
  v_mfma_f32_16x16x32_bf16 a[120:123], a[248:251], v[76:79], a[120:123]
  ds_read_b128 a[220:223], v232 offset:9152
  v_cvt_pk_bf16_f32 v93, v58, v59
  v_mfma_f32_16x16x32_bf16 a[28:31], a[252:255], v[64:67], a[28:31]
  v_exp_f32 v62, v62
  v_mfma_f32_16x16x32_bf16 a[60:63], a[252:255], v[68:71], a[60:63]
  v_add_f32 v211, v211, v60
  v_add_f32 v211, v211, v61
  v_mfma_f32_16x16x32_bf16 a[92:95], a[252:255], v[72:75], a[92:95]
  v_exp_f32 v63, v63
  v_mfma_f32_16x16x32_bf16 a[124:127], a[252:255], v[76:79], a[124:127]
  v_cvt_pk_bf16_f32 v94, v60, v61
  v_add_f32 v211, v211, v62
  v_mfma_f32_16x16x32_bf16 v[96:99], a[128:131], v[64:67], v[96:99]
  v_add_f32 v211, v211, v63
  v_cvt_pk_bf16_f32 v95, v62, v63
  v_mfma_f32_16x16x32_bf16 v[32:35], a[192:195], v[128:131], v[192:195]
  v_exp_f32 v0, v0
  v_mfma_f32_16x16x32_bf16 v[32:35], a[196:199], v[132:135], v[32:35]
  ds_read_b64_tr_b16 a[224:225], v233 offset:8448
  v_mfma_f32_16x16x32_bf16 v[32:35], a[200:203], v[136:139], v[32:35]
  v_exp_f32 v1, v1
  v_mfma_f32_16x16x32_bf16 v[32:35], a[204:207], v[140:143], v[32:35]
  buffer_load_dwordx4 v255, s[12:15], s93 offen offset:3168 lds
  v_mfma_f32_16x16x32_bf16 v[36:39], a[208:211], v[128:131], v[192:195]
  s_waitcnt lgkmcnt(1)
  v_exp_f32 v8, v8
  v_mfma_f32_16x16x32_bf16 v[36:39], a[212:215], v[132:135], v[36:39]
  ds_read_b64_tr_b16 a[226:227], v233 offset:8960
  v_cvt_pk_bf16_f32 v64, v0, v1
  v_mfma_f32_16x16x32_bf16 v[36:39], a[216:219], v[136:139], v[36:39]
  v_exp_f32 v9, v9
  v_mfma_f32_16x16x32_bf16 v[36:39], a[220:223], v[140:143], v[36:39]
  ds_read_b64_tr_b16 a[228:229], v233 offset:8480
  v_add_f32 v209, v209, v8
  v_mfma_f32_16x16x32_bf16 v[40:43], a[192:195], v[144:147], v[196:199]
  v_exp_f32 v2, v2
  v_mfma_f32_16x16x32_bf16 v[40:43], a[196:199], v[148:151], v[40:43]
  ds_read_b64_tr_b16 a[230:231], v233 offset:8992
  v_add_f32 v209, v209, v9
  v_mfma_f32_16x16x32_bf16 v[40:43], a[200:203], v[152:155], v[40:43]
  v_exp_f32 v3, v3
  v_mfma_f32_16x16x32_bf16 v[40:43], a[204:207], v[156:159], v[40:43]
  ds_read_b64_tr_b16 a[232:233], v233 offset:8512
  v_cvt_pk_bf16_f32 v68, v8, v9
  v_mfma_f32_16x16x32_bf16 v[44:47], a[208:211], v[144:147], v[196:199]
  v_exp_f32 v10, v10
  v_mfma_f32_16x16x32_bf16 v[44:47], a[212:215], v[148:151], v[44:47]
  ds_read_b64_tr_b16 a[234:235], v233 offset:9024
  v_cvt_pk_bf16_f32 v65, v2, v3
  v_mfma_f32_16x16x32_bf16 v[44:47], a[216:219], v[152:155], v[44:47]
  v_exp_f32 v11, v11
  v_mfma_f32_16x16x32_bf16 v[44:47], a[220:223], v[156:159], v[44:47]
  ds_read_b64_tr_b16 a[236:237], v233 offset:8544
  v_add_f32 v209, v209, v10
  v_mfma_f32_16x16x32_bf16 v[48:51], a[192:195], v[160:163], v[200:203]
  v_exp_f32 v4, v4
  v_mfma_f32_16x16x32_bf16 v[48:51], a[196:199], v[164:167], v[48:51]
  ds_read_b64_tr_b16 a[238:239], v233 offset:9056
  v_add_f32 v209, v209, v11
  v_mfma_f32_16x16x32_bf16 v[48:51], a[200:203], v[168:171], v[48:51]
  v_exp_f32 v5, v5
  v_mfma_f32_16x16x32_bf16 v[48:51], a[204:207], v[172:175], v[48:51]
  ds_read_b64_tr_b16 a[240:241], v233 offset:8576
  v_cvt_pk_bf16_f32 v69, v10, v11
  v_mfma_f32_16x16x32_bf16 v[52:55], a[208:211], v[160:163], v[200:203]
  v_exp_f32 v12, v12
  v_mfma_f32_16x16x32_bf16 v[52:55], a[212:215], v[164:167], v[52:55]
  ds_read_b64_tr_b16 a[242:243], v233 offset:9088
  v_cvt_pk_bf16_f32 v66, v4, v5
  v_mfma_f32_16x16x32_bf16 v[52:55], a[216:219], v[168:171], v[52:55]
  v_exp_f32 v13, v13
  v_mfma_f32_16x16x32_bf16 v[52:55], a[220:223], v[172:175], v[52:55]
  ds_read_b64_tr_b16 a[244:245], v233 offset:8608
  v_add_f32 v209, v209, v12
  v_mfma_f32_16x16x32_bf16 v[56:59], a[192:195], v[176:179], v[204:207]
  v_exp_f32 v6, v6
  v_mfma_f32_16x16x32_bf16 v[56:59], a[196:199], v[180:183], v[56:59]
  ds_read_b64_tr_b16 a[246:247], v233 offset:9120
  v_add_f32 v209, v209, v13
  v_mfma_f32_16x16x32_bf16 v[56:59], a[200:203], v[184:187], v[56:59]
  v_exp_f32 v7, v7
  v_mfma_f32_16x16x32_bf16 v[56:59], a[204:207], v[188:191], v[56:59]
  ds_read_b64_tr_b16 a[248:249], v233 offset:8640
  v_cvt_pk_bf16_f32 v70, v12, v13
  v_mfma_f32_16x16x32_bf16 v[60:63], a[208:211], v[176:179], v[204:207]
  v_exp_f32 v14, v14
  v_mfma_f32_16x16x32_bf16 v[60:63], a[212:215], v[180:183], v[60:63]
  s_waitcnt vmcnt(16)
  ds_read_b64_tr_b16 a[250:251], v233 offset:9152
  v_cvt_pk_bf16_f32 v67, v6, v7
  v_mfma_f32_16x16x32_bf16 v[60:63], a[216:219], v[184:187], v[60:63]
  s_barrier
  v_exp_f32 v15, v15
  v_mfma_f32_16x16x32_bf16 v[60:63], a[220:223], v[188:191], v[60:63]
  s_add_u32 s93, s94, 3
  s_waitcnt lgkmcnt(2)
  ds_read_b64_tr_b16 a[252:253], v233 offset:8672
  v_add_u32 v232, 101376, v234
  v_mfma_f32_16x16x32_bf16 a[0:3], a[224:227], v[80:83], a[0:3]
  s_and_b32 s93, s93, 15
  v_exp_f32 v16, v16
  v_mfma_f32_16x16x32_bf16 a[32:35], a[224:227], v[84:87], a[32:35]
  s_lshl_b32 s93, s93, 16
  ds_read_b64_tr_b16 a[254:255], v233 offset:9184
  v_add_f32 v209, v209, v14
  v_mfma_f32_16x16x32_bf16 a[64:67], a[224:227], v[88:91], a[64:67]
  s_add_u32 m0, s32, 67584
  v_exp_f32 v17, v17
  v_mfma_f32_16x16x32_bf16 a[96:99], a[224:227], v[92:95], a[96:99]
  buffer_load_dwordx4 v252, s[12:15], s93 offen offset:0 lds
  v_mfma_f32_16x16x32_bf16 a[4:7], a[228:231], v[80:83], a[4:7]
  v_exp_f32 v18, v18
  v_mfma_f32_16x16x32_bf16 a[36:39], a[228:231], v[84:87], a[36:39]
  ds_read_b128 a[192:195], v232 offset:0
  v_add_f32 v209, v209, v15
  v_cvt_pk_bf16_f32 v71, v14, v15
  v_mfma_f32_16x16x32_bf16 a[68:71], a[228:231], v[88:91], a[68:71]
  v_exp_f32 v19, v19
  v_mfma_f32_16x16x32_bf16 a[100:103], a[228:231], v[92:95], a[100:103]
  ds_read_b128 a[196:199], v232 offset:64
  v_add_u32 v233, 118272, v235
  v_add_f32 v210, v210, v16
  v_mfma_f32_16x16x32_bf16 a[8:11], a[232:235], v[80:83], a[8:11]
  v_exp_f32 v20, v20
  v_mfma_f32_16x16x32_bf16 a[40:43], a[232:235], v[84:87], a[40:43]
  buffer_load_dwordx4 v253, s[12:15], s93 offen offset:1056 lds
  v_mfma_f32_16x16x32_bf16 a[72:75], a[232:235], v[88:91], a[72:75]
  v_exp_f32 v21, v21
  v_mfma_f32_16x16x32_bf16 a[104:107], a[232:235], v[92:95], a[104:107]
  ds_read_b128 a[200:203], v232 offset:128
  v_add_f32 v210, v210, v17
  v_cvt_pk_bf16_f32 v72, v16, v17
  v_mfma_f32_16x16x32_bf16 a[12:15], a[236:239], v[80:83], a[12:15]
  v_exp_f32 v22, v22
  v_mfma_f32_16x16x32_bf16 a[44:47], a[236:239], v[84:87], a[44:47]
  ds_read_b128 a[204:207], v232 offset:192
  v_add_f32 v210, v210, v18
  v_add_f32 v210, v210, v19
  v_mfma_f32_16x16x32_bf16 a[76:79], a[236:239], v[88:91], a[76:79]
  v_exp_f32 v23, v23
  v_mfma_f32_16x16x32_bf16 a[108:111], a[236:239], v[92:95], a[108:111]
  buffer_load_dwordx4 v254, s[12:15], s93 offen offset:2112 lds
  v_mfma_f32_16x16x32_bf16 a[16:19], a[240:243], v[80:83], a[16:19]
  v_exp_f32 v24, v24
  v_mfma_f32_16x16x32_bf16 a[48:51], a[240:243], v[84:87], a[48:51]
  ds_read_b128 a[208:211], v232 offset:512
  v_cvt_pk_bf16_f32 v73, v18, v19
  v_add_f32 v210, v210, v20
  v_mfma_f32_16x16x32_bf16 a[80:83], a[240:243], v[88:91], a[80:83]
  v_exp_f32 v25, v25
  v_mfma_f32_16x16x32_bf16 a[112:115], a[240:243], v[92:95], a[112:115]
  ds_read_b128 a[212:215], v232 offset:576
  v_add_f32 v210, v210, v21
  v_cvt_pk_bf16_f32 v74, v20, v21
  v_mfma_f32_16x16x32_bf16 a[20:23], a[244:247], v[80:83], a[20:23]
  v_exp_f32 v26, v26
  v_mfma_f32_16x16x32_bf16 a[52:55], a[244:247], v[84:87], a[52:55]
  v_add_f32 v210, v210, v22
  v_add_f32 v210, v210, v23
  v_cvt_pk_bf16_f32 v75, v22, v23
  v_mfma_f32_16x16x32_bf16 a[84:87], a[244:247], v[88:91], a[84:87]
  v_exp_f32 v27, v27
  v_mfma_f32_16x16x32_bf16 a[116:119], a[244:247], v[92:95], a[116:119]
  buffer_load_dwordx4 v255, s[12:15], s93 offen offset:3168 lds
  s_waitcnt lgkmcnt(1)
  v_mfma_f32_16x16x32_bf16 a[24:27], a[248:251], v[80:83], a[24:27]
  v_exp_f32 v28, v28
  v_mfma_f32_16x16x32_bf16 a[56:59], a[248:251], v[84:87], a[56:59]
  ds_read_b128 a[216:219], v232 offset:640
  v_add_f32 v211, v211, v24
  v_add_f32 v211, v211, v25
  v_mfma_f32_16x16x32_bf16 a[88:91], a[248:251], v[88:91], a[88:91]
  v_exp_f32 v29, v29
  v_mfma_f32_16x16x32_bf16 a[120:123], a[248:251], v[92:95], a[120:123]
  ds_read_b128 a[220:223], v232 offset:704
  v_cvt_pk_bf16_f32 v76, v24, v25
  v_add_f32 v211, v211, v26
  v_mfma_f32_16x16x32_bf16 a[28:31], a[252:255], v[80:83], a[28:31]
  v_exp_f32 v30, v30
  v_mfma_f32_16x16x32_bf16 a[60:63], a[252:255], v[84:87], a[60:63]
  v_add_f32 v211, v211, v27
  v_cvt_pk_bf16_f32 v77, v26, v27
  v_add_f32 v211, v211, v28
  v_mfma_f32_16x16x32_bf16 a[92:95], a[252:255], v[88:91], a[92:95]
  v_exp_f32 v31, v31
  v_mfma_f32_16x16x32_bf16 a[124:127], a[252:255], v[92:95], a[124:127]
  v_add_f32 v211, v211, v29
  v_cvt_pk_bf16_f32 v78, v28, v29
  v_mfma_f32_16x16x32_bf16 v[96:99], a[128:131], v[80:83], v[96:99]
  v_add_f32 v211, v211, v30
  v_add_f32 v211, v211, v31
  v_cvt_pk_bf16_f32 v79, v30, v31
  v_mfma_f32_16x16x32_bf16 v[0:3], a[192:195], v[128:131], v[192:195]
  v_exp_f32 v32, v32
  v_mfma_f32_16x16x32_bf16 v[0:3], a[196:199], v[132:135], v[0:3]
  ds_read_b64_tr_b16 a[224:225], v233 offset:0
  v_mfma_f32_16x16x32_bf16 v[0:3], a[200:203], v[136:139], v[0:3]
  v_exp_f32 v33, v33
  v_mfma_f32_16x16x32_bf16 v[0:3], a[204:207], v[140:143], v[0:3]
  s_add_u32 s93, s94, 4
  ds_read_b64_tr_b16 a[226:227], v233 offset:512
  v_cvt_pk_bf16_f32 v80, v32, v33
  v_mfma_f32_16x16x32_bf16 v[4:7], a[208:211], v[128:131], v[192:195]
  s_and_b32 s93, s93, 15
  s_waitcnt lgkmcnt(2)
  v_exp_f32 v40, v40
  v_mfma_f32_16x16x32_bf16 v[4:7], a[212:215], v[132:135], v[4:7]
  s_lshl_b32 s93, s93, 16
  ds_read_b64_tr_b16 a[228:229], v233 offset:32
  v_add_f32 v209, v209, v40
  v_mfma_f32_16x16x32_bf16 v[4:7], a[216:219], v[136:139], v[4:7]
  s_add_u32 m0, s32, 84480
  v_exp_f32 v41, v41
  v_mfma_f32_16x16x32_bf16 v[4:7], a[220:223], v[140:143], v[4:7]
  buffer_load_dwordx4 v252, s[12:15], s93 offen offset:0 lds
  v_mfma_f32_16x16x32_bf16 v[8:11], a[192:195], v[144:147], v[196:199]
  ds_read_b64_tr_b16 a[230:231], v233 offset:544
  v_exp_f32 v34, v34
  v_mfma_f32_16x16x32_bf16 v[8:11], a[196:199], v[148:151], v[8:11]
  ds_read_b64_tr_b16 a[232:233], v233 offset:64
  v_add_f32 v209, v209, v41
  v_mfma_f32_16x16x32_bf16 v[8:11], a[200:203], v[152:155], v[8:11]
  v_exp_f32 v35, v35
  v_mfma_f32_16x16x32_bf16 v[8:11], a[204:207], v[156:159], v[8:11]
  ds_read_b64_tr_b16 a[234:235], v233 offset:576
  v_cvt_pk_bf16_f32 v84, v40, v41
  v_mfma_f32_16x16x32_bf16 v[12:15], a[208:211], v[144:147], v[196:199]
  v_exp_f32 v42, v42
  v_mfma_f32_16x16x32_bf16 v[12:15], a[212:215], v[148:151], v[12:15]
  ds_read_b64_tr_b16 a[236:237], v233 offset:96
  v_cvt_pk_bf16_f32 v81, v34, v35
  v_mfma_f32_16x16x32_bf16 v[12:15], a[216:219], v[152:155], v[12:15]
  v_exp_f32 v43, v43
  v_mfma_f32_16x16x32_bf16 v[12:15], a[220:223], v[156:159], v[12:15]
  ds_read_b64_tr_b16 a[238:239], v233 offset:608
  v_add_f32 v209, v209, v42
  v_mfma_f32_16x16x32_bf16 v[16:19], a[192:195], v[160:163], v[200:203]
  v_exp_f32 v36, v36
  v_mfma_f32_16x16x32_bf16 v[16:19], a[196:199], v[164:167], v[16:19]
  ds_read_b64_tr_b16 a[240:241], v233 offset:128
  v_add_f32 v209, v209, v43
  v_mfma_f32_16x16x32_bf16 v[16:19], a[200:203], v[168:171], v[16:19]
  v_exp_f32 v37, v37
  v_mfma_f32_16x16x32_bf16 v[16:19], a[204:207], v[172:175], v[16:19]
  ds_read_b64_tr_b16 a[242:243], v233 offset:640
  v_cvt_pk_bf16_f32 v85, v42, v43
  v_mfma_f32_16x16x32_bf16 v[20:23], a[208:211], v[160:163], v[200:203]
  v_exp_f32 v44, v44
  v_mfma_f32_16x16x32_bf16 v[20:23], a[212:215], v[164:167], v[20:23]
  ds_read_b64_tr_b16 a[244:245], v233 offset:160
  v_cvt_pk_bf16_f32 v82, v36, v37
  v_mfma_f32_16x16x32_bf16 v[20:23], a[216:219], v[168:171], v[20:23]
  v_exp_f32 v45, v45
  v_mfma_f32_16x16x32_bf16 v[20:23], a[220:223], v[172:175], v[20:23]
  ds_read_b64_tr_b16 a[246:247], v233 offset:672
  v_add_f32 v209, v209, v44
  v_mfma_f32_16x16x32_bf16 v[24:27], a[192:195], v[176:179], v[204:207]
  v_exp_f32 v38, v38
  v_mfma_f32_16x16x32_bf16 v[24:27], a[196:199], v[180:183], v[24:27]
  ds_read_b64_tr_b16 a[248:249], v233 offset:192
  v_add_f32 v209, v209, v45
  v_mfma_f32_16x16x32_bf16 v[24:27], a[200:203], v[184:187], v[24:27]
  v_exp_f32 v39, v39
  v_mfma_f32_16x16x32_bf16 v[24:27], a[204:207], v[188:191], v[24:27]
  buffer_load_dwordx4 v253, s[12:15], s93 offen offset:1056 lds
  v_mfma_f32_16x16x32_bf16 v[28:31], a[208:211], v[176:179], v[204:207]
  ds_read_b64_tr_b16 a[250:251], v233 offset:704
  v_exp_f32 v46, v46
  v_mfma_f32_16x16x32_bf16 v[28:31], a[212:215], v[180:183], v[28:31]
  ds_read_b64_tr_b16 a[252:253], v233 offset:224
  v_cvt_pk_bf16_f32 v86, v44, v45
  v_mfma_f32_16x16x32_bf16 v[28:31], a[216:219], v[184:187], v[28:31]
  v_exp_f32 v47, v47
  v_mfma_f32_16x16x32_bf16 v[28:31], a[220:223], v[188:191], v[28:31]
  s_waitcnt lgkmcnt(2)
  ds_read_b64_tr_b16 a[254:255], v233 offset:736
  v_cvt_pk_bf16_f32 v83, v38, v39
  v_mfma_f32_16x16x32_bf16 a[0:3], a[224:227], v[64:67], a[0:3]
  v_exp_f32 v48, v48
  v_mfma_f32_16x16x32_bf16 a[32:35], a[224:227], v[68:71], a[32:35]
  ds_read_b128 a[192:195], v232 offset:8448
  v_add_f32 v209, v209, v46
  v_mfma_f32_16x16x32_bf16 a[64:67], a[224:227], v[72:75], a[64:67]
  v_exp_f32 v49, v49
  v_mfma_f32_16x16x32_bf16 a[96:99], a[224:227], v[76:79], a[96:99]
  v_add_f32 v209, v209, v47
  v_cvt_pk_bf16_f32 v87, v46, v47
  v_mfma_f32_16x16x32_bf16 a[4:7], a[228:231], v[64:67], a[4:7]
  ds_read_b128 a[196:199], v232 offset:8512
  v_exp_f32 v50, v50
  v_mfma_f32_16x16x32_bf16 a[36:39], a[228:231], v[68:71], a[36:39]
  v_add_f32 v210, v210, v48
  v_add_f32 v210, v210, v49
  v_mfma_f32_16x16x32_bf16 a[68:71], a[228:231], v[72:75], a[68:71]
  v_exp_f32 v51, v51
  v_mfma_f32_16x16x32_bf16 a[100:103], a[228:231], v[76:79], a[100:103]
  v_cvt_pk_bf16_f32 v88, v48, v49
  v_add_f32 v210, v210, v50
  v_mfma_f32_16x16x32_bf16 a[8:11], a[232:235], v[64:67], a[8:11]
  ds_read_b128 a[200:203], v232 offset:8576
  v_exp_f32 v52, v52
  v_mfma_f32_16x16x32_bf16 a[40:43], a[232:235], v[68:71], a[40:43]
  v_add_f32 v210, v210, v51
  v_cvt_pk_bf16_f32 v89, v50, v51
  v_mfma_f32_16x16x32_bf16 a[72:75], a[232:235], v[72:75], a[72:75]
  v_exp_f32 v53, v53
  v_mfma_f32_16x16x32_bf16 a[104:107], a[232:235], v[76:79], a[104:107]
  ds_read_b128 a[204:207], v232 offset:8640
  v_add_f32 v210, v210, v52
  v_mfma_f32_16x16x32_bf16 a[12:15], a[236:239], v[64:67], a[12:15]
  v_exp_f32 v54, v54
  v_mfma_f32_16x16x32_bf16 a[44:47], a[236:239], v[68:71], a[44:47]
  v_add_f32 v210, v210, v53
  v_cvt_pk_bf16_f32 v90, v52, v53
  v_mfma_f32_16x16x32_bf16 a[76:79], a[236:239], v[72:75], a[76:79]
  v_exp_f32 v55, v55
  v_mfma_f32_16x16x32_bf16 a[108:111], a[236:239], v[76:79], a[108:111]
  buffer_load_dwordx4 v254, s[12:15], s93 offen offset:2112 lds
  v_mfma_f32_16x16x32_bf16 a[16:19], a[240:243], v[64:67], a[16:19]
  ds_read_b128 a[208:211], v232 offset:8960
  v_exp_f32 v56, v56
  v_mfma_f32_16x16x32_bf16 a[48:51], a[240:243], v[68:71], a[48:51]
  v_add_f32 v210, v210, v54
  v_add_f32 v210, v210, v55
  v_mfma_f32_16x16x32_bf16 a[80:83], a[240:243], v[72:75], a[80:83]
  ds_read_b128 a[212:215], v232 offset:9024
  v_exp_f32 v57, v57
  v_mfma_f32_16x16x32_bf16 a[112:115], a[240:243], v[76:79], a[112:115]
  v_cvt_pk_bf16_f32 v91, v54, v55
  v_add_f32 v211, v211, v56
  v_mfma_f32_16x16x32_bf16 a[20:23], a[244:247], v[64:67], a[20:23]
  v_exp_f32 v58, v58
  v_mfma_f32_16x16x32_bf16 a[52:55], a[244:247], v[68:71], a[52:55]
  v_add_f32 v211, v211, v57
  v_cvt_pk_bf16_f32 v92, v56, v57
  v_mfma_f32_16x16x32_bf16 a[84:87], a[244:247], v[72:75], a[84:87]
  ds_read_b128 a[216:219], v232 offset:9088
  v_exp_f32 v59, v59
  v_mfma_f32_16x16x32_bf16 a[116:119], a[244:247], v[76:79], a[116:119]
  s_waitcnt lgkmcnt(1)
  v_add_f32 v211, v211, v58
  v_add_f32 v211, v211, v59
  v_mfma_f32_16x16x32_bf16 a[24:27], a[248:251], v[64:67], a[24:27]
  v_exp_f32 v60, v60
  v_mfma_f32_16x16x32_bf16 a[56:59], a[248:251], v[68:71], a[56:59]
  ds_read_b128 a[220:223], v232 offset:9152
  v_cvt_pk_bf16_f32 v93, v58, v59
  v_mfma_f32_16x16x32_bf16 a[88:91], a[248:251], v[72:75], a[88:91]
  v_exp_f32 v61, v61
  v_mfma_f32_16x16x32_bf16 a[120:123], a[248:251], v[76:79], a[120:123]
  v_add_f32 v211, v211, v60
  v_add_f32 v211, v211, v61
  v_mfma_f32_16x16x32_bf16 a[28:31], a[252:255], v[64:67], a[28:31]
  v_exp_f32 v62, v62
  v_mfma_f32_16x16x32_bf16 a[60:63], a[252:255], v[68:71], a[60:63]
  v_cvt_pk_bf16_f32 v94, v60, v61
  v_add_f32 v211, v211, v62
  v_mfma_f32_16x16x32_bf16 a[92:95], a[252:255], v[72:75], a[92:95]
  v_exp_f32 v63, v63
  v_mfma_f32_16x16x32_bf16 a[124:127], a[252:255], v[76:79], a[124:127]
  v_add_f32 v211, v211, v63
  v_cvt_pk_bf16_f32 v95, v62, v63
  v_mfma_f32_16x16x32_bf16 v[96:99], a[128:131], v[64:67], v[96:99]
  v_mfma_f32_16x16x32_bf16 v[32:35], a[192:195], v[128:131], v[192:195]
  v_exp_f32 v0, v0
  v_mfma_f32_16x16x32_bf16 v[32:35], a[196:199], v[132:135], v[32:35]
  ds_read_b64_tr_b16 a[224:225], v233 offset:8448
  v_mfma_f32_16x16x32_bf16 v[32:35], a[200:203], v[136:139], v[32:35]
  v_exp_f32 v1, v1
  v_mfma_f32_16x16x32_bf16 v[32:35], a[204:207], v[140:143], v[32:35]
  buffer_load_dwordx4 v255, s[12:15], s93 offen offset:3168 lds
  v_mfma_f32_16x16x32_bf16 v[36:39], a[208:211], v[128:131], v[192:195]
  ds_read_b64_tr_b16 a[226:227], v233 offset:8960
  v_exp_f32 v8, v8
  v_mfma_f32_16x16x32_bf16 v[36:39], a[212:215], v[132:135], v[36:39]
  s_waitcnt lgkmcnt(2)
  ds_read_b64_tr_b16 a[228:229], v233 offset:8480
  v_cvt_pk_bf16_f32 v64, v0, v1
  v_mfma_f32_16x16x32_bf16 v[36:39], a[216:219], v[136:139], v[36:39]
  v_exp_f32 v9, v9
  v_mfma_f32_16x16x32_bf16 v[36:39], a[220:223], v[140:143], v[36:39]
  ds_read_b64_tr_b16 a[230:231], v233 offset:8992
  v_add_f32 v209, v209, v8
  v_mfma_f32_16x16x32_bf16 v[40:43], a[192:195], v[144:147], v[196:199]
  v_exp_f32 v2, v2
  v_mfma_f32_16x16x32_bf16 v[40:43], a[196:199], v[148:151], v[40:43]
  ds_read_b64_tr_b16 a[232:233], v233 offset:8512
  v_add_f32 v209, v209, v9
  v_mfma_f32_16x16x32_bf16 v[40:43], a[200:203], v[152:155], v[40:43]
  v_exp_f32 v3, v3
  v_mfma_f32_16x16x32_bf16 v[40:43], a[204:207], v[156:159], v[40:43]
  ds_read_b64_tr_b16 a[234:235], v233 offset:9024
  v_cvt_pk_bf16_f32 v68, v8, v9
  v_mfma_f32_16x16x32_bf16 v[44:47], a[208:211], v[144:147], v[196:199]
  v_exp_f32 v10, v10
  v_mfma_f32_16x16x32_bf16 v[44:47], a[212:215], v[148:151], v[44:47]
  ds_read_b64_tr_b16 a[236:237], v233 offset:8544
  v_cvt_pk_bf16_f32 v65, v2, v3
  v_mfma_f32_16x16x32_bf16 v[44:47], a[216:219], v[152:155], v[44:47]
  v_exp_f32 v11, v11
  v_mfma_f32_16x16x32_bf16 v[44:47], a[220:223], v[156:159], v[44:47]
  ds_read_b64_tr_b16 a[238:239], v233 offset:9056
  v_add_f32 v209, v209, v10
  v_mfma_f32_16x16x32_bf16 v[48:51], a[192:195], v[160:163], v[200:203]
  v_exp_f32 v4, v4
  v_mfma_f32_16x16x32_bf16 v[48:51], a[196:199], v[164:167], v[48:51]
  ds_read_b64_tr_b16 a[240:241], v233 offset:8576
  v_add_f32 v209, v209, v11
  v_mfma_f32_16x16x32_bf16 v[48:51], a[200:203], v[168:171], v[48:51]
  v_exp_f32 v5, v5
  v_mfma_f32_16x16x32_bf16 v[48:51], a[204:207], v[172:175], v[48:51]
  ds_read_b64_tr_b16 a[242:243], v233 offset:9088
  v_cvt_pk_bf16_f32 v69, v10, v11
  v_mfma_f32_16x16x32_bf16 v[52:55], a[208:211], v[160:163], v[200:203]
  v_exp_f32 v12, v12
  v_mfma_f32_16x16x32_bf16 v[52:55], a[212:215], v[164:167], v[52:55]
  ds_read_b64_tr_b16 a[244:245], v233 offset:8608
  v_cvt_pk_bf16_f32 v66, v4, v5
  v_mfma_f32_16x16x32_bf16 v[52:55], a[216:219], v[168:171], v[52:55]
  v_exp_f32 v13, v13
  v_mfma_f32_16x16x32_bf16 v[52:55], a[220:223], v[172:175], v[52:55]
  ds_read_b64_tr_b16 a[246:247], v233 offset:9120
  v_add_f32 v209, v209, v12
  v_mfma_f32_16x16x32_bf16 v[56:59], a[192:195], v[176:179], v[204:207]
  v_exp_f32 v6, v6
  v_mfma_f32_16x16x32_bf16 v[56:59], a[196:199], v[180:183], v[56:59]
  ds_read_b64_tr_b16 a[248:249], v233 offset:8640
  v_add_f32 v209, v209, v13
  v_mfma_f32_16x16x32_bf16 v[56:59], a[200:203], v[184:187], v[56:59]
  v_exp_f32 v7, v7
  v_mfma_f32_16x16x32_bf16 v[56:59], a[204:207], v[188:191], v[56:59]
  ds_read_b64_tr_b16 a[250:251], v233 offset:9152
  v_cvt_pk_bf16_f32 v70, v12, v13
  v_mfma_f32_16x16x32_bf16 v[60:63], a[208:211], v[176:179], v[204:207]
  v_exp_f32 v14, v14
  v_mfma_f32_16x16x32_bf16 v[60:63], a[212:215], v[180:183], v[60:63]
  s_waitcnt vmcnt(17)
  ds_read_b64_tr_b16 a[252:253], v233 offset:8672
  v_cvt_pk_bf16_f32 v67, v6, v7
  v_mfma_f32_16x16x32_bf16 v[60:63], a[216:219], v[184:187], v[60:63]
  s_barrier
  v_exp_f32 v15, v15
  v_mfma_f32_16x16x32_bf16 v[60:63], a[220:223], v[188:191], v[60:63]
  s_add_u32 s93, s94, 5
  s_waitcnt lgkmcnt(2)
  ds_read_b64_tr_b16 a[254:255], v233 offset:9184
  v_add_f32 v209, v209, v14
  v_mfma_f32_16x16x32_bf16 a[0:3], a[224:227], v[80:83], a[0:3]
  s_and_b32 s93, s93, 15
  v_exp_f32 v16, v16
  v_mfma_f32_16x16x32_bf16 a[32:35], a[224:227], v[84:87], a[32:35]
  s_lshl_b32 s93, s93, 16
  v_add_f32 v209, v209, v15
  v_cvt_pk_bf16_f32 v71, v14, v15
  v_mfma_f32_16x16x32_bf16 a[64:67], a[224:227], v[88:91], a[64:67]
  s_add_u32 m0, s32, 101376
  v_exp_f32 v17, v17
  v_mfma_f32_16x16x32_bf16 a[96:99], a[224:227], v[92:95], a[96:99]
  buffer_load_dwordx4 v252, s[12:15], s93 offen offset:0 lds
  v_mfma_f32_16x16x32_bf16 a[4:7], a[228:231], v[80:83], a[4:7]
  v_exp_f32 v18, v18
  v_mfma_f32_16x16x32_bf16 a[36:39], a[228:231], v[84:87], a[36:39]
  buffer_load_dwordx4 v253, s[12:15], s93 offen offset:1056 lds
  v_mfma_f32_16x16x32_bf16 a[68:71], a[228:231], v[88:91], a[68:71]
  v_exp_f32 v19, v19
  v_mfma_f32_16x16x32_bf16 a[100:103], a[228:231], v[92:95], a[100:103]
  v_add_u32 v233, 0, v235
  ds_read_b64_tr_b16 a[192:193], v233 offset:0
  ds_read_b64_tr_b16 a[194:195], v233 offset:512
  ds_read_b64_tr_b16 a[196:197], v233 offset:32
  v_add_f32 v210, v210, v16
  v_mfma_f32_16x16x32_bf16 a[8:11], a[232:235], v[80:83], a[8:11]
  ds_read_b64_tr_b16 a[198:199], v233 offset:544
  v_exp_f32 v20, v20
  v_mfma_f32_16x16x32_bf16 a[40:43], a[232:235], v[84:87], a[40:43]
  buffer_load_dwordx4 v254, s[12:15], s93 offen offset:2112 lds
  v_mfma_f32_16x16x32_bf16 a[72:75], a[232:235], v[88:91], a[72:75]
  ds_read_b64_tr_b16 a[200:201], v233 offset:64
  v_exp_f32 v21, v21
  v_mfma_f32_16x16x32_bf16 a[104:107], a[232:235], v[92:95], a[104:107]
  v_add_f32 v210, v210, v17
  v_cvt_pk_bf16_f32 v72, v16, v17
  v_add_f32 v210, v210, v18
  v_mfma_f32_16x16x32_bf16 a[12:15], a[236:239], v[80:83], a[12:15]
  ds_read_b64_tr_b16 a[202:203], v233 offset:576
  v_exp_f32 v22, v22
  v_mfma_f32_16x16x32_bf16 a[44:47], a[236:239], v[84:87], a[44:47]
  buffer_load_dwordx4 v255, s[12:15], s93 offen offset:3168 lds
  s_add_u32 s93, s94, 6
  s_and_b32 s93, s93, 15
  s_lshl_b32 s93, s93, 16
  v_mfma_f32_16x16x32_bf16 a[76:79], a[236:239], v[88:91], a[76:79]
  s_add_u32 m0, s32, 118272
  ds_read_b64_tr_b16 a[204:205], v233 offset:96
  v_exp_f32 v23, v23
  v_mfma_f32_16x16x32_bf16 a[108:111], a[236:239], v[92:95], a[108:111]
  buffer_load_dwordx4 v252, s[12:15], s93 offen offset:0 lds
  v_mfma_f32_16x16x32_bf16 a[16:19], a[240:243], v[80:83], a[16:19]
  ds_read_b64_tr_b16 a[206:207], v233 offset:608
  v_exp_f32 v24, v24
  v_mfma_f32_16x16x32_bf16 a[48:51], a[240:243], v[84:87], a[48:51]
  ds_read_b64_tr_b16 a[208:209], v233 offset:128
  v_add_f32 v210, v210, v19
  v_cvt_pk_bf16_f32 v73, v18, v19
  v_mfma_f32_16x16x32_bf16 a[80:83], a[240:243], v[88:91], a[80:83]
  ds_read_b64_tr_b16 a[210:211], v233 offset:640
  v_exp_f32 v25, v25
  v_mfma_f32_16x16x32_bf16 a[112:115], a[240:243], v[92:95], a[112:115]
  buffer_load_dwordx4 v253, s[12:15], s93 offen offset:1056 lds
  v_mfma_f32_16x16x32_bf16 a[20:23], a[244:247], v[80:83], a[20:23]
  ds_read_b64_tr_b16 a[212:213], v233 offset:160
  v_exp_f32 v26, v26
  v_mfma_f32_16x16x32_bf16 a[52:55], a[244:247], v[84:87], a[52:55]
  ds_read_b64_tr_b16 a[214:215], v233 offset:672
  v_add_f32 v210, v210, v20
  v_add_f32 v210, v210, v21
  v_mfma_f32_16x16x32_bf16 a[84:87], a[244:247], v[88:91], a[84:87]
  v_exp_f32 v27, v27
  v_mfma_f32_16x16x32_bf16 a[116:119], a[244:247], v[92:95], a[116:119]
  buffer_load_dwordx4 v254, s[12:15], s93 offen offset:2112 lds
  s_waitcnt lgkmcnt(3)
  v_mfma_f32_16x16x32_bf16 a[24:27], a[248:251], v[80:83], a[24:27]
  v_exp_f32 v28, v28
  v_mfma_f32_16x16x32_bf16 a[56:59], a[248:251], v[84:87], a[56:59]
  buffer_load_dwordx4 v255, s[12:15], s93 offen offset:3168 lds
  v_mfma_f32_16x16x32_bf16 a[88:91], a[248:251], v[88:91], a[88:91]
  v_exp_f32 v29, v29
  v_mfma_f32_16x16x32_bf16 a[120:123], a[248:251], v[92:95], a[120:123]
  ds_read_b64_tr_b16 a[216:217], v233 offset:192
  v_cvt_pk_bf16_f32 v74, v20, v21
  v_add_f32 v210, v210, v22
  v_mfma_f32_16x16x32_bf16 a[28:31], a[252:255], v[80:83], a[28:31]
  v_exp_f32 v30, v30
  v_mfma_f32_16x16x32_bf16 a[60:63], a[252:255], v[84:87], a[60:63]
  ds_read_b64_tr_b16 a[218:219], v233 offset:704
  v_add_f32 v210, v210, v23
  v_cvt_pk_bf16_f32 v75, v22, v23
  v_mfma_f32_16x16x32_bf16 a[92:95], a[252:255], v[88:91], a[92:95]
  v_exp_f32 v31, v31
  v_mfma_f32_16x16x32_bf16 a[124:127], a[252:255], v[92:95], a[124:127]
  ds_read_b64_tr_b16 a[220:221], v233 offset:224
  v_add_f32 v211, v211, v24
  v_add_f32 v211, v211, v25
  v_mfma_f32_16x16x32_bf16 v[96:99], a[128:131], v[80:83], v[96:99]
  ds_read_b64_tr_b16 a[222:223], v233 offset:736
  v_cvt_pk_bf16_f32 v76, v24, v25
  v_add_f32 v211, v211, v26
  v_add_f32 v211, v211, v27
  v_cvt_pk_bf16_f32 v77, v26, v27
  v_add_f32 v211, v211, v28
  v_add_f32 v211, v211, v29
  v_cvt_pk_bf16_f32 v78, v28, v29
  v_add_f32 v211, v211, v30
  v_add_f32 v211, v211, v31
  v_cvt_pk_bf16_f32 v79, v30, v31
  v_exp_f32 v32, v32
  v_exp_f32 v33, v33
  v_exp_f32 v34, v34
  v_mfma_f32_16x16x32_bf16 a[0:3], a[192:195], v[64:67], a[0:3]
  ds_read_b64_tr_b16 a[224:225], v233 offset:8448
  v_cvt_pk_bf16_f32 v80, v32, v33
  v_exp_f32 v35, v35
  v_exp_f32 v36, v36
  v_mfma_f32_16x16x32_bf16 a[4:7], a[196:199], v[64:67], a[4:7]
  ds_read_b64_tr_b16 a[226:227], v233 offset:8960
  v_cvt_pk_bf16_f32 v81, v34, v35
  v_exp_f32 v37, v37
  v_mfma_f32_16x16x32_bf16 a[8:11], a[200:203], v[64:67], a[8:11]
  ds_read_b64_tr_b16 a[228:229], v233 offset:8480
  v_cvt_pk_bf16_f32 v82, v36, v37
  v_exp_f32 v38, v38
  v_exp_f32 v39, v39
  v_mfma_f32_16x16x32_bf16 a[12:15], a[204:207], v[64:67], a[12:15]
  s_waitcnt lgkmcnt(2)
  ds_read_b64_tr_b16 a[230:231], v233 offset:8992
  v_exp_f32 v40, v40
  v_cvt_pk_bf16_f32 v83, v38, v39
  v_add_f32 v209, v209, v40
  v_mfma_f32_16x16x32_bf16 a[16:19], a[208:211], v[64:67], a[16:19]
  ds_read_b64_tr_b16 a[232:233], v233 offset:8512
  v_exp_f32 v41, v41
  v_mfma_f32_16x16x32_bf16 a[20:23], a[212:215], v[64:67], a[20:23]
  ds_read_b64_tr_b16 a[234:235], v233 offset:9024
  v_add_f32 v209, v209, v41
  v_cvt_pk_bf16_f32 v84, v40, v41
  v_mfma_f32_16x16x32_bf16 a[24:27], a[216:219], v[64:67], a[24:27]
  ds_read_b64_tr_b16 a[236:237], v233 offset:8544
  v_exp_f32 v42, v42
  v_mfma_f32_16x16x32_bf16 a[28:31], a[220:223], v[64:67], a[28:31]
  ds_read_b64_tr_b16 a[238:239], v233 offset:9056
  v_add_f32 v209, v209, v42
  v_exp_f32 v43, v43
  v_mfma_f32_16x16x32_bf16 v[96:99], a[128:131], v[64:67], v[96:99]
  ds_read_b64_tr_b16 a[240:241], v233 offset:8576
  v_add_f32 v209, v209, v43
  ds_read_b64_tr_b16 a[242:243], v233 offset:9088
  v_mfma_f32_16x16x32_bf16 v[96:99], a[128:131], v[80:83], v[96:99]
  ds_read_b64_tr_b16 a[244:245], v233 offset:8608
  v_cvt_pk_bf16_f32 v85, v42, v43
  s_waitcnt lgkmcnt(5)
  ds_read_b64_tr_b16 a[246:247], v233 offset:9120
  v_mfma_f32_16x16x32_bf16 a[0:3], a[224:227], v[80:83], a[0:3]
  ds_read_b64_tr_b16 a[248:249], v233 offset:8640
  v_exp_f32 v44, v44
  ds_read_b64_tr_b16 a[250:251], v233 offset:9152
  v_add_f32 v209, v209, v44
  v_mfma_f32_16x16x32_bf16 a[4:7], a[228:231], v[80:83], a[4:7]
  ds_read_b64_tr_b16 a[252:253], v233 offset:8672
  v_exp_f32 v45, v45
  ds_read_b64_tr_b16 a[254:255], v233 offset:9184
  v_mfma_f32_16x16x32_bf16 a[8:11], a[232:235], v[80:83], a[8:11]
  s_lshl_b32 s35, s3, 2
  s_waitcnt lgkmcnt(5)
  v_mov_b32 v230, 152064
  v_rcp_f32 v216, v96
  v_add_f32 v209, v209, v45
  v_mfma_f32_16x16x32_bf16 a[12:15], a[236:239], v[80:83], a[12:15]
  s_add_u32 s35, s35, 152064
  v_mov_b32 v229, s35
  v_cvt_pk_bf16_f32 v86, v44, v45
  v_mfma_f32_16x16x32_bf16 a[16:19], a[240:243], v[80:83], a[16:19]
  s_mov_b32 s33, 0x4b800000
  s_waitcnt lgkmcnt(0)
  v_exp_f32 v46, v46
  v_cmp_nge_f32 vcc, s33, v96
  v_add_f32 v209, v209, v46
  v_mfma_f32_16x16x32_bf16 a[20:23], a[244:247], v[80:83], a[20:23]
  s_mov_b64 s[54:55], 0
  v_exp_f32 v47, v47
  v_mfma_f32_16x16x32_bf16 a[24:27], a[248:251], v[80:83], a[24:27]
  s_or_b64 s[54:55], s[54:55], vcc
  v_add_f32 v209, v209, v47
  v_cvt_pk_bf16_f32 v87, v46, v47
  v_mfma_f32_16x16x32_bf16 a[28:31], a[252:255], v[80:83], a[28:31]
  v_mfma_f32_16x16x32_bf16 a[32:35], a[192:195], v[68:71], a[32:35]
  v_exp_f32 v48, v48
  v_mfma_f32_16x16x32_bf16 a[32:35], a[224:227], v[84:87], a[32:35]
  v_add_f32 v210, v210, v48
  v_exp_f32 v49, v49
  v_accvgpr_read_b32 v104, a0
  v_accvgpr_read_b32 v105, a1
  v_accvgpr_read_b32 v106, a2
  v_mfma_f32_16x16x32_bf16 a[36:39], a[196:199], v[68:71], a[36:39]
  v_accvgpr_read_b32 v107, a3
  v_accvgpr_read_b32 v108, a4
  v_accvgpr_read_b32 v109, a5
  v_accvgpr_read_b32 v110, a6
  v_accvgpr_read_b32 v111, a7
  v_mul_f32 v104, v216, v104
  v_mfma_f32_16x16x32_bf16 a[36:39], a[228:231], v[84:87], a[36:39]
  s_mov_b32 s34, 0
  v_mul_f32 v105, v216, v105
  v_mul_f32 v106, v216, v106
  v_mul_f32 v107, v216, v107
  v_mul_f32 v108, v216, v108
  v_mul_f32 v109, v216, v109
  v_mul_f32 v110, v216, v110
  v_mfma_f32_16x16x32_bf16 a[40:43], a[200:203], v[68:71], a[40:43]
  v_mul_f32 v111, v216, v111
  v_cvt_pk_bf16_f32 v112, v104, v105
  v_cvt_pk_bf16_f32 v113, v106, v107
  v_cvt_pk_bf16_f32 v114, v108, v109
  v_cvt_pk_bf16_f32 v115, v110, v111
  v_add_f32 v210, v210, v49
  v_mfma_f32_16x16x32_bf16 a[40:43], a[232:235], v[84:87], a[40:43]
  buffer_store_dwordx4 v[112:115], v238, s[24:27], s34 offen offset:0
  v_cvt_pk_bf16_f32 v88, v48, v49
  v_exp_f32 v50, v50
  v_mfma_f32_16x16x32_bf16 a[44:47], a[204:207], v[68:71], a[44:47]
  s_mov_b32 s34, 8192
  v_add_f32 v210, v210, v50
  v_accvgpr_read_b32 v116, a8
  v_accvgpr_read_b32 v117, a9
  v_accvgpr_read_b32 v118, a10
  v_accvgpr_read_b32 v119, a11
  v_accvgpr_read_b32 v120, a12
  v_mfma_f32_16x16x32_bf16 a[44:47], a[236:239], v[84:87], a[44:47]
  v_accvgpr_read_b32 v121, a13
  v_accvgpr_read_b32 v122, a14
  v_accvgpr_read_b32 v123, a15
  v_mul_f32 v116, v216, v116
  v_mul_f32 v117, v216, v117
  v_mul_f32 v118, v216, v118
  v_mfma_f32_16x16x32_bf16 a[48:51], a[208:211], v[68:71], a[48:51]
  v_mul_f32 v119, v216, v119
  v_mul_f32 v120, v216, v120
  v_mul_f32 v121, v216, v121
  v_mul_f32 v122, v216, v122
  v_mul_f32 v123, v216, v123
  v_cvt_pk_bf16_f32 v124, v116, v117
  v_mfma_f32_16x16x32_bf16 a[48:51], a[240:243], v[84:87], a[48:51]
  v_cvt_pk_bf16_f32 v125, v118, v119
  v_cvt_pk_bf16_f32 v126, v120, v121
  v_cvt_pk_bf16_f32 v127, v122, v123
  v_exp_f32 v51, v51
  v_mov_b32 v225, v209
  v_mfma_f32_16x16x32_bf16 a[52:55], a[212:215], v[68:71], a[52:55]
  buffer_store_dwordx4 v[124:127], v238, s[24:27], s34 offen offset:0
  v_add_f32 v210, v210, v51
  v_permlane16_swap_b32 v209, v225
  v_cvt_pk_bf16_f32 v89, v50, v51
  v_mfma_f32_16x16x32_bf16 a[52:55], a[244:247], v[84:87], a[52:55]
  s_mov_b32 s34, 16384
  v_accvgpr_read_b32 v104, a16
  v_accvgpr_read_b32 v105, a17
  v_accvgpr_read_b32 v106, a18
  v_accvgpr_read_b32 v107, a19
  v_accvgpr_read_b32 v108, a20
  v_accvgpr_read_b32 v109, a21
  v_mfma_f32_16x16x32_bf16 a[56:59], a[216:219], v[68:71], a[56:59]
  v_accvgpr_read_b32 v110, a22
  v_accvgpr_read_b32 v111, a23
  v_mul_f32 v104, v216, v104
  v_mul_f32 v105, v216, v105
  v_mul_f32 v106, v216, v106
  v_mul_f32 v107, v216, v107
  v_mul_f32 v108, v216, v108
  v_mul_f32 v109, v216, v109
  v_mul_f32 v110, v216, v110
  v_mul_f32 v111, v216, v111
  v_cvt_pk_bf16_f32 v112, v104, v105
  v_cvt_pk_bf16_f32 v113, v106, v107
  v_cvt_pk_bf16_f32 v114, v108, v109
  v_cvt_pk_bf16_f32 v115, v110, v111
  v_mfma_f32_16x16x32_bf16 a[56:59], a[248:251], v[84:87], a[56:59]
  buffer_store_dwordx4 v[112:115], v238, s[24:27], s34 offen offset:0
  v_add_f32 v209, v209, v225
  v_exp_f32 v52, v52
  v_mfma_f32_16x16x32_bf16 a[60:63], a[220:223], v[68:71], a[60:63]
  s_mov_b32 s34, 24576
  v_add_f32 v210, v210, v52
  v_mov_b32 v225, v209
  v_exp_f32 v53, v53
  v_accvgpr_read_b32 v116, a24
  v_permlane32_swap_b32 v209, v225
  v_mfma_f32_16x16x32_bf16 a[60:63], a[252:255], v[84:87], a[60:63]
  v_add_f32 v210, v210, v53
  v_accvgpr_read_b32 v117, a25
  v_accvgpr_read_b32 v118, a26
  v_accvgpr_read_b32 v119, a27
  v_accvgpr_read_b32 v120, a28
  v_accvgpr_read_b32 v121, a29
  v_accvgpr_read_b32 v122, a30
  v_accvgpr_read_b32 v123, a31
  v_mul_f32 v116, v216, v116
  v_mul_f32 v117, v216, v117
  v_mul_f32 v118, v216, v118
  v_mul_f32 v119, v216, v119
  v_mul_f32 v120, v216, v120
  v_mul_f32 v121, v216, v121
  v_mul_f32 v122, v216, v122
  v_mul_f32 v123, v216, v123
  v_cvt_pk_bf16_f32 v124, v116, v117
  v_cvt_pk_bf16_f32 v125, v118, v119
  v_cvt_pk_bf16_f32 v126, v120, v121
  v_cvt_pk_bf16_f32 v127, v122, v123
  v_mfma_f32_16x16x32_bf16 a[64:67], a[192:195], v[72:75], a[64:67]
  buffer_store_dwordx4 v[124:127], v238, s[24:27], s34 offen offset:0
  v_add_f32 v209, v209, v225
  v_cvt_pk_bf16_f32 v90, v52, v53
  v_cmp_nge_f32 vcc, s33, v209
  v_exp_f32 v54, v54
  v_exp_f32 v55, v55
  s_nop 0
  v_cvt_pk_bf16_f32 v91, v54, v55
  s_nop 1
  v_mfma_f32_16x16x32_bf16 a[64:67], a[224:227], v[88:91], a[64:67]
  s_or_b64 s[54:55], s[54:55], vcc
  v_rcp_f32 v217, v209
  v_add_f32 v210, v210, v54
  v_add_f32 v210, v210, v55
  v_exp_f32 v56, v56
  v_mfma_f32_16x16x32_bf16 a[68:71], a[196:199], v[72:75], a[68:71]
  v_add_f32 v211, v211, v56
  v_exp_f32 v57, v57
  v_accvgpr_read_b32 v0, a32
  v_accvgpr_read_b32 v1, a33
  v_accvgpr_read_b32 v2, a34
  v_mfma_f32_16x16x32_bf16 a[68:71], a[228:231], v[88:91], a[68:71]
  s_mov_b32 s34, 0
  v_accvgpr_read_b32 v3, a35
  v_accvgpr_read_b32 v4, a36
  v_accvgpr_read_b32 v5, a37
  v_accvgpr_read_b32 v6, a38
  v_accvgpr_read_b32 v7, a39
  v_mul_f32 v0, v217, v0
  v_mfma_f32_16x16x32_bf16 a[72:75], a[200:203], v[72:75], a[72:75]
  v_mul_f32 v1, v217, v1
  v_mul_f32 v2, v217, v2
  v_mul_f32 v3, v217, v3
  v_mul_f32 v4, v217, v4
  v_mul_f32 v5, v217, v5
  v_mul_f32 v6, v217, v6
  v_mfma_f32_16x16x32_bf16 a[72:75], a[232:235], v[88:91], a[72:75]
  v_mul_f32 v7, v217, v7
  v_cvt_pk_bf16_f32 v8, v0, v1
  v_cvt_pk_bf16_f32 v9, v2, v3
  v_cvt_pk_bf16_f32 v10, v4, v5
  v_cvt_pk_bf16_f32 v11, v6, v7
  v_add_f32 v211, v211, v57
  v_mfma_f32_16x16x32_bf16 a[76:79], a[204:207], v[72:75], a[76:79]
  buffer_store_dwordx4 v[8:11], v238, s[24:27], s34 offen offset:1024
  v_cvt_pk_bf16_f32 v92, v56, v57
  v_exp_f32 v58, v58
  v_mfma_f32_16x16x32_bf16 a[76:79], a[236:239], v[88:91], a[76:79]
  s_mov_b32 s34, 8192
  v_add_f32 v211, v211, v58
  v_accvgpr_read_b32 v16, a40
  v_accvgpr_read_b32 v17, a41
  v_accvgpr_read_b32 v18, a42
  v_accvgpr_read_b32 v19, a43
  v_accvgpr_read_b32 v20, a44
  v_mfma_f32_16x16x32_bf16 a[80:83], a[208:211], v[72:75], a[80:83]
  v_accvgpr_read_b32 v21, a45
  v_accvgpr_read_b32 v22, a46
  v_accvgpr_read_b32 v23, a47
  v_mul_f32 v16, v217, v16
  v_mul_f32 v17, v217, v17
  v_mul_f32 v18, v217, v18
  v_mfma_f32_16x16x32_bf16 a[80:83], a[240:243], v[88:91], a[80:83]
  v_mul_f32 v19, v217, v19
  v_mul_f32 v20, v217, v20
  v_mul_f32 v21, v217, v21
  v_mul_f32 v22, v217, v22
  v_mul_f32 v23, v217, v23
  v_cvt_pk_bf16_f32 v24, v16, v17
  v_cvt_pk_bf16_f32 v25, v18, v19
  v_cvt_pk_bf16_f32 v26, v20, v21
  v_cvt_pk_bf16_f32 v27, v22, v23
  v_mfma_f32_16x16x32_bf16 a[84:87], a[212:215], v[72:75], a[84:87]
  buffer_store_dwordx4 v[24:27], v238, s[24:27], s34 offen offset:1024
  v_exp_f32 v59, v59
  v_mov_b32 v226, v210
  v_mfma_f32_16x16x32_bf16 a[84:87], a[244:247], v[88:91], a[84:87]
  s_mov_b32 s34, 16384
  v_add_f32 v211, v211, v59
  v_permlane16_swap_b32 v210, v226
  v_cvt_pk_bf16_f32 v93, v58, v59
  v_accvgpr_read_b32 v0, a48
  v_accvgpr_read_b32 v1, a49
  v_accvgpr_read_b32 v2, a50
  v_mfma_f32_16x16x32_bf16 a[88:91], a[216:219], v[72:75], a[88:91]
  v_accvgpr_read_b32 v3, a51
  v_accvgpr_read_b32 v4, a52
  v_accvgpr_read_b32 v5, a53
  v_accvgpr_read_b32 v6, a54
  v_accvgpr_read_b32 v7, a55
  v_mul_f32 v0, v217, v0
  v_mul_f32 v1, v217, v1
  v_mul_f32 v2, v217, v2
  v_mul_f32 v3, v217, v3
  v_mul_f32 v4, v217, v4
  v_mul_f32 v5, v217, v5
  v_mul_f32 v6, v217, v6
  v_mul_f32 v7, v217, v7
  v_cvt_pk_bf16_f32 v8, v0, v1
  v_cvt_pk_bf16_f32 v9, v2, v3
  v_cvt_pk_bf16_f32 v10, v4, v5
  v_cvt_pk_bf16_f32 v11, v6, v7
  v_mfma_f32_16x16x32_bf16 a[88:91], a[248:251], v[88:91], a[88:91]
  buffer_store_dwordx4 v[8:11], v238, s[24:27], s34 offen offset:1024
  v_add_f32 v210, v210, v226
  v_exp_f32 v60, v60
  v_mfma_f32_16x16x32_bf16 a[92:95], a[220:223], v[72:75], a[92:95]
  s_mov_b32 s34, 24576
  v_add_f32 v211, v211, v60
  v_mov_b32 v226, v210
  v_exp_f32 v61, v61
  v_accvgpr_read_b32 v16, a56
  v_permlane32_swap_b32 v210, v226
  v_mfma_f32_16x16x32_bf16 a[92:95], a[252:255], v[88:91], a[92:95]
  v_add_f32 v211, v211, v61
  v_accvgpr_read_b32 v17, a57
  v_accvgpr_read_b32 v18, a58
  v_accvgpr_read_b32 v19, a59
  v_accvgpr_read_b32 v20, a60
  v_accvgpr_read_b32 v21, a61
  v_accvgpr_read_b32 v22, a62
  v_accvgpr_read_b32 v23, a63
  v_mul_f32 v16, v217, v16
  v_mul_f32 v17, v217, v17
  v_mul_f32 v18, v217, v18
  v_mul_f32 v19, v217, v19
  v_mul_f32 v20, v217, v20
  v_mul_f32 v21, v217, v21
  v_mul_f32 v22, v217, v22
  v_mul_f32 v23, v217, v23
  v_cvt_pk_bf16_f32 v24, v16, v17
  v_cvt_pk_bf16_f32 v25, v18, v19
  v_cvt_pk_bf16_f32 v26, v20, v21
  v_cvt_pk_bf16_f32 v27, v22, v23
  v_mfma_f32_16x16x32_bf16 a[96:99], a[192:195], v[76:79], a[96:99]
  buffer_store_dwordx4 v[24:27], v238, s[24:27], s34 offen offset:1024
  v_add_f32 v210, v210, v226
  v_cvt_pk_bf16_f32 v94, v60, v61
  v_cmp_nge_f32 vcc, s33, v210
  v_exp_f32 v62, v62
  v_exp_f32 v63, v63
  s_nop 0
  v_cvt_pk_bf16_f32 v95, v62, v63
  s_nop 1
  v_mfma_f32_16x16x32_bf16 a[96:99], a[224:227], v[92:95], a[96:99]
  s_or_b64 s[54:55], s[54:55], vcc
  v_rcp_f32 v218, v210
  v_add_f32 v211, v211, v62
  v_add_f32 v211, v211, v63
  v_accvgpr_read_b32 v0, a64
  v_accvgpr_read_b32 v1, a65
  v_mfma_f32_16x16x32_bf16 a[100:103], a[196:199], v[76:79], a[100:103]
  v_accvgpr_read_b32 v2, a66
  v_accvgpr_read_b32 v3, a67
  v_accvgpr_read_b32 v4, a68
  v_accvgpr_read_b32 v5, a69
  v_accvgpr_read_b32 v6, a70
  v_accvgpr_read_b32 v7, a71
  v_mfma_f32_16x16x32_bf16 a[100:103], a[228:231], v[92:95], a[100:103]
  s_mov_b32 s34, 0
  v_mul_f32 v0, v218, v0
  v_mul_f32 v1, v218, v1
  v_mul_f32 v2, v218, v2
  v_mul_f32 v3, v218, v3
  v_mul_f32 v4, v218, v4
  v_mul_f32 v5, v218, v5
  v_mfma_f32_16x16x32_bf16 a[104:107], a[200:203], v[76:79], a[104:107]
  v_mul_f32 v6, v218, v6
  v_mul_f32 v7, v218, v7
  v_cvt_pk_bf16_f32 v8, v0, v1
  v_cvt_pk_bf16_f32 v9, v2, v3
  v_cvt_pk_bf16_f32 v10, v4, v5
  v_cvt_pk_bf16_f32 v11, v6, v7
  v_mfma_f32_16x16x32_bf16 a[104:107], a[232:235], v[92:95], a[104:107]
  buffer_store_dwordx4 v[8:11], v238, s[24:27], s34 offen offset:2048
  v_accvgpr_read_b32 v16, a72
  v_accvgpr_read_b32 v17, a73
  v_accvgpr_read_b32 v18, a74
  v_mfma_f32_16x16x32_bf16 a[108:111], a[204:207], v[76:79], a[108:111]
  s_mov_b32 s34, 8192
  v_accvgpr_read_b32 v19, a75
  v_accvgpr_read_b32 v20, a76
  v_accvgpr_read_b32 v21, a77
  v_accvgpr_read_b32 v22, a78
  v_accvgpr_read_b32 v23, a79
  v_mul_f32 v16, v218, v16
  v_mfma_f32_16x16x32_bf16 a[108:111], a[236:239], v[92:95], a[108:111]
  v_mul_f32 v17, v218, v17
  v_mul_f32 v18, v218, v18
  v_mul_f32 v19, v218, v19
  v_mul_f32 v20, v218, v20
  v_mul_f32 v21, v218, v21
  v_mul_f32 v22, v218, v22
  v_mfma_f32_16x16x32_bf16 a[112:115], a[208:211], v[76:79], a[112:115]
  v_mul_f32 v23, v218, v23
  v_cvt_pk_bf16_f32 v24, v16, v17
  v_cvt_pk_bf16_f32 v25, v18, v19
  v_cvt_pk_bf16_f32 v26, v20, v21
  v_cvt_pk_bf16_f32 v27, v22, v23
  v_mov_b32 v227, v211
  v_mfma_f32_16x16x32_bf16 a[112:115], a[240:243], v[92:95], a[112:115]
  buffer_store_dwordx4 v[24:27], v238, s[24:27], s34 offen offset:2048
  v_permlane16_swap_b32 v211, v227
  v_accvgpr_read_b32 v32, a80
  v_accvgpr_read_b32 v33, a81
  v_mfma_f32_16x16x32_bf16 a[116:119], a[212:215], v[76:79], a[116:119]
  s_mov_b32 s34, 16384
  v_accvgpr_read_b32 v34, a82
  v_accvgpr_read_b32 v35, a83
  v_accvgpr_read_b32 v36, a84
  v_accvgpr_read_b32 v37, a85
  v_accvgpr_read_b32 v38, a86
  v_accvgpr_read_b32 v39, a87
  v_mfma_f32_16x16x32_bf16 a[116:119], a[244:247], v[92:95], a[116:119]
  v_mul_f32 v32, v218, v32
  v_mul_f32 v33, v218, v33
  v_mul_f32 v34, v218, v34
  v_mul_f32 v35, v218, v35
  v_mul_f32 v36, v218, v36
  v_mul_f32 v37, v218, v37
  v_mfma_f32_16x16x32_bf16 a[120:123], a[216:219], v[76:79], a[120:123]
  v_mul_f32 v38, v218, v38
  v_mul_f32 v39, v218, v39
  v_cvt_pk_bf16_f32 v40, v32, v33
  v_cvt_pk_bf16_f32 v41, v34, v35
  v_cvt_pk_bf16_f32 v42, v36, v37
  v_cvt_pk_bf16_f32 v43, v38, v39
  v_mfma_f32_16x16x32_bf16 a[120:123], a[248:251], v[92:95], a[120:123]
  buffer_store_dwordx4 v[40:43], v238, s[24:27], s34 offen offset:2048
  v_add_f32 v211, v211, v227
  v_mov_b32 v227, v211
  v_accvgpr_read_b32 v48, a88
  v_mfma_f32_16x16x32_bf16 a[124:127], a[220:223], v[76:79], a[124:127]
  s_mov_b32 s34, 24576
  v_permlane32_swap_b32 v211, v227
  v_accvgpr_read_b32 v49, a89
  v_accvgpr_read_b32 v50, a90
  v_accvgpr_read_b32 v51, a91
  v_accvgpr_read_b32 v52, a92
  v_accvgpr_read_b32 v53, a93
  v_mfma_f32_16x16x32_bf16 a[124:127], a[252:255], v[92:95], a[124:127]
  v_accvgpr_read_b32 v54, a94
  v_accvgpr_read_b32 v55, a95
  v_mul_f32 v48, v218, v48
  v_mul_f32 v49, v218, v49
  v_mul_f32 v50, v218, v50
  v_mul_f32 v51, v218, v51
  v_mul_f32 v52, v218, v52
  v_mul_f32 v53, v218, v53
  v_mul_f32 v54, v218, v54
  v_mul_f32 v55, v218, v55
  v_cvt_pk_bf16_f32 v56, v48, v49
  v_cvt_pk_bf16_f32 v57, v50, v51
  v_cvt_pk_bf16_f32 v58, v52, v53
  v_cvt_pk_bf16_f32 v59, v54, v55
  v_add_f32 v211, v211, v227
  v_rcp_f32 v219, v211
  v_cmp_nge_f32 vcc, s33, v211
  s_nop 0
  s_or_b64 s[54:55], s[54:55], vcc
  s_cselect_b32 s33, 1, 0
  v_mov_b32 v228, s33
  ds_write_b32 v229, v228
  buffer_store_dwordx4 v[56:59], v238, s[24:27], s34 offen offset:2048
  s_mov_b32 s34, 0
  v_accvgpr_read_b32 v0, a96
  v_accvgpr_read_b32 v1, a97
  v_accvgpr_read_b32 v2, a98
  v_accvgpr_read_b32 v3, a99
  v_accvgpr_read_b32 v4, a100
  v_accvgpr_read_b32 v5, a101
  v_accvgpr_read_b32 v6, a102
  v_accvgpr_read_b32 v7, a103
  v_mul_f32 v0, v219, v0
  v_mul_f32 v1, v219, v1
  v_mul_f32 v2, v219, v2
  v_mul_f32 v3, v219, v3
  v_mul_f32 v4, v219, v4
  v_mul_f32 v5, v219, v5
  v_mul_f32 v6, v219, v6
  v_mul_f32 v7, v219, v7
  v_cvt_pk_bf16_f32 v8, v0, v1
  v_cvt_pk_bf16_f32 v9, v2, v3
  v_cvt_pk_bf16_f32 v10, v4, v5
  v_cvt_pk_bf16_f32 v11, v6, v7
  buffer_store_dwordx4 v[8:11], v238, s[24:27], s34 offen offset:3072
  s_waitcnt lgkmcnt(0)
  s_barrier
  ds_read_b128 v[220:223], v230 offset:0
  s_mov_b32 s34, 8192
  v_accvgpr_read_b32 v16, a104
  v_accvgpr_read_b32 v17, a105
  v_accvgpr_read_b32 v18, a106
  v_accvgpr_read_b32 v19, a107
  v_accvgpr_read_b32 v20, a108
  v_accvgpr_read_b32 v21, a109
  v_accvgpr_read_b32 v22, a110
  v_accvgpr_read_b32 v23, a111
  v_mul_f32 v16, v219, v16
  v_mul_f32 v17, v219, v17
  v_mul_f32 v18, v219, v18
  v_mul_f32 v19, v219, v19
  v_mul_f32 v20, v219, v20
  v_mul_f32 v21, v219, v21
  v_mul_f32 v22, v219, v22
  v_mul_f32 v23, v219, v23
  v_cvt_pk_bf16_f32 v24, v16, v17
  v_cvt_pk_bf16_f32 v25, v18, v19
  v_cvt_pk_bf16_f32 v26, v20, v21
  v_cvt_pk_bf16_f32 v27, v22, v23
  buffer_store_dwordx4 v[24:27], v238, s[24:27], s34 offen offset:3072
  s_mov_b32 s34, 16384
  v_accvgpr_read_b32 v32, a112
  v_accvgpr_read_b32 v33, a113
  v_accvgpr_read_b32 v34, a114
  v_accvgpr_read_b32 v35, a115
  v_accvgpr_read_b32 v36, a116
  v_accvgpr_read_b32 v37, a117
  v_accvgpr_read_b32 v38, a118
  v_accvgpr_read_b32 v39, a119
  v_mul_f32 v32, v219, v32
  v_mul_f32 v33, v219, v33
  v_mul_f32 v34, v219, v34
  v_mul_f32 v35, v219, v35
  v_mul_f32 v36, v219, v36
  v_mul_f32 v37, v219, v37
  v_mul_f32 v38, v219, v38
  v_mul_f32 v39, v219, v39
  v_cvt_pk_bf16_f32 v40, v32, v33
  v_cvt_pk_bf16_f32 v41, v34, v35
  v_cvt_pk_bf16_f32 v42, v36, v37
  v_cvt_pk_bf16_f32 v43, v38, v39
  buffer_store_dwordx4 v[40:43], v238, s[24:27], s34 offen offset:3072
  s_mov_b32 s34, 24576
  v_accvgpr_read_b32 v48, a120
  v_accvgpr_read_b32 v49, a121
  v_accvgpr_read_b32 v50, a122
  v_accvgpr_read_b32 v51, a123
  v_accvgpr_read_b32 v52, a124
  v_accvgpr_read_b32 v53, a125
  v_accvgpr_read_b32 v54, a126
  v_accvgpr_read_b32 v55, a127
  v_mul_f32 v48, v219, v48
  v_mul_f32 v49, v219, v49
  v_mul_f32 v50, v219, v50
  v_mul_f32 v51, v219, v51
  v_mul_f32 v52, v219, v52
  v_mul_f32 v53, v219, v53
  v_mul_f32 v54, v219, v54
  v_mul_f32 v55, v219, v55
  v_cvt_pk_bf16_f32 v56, v48, v49
  v_cvt_pk_bf16_f32 v57, v50, v51
  v_cvt_pk_bf16_f32 v58, v52, v53
  v_cvt_pk_bf16_f32 v59, v54, v55
  buffer_store_dwordx4 v[56:59], v238, s[24:27], s34 offen offset:3072
  s_waitcnt lgkmcnt(0)
  v_or3_b32 v228, v220, v221, v222
  v_or_b32 v228, v228, v223
  s_nop 0
  v_readfirstlane_b32 s33, v228
  s_nop 0
  s_andn2_b32 s33, s33, s52
  s_cbranch_scc0 L_w012_end
  s_waitcnt vmcnt(0)
  s_barrier
  v_mov_b32 v232, v234
  s_mov_b32 s46, 0
  s_mov_b32 m0, s32
L_w012_mx:
  s_nop 0
  buffer_load_dwordx4 v240, s[16:19], s46 offen offset:0 nt lds
  buffer_load_dwordx4 v241, s[16:19], s46 offen offset:1056 nt lds
  buffer_load_dwordx4 v242, s[16:19], s46 offen offset:2112 nt lds
  buffer_load_dwordx4 v243, s[16:19], s46 offen offset:3168 nt lds
  s_waitcnt vmcnt(0)
  s_barrier
  ds_read_b128 a[192:195], v232 offset:0
  ds_read_b128 a[196:199], v232 offset:64
  ds_read_b128 a[200:203], v232 offset:128
  ds_read_b128 a[204:207], v232 offset:192
  ds_read_b128 a[208:211], v232 offset:512
  ds_read_b128 a[212:215], v232 offset:576
  ds_read_b128 a[216:219], v232 offset:640
  ds_read_b128 a[220:223], v232 offset:704
  s_waitcnt lgkmcnt(0)
  v_mfma_f32_16x16x32_bf16 v[0:3], a[192:195], v[128:131], 0
  v_mfma_f32_16x16x32_bf16 v[0:3], a[196:199], v[132:135], v[0:3]
  v_mfma_f32_16x16x32_bf16 v[0:3], a[200:203], v[136:139], v[0:3]
  v_mfma_f32_16x16x32_bf16 v[0:3], a[204:207], v[140:143], v[0:3]
  v_mfma_f32_16x16x32_bf16 v[4:7], a[208:211], v[128:131], 0
  v_mfma_f32_16x16x32_bf16 v[4:7], a[212:215], v[132:135], v[4:7]
  v_mfma_f32_16x16x32_bf16 v[4:7], a[216:219], v[136:139], v[4:7]
  v_mfma_f32_16x16x32_bf16 v[4:7], a[220:223], v[140:143], v[4:7]
  v_mfma_f32_16x16x32_bf16 v[8:11], a[192:195], v[144:147], 0
  v_mfma_f32_16x16x32_bf16 v[8:11], a[196:199], v[148:151], v[8:11]
  v_mfma_f32_16x16x32_bf16 v[8:11], a[200:203], v[152:155], v[8:11]
  v_mfma_f32_16x16x32_bf16 v[8:11], a[204:207], v[156:159], v[8:11]
  v_mfma_f32_16x16x32_bf16 v[12:15], a[208:211], v[144:147], 0
  v_mfma_f32_16x16x32_bf16 v[12:15], a[212:215], v[148:151], v[12:15]
  v_mfma_f32_16x16x32_bf16 v[12:15], a[216:219], v[152:155], v[12:15]
  v_mfma_f32_16x16x32_bf16 v[12:15], a[220:223], v[156:159], v[12:15]
  v_mfma_f32_16x16x32_bf16 v[16:19], a[192:195], v[160:163], 0
  v_mfma_f32_16x16x32_bf16 v[16:19], a[196:199], v[164:167], v[16:19]
  v_mfma_f32_16x16x32_bf16 v[16:19], a[200:203], v[168:171], v[16:19]
  v_mfma_f32_16x16x32_bf16 v[16:19], a[204:207], v[172:175], v[16:19]
  v_mfma_f32_16x16x32_bf16 v[20:23], a[208:211], v[160:163], 0
  v_mfma_f32_16x16x32_bf16 v[20:23], a[212:215], v[164:167], v[20:23]
  v_mfma_f32_16x16x32_bf16 v[20:23], a[216:219], v[168:171], v[20:23]
  v_mfma_f32_16x16x32_bf16 v[20:23], a[220:223], v[172:175], v[20:23]
  v_mfma_f32_16x16x32_bf16 v[24:27], a[192:195], v[176:179], 0
  v_mfma_f32_16x16x32_bf16 v[24:27], a[196:199], v[180:183], v[24:27]
  v_mfma_f32_16x16x32_bf16 v[24:27], a[200:203], v[184:187], v[24:27]
  v_mfma_f32_16x16x32_bf16 v[24:27], a[204:207], v[188:191], v[24:27]
  v_mfma_f32_16x16x32_bf16 v[28:31], a[208:211], v[176:179], 0
  v_mfma_f32_16x16x32_bf16 v[28:31], a[212:215], v[180:183], v[28:31]
  v_mfma_f32_16x16x32_bf16 v[28:31], a[216:219], v[184:187], v[28:31]
  v_mfma_f32_16x16x32_bf16 v[28:31], a[220:223], v[188:191], v[28:31]
  s_nop 7
  v_max3_f32 v212, v0, v1, v212
  v_max3_f32 v212, v2, v3, v212
  v_max3_f32 v212, v4, v5, v212
  v_max3_f32 v212, v6, v7, v212
  v_max3_f32 v213, v8, v9, v213
  v_max3_f32 v213, v10, v11, v213
  v_max3_f32 v213, v12, v13, v213
  v_max3_f32 v213, v14, v15, v213
  v_max3_f32 v214, v16, v17, v214
  v_max3_f32 v214, v18, v19, v214
  v_max3_f32 v214, v20, v21, v214
  v_max3_f32 v214, v22, v23, v214
  v_max3_f32 v215, v24, v25, v215
  v_max3_f32 v215, v26, v27, v215
  v_max3_f32 v215, v28, v29, v215
  v_max3_f32 v215, v30, v31, v215
  ds_read_b128 a[192:195], v232 offset:8448
  ds_read_b128 a[196:199], v232 offset:8512
  ds_read_b128 a[200:203], v232 offset:8576
  ds_read_b128 a[204:207], v232 offset:8640
  ds_read_b128 a[208:211], v232 offset:8960
  ds_read_b128 a[212:215], v232 offset:9024
  ds_read_b128 a[216:219], v232 offset:9088
  ds_read_b128 a[220:223], v232 offset:9152
  s_waitcnt lgkmcnt(0)
  v_mfma_f32_16x16x32_bf16 v[0:3], a[192:195], v[128:131], 0
  v_mfma_f32_16x16x32_bf16 v[0:3], a[196:199], v[132:135], v[0:3]
  v_mfma_f32_16x16x32_bf16 v[0:3], a[200:203], v[136:139], v[0:3]
  v_mfma_f32_16x16x32_bf16 v[0:3], a[204:207], v[140:143], v[0:3]
  v_mfma_f32_16x16x32_bf16 v[4:7], a[208:211], v[128:131], 0
  v_mfma_f32_16x16x32_bf16 v[4:7], a[212:215], v[132:135], v[4:7]
  v_mfma_f32_16x16x32_bf16 v[4:7], a[216:219], v[136:139], v[4:7]
  v_mfma_f32_16x16x32_bf16 v[4:7], a[220:223], v[140:143], v[4:7]
  v_mfma_f32_16x16x32_bf16 v[8:11], a[192:195], v[144:147], 0
  v_mfma_f32_16x16x32_bf16 v[8:11], a[196:199], v[148:151], v[8:11]
  v_mfma_f32_16x16x32_bf16 v[8:11], a[200:203], v[152:155], v[8:11]
  v_mfma_f32_16x16x32_bf16 v[8:11], a[204:207], v[156:159], v[8:11]
  v_mfma_f32_16x16x32_bf16 v[12:15], a[208:211], v[144:147], 0
  v_mfma_f32_16x16x32_bf16 v[12:15], a[212:215], v[148:151], v[12:15]
  v_mfma_f32_16x16x32_bf16 v[12:15], a[216:219], v[152:155], v[12:15]
  v_mfma_f32_16x16x32_bf16 v[12:15], a[220:223], v[156:159], v[12:15]
  v_mfma_f32_16x16x32_bf16 v[16:19], a[192:195], v[160:163], 0
  v_mfma_f32_16x16x32_bf16 v[16:19], a[196:199], v[164:167], v[16:19]
  v_mfma_f32_16x16x32_bf16 v[16:19], a[200:203], v[168:171], v[16:19]
  v_mfma_f32_16x16x32_bf16 v[16:19], a[204:207], v[172:175], v[16:19]
  v_mfma_f32_16x16x32_bf16 v[20:23], a[208:211], v[160:163], 0
  v_mfma_f32_16x16x32_bf16 v[20:23], a[212:215], v[164:167], v[20:23]
  v_mfma_f32_16x16x32_bf16 v[20:23], a[216:219], v[168:171], v[20:23]
  v_mfma_f32_16x16x32_bf16 v[20:23], a[220:223], v[172:175], v[20:23]
  v_mfma_f32_16x16x32_bf16 v[24:27], a[192:195], v[176:179], 0
  v_mfma_f32_16x16x32_bf16 v[24:27], a[196:199], v[180:183], v[24:27]
  v_mfma_f32_16x16x32_bf16 v[24:27], a[200:203], v[184:187], v[24:27]
  v_mfma_f32_16x16x32_bf16 v[24:27], a[204:207], v[188:191], v[24:27]
  v_mfma_f32_16x16x32_bf16 v[28:31], a[208:211], v[176:179], 0
  v_mfma_f32_16x16x32_bf16 v[28:31], a[212:215], v[180:183], v[28:31]
  v_mfma_f32_16x16x32_bf16 v[28:31], a[216:219], v[184:187], v[28:31]
  v_mfma_f32_16x16x32_bf16 v[28:31], a[220:223], v[188:191], v[28:31]
  s_nop 7
  v_max3_f32 v212, v0, v1, v212
  v_max3_f32 v212, v2, v3, v212
  v_max3_f32 v212, v4, v5, v212
  v_max3_f32 v212, v6, v7, v212
  v_max3_f32 v213, v8, v9, v213
  v_max3_f32 v213, v10, v11, v213
  v_max3_f32 v213, v12, v13, v213
  v_max3_f32 v213, v14, v15, v213
  v_max3_f32 v214, v16, v17, v214
  v_max3_f32 v214, v18, v19, v214
  v_max3_f32 v214, v20, v21, v214
  v_max3_f32 v214, v22, v23, v214
  v_max3_f32 v215, v24, v25, v215
  v_max3_f32 v215, v26, v27, v215
  v_max3_f32 v215, v28, v29, v215
  v_max3_f32 v215, v30, v31, v215
  s_barrier
  s_add_u32 s46, s46, 16384
  s_cmp_lt_u32 s46, 262144
  s_cbranch_scc1 L_w012_mx
  s_mov_b32 s52, 1
  s_mov_b32 s34, 0
  s_add_u32 m0, s32, 0
  s_nop 0
  buffer_load_dwordx4 v240, s[16:19], s34 offen offset:0 nt lds
  buffer_load_dwordx4 v241, s[16:19], s34 offen offset:1056 nt lds
  buffer_load_dwordx4 v242, s[16:19], s34 offen offset:2112 nt lds
  buffer_load_dwordx4 v243, s[16:19], s34 offen offset:3168 nt lds
  s_mov_b32 s34, 0
  s_add_u32 m0, s32, 16896
  s_nop 0
  buffer_load_dwordx4 v240, s[20:23], s34 offen offset:0 nt lds
  buffer_load_dwordx4 v241, s[20:23], s34 offen offset:1056 nt lds
  buffer_load_dwordx4 v242, s[20:23], s34 offen offset:2112 nt lds
  buffer_load_dwordx4 v243, s[20:23], s34 offen offset:3168 nt lds
  s_mov_b32 s34, 16384
  s_add_u32 m0, s32, 33792
  s_nop 0
  buffer_load_dwordx4 v240, s[16:19], s34 offen offset:0 nt lds
  buffer_load_dwordx4 v241, s[16:19], s34 offen offset:1056 nt lds
  buffer_load_dwordx4 v242, s[16:19], s34 offen offset:2112 nt lds
  buffer_load_dwordx4 v243, s[16:19], s34 offen offset:3168 nt lds
  s_mov_b32 s34, 32768
  s_add_u32 m0, s32, 67584
  s_nop 0
  buffer_load_dwordx4 v240, s[16:19], s34 offen offset:0 nt lds
  buffer_load_dwordx4 v241, s[16:19], s34 offen offset:1056 nt lds
  buffer_load_dwordx4 v242, s[16:19], s34 offen offset:2112 nt lds
  buffer_load_dwordx4 v243, s[16:19], s34 offen offset:3168 nt lds
  s_mov_b32 s34, 16384
  s_add_u32 m0, s32, 50688
  s_nop 0
  buffer_load_dwordx4 v240, s[20:23], s34 offen offset:0 nt lds
  buffer_load_dwordx4 v241, s[20:23], s34 offen offset:1056 nt lds
  buffer_load_dwordx4 v242, s[20:23], s34 offen offset:2112 nt lds
  buffer_load_dwordx4 v243, s[20:23], s34 offen offset:3168 nt lds
  s_lshl_b32 s35, s28, 4
  v_mov_b32 v228, s35
  global_load_dwordx4 v[224:227], v228, s[100:101] sc1
  s_lshr_b32 s97, s29, 3
  s_lshl_b32 s97, s97, 2
  s_add_u32 s35, s35, s97
  v_mov_b32 v228, s35
  global_load_dword v229, v228, s[100:101] sc1
  s_waitcnt vmcnt(0)
  s_barrier
  ds_read_b128 a[192:195], v232 offset:0
  ds_read_b128 a[196:199], v232 offset:64
  ds_read_b128 a[200:203], v232 offset:128
  ds_read_b128 a[204:207], v232 offset:192
  ds_read_b128 a[208:211], v232 offset:512
  ds_read_b128 a[212:215], v232 offset:576
  ds_read_b128 a[216:219], v232 offset:640
  ds_read_b128 a[220:223], v232 offset:704
  s_waitcnt lgkmcnt(0)
  v_mfma_f32_16x16x32_bf16 v[0:3], a[192:195], v[128:131], 0
  v_mfma_f32_16x16x32_bf16 v[0:3], a[196:199], v[132:135], v[0:3]
  v_mfma_f32_16x16x32_bf16 v[0:3], a[200:203], v[136:139], v[0:3]
  v_mfma_f32_16x16x32_bf16 v[0:3], a[204:207], v[140:143], v[0:3]
  v_mfma_f32_16x16x32_bf16 v[4:7], a[208:211], v[128:131], 0
  v_mfma_f32_16x16x32_bf16 v[4:7], a[212:215], v[132:135], v[4:7]
  v_mfma_f32_16x16x32_bf16 v[4:7], a[216:219], v[136:139], v[4:7]
  v_mov_b32 v233, v235
  v_mfma_f32_16x16x32_bf16 v[4:7], a[220:223], v[140:143], v[4:7]
  v_mfma_f32_16x16x32_bf16 v[8:11], a[192:195], v[144:147], 0
  v_mov_b32 v208, 0
  v_mfma_f32_16x16x32_bf16 v[8:11], a[196:199], v[148:151], v[8:11]
  v_max3_f32 v216, v0, v1, v212
  v_max3_f32 v216, v2, v3, v216
  v_mfma_f32_16x16x32_bf16 v[8:11], a[200:203], v[152:155], v[8:11]
  s_mov_b32 s98, 0
  v_mfma_f32_16x16x32_bf16 v[8:11], a[204:207], v[156:159], v[8:11]
  s_mov_b32 s47, 49152
  v_max3_f32 v216, v4, v5, v216
  v_max3_f32 v216, v6, v7, v216
  v_mfma_f32_16x16x32_bf16 v[12:15], a[208:211], v[144:147], 0
  s_mov_b32 s46, 53248
  v_mov_b32 v217, v216
  v_mfma_f32_16x16x32_bf16 v[12:15], a[212:215], v[148:151], v[12:15]
  s_mov_b32 s48, 33792
  v_permlane16_swap_b32 v216, v217
  v_max_f32 v216, v216, v217
  v_mfma_f32_16x16x32_bf16 v[12:15], a[216:219], v[152:155], v[12:15]
  s_mov_b32 s49, 67584
  v_mov_b32 v217, v216
  v_mfma_f32_16x16x32_bf16 v[12:15], a[220:223], v[156:159], v[12:15]
  s_mov_b32 s50, 101376
  v_permlane32_swap_b32 v216, v217
  v_max_f32 v216, v216, v217
  v_mfma_f32_16x16x32_bf16 v[16:19], a[192:195], v[160:163], 0
  s_mov_b32 s51, 0
  v_sub_f32 v192, 0, v216
  v_sub_f32 v193, 0, v216
  v_mfma_f32_16x16x32_bf16 v[16:19], a[196:199], v[164:167], v[16:19]
  s_mov_b32 s40, 0
  v_sub_f32 v194, 0, v216
  v_sub_f32 v195, 0, v216
  v_mfma_f32_16x16x32_bf16 v[16:19], a[200:203], v[168:171], v[16:19]
  s_mov_b32 s41, 33792
  v_sub_f32 v0, v0, v216
  v_sub_f32 v1, v1, v216
  v_mfma_f32_16x16x32_bf16 v[16:19], a[204:207], v[172:175], v[16:19]
  s_mov_b32 s42, 67584
  v_sub_f32 v2, v2, v216
  v_max3_f32 v218, v8, v9, v213
  v_mfma_f32_16x16x32_bf16 v[20:23], a[208:211], v[160:163], 0
  s_mov_b32 s43, 101376
  v_mov_b32 v209, 0
  v_sub_f32 v3, v3, v216
  v_mfma_f32_16x16x32_bf16 v[20:23], a[212:215], v[164:167], v[20:23]
  s_mov_b32 s7, 118272
  v_max3_f32 v218, v10, v11, v218
  v_sub_f32 v4, v4, v216
  v_mfma_f32_16x16x32_bf16 v[20:23], a[216:219], v[168:171], v[20:23]
  v_max3_f32 v218, v12, v13, v218
  v_sub_f32 v5, v5, v216
  v_mfma_f32_16x16x32_bf16 v[20:23], a[220:223], v[172:175], v[20:23]
  v_max3_f32 v218, v14, v15, v218
  v_sub_f32 v6, v6, v216
  v_mov_b32 v219, v218
  v_mfma_f32_16x16x32_bf16 v[24:27], a[192:195], v[176:179], 0
  ds_read_b128 a[192:195], v232 offset:8448
  v_sub_f32 v7, v7, v216
  v_permlane16_swap_b32 v218, v219
  v_max_f32 v218, v218, v219
  v_mfma_f32_16x16x32_bf16 v[24:27], a[196:199], v[180:183], v[24:27]
  ds_read_b128 a[196:199], v232 offset:8512
  v_mov_b32 v219, v218
  v_mfma_f32_16x16x32_bf16 v[24:27], a[200:203], v[184:187], v[24:27]
  ds_read_b128 a[200:203], v232 offset:8576
  v_permlane32_swap_b32 v218, v219
  v_max_f32 v218, v218, v219
  v_sub_f32 v196, 0, v218
  v_mfma_f32_16x16x32_bf16 v[24:27], a[204:207], v[188:191], v[24:27]
  ds_read_b128 a[204:207], v232 offset:8640
  v_sub_f32 v197, 0, v218
  v_sub_f32 v198, 0, v218
  v_mfma_f32_16x16x32_bf16 v[28:31], a[208:211], v[176:179], 0
  ds_read_b128 a[208:211], v232 offset:8960
  v_sub_f32 v199, 0, v218
  v_sub_f32 v8, v8, v218
  v_mfma_f32_16x16x32_bf16 v[28:31], a[212:215], v[180:183], v[28:31]
  s_mov_b32 s34, 49152
  ds_read_b128 a[212:215], v232 offset:9024
  v_sub_f32 v9, v9, v218
  v_sub_f32 v10, v10, v218
  v_max3_f32 v220, v16, v17, v214
  v_mov_b32 v210, 0
  v_mfma_f32_16x16x32_bf16 v[28:31], a[216:219], v[184:187], v[28:31]
  s_add_u32 m0, s32, 101376
  ds_read_b128 a[216:219], v232 offset:9088
  v_sub_f32 v11, v11, v218
  v_max3_f32 v220, v18, v19, v220
  v_sub_f32 v12, v12, v218
  v_max3_f32 v220, v20, v21, v220
  v_mfma_f32_16x16x32_bf16 v[28:31], a[220:223], v[188:191], v[28:31]
  s_waitcnt lgkmcnt(1)
  ds_read_b128 a[220:223], v232 offset:9152
  v_sub_f32 v13, v13, v218
  v_max3_f32 v220, v22, v23, v220
  v_sub_f32 v14, v14, v218
  v_mov_b32 v221, v220
  v_mfma_f32_16x16x32_bf16 v[32:35], a[192:195], v[128:131], v[192:195]
  v_sub_f32 v15, v15, v218
  v_permlane16_swap_b32 v220, v221
  v_max_f32 v220, v220, v221
  v_mfma_f32_16x16x32_bf16 v[32:35], a[196:199], v[132:135], v[32:35]
  v_mov_b32 v221, v220
  v_mov_b32 v96, 0x3f803f80
  v_mfma_f32_16x16x32_bf16 v[32:35], a[200:203], v[136:139], v[32:35]
  v_permlane32_swap_b32 v220, v221
  v_max_f32 v220, v220, v221
  v_sub_f32 v200, 0, v220
  v_mfma_f32_16x16x32_bf16 v[32:35], a[204:207], v[140:143], v[32:35]
  v_sub_f32 v201, 0, v220
  v_sub_f32 v202, 0, v220
  v_mfma_f32_16x16x32_bf16 v[36:39], a[208:211], v[128:131], v[192:195]
  buffer_load_dwordx4 v240, s[16:19], s34 offen offset:0 nt lds
  v_sub_f32 v203, 0, v220
  v_sub_f32 v16, v16, v220
  v_accvgpr_write_b32 a128, v96
  v_accvgpr_write_b32 a129, v96
  v_accvgpr_write_b32 a130, v96
  v_accvgpr_write_b32 a131, v96
  v_mfma_f32_16x16x32_bf16 v[36:39], a[212:215], v[132:135], v[36:39]
  s_waitcnt lgkmcnt(0)
  v_sub_f32 v17, v17, v220
  v_sub_f32 v18, v18, v220
  v_max3_f32 v222, v24, v25, v215
  v_mov_b32 v211, 0
  v_exp_f32 v0, v0
  v_exp_f32 v1, v1
  v_mfma_f32_16x16x32_bf16 v[36:39], a[216:219], v[136:139], v[36:39]
  v_sub_f32 v19, v19, v220
  v_max3_f32 v222, v26, v27, v222
  v_sub_f32 v20, v20, v220
  v_max3_f32 v222, v28, v29, v222
  v_cvt_pk_bf16_f32 v64, v0, v1
  v_exp_f32 v2, v2
  v_mfma_f32_16x16x32_bf16 v[36:39], a[220:223], v[140:143], v[36:39]
  buffer_load_dwordx4 v241, s[16:19], s34 offen offset:1056 nt lds
  v_sub_f32 v21, v21, v220
  v_max3_f32 v222, v30, v31, v222
  v_sub_f32 v22, v22, v220
  v_mov_b32 v223, v222
  v_exp_f32 v3, v3
  v_mfma_f32_16x16x32_bf16 v[40:43], a[192:195], v[144:147], v[196:199]
  v_sub_f32 v23, v23, v220
  v_permlane16_swap_b32 v222, v223
  v_max_f32 v222, v222, v223
  v_cvt_pk_bf16_f32 v65, v2, v3
  v_exp_f32 v4, v4
  v_mfma_f32_16x16x32_bf16 v[40:43], a[196:199], v[148:151], v[40:43]
  v_mov_b32 v223, v222
  v_exp_f32 v5, v5
  v_mfma_f32_16x16x32_bf16 v[40:43], a[200:203], v[152:155], v[40:43]
  buffer_load_dwordx4 v242, s[16:19], s34 offen offset:2112 nt lds
  v_permlane32_swap_b32 v222, v223
  v_max_f32 v222, v222, v223
  v_sub_f32 v204, 0, v222
  v_cvt_pk_bf16_f32 v66, v4, v5
  v_exp_f32 v6, v6
  v_mfma_f32_16x16x32_bf16 v[40:43], a[204:207], v[156:159], v[40:43]
  v_sub_f32 v205, 0, v222
  v_sub_f32 v206, 0, v222
  v_exp_f32 v7, v7
  v_mfma_f32_16x16x32_bf16 v[44:47], a[208:211], v[144:147], v[196:199]
  v_sub_f32 v207, 0, v222
  v_sub_f32 v24, v24, v222
  v_cvt_pk_bf16_f32 v67, v6, v7
  v_exp_f32 v8, v8
  v_mfma_f32_16x16x32_bf16 v[44:47], a[212:215], v[148:151], v[44:47]
  buffer_load_dwordx4 v243, s[16:19], s34 offen offset:3168 nt lds
  s_mov_b32 s34, 32768
  s_add_u32 m0, s32, 84480
  v_sub_f32 v25, v25, v222
  v_sub_f32 v26, v26, v222
  v_add_f32 v209, v209, v8
  v_exp_f32 v9, v9
  v_mfma_f32_16x16x32_bf16 v[44:47], a[216:219], v[152:155], v[44:47]
  v_sub_f32 v27, v27, v222
  v_sub_f32 v28, v28, v222
  v_add_f32 v209, v209, v9
  v_cvt_pk_bf16_f32 v68, v8, v9
  v_exp_f32 v10, v10
  v_exp_f32 v11, v11
  v_mfma_f32_16x16x32_bf16 v[44:47], a[220:223], v[156:159], v[44:47]
  v_sub_f32 v29, v29, v222
  v_sub_f32 v30, v30, v222
  v_add_f32 v209, v209, v10
  v_add_f32 v209, v209, v11
  v_cvt_pk_bf16_f32 v69, v10, v11
  v_exp_f32 v12, v12
  v_mfma_f32_16x16x32_bf16 v[48:51], a[192:195], v[160:163], v[200:203]
  buffer_load_dwordx4 v240, s[20:23], s34 offen offset:0 nt lds
  v_sub_f32 v31, v31, v222
  v_add_f32 v209, v209, v12
  v_exp_f32 v13, v13
  v_mfma_f32_16x16x32_bf16 v[48:51], a[196:199], v[164:167], v[48:51]
  v_add_f32 v209, v209, v13
  v_cvt_pk_bf16_f32 v70, v12, v13
  v_exp_f32 v14, v14
  v_mfma_f32_16x16x32_bf16 v[48:51], a[200:203], v[168:171], v[48:51]
  v_add_f32 v209, v209, v14
  v_exp_f32 v15, v15
  v_mfma_f32_16x16x32_bf16 v[48:51], a[204:207], v[172:175], v[48:51]
  v_add_f32 v209, v209, v15
  v_cvt_pk_bf16_f32 v71, v14, v15
  v_exp_f32 v16, v16
  v_mfma_f32_16x16x32_bf16 v[52:55], a[208:211], v[160:163], v[200:203]
  v_add_f32 v210, v210, v16
  v_exp_f32 v17, v17
  v_mfma_f32_16x16x32_bf16 v[52:55], a[212:215], v[164:167], v[52:55]
  v_add_f32 v210, v210, v17
  v_cvt_pk_bf16_f32 v72, v16, v17
  v_exp_f32 v18, v18
  v_mfma_f32_16x16x32_bf16 v[52:55], a[216:219], v[168:171], v[52:55]
  v_add_f32 v210, v210, v18
  v_exp_f32 v19, v19
  v_mfma_f32_16x16x32_bf16 v[52:55], a[220:223], v[172:175], v[52:55]
  buffer_load_dwordx4 v241, s[20:23], s34 offen offset:1056 nt lds
  v_add_f32 v210, v210, v19
  v_cvt_pk_bf16_f32 v73, v18, v19
  v_exp_f32 v20, v20
  v_exp_f32 v21, v21
  v_mfma_f32_16x16x32_bf16 v[56:59], a[192:195], v[176:179], v[204:207]
  v_add_f32 v210, v210, v20
  v_add_f32 v210, v210, v21
  v_cvt_pk_bf16_f32 v74, v20, v21
  v_exp_f32 v22, v22
  v_mfma_f32_16x16x32_bf16 v[56:59], a[196:199], v[180:183], v[56:59]
  v_add_f32 v210, v210, v22
  v_exp_f32 v23, v23
  v_mfma_f32_16x16x32_bf16 v[56:59], a[200:203], v[184:187], v[56:59]
  v_add_f32 v210, v210, v23
  v_cvt_pk_bf16_f32 v75, v22, v23
  v_exp_f32 v24, v24
  v_mfma_f32_16x16x32_bf16 v[56:59], a[204:207], v[188:191], v[56:59]
  v_add_f32 v211, v211, v24
  v_exp_f32 v25, v25
  v_mfma_f32_16x16x32_bf16 v[60:63], a[208:211], v[176:179], v[204:207]
  v_add_f32 v211, v211, v25
  v_cvt_pk_bf16_f32 v76, v24, v25
  v_exp_f32 v26, v26
  v_mfma_f32_16x16x32_bf16 v[60:63], a[212:215], v[180:183], v[60:63]
  v_add_f32 v211, v211, v26
  v_add_u32 v232, 33792, v234
  v_exp_f32 v27, v27
  v_mfma_f32_16x16x32_bf16 v[60:63], a[216:219], v[184:187], v[60:63]
  v_add_f32 v211, v211, v27
  v_cvt_pk_bf16_f32 v77, v26, v27
  v_exp_f32 v28, v28
  v_mfma_f32_16x16x32_bf16 v[60:63], a[220:223], v[188:191], v[60:63]
  buffer_load_dwordx4 v242, s[20:23], s34 offen offset:2112 nt lds
  v_add_f32 v211, v211, v28
  v_exp_f32 v29, v29
  buffer_load_dwordx4 v243, s[20:23], s34 offen offset:3168 nt lds
  v_add_f32 v211, v211, v29
  v_cvt_pk_bf16_f32 v78, v28, v29
  v_exp_f32 v30, v30
  s_nop 0
  v_add_f32 v211, v211, v30
  v_exp_f32 v31, v31
  s_nop 0
  v_add_f32 v211, v211, v31
  v_cvt_pk_bf16_f32 v79, v30, v31
  s_waitcnt vmcnt(8)
  s_barrier
  ds_read_b128 a[192:195], v232 offset:0
  ds_read_b128 a[196:199], v232 offset:64
  ds_read_b128 a[200:203], v232 offset:128
  ds_read_b128 a[204:207], v232 offset:192
  ds_read_b128 a[208:211], v232 offset:512
  ds_read_b128 a[212:215], v232 offset:576
  ds_read_b128 a[216:219], v232 offset:640
  ds_read_b128 a[220:223], v232 offset:704
  s_waitcnt lgkmcnt(0)
  s_branch L_w012_join
L_w012_end:
  s_branch L_p3
L_w3:
  s_lshr_b32 s54, s29, 3
  s_and_b32 s55, s29, 7
  s_lshl_b32 s33, s28, 2
  s_add_u32 s33, s33, s54
  s_lshl_b32 s33, s33, 5
  s_add_u32 s33, s33, s55
  s_lshl_b32 s33, s33, 2
  s_add_u32 s33, s33, 0x3000000
  s_lshl_b32 s34, s28, 3
  s_add_u32 s34, s34, s55
  s_lshl_b32 s34, s34, 7
  s_add_u32 s34, s34, s54
  s_lshl_b32 s34, s34, 2
  s_add_u32 s34, s34, 0x3001000
  v_mov_b32 v8, s33
  v_lshlrev_b32 v9, 7, v239
  v_add_u32 v9, s34, v9
  v_mov_b32 v10, 0
  s_mov_b64 exec, 1
  global_store_dword v8, v10, s[44:45] sc1
  s_mov_b64 exec, 15
  global_store_dword v9, v10, s[44:45] sc1
  s_mov_b64 exec, -1
  s_waitcnt vmcnt(14)
  s_barrier
  ds_read_b128 a[64:67], v236 offset:0
  ds_read_b128 a[68:71], v236 offset:4224
  ds_read_b128 a[72:75], v236 offset:512
  ds_read_b128 a[80:83], v236 offset:64
  ds_read_b128 a[84:87], v236 offset:4288
  ds_read_b128 a[88:91], v236 offset:576
  ds_read_b64_tr_b16 a[0:1], v237 offset:0
  ds_read_b64_tr_b16 a[2:3], v237 offset:8448
  ds_read_b64_tr_b16 a[32:33], v237 offset:512
  ds_read_b64_tr_b16 a[34:35], v237 offset:8960
  ds_read_b64_tr_b16 a[4:5], v237 offset:32
  ds_read_b64_tr_b16 a[6:7], v237 offset:8480
  ds_read_b64_tr_b16 a[36:37], v237 offset:544
  ds_read_b64_tr_b16 a[38:39], v237 offset:8992
  ds_read_b64_tr_b16 a[8:9], v237 offset:64
  s_waitcnt lgkmcnt(7)
  ds_read_b64_tr_b16 a[10:11], v237 offset:8512
  v_mfma_f32_16x16x32_bf16 v[0:3], a[0:3], a[64:67], 0
  ds_read_b64_tr_b16 a[40:41], v237 offset:576
  s_waitcnt lgkmcnt(7)
  ds_read_b64_tr_b16 a[42:43], v237 offset:9024
  v_mfma_f32_16x16x32_bf16 v[0:3], a[32:35], a[80:83], v[0:3]
  ds_read_b64_tr_b16 a[12:13], v237 offset:96
  ds_read_b64_tr_b16 a[14:15], v237 offset:8544
  v_mfma_f32_16x16x32_bf16 v[32:35], a[0:3], a[68:71], 0
  ds_read_b64_tr_b16 a[44:45], v237 offset:608
  ds_read_b64_tr_b16 a[46:47], v237 offset:9056
  v_mfma_f32_16x16x32_bf16 v[32:35], a[32:35], a[84:87], v[32:35]
  ds_read_b64_tr_b16 a[16:17], v237 offset:128
  ds_read_b64_tr_b16 a[18:19], v237 offset:8576
  v_mfma_f32_16x16x32_bf16 v[64:67], a[0:3], a[72:75], 0
  ds_read_b64_tr_b16 a[48:49], v237 offset:640
  ds_read_b64_tr_b16 a[50:51], v237 offset:9088
  v_mfma_f32_16x16x32_bf16 v[64:67], a[32:35], a[88:91], v[64:67]
  s_waitcnt lgkmcnt(9)
  ds_read_b64_tr_b16 a[20:21], v237 offset:160
  v_mfma_f32_16x16x32_bf16 v[4:7], a[4:7], a[64:67], 0
  ds_read_b64_tr_b16 a[22:23], v237 offset:8608
  ds_read_b64_tr_b16 a[52:53], v237 offset:672
  v_mfma_f32_16x16x32_bf16 v[4:7], a[36:39], a[80:83], v[4:7]
  ds_read_b64_tr_b16 a[54:55], v237 offset:9120
  ds_read_b64_tr_b16 a[24:25], v237 offset:192
  v_mfma_f32_16x16x32_bf16 v[36:39], a[4:7], a[68:71], 0
  ds_read_b64_tr_b16 a[26:27], v237 offset:8640
  ds_read_b64_tr_b16 a[56:57], v237 offset:704
  v_mfma_f32_16x16x32_bf16 v[36:39], a[36:39], a[84:87], v[36:39]
  s_mov_b32 s34, 0
  ds_read_b64_tr_b16 a[58:59], v237 offset:9152
  ds_read_b64_tr_b16 a[28:29], v237 offset:224
  v_mfma_f32_16x16x32_bf16 v[68:71], a[4:7], a[72:75], 0
  s_add_u32 m0, s32, 0
  s_add_u32 s33, s30, 2
  s_and_b32 s33, s33, 7
  ds_read_b64_tr_b16 a[30:31], v237 offset:8672
  ds_read_b64_tr_b16 a[60:61], v237 offset:736
  v_mfma_f32_16x16x32_bf16 v[68:71], a[36:39], a[88:91], v[68:71]
  s_lshl_b32 s36, s33, 7
  buffer_load_dwordx4 v240, s[16:19], s34 offen offset:0 nt lds
  ds_read_b64_tr_b16 a[62:63], v237 offset:9184
  v_mfma_f32_16x16x32_bf16 v[8:11], a[8:11], a[64:67], 0
  s_lshl_b32 s38, s33, 19
  buffer_load_dwordx4 v241, s[16:19], s34 offen offset:1056 nt lds
  s_waitcnt lgkmcnt(5)
  v_mfma_f32_16x16x32_bf16 v[8:11], a[40:43], a[80:83], v[8:11]
  s_waitcnt lgkmcnt(0)
  s_waitcnt vmcnt(4)
  s_add_u32 s37, s36, 16384
  v_mfma_f32_16x16x32_bf16 v[40:43], a[8:11], a[68:71], 0
  s_barrier
  s_add_u32 m0, s31, 0
  v_mfma_f32_16x16x32_bf16 v[40:43], a[40:43], a[84:87], v[40:43]
  buffer_load_dwordx4 v244, s[8:11], s36 offen offset:0 lds
  ds_read_b128 a[160:163], v236 offset:33792
  v_mfma_f32_16x16x32_bf16 v[72:75], a[8:11], a[72:75], 0
  buffer_load_dwordx4 v245, s[8:11], s36 offen offset:1056 lds
  ds_read_b128 a[164:167], v236 offset:38016
  v_mfma_f32_16x16x32_bf16 v[72:75], a[40:43], a[88:91], v[72:75]
  ds_read_b128 a[168:171], v236 offset:34304
  v_mfma_f32_16x16x32_bf16 v[12:15], a[12:15], a[64:67], 0
  buffer_load_dwordx4 v246, s[8:11], s36 offen offset:2112 lds
  ds_read_b128 a[176:179], v236 offset:33856
  v_mfma_f32_16x16x32_bf16 v[12:15], a[44:47], a[80:83], v[12:15]
  buffer_load_dwordx4 v247, s[8:11], s36 offen offset:3168 lds
  s_add_u32 m0, s31, 4224
  ds_read_b128 a[180:183], v236 offset:38080
  v_mfma_f32_16x16x32_bf16 v[44:47], a[12:15], a[68:71], 0
  buffer_load_dwordx4 v244, s[8:11], s37 offen offset:0 lds
  v_mfma_f32_16x16x32_bf16 v[44:47], a[44:47], a[84:87], v[44:47]
  buffer_load_dwordx4 v245, s[8:11], s37 offen offset:1056 lds
  ds_read_b128 a[184:187], v236 offset:34368
  v_mfma_f32_16x16x32_bf16 v[76:79], a[12:15], a[72:75], 0
  ds_read_b64_tr_b16 a[96:97], v237 offset:16896
  v_mfma_f32_16x16x32_bf16 v[76:79], a[44:47], a[88:91], v[76:79]
  buffer_load_dwordx4 v246, s[8:11], s37 offen offset:2112 lds
  ds_read_b64_tr_b16 a[98:99], v237 offset:25344
  v_mfma_f32_16x16x32_bf16 v[16:19], a[16:19], a[64:67], 0
  buffer_load_dwordx4 v247, s[8:11], s37 offen offset:3168 lds
  ds_read_b64_tr_b16 a[128:129], v237 offset:17408
  v_mfma_f32_16x16x32_bf16 v[16:19], a[48:51], a[80:83], v[16:19]
  s_add_u32 m0, s32, 118272
  ds_read_b64_tr_b16 a[130:131], v237 offset:25856
  v_mfma_f32_16x16x32_bf16 v[48:51], a[16:19], a[68:71], 0
  buffer_load_dwordx4 v248, s[12:15], s38 offen offset:0 lds
  ds_read_b64_tr_b16 a[100:101], v237 offset:16928
  v_mfma_f32_16x16x32_bf16 v[48:51], a[48:51], a[84:87], v[48:51]
  buffer_load_dwordx4 v249, s[12:15], s38 offen offset:1056 lds
  v_mfma_f32_16x16x32_bf16 v[80:83], a[16:19], a[72:75], 0
  buffer_load_dwordx4 v250, s[12:15], s38 offen offset:2112 lds
  ds_read_b64_tr_b16 a[102:103], v237 offset:25376
  v_mfma_f32_16x16x32_bf16 v[80:83], a[48:51], a[88:91], v[80:83]
  buffer_load_dwordx4 v251, s[12:15], s38 offen offset:3168 lds
  ds_read_b64_tr_b16 a[132:133], v237 offset:17440
  v_mfma_f32_16x16x32_bf16 v[20:23], a[20:23], a[64:67], 0
  ds_read_b64_tr_b16 a[134:135], v237 offset:25888
  v_mfma_f32_16x16x32_bf16 v[20:23], a[52:55], a[80:83], v[20:23]
  ds_read_b64_tr_b16 a[104:105], v237 offset:16960
  ds_read_b64_tr_b16 a[106:107], v237 offset:25408
  v_mfma_f32_16x16x32_bf16 v[52:55], a[20:23], a[68:71], 0
  ds_read_b64_tr_b16 a[136:137], v237 offset:17472
  ds_read_b64_tr_b16 a[138:139], v237 offset:25920
  v_mfma_f32_16x16x32_bf16 v[52:55], a[52:55], a[84:87], v[52:55]
  ds_read_b64_tr_b16 a[108:109], v237 offset:16992
  v_mfma_f32_16x16x32_bf16 v[84:87], a[20:23], a[72:75], 0
  ds_read_b64_tr_b16 a[110:111], v237 offset:25440
  ds_read_b64_tr_b16 a[140:141], v237 offset:17504
  v_mfma_f32_16x16x32_bf16 v[84:87], a[52:55], a[88:91], v[84:87]
  ds_read_b64_tr_b16 a[142:143], v237 offset:25952
  v_mfma_f32_16x16x32_bf16 v[24:27], a[24:27], a[64:67], 0
  ds_read_b64_tr_b16 a[112:113], v237 offset:17024
  ds_read_b64_tr_b16 a[114:115], v237 offset:25472
  v_mfma_f32_16x16x32_bf16 v[24:27], a[56:59], a[80:83], v[24:27]
  ds_read_b64_tr_b16 a[144:145], v237 offset:17536
  ds_read_b64_tr_b16 a[146:147], v237 offset:25984
  v_mfma_f32_16x16x32_bf16 v[56:59], a[24:27], a[68:71], 0
  ds_read_b64_tr_b16 a[116:117], v237 offset:17056
  v_mfma_f32_16x16x32_bf16 v[56:59], a[56:59], a[84:87], v[56:59]
  ds_read_b64_tr_b16 a[118:119], v237 offset:25504
  ds_read_b64_tr_b16 a[148:149], v237 offset:17568
  v_mfma_f32_16x16x32_bf16 v[88:91], a[24:27], a[72:75], 0
  ds_read_b64_tr_b16 a[150:151], v237 offset:26016
  v_mfma_f32_16x16x32_bf16 v[88:91], a[56:59], a[88:91], v[88:91]
  ds_read_b64_tr_b16 a[120:121], v237 offset:17088
  ds_read_b64_tr_b16 a[122:123], v237 offset:25536
  v_mfma_f32_16x16x32_bf16 v[28:31], a[28:31], a[64:67], 0
  ds_read_b64_tr_b16 a[152:153], v237 offset:17600
  ds_read_b64_tr_b16 a[154:155], v237 offset:26048
  v_mfma_f32_16x16x32_bf16 v[28:31], a[60:63], a[80:83], v[28:31]
  ds_read_b64_tr_b16 a[124:125], v237 offset:17120
  v_mfma_f32_16x16x32_bf16 v[60:63], a[28:31], a[68:71], 0
  ds_read_b64_tr_b16 a[126:127], v237 offset:25568
  ds_read_b64_tr_b16 a[156:157], v237 offset:17632
  v_mfma_f32_16x16x32_bf16 v[60:63], a[60:63], a[84:87], v[60:63]
  ds_read_b64_tr_b16 a[158:159], v237 offset:26080
  v_mfma_f32_16x16x32_bf16 v[92:95], a[28:31], a[72:75], 0
  v_mfma_f32_16x16x32_bf16 v[92:95], a[60:63], a[88:91], v[92:95]
  s_waitcnt lgkmcnt(0)
  s_add_u32 s33, s30, 3
  s_and_b32 s33, s33, 7
  s_lshl_b32 s36, s33, 7
  s_lshl_b32 s38, s33, 19
  v_mfma_f32_16x16x32_bf16 v[0:3], a[96:99], a[160:163], v[0:3]
  s_waitcnt vmcnt(0)
  s_add_u32 s37, s36, 16384
  v_mfma_f32_16x16x32_bf16 v[0:3], a[128:131], a[176:179], v[0:3]
  s_barrier
  s_add_u32 m0, s31, 33792
  v_mfma_f32_16x16x32_bf16 v[32:35], a[96:99], a[164:167], v[32:35]
  buffer_load_dwordx4 v244, s[8:11], s36 offen offset:0 lds
  ds_read_b128 a[64:67], v236 offset:0
  v_mfma_f32_16x16x32_bf16 v[32:35], a[128:131], a[180:183], v[32:35]
  buffer_load_dwordx4 v245, s[8:11], s36 offen offset:1056 lds
  v_mfma_f32_16x16x32_bf16 v[64:67], a[96:99], a[168:171], v[64:67]
  buffer_load_dwordx4 v246, s[8:11], s36 offen offset:2112 lds
  ds_read_b128 a[68:71], v236 offset:4224
  v_mfma_f32_16x16x32_bf16 v[64:67], a[128:131], a[184:187], v[64:67]
  ds_read_b128 a[72:75], v236 offset:512
  v_mfma_f32_16x16x32_bf16 v[4:7], a[100:103], a[160:163], v[4:7]
  buffer_load_dwordx4 v247, s[8:11], s36 offen offset:3168 lds
  s_add_u32 m0, s31, 38016
  ds_read_b128 a[80:83], v236 offset:64
  v_mfma_f32_16x16x32_bf16 v[4:7], a[132:135], a[176:179], v[4:7]
  buffer_load_dwordx4 v244, s[8:11], s37 offen offset:0 lds
  v_mfma_f32_16x16x32_bf16 v[36:39], a[100:103], a[164:167], v[36:39]
  buffer_load_dwordx4 v245, s[8:11], s37 offen offset:1056 lds
  ds_read_b128 a[84:87], v236 offset:4288
  v_mfma_f32_16x16x32_bf16 v[36:39], a[132:135], a[180:183], v[36:39]
  ds_read_b128 a[88:91], v236 offset:576
  v_mfma_f32_16x16x32_bf16 v[68:71], a[100:103], a[168:171], v[68:71]
  buffer_load_dwordx4 v246, s[8:11], s37 offen offset:2112 lds
  ds_read_b64_tr_b16 a[0:1], v237 offset:0
  v_mfma_f32_16x16x32_bf16 v[68:71], a[132:135], a[184:187], v[68:71]
  buffer_load_dwordx4 v247, s[8:11], s37 offen offset:3168 lds
  s_add_u32 m0, s32, 135168
  v_mfma_f32_16x16x32_bf16 v[8:11], a[104:107], a[160:163], v[8:11]
  s_add_u32 s33, s30, 4
  buffer_load_dwordx4 v248, s[12:15], s38 offen offset:0 lds
  ds_read_b64_tr_b16 a[2:3], v237 offset:8448
  v_mfma_f32_16x16x32_bf16 v[8:11], a[136:139], a[176:179], v[8:11]
  s_and_b32 s33, s33, 7
  ds_read_b64_tr_b16 a[32:33], v237 offset:512
  v_mfma_f32_16x16x32_bf16 v[40:43], a[104:107], a[164:167], v[40:43]
  s_lshl_b32 s36, s33, 7
  buffer_load_dwordx4 v249, s[12:15], s38 offen offset:1056 lds
  ds_read_b64_tr_b16 a[34:35], v237 offset:8960
  v_mfma_f32_16x16x32_bf16 v[40:43], a[136:139], a[180:183], v[40:43]
  buffer_load_dwordx4 v250, s[12:15], s38 offen offset:2112 lds
  v_mfma_f32_16x16x32_bf16 v[72:75], a[104:107], a[168:171], v[72:75]
  buffer_load_dwordx4 v251, s[12:15], s38 offen offset:3168 lds
  s_lshl_b32 s38, s33, 19
  s_add_u32 s37, s36, 16384
  ds_read_b64_tr_b16 a[4:5], v237 offset:32
  v_mfma_f32_16x16x32_bf16 v[72:75], a[136:139], a[184:187], v[72:75]
  ds_read_b64_tr_b16 a[6:7], v237 offset:8480
  s_waitcnt lgkmcnt(6)
  s_add_u32 m0, s31, 0
  v_mfma_f32_16x16x32_bf16 v[12:15], a[108:111], a[160:163], v[12:15]
  buffer_load_dwordx4 v244, s[8:11], s36 offen offset:0 lds
  ds_read_b64_tr_b16 a[36:37], v237 offset:544
  v_mfma_f32_16x16x32_bf16 v[12:15], a[140:143], a[176:179], v[12:15]
  ds_read_b64_tr_b16 a[38:39], v237 offset:8992
  v_mfma_f32_16x16x32_bf16 v[44:47], a[108:111], a[164:167], v[44:47]
  ds_read_b64_tr_b16 a[8:9], v237 offset:64
  ds_read_b64_tr_b16 a[10:11], v237 offset:8512
  v_mfma_f32_16x16x32_bf16 v[44:47], a[140:143], a[180:183], v[44:47]
  buffer_load_dwordx4 v245, s[8:11], s36 offen offset:1056 lds
  v_mfma_f32_16x16x32_bf16 v[76:79], a[108:111], a[168:171], v[76:79]
  ds_read_b64_tr_b16 a[40:41], v237 offset:576
  ds_read_b64_tr_b16 a[42:43], v237 offset:9024
  v_mfma_f32_16x16x32_bf16 v[76:79], a[140:143], a[184:187], v[76:79]
  ds_read_b64_tr_b16 a[12:13], v237 offset:96
  v_mfma_f32_16x16x32_bf16 v[16:19], a[112:115], a[160:163], v[16:19]
  buffer_load_dwordx4 v246, s[8:11], s36 offen offset:2112 lds
  ds_read_b64_tr_b16 a[14:15], v237 offset:8544
  v_mfma_f32_16x16x32_bf16 v[16:19], a[144:147], a[176:179], v[16:19]
  ds_read_b64_tr_b16 a[44:45], v237 offset:608
  v_mfma_f32_16x16x32_bf16 v[48:51], a[112:115], a[164:167], v[48:51]
  buffer_load_dwordx4 v247, s[8:11], s36 offen offset:3168 lds
  ds_read_b64_tr_b16 a[46:47], v237 offset:9056
  v_mfma_f32_16x16x32_bf16 v[48:51], a[144:147], a[180:183], v[48:51]
  ds_read_b64_tr_b16 a[16:17], v237 offset:128
  v_mfma_f32_16x16x32_bf16 v[80:83], a[112:115], a[168:171], v[80:83]
  s_add_u32 m0, s31, 4224
  ds_read_b64_tr_b16 a[18:19], v237 offset:8576
  ds_read_b64_tr_b16 a[48:49], v237 offset:640
  v_mfma_f32_16x16x32_bf16 v[80:83], a[144:147], a[184:187], v[80:83]
  buffer_load_dwordx4 v244, s[8:11], s37 offen offset:0 lds
  v_mfma_f32_16x16x32_bf16 v[20:23], a[116:119], a[160:163], v[20:23]
  ds_read_b64_tr_b16 a[50:51], v237 offset:9088
  ds_read_b64_tr_b16 a[20:21], v237 offset:160
  v_mfma_f32_16x16x32_bf16 v[20:23], a[148:151], a[176:179], v[20:23]
  ds_read_b64_tr_b16 a[22:23], v237 offset:8608
  v_mfma_f32_16x16x32_bf16 v[52:55], a[116:119], a[164:167], v[52:55]
  buffer_load_dwordx4 v245, s[8:11], s37 offen offset:1056 lds
  ds_read_b64_tr_b16 a[52:53], v237 offset:672
  v_mfma_f32_16x16x32_bf16 v[52:55], a[148:151], a[180:183], v[52:55]
  ds_read_b64_tr_b16 a[54:55], v237 offset:9120
  v_mfma_f32_16x16x32_bf16 v[84:87], a[116:119], a[168:171], v[84:87]
  ds_read_b64_tr_b16 a[24:25], v237 offset:192
  ds_read_b64_tr_b16 a[26:27], v237 offset:8640
  v_mfma_f32_16x16x32_bf16 v[84:87], a[148:151], a[184:187], v[84:87]
  buffer_load_dwordx4 v246, s[8:11], s37 offen offset:2112 lds
  v_mfma_f32_16x16x32_bf16 v[24:27], a[120:123], a[160:163], v[24:27]
  ds_read_b64_tr_b16 a[56:57], v237 offset:704
  ds_read_b64_tr_b16 a[58:59], v237 offset:9152
  v_mfma_f32_16x16x32_bf16 v[24:27], a[152:155], a[176:179], v[24:27]
  ds_read_b64_tr_b16 a[28:29], v237 offset:224
  v_mfma_f32_16x16x32_bf16 v[56:59], a[120:123], a[164:167], v[56:59]
  buffer_load_dwordx4 v247, s[8:11], s37 offen offset:3168 lds
  ds_read_b64_tr_b16 a[30:31], v237 offset:8672
  v_mfma_f32_16x16x32_bf16 v[56:59], a[152:155], a[180:183], v[56:59]
  ds_read_b64_tr_b16 a[60:61], v237 offset:736
  v_mfma_f32_16x16x32_bf16 v[88:91], a[120:123], a[168:171], v[88:91]
  ds_read_b64_tr_b16 a[62:63], v237 offset:9184
  v_mfma_f32_16x16x32_bf16 v[88:91], a[152:155], a[184:187], v[88:91]
  v_mfma_f32_16x16x32_bf16 v[28:31], a[124:127], a[160:163], v[28:31]
  s_waitcnt lgkmcnt(0)
  v_mfma_f32_16x16x32_bf16 v[28:31], a[156:159], a[176:179], v[28:31]
  s_barrier
  s_add_u32 m0, s32, 118272
  v_mfma_f32_16x16x32_bf16 v[60:63], a[124:127], a[164:167], v[60:63]
  buffer_load_dwordx4 v248, s[12:15], s38 offen offset:0 lds
  v_mfma_f32_16x16x32_bf16 v[60:63], a[156:159], a[180:183], v[60:63]
  buffer_load_dwordx4 v249, s[12:15], s38 offen offset:1056 lds
  v_mfma_f32_16x16x32_bf16 v[92:95], a[124:127], a[168:171], v[92:95]
  buffer_load_dwordx4 v250, s[12:15], s38 offen offset:2112 lds
  v_mfma_f32_16x16x32_bf16 v[92:95], a[156:159], a[184:187], v[92:95]
  buffer_load_dwordx4 v251, s[12:15], s38 offen offset:3168 lds
  s_waitcnt vmcnt(38)
  s_getreg_b32 s34, hwreg(HW_REG_XCC_ID, 0, 4)
  s_mul_i32 s33, s34, s34
  s_lshl_b32 s33, s33, 8
  s_add_u32 s33, s33, s34
  s_lshl_b32 s33, s33, 8
  s_add_u32 s33, s33, 1
  s_lshr_b32 s34, s29, 3
  s_lshl_b32 s35, s28, 2
  s_add_u32 s34, s34, s35
  s_lshl_b32 s34, s34, 2
  v_mov_b32 v228, s34
  v_mov_b32 v229, s33
  s_mov_b64 exec, 1
  global_atomic_add v228, v229, s[100:101] sc1
  s_mov_b64 exec, -1
  v_mfma_f32_16x16x32_bf16 v[0:3], a[0:3], a[64:67], v[0:3]
  s_waitcnt vmcnt(13)
  v_mfma_f32_16x16x32_bf16 v[0:3], a[32:35], a[80:83], v[0:3]
  s_barrier
  s_mov_b32 s34, 0
  s_add_u32 m0, s32, 0
  v_mfma_f32_16x16x32_bf16 v[32:35], a[0:3], a[68:71], v[32:35]
  buffer_load_dwordx4 v242, s[16:19], s34 offen offset:2112 nt lds
  ds_read_b128 a[160:163], v236 offset:33792
  v_mfma_f32_16x16x32_bf16 v[32:35], a[32:35], a[84:87], v[32:35]
  ds_read_b128 a[164:167], v236 offset:38016
  v_mfma_f32_16x16x32_bf16 v[64:67], a[0:3], a[72:75], v[64:67]
  ds_read_b128 a[168:171], v236 offset:34304
  v_mfma_f32_16x16x32_bf16 v[64:67], a[32:35], a[88:91], v[64:67]
  s_add_u32 s33, s30, 5
  ds_read_b128 a[176:179], v236 offset:33856
  v_mfma_f32_16x16x32_bf16 v[4:7], a[4:7], a[64:67], v[4:7]
  s_and_b32 s33, s33, 7
  buffer_load_dwordx4 v243, s[16:19], s34 offen offset:3168 nt lds
  ds_read_b128 a[180:183], v236 offset:38080
  v_mfma_f32_16x16x32_bf16 v[4:7], a[36:39], a[80:83], v[4:7]
  s_lshl_b32 s36, s33, 7
  ds_read_b128 a[184:187], v236 offset:34368
  v_mfma_f32_16x16x32_bf16 v[36:39], a[4:7], a[68:71], v[36:39]
  s_lshl_b32 s38, s33, 19
  ds_read_b64_tr_b16 a[96:97], v237 offset:16896
  v_mfma_f32_16x16x32_bf16 v[36:39], a[36:39], a[84:87], v[36:39]
  s_add_u32 s37, s36, 16384
  ds_read_b64_tr_b16 a[98:99], v237 offset:25344
  v_mfma_f32_16x16x32_bf16 v[68:71], a[4:7], a[72:75], v[68:71]
  ds_read_b64_tr_b16 a[128:129], v237 offset:17408
  ds_read_b64_tr_b16 a[130:131], v237 offset:25856
  s_waitcnt lgkmcnt(4)
  s_add_u32 m0, s31, 33792
  v_mfma_f32_16x16x32_bf16 v[68:71], a[36:39], a[88:91], v[68:71]
  buffer_load_dwordx4 v244, s[8:11], s36 offen offset:0 lds
  v_mfma_f32_16x16x32_bf16 v[8:11], a[8:11], a[64:67], v[8:11]
  ds_read_b64_tr_b16 a[100:101], v237 offset:16928
  v_mfma_f32_16x16x32_bf16 v[8:11], a[40:43], a[80:83], v[8:11]
  ds_read_b64_tr_b16 a[102:103], v237 offset:25376
  v_mfma_f32_16x16x32_bf16 v[40:43], a[8:11], a[68:71], v[40:43]
  ds_read_b64_tr_b16 a[132:133], v237 offset:17440
  v_mfma_f32_16x16x32_bf16 v[40:43], a[40:43], a[84:87], v[40:43]
  buffer_load_dwordx4 v245, s[8:11], s36 offen offset:1056 lds
  ds_read_b64_tr_b16 a[134:135], v237 offset:25888
  v_mfma_f32_16x16x32_bf16 v[72:75], a[8:11], a[72:75], v[72:75]
  ds_read_b64_tr_b16 a[104:105], v237 offset:16960
  v_mfma_f32_16x16x32_bf16 v[72:75], a[40:43], a[88:91], v[72:75]
  ds_read_b64_tr_b16 a[106:107], v237 offset:25408
  v_mfma_f32_16x16x32_bf16 v[12:15], a[12:15], a[64:67], v[12:15]
  ds_read_b64_tr_b16 a[136:137], v237 offset:17472
  v_mfma_f32_16x16x32_bf16 v[12:15], a[44:47], a[80:83], v[12:15]
  buffer_load_dwordx4 v246, s[8:11], s36 offen offset:2112 lds
  ds_read_b64_tr_b16 a[138:139], v237 offset:25920
  v_mfma_f32_16x16x32_bf16 v[44:47], a[12:15], a[68:71], v[44:47]
  ds_read_b64_tr_b16 a[108:109], v237 offset:16992
  v_mfma_f32_16x16x32_bf16 v[44:47], a[44:47], a[84:87], v[44:47]
  ds_read_b64_tr_b16 a[110:111], v237 offset:25440
  v_mfma_f32_16x16x32_bf16 v[76:79], a[12:15], a[72:75], v[76:79]
  ds_read_b64_tr_b16 a[140:141], v237 offset:17504
  v_mfma_f32_16x16x32_bf16 v[76:79], a[44:47], a[88:91], v[76:79]
  buffer_load_dwordx4 v247, s[8:11], s36 offen offset:3168 lds
  ds_read_b64_tr_b16 a[142:143], v237 offset:25952
  v_mfma_f32_16x16x32_bf16 v[16:19], a[16:19], a[64:67], v[16:19]
  ds_read_b64_tr_b16 a[112:113], v237 offset:17024
  v_mfma_f32_16x16x32_bf16 v[16:19], a[48:51], a[80:83], v[16:19]
  s_add_u32 m0, s31, 38016
  ds_read_b64_tr_b16 a[114:115], v237 offset:25472
  v_mfma_f32_16x16x32_bf16 v[48:51], a[16:19], a[68:71], v[48:51]
  buffer_load_dwordx4 v244, s[8:11], s37 offen offset:0 lds
  v_mfma_f32_16x16x32_bf16 v[48:51], a[48:51], a[84:87], v[48:51]
  ds_read_b64_tr_b16 a[144:145], v237 offset:17536
  v_mfma_f32_16x16x32_bf16 v[80:83], a[16:19], a[72:75], v[80:83]
  ds_read_b64_tr_b16 a[146:147], v237 offset:25984
  ds_read_b64_tr_b16 a[116:117], v237 offset:17056
  v_mfma_f32_16x16x32_bf16 v[80:83], a[48:51], a[88:91], v[80:83]
  ds_read_b64_tr_b16 a[118:119], v237 offset:25504
  v_mfma_f32_16x16x32_bf16 v[20:23], a[20:23], a[64:67], v[20:23]
  buffer_load_dwordx4 v245, s[8:11], s37 offen offset:1056 lds
  v_mfma_f32_16x16x32_bf16 v[20:23], a[52:55], a[80:83], v[20:23]
  ds_read_b64_tr_b16 a[148:149], v237 offset:17568
  v_mfma_f32_16x16x32_bf16 v[52:55], a[20:23], a[68:71], v[52:55]
  ds_read_b64_tr_b16 a[150:151], v237 offset:26016
  ds_read_b64_tr_b16 a[120:121], v237 offset:17088
  v_mfma_f32_16x16x32_bf16 v[52:55], a[52:55], a[84:87], v[52:55]
  buffer_load_dwordx4 v246, s[8:11], s37 offen offset:2112 lds
  v_mfma_f32_16x16x32_bf16 v[84:87], a[20:23], a[72:75], v[84:87]
  ds_read_b64_tr_b16 a[122:123], v237 offset:25536
  v_mfma_f32_16x16x32_bf16 v[84:87], a[52:55], a[88:91], v[84:87]
  ds_read_b64_tr_b16 a[152:153], v237 offset:17600
  v_mfma_f32_16x16x32_bf16 v[24:27], a[24:27], a[64:67], v[24:27]
  ds_read_b64_tr_b16 a[154:155], v237 offset:26048
  ds_read_b64_tr_b16 a[124:125], v237 offset:17120
  v_mfma_f32_16x16x32_bf16 v[24:27], a[56:59], a[80:83], v[24:27]
  buffer_load_dwordx4 v247, s[8:11], s37 offen offset:3168 lds
  v_mfma_f32_16x16x32_bf16 v[56:59], a[24:27], a[68:71], v[56:59]
  ds_read_b64_tr_b16 a[126:127], v237 offset:25568
  v_mfma_f32_16x16x32_bf16 v[56:59], a[56:59], a[84:87], v[56:59]
  ds_read_b64_tr_b16 a[156:157], v237 offset:17632
  v_mfma_f32_16x16x32_bf16 v[88:91], a[24:27], a[72:75], v[88:91]
  ds_read_b64_tr_b16 a[158:159], v237 offset:26080
  v_mfma_f32_16x16x32_bf16 v[88:91], a[56:59], a[88:91], v[88:91]
  v_mfma_f32_16x16x32_bf16 v[28:31], a[28:31], a[64:67], v[28:31]
  s_waitcnt lgkmcnt(0)
  v_mfma_f32_16x16x32_bf16 v[28:31], a[60:63], a[80:83], v[28:31]
  s_barrier
  s_add_u32 m0, s32, 135168
  v_mfma_f32_16x16x32_bf16 v[60:63], a[28:31], a[68:71], v[60:63]
  buffer_load_dwordx4 v248, s[12:15], s38 offen offset:0 lds
  v_mfma_f32_16x16x32_bf16 v[60:63], a[60:63], a[84:87], v[60:63]
  buffer_load_dwordx4 v249, s[12:15], s38 offen offset:1056 lds
  v_mfma_f32_16x16x32_bf16 v[92:95], a[28:31], a[72:75], v[92:95]
  buffer_load_dwordx4 v250, s[12:15], s38 offen offset:2112 lds
  v_mfma_f32_16x16x32_bf16 v[92:95], a[60:63], a[88:91], v[92:95]
  buffer_load_dwordx4 v251, s[12:15], s38 offen offset:3168 lds
  v_mfma_f32_16x16x32_bf16 v[0:3], a[96:99], a[160:163], v[0:3]
  s_waitcnt vmcnt(15)
  v_mfma_f32_16x16x32_bf16 v[0:3], a[128:131], a[176:179], v[0:3]
  s_barrier
  s_mov_b32 s34, 0
  s_add_u32 m0, s32, 16896
  v_mfma_f32_16x16x32_bf16 v[32:35], a[96:99], a[164:167], v[32:35]
  buffer_load_dwordx4 v240, s[20:23], s34 offen offset:0 nt lds
  ds_read_b128 a[64:67], v236 offset:0
  v_mfma_f32_16x16x32_bf16 v[32:35], a[128:131], a[180:183], v[32:35]
  ds_read_b128 a[68:71], v236 offset:4224
  v_mfma_f32_16x16x32_bf16 v[64:67], a[96:99], a[168:171], v[64:67]
  ds_read_b128 a[72:75], v236 offset:512
  v_mfma_f32_16x16x32_bf16 v[64:67], a[128:131], a[184:187], v[64:67]
  s_add_u32 s33, s30, 6
  ds_read_b128 a[80:83], v236 offset:64
  v_mfma_f32_16x16x32_bf16 v[4:7], a[100:103], a[160:163], v[4:7]
  s_and_b32 s33, s33, 7
  buffer_load_dwordx4 v241, s[20:23], s34 offen offset:1056 nt lds
  ds_read_b128 a[84:87], v236 offset:4288
  v_mfma_f32_16x16x32_bf16 v[4:7], a[132:135], a[176:179], v[4:7]
  s_lshl_b32 s36, s33, 7
  ds_read_b128 a[88:91], v236 offset:576
  v_mfma_f32_16x16x32_bf16 v[36:39], a[100:103], a[164:167], v[36:39]
  s_lshl_b32 s38, s33, 19
  ds_read_b64_tr_b16 a[0:1], v237 offset:0
  v_mfma_f32_16x16x32_bf16 v[36:39], a[132:135], a[180:183], v[36:39]
  s_add_u32 s37, s36, 16384
  ds_read_b64_tr_b16 a[2:3], v237 offset:8448
  v_mfma_f32_16x16x32_bf16 v[68:71], a[100:103], a[168:171], v[68:71]
  ds_read_b64_tr_b16 a[32:33], v237 offset:512
  ds_read_b64_tr_b16 a[34:35], v237 offset:8960
  s_waitcnt lgkmcnt(4)
  s_add_u32 m0, s31, 0
  v_mfma_f32_16x16x32_bf16 v[68:71], a[132:135], a[184:187], v[68:71]
  buffer_load_dwordx4 v244, s[8:11], s36 offen offset:0 lds
  v_mfma_f32_16x16x32_bf16 v[8:11], a[104:107], a[160:163], v[8:11]
  ds_read_b64_tr_b16 a[4:5], v237 offset:32
  v_mfma_f32_16x16x32_bf16 v[8:11], a[136:139], a[176:179], v[8:11]
  ds_read_b64_tr_b16 a[6:7], v237 offset:8480
  v_mfma_f32_16x16x32_bf16 v[40:43], a[104:107], a[164:167], v[40:43]
  ds_read_b64_tr_b16 a[36:37], v237 offset:544
  v_mfma_f32_16x16x32_bf16 v[40:43], a[136:139], a[180:183], v[40:43]
  buffer_load_dwordx4 v245, s[8:11], s36 offen offset:1056 lds
  ds_read_b64_tr_b16 a[38:39], v237 offset:8992
  v_mfma_f32_16x16x32_bf16 v[72:75], a[104:107], a[168:171], v[72:75]
  ds_read_b64_tr_b16 a[8:9], v237 offset:64
  v_mfma_f32_16x16x32_bf16 v[72:75], a[136:139], a[184:187], v[72:75]
  ds_read_b64_tr_b16 a[10:11], v237 offset:8512
  v_mfma_f32_16x16x32_bf16 v[12:15], a[108:111], a[160:163], v[12:15]
  ds_read_b64_tr_b16 a[40:41], v237 offset:576
  v_mfma_f32_16x16x32_bf16 v[12:15], a[140:143], a[176:179], v[12:15]
  buffer_load_dwordx4 v246, s[8:11], s36 offen offset:2112 lds
  ds_read_b64_tr_b16 a[42:43], v237 offset:9024
  v_mfma_f32_16x16x32_bf16 v[44:47], a[108:111], a[164:167], v[44:47]
  ds_read_b64_tr_b16 a[12:13], v237 offset:96
  v_mfma_f32_16x16x32_bf16 v[44:47], a[140:143], a[180:183], v[44:47]
  ds_read_b64_tr_b16 a[14:15], v237 offset:8544
  v_mfma_f32_16x16x32_bf16 v[76:79], a[108:111], a[168:171], v[76:79]
  ds_read_b64_tr_b16 a[44:45], v237 offset:608
  v_mfma_f32_16x16x32_bf16 v[76:79], a[140:143], a[184:187], v[76:79]
  buffer_load_dwordx4 v247, s[8:11], s36 offen offset:3168 lds
  ds_read_b64_tr_b16 a[46:47], v237 offset:9056
  v_mfma_f32_16x16x32_bf16 v[16:19], a[112:115], a[160:163], v[16:19]
  ds_read_b64_tr_b16 a[16:17], v237 offset:128
  v_mfma_f32_16x16x32_bf16 v[16:19], a[144:147], a[176:179], v[16:19]
  s_add_u32 m0, s31, 4224
  ds_read_b64_tr_b16 a[18:19], v237 offset:8576
  v_mfma_f32_16x16x32_bf16 v[48:51], a[112:115], a[164:167], v[48:51]
  buffer_load_dwordx4 v244, s[8:11], s37 offen offset:0 lds
  v_mfma_f32_16x16x32_bf16 v[48:51], a[144:147], a[180:183], v[48:51]
  ds_read_b64_tr_b16 a[48:49], v237 offset:640
  v_mfma_f32_16x16x32_bf16 v[80:83], a[112:115], a[168:171], v[80:83]
  ds_read_b64_tr_b16 a[50:51], v237 offset:9088
  ds_read_b64_tr_b16 a[20:21], v237 offset:160
  v_mfma_f32_16x16x32_bf16 v[80:83], a[144:147], a[184:187], v[80:83]
  ds_read_b64_tr_b16 a[22:23], v237 offset:8608
  v_mfma_f32_16x16x32_bf16 v[20:23], a[116:119], a[160:163], v[20:23]
  buffer_load_dwordx4 v245, s[8:11], s37 offen offset:1056 lds
  v_mfma_f32_16x16x32_bf16 v[20:23], a[148:151], a[176:179], v[20:23]
  ds_read_b64_tr_b16 a[52:53], v237 offset:672
  v_mfma_f32_16x16x32_bf16 v[52:55], a[116:119], a[164:167], v[52:55]
  ds_read_b64_tr_b16 a[54:55], v237 offset:9120
  ds_read_b64_tr_b16 a[24:25], v237 offset:192
  v_mfma_f32_16x16x32_bf16 v[52:55], a[148:151], a[180:183], v[52:55]
  buffer_load_dwordx4 v246, s[8:11], s37 offen offset:2112 lds
  v_mfma_f32_16x16x32_bf16 v[84:87], a[116:119], a[168:171], v[84:87]
  ds_read_b64_tr_b16 a[26:27], v237 offset:8640
  v_mfma_f32_16x16x32_bf16 v[84:87], a[148:151], a[184:187], v[84:87]
  ds_read_b64_tr_b16 a[56:57], v237 offset:704
  v_mfma_f32_16x16x32_bf16 v[24:27], a[120:123], a[160:163], v[24:27]
  ds_read_b64_tr_b16 a[58:59], v237 offset:9152
  ds_read_b64_tr_b16 a[28:29], v237 offset:224
  v_mfma_f32_16x16x32_bf16 v[24:27], a[152:155], a[176:179], v[24:27]
  buffer_load_dwordx4 v247, s[8:11], s37 offen offset:3168 lds
  v_mfma_f32_16x16x32_bf16 v[56:59], a[120:123], a[164:167], v[56:59]
  ds_read_b64_tr_b16 a[30:31], v237 offset:8672
  v_mfma_f32_16x16x32_bf16 v[56:59], a[152:155], a[180:183], v[56:59]
  ds_read_b64_tr_b16 a[60:61], v237 offset:736
  v_mfma_f32_16x16x32_bf16 v[88:91], a[120:123], a[168:171], v[88:91]
  ds_read_b64_tr_b16 a[62:63], v237 offset:9184
  v_mfma_f32_16x16x32_bf16 v[88:91], a[152:155], a[184:187], v[88:91]
  v_mfma_f32_16x16x32_bf16 v[28:31], a[124:127], a[160:163], v[28:31]
  s_waitcnt lgkmcnt(0)
  v_mfma_f32_16x16x32_bf16 v[28:31], a[156:159], a[176:179], v[28:31]
  s_barrier
  s_add_u32 m0, s32, 118272
  v_mfma_f32_16x16x32_bf16 v[60:63], a[124:127], a[164:167], v[60:63]
  buffer_load_dwordx4 v248, s[12:15], s38 offen offset:0 lds
  v_mfma_f32_16x16x32_bf16 v[60:63], a[156:159], a[180:183], v[60:63]
  buffer_load_dwordx4 v249, s[12:15], s38 offen offset:1056 lds
  v_mfma_f32_16x16x32_bf16 v[92:95], a[124:127], a[168:171], v[92:95]
  buffer_load_dwordx4 v250, s[12:15], s38 offen offset:2112 lds
  v_mfma_f32_16x16x32_bf16 v[92:95], a[156:159], a[184:187], v[92:95]
  buffer_load_dwordx4 v251, s[12:15], s38 offen offset:3168 lds
  v_mfma_f32_16x16x32_bf16 v[0:3], a[0:3], a[64:67], v[0:3]
  s_waitcnt vmcnt(14)
  v_mfma_f32_16x16x32_bf16 v[0:3], a[32:35], a[80:83], v[0:3]
  s_barrier
  s_mov_b32 s34, 0
  s_add_u32 m0, s32, 16896
  v_mfma_f32_16x16x32_bf16 v[32:35], a[0:3], a[68:71], v[32:35]
  buffer_load_dwordx4 v242, s[20:23], s34 offen offset:2112 nt lds
  ds_read_b128 a[160:163], v236 offset:33792
  v_mfma_f32_16x16x32_bf16 v[32:35], a[32:35], a[84:87], v[32:35]
  ds_read_b128 a[164:167], v236 offset:38016
  v_mfma_f32_16x16x32_bf16 v[64:67], a[0:3], a[72:75], v[64:67]
  ds_read_b128 a[168:171], v236 offset:34304
  v_mfma_f32_16x16x32_bf16 v[64:67], a[32:35], a[88:91], v[64:67]
  s_add_u32 s33, s30, 7
  ds_read_b128 a[176:179], v236 offset:33856
  v_mfma_f32_16x16x32_bf16 v[4:7], a[4:7], a[64:67], v[4:7]
  s_and_b32 s33, s33, 7
  buffer_load_dwordx4 v243, s[20:23], s34 offen offset:3168 nt lds
  ds_read_b128 a[180:183], v236 offset:38080
  v_mfma_f32_16x16x32_bf16 v[4:7], a[36:39], a[80:83], v[4:7]
  s_lshl_b32 s36, s33, 7
  ds_read_b128 a[184:187], v236 offset:34368
  v_mfma_f32_16x16x32_bf16 v[36:39], a[4:7], a[68:71], v[36:39]
  s_lshl_b32 s38, s33, 19
  ds_read_b64_tr_b16 a[96:97], v237 offset:16896
  v_mfma_f32_16x16x32_bf16 v[36:39], a[36:39], a[84:87], v[36:39]
  s_add_u32 s37, s36, 16384
  ds_read_b64_tr_b16 a[98:99], v237 offset:25344
  v_mfma_f32_16x16x32_bf16 v[68:71], a[4:7], a[72:75], v[68:71]
  ds_read_b64_tr_b16 a[128:129], v237 offset:17408
  ds_read_b64_tr_b16 a[130:131], v237 offset:25856
  s_waitcnt lgkmcnt(4)
  s_add_u32 m0, s31, 33792
  v_mfma_f32_16x16x32_bf16 v[68:71], a[36:39], a[88:91], v[68:71]
  buffer_load_dwordx4 v244, s[8:11], s36 offen offset:0 lds
  v_mfma_f32_16x16x32_bf16 v[8:11], a[8:11], a[64:67], v[8:11]
  ds_read_b64_tr_b16 a[100:101], v237 offset:16928
  v_mfma_f32_16x16x32_bf16 v[8:11], a[40:43], a[80:83], v[8:11]
  ds_read_b64_tr_b16 a[102:103], v237 offset:25376
  v_mfma_f32_16x16x32_bf16 v[40:43], a[8:11], a[68:71], v[40:43]
  ds_read_b64_tr_b16 a[132:133], v237 offset:17440
  v_mfma_f32_16x16x32_bf16 v[40:43], a[40:43], a[84:87], v[40:43]
  buffer_load_dwordx4 v245, s[8:11], s36 offen offset:1056 lds
  ds_read_b64_tr_b16 a[134:135], v237 offset:25888
  v_mfma_f32_16x16x32_bf16 v[72:75], a[8:11], a[72:75], v[72:75]
  ds_read_b64_tr_b16 a[104:105], v237 offset:16960
  v_mfma_f32_16x16x32_bf16 v[72:75], a[40:43], a[88:91], v[72:75]
  ds_read_b64_tr_b16 a[106:107], v237 offset:25408
  v_mfma_f32_16x16x32_bf16 v[12:15], a[12:15], a[64:67], v[12:15]
  ds_read_b64_tr_b16 a[136:137], v237 offset:17472
  v_mfma_f32_16x16x32_bf16 v[12:15], a[44:47], a[80:83], v[12:15]
  buffer_load_dwordx4 v246, s[8:11], s36 offen offset:2112 lds
  ds_read_b64_tr_b16 a[138:139], v237 offset:25920
  v_mfma_f32_16x16x32_bf16 v[44:47], a[12:15], a[68:71], v[44:47]
  ds_read_b64_tr_b16 a[108:109], v237 offset:16992
  v_mfma_f32_16x16x32_bf16 v[44:47], a[44:47], a[84:87], v[44:47]
  ds_read_b64_tr_b16 a[110:111], v237 offset:25440
  v_mfma_f32_16x16x32_bf16 v[76:79], a[12:15], a[72:75], v[76:79]
  ds_read_b64_tr_b16 a[140:141], v237 offset:17504
  v_mfma_f32_16x16x32_bf16 v[76:79], a[44:47], a[88:91], v[76:79]
  buffer_load_dwordx4 v247, s[8:11], s36 offen offset:3168 lds
  ds_read_b64_tr_b16 a[142:143], v237 offset:25952
  v_mfma_f32_16x16x32_bf16 v[16:19], a[16:19], a[64:67], v[16:19]
  ds_read_b64_tr_b16 a[112:113], v237 offset:17024
  v_mfma_f32_16x16x32_bf16 v[16:19], a[48:51], a[80:83], v[16:19]
  s_add_u32 m0, s31, 38016
  ds_read_b64_tr_b16 a[114:115], v237 offset:25472
  v_mfma_f32_16x16x32_bf16 v[48:51], a[16:19], a[68:71], v[48:51]
  buffer_load_dwordx4 v244, s[8:11], s37 offen offset:0 lds
  v_mfma_f32_16x16x32_bf16 v[48:51], a[48:51], a[84:87], v[48:51]
  ds_read_b64_tr_b16 a[144:145], v237 offset:17536
  v_mfma_f32_16x16x32_bf16 v[80:83], a[16:19], a[72:75], v[80:83]
  ds_read_b64_tr_b16 a[146:147], v237 offset:25984
  ds_read_b64_tr_b16 a[116:117], v237 offset:17056
  v_mfma_f32_16x16x32_bf16 v[80:83], a[48:51], a[88:91], v[80:83]
  ds_read_b64_tr_b16 a[118:119], v237 offset:25504
  v_mfma_f32_16x16x32_bf16 v[20:23], a[20:23], a[64:67], v[20:23]
  buffer_load_dwordx4 v245, s[8:11], s37 offen offset:1056 lds
  v_mfma_f32_16x16x32_bf16 v[20:23], a[52:55], a[80:83], v[20:23]
  ds_read_b64_tr_b16 a[148:149], v237 offset:17568
  v_mfma_f32_16x16x32_bf16 v[52:55], a[20:23], a[68:71], v[52:55]
  ds_read_b64_tr_b16 a[150:151], v237 offset:26016
  ds_read_b64_tr_b16 a[120:121], v237 offset:17088
  v_mfma_f32_16x16x32_bf16 v[52:55], a[52:55], a[84:87], v[52:55]
  buffer_load_dwordx4 v246, s[8:11], s37 offen offset:2112 lds
  v_mfma_f32_16x16x32_bf16 v[84:87], a[20:23], a[72:75], v[84:87]
  ds_read_b64_tr_b16 a[122:123], v237 offset:25536
  v_mfma_f32_16x16x32_bf16 v[84:87], a[52:55], a[88:91], v[84:87]
  ds_read_b64_tr_b16 a[152:153], v237 offset:17600
  v_mfma_f32_16x16x32_bf16 v[24:27], a[24:27], a[64:67], v[24:27]
  ds_read_b64_tr_b16 a[154:155], v237 offset:26048
  ds_read_b64_tr_b16 a[124:125], v237 offset:17120
  v_mfma_f32_16x16x32_bf16 v[24:27], a[56:59], a[80:83], v[24:27]
  buffer_load_dwordx4 v247, s[8:11], s37 offen offset:3168 lds
  v_mfma_f32_16x16x32_bf16 v[56:59], a[24:27], a[68:71], v[56:59]
  ds_read_b64_tr_b16 a[126:127], v237 offset:25568
  v_mfma_f32_16x16x32_bf16 v[56:59], a[56:59], a[84:87], v[56:59]
  ds_read_b64_tr_b16 a[156:157], v237 offset:17632
  v_mfma_f32_16x16x32_bf16 v[88:91], a[24:27], a[72:75], v[88:91]
  ds_read_b64_tr_b16 a[158:159], v237 offset:26080
  v_mfma_f32_16x16x32_bf16 v[88:91], a[56:59], a[88:91], v[88:91]
  v_mfma_f32_16x16x32_bf16 v[28:31], a[28:31], a[64:67], v[28:31]
  s_waitcnt lgkmcnt(0)
  v_mfma_f32_16x16x32_bf16 v[28:31], a[60:63], a[80:83], v[28:31]
  s_barrier
  s_add_u32 m0, s32, 135168
  v_mfma_f32_16x16x32_bf16 v[60:63], a[28:31], a[68:71], v[60:63]
  buffer_load_dwordx4 v248, s[12:15], s38 offen offset:0 lds
  v_mfma_f32_16x16x32_bf16 v[60:63], a[60:63], a[84:87], v[60:63]
  buffer_load_dwordx4 v249, s[12:15], s38 offen offset:1056 lds
  v_mfma_f32_16x16x32_bf16 v[92:95], a[28:31], a[72:75], v[92:95]
  buffer_load_dwordx4 v250, s[12:15], s38 offen offset:2112 lds
  v_mfma_f32_16x16x32_bf16 v[92:95], a[60:63], a[88:91], v[92:95]
  buffer_load_dwordx4 v251, s[12:15], s38 offen offset:3168 lds
  v_mfma_f32_16x16x32_bf16 v[0:3], a[96:99], a[160:163], v[0:3]
  s_waitcnt vmcnt(14)
  v_mfma_f32_16x16x32_bf16 v[0:3], a[128:131], a[176:179], v[0:3]
  s_barrier
  s_mov_b32 s34, 16384
  s_add_u32 m0, s32, 33792
  v_mfma_f32_16x16x32_bf16 v[32:35], a[96:99], a[164:167], v[32:35]
  buffer_load_dwordx4 v240, s[16:19], s34 offen offset:0 nt lds
  ds_read_b128 a[64:67], v236 offset:0
  v_mfma_f32_16x16x32_bf16 v[32:35], a[128:131], a[180:183], v[32:35]
  ds_read_b128 a[68:71], v236 offset:4224
  v_mfma_f32_16x16x32_bf16 v[64:67], a[96:99], a[168:171], v[64:67]
  ds_read_b128 a[72:75], v236 offset:512
  v_mfma_f32_16x16x32_bf16 v[64:67], a[128:131], a[184:187], v[64:67]
  ds_read_b128 a[80:83], v236 offset:64
  v_mfma_f32_16x16x32_bf16 v[4:7], a[100:103], a[160:163], v[4:7]
  ds_read_b128 a[84:87], v236 offset:4288
  v_mfma_f32_16x16x32_bf16 v[4:7], a[132:135], a[176:179], v[4:7]
  ds_read_b128 a[88:91], v236 offset:576
  v_mfma_f32_16x16x32_bf16 v[36:39], a[100:103], a[164:167], v[36:39]
  ds_read_b64_tr_b16 a[0:1], v237 offset:0
  v_mfma_f32_16x16x32_bf16 v[36:39], a[132:135], a[180:183], v[36:39]
  ds_read_b64_tr_b16 a[2:3], v237 offset:8448
  v_mfma_f32_16x16x32_bf16 v[68:71], a[100:103], a[168:171], v[68:71]
  ds_read_b64_tr_b16 a[32:33], v237 offset:512
  v_mfma_f32_16x16x32_bf16 v[68:71], a[132:135], a[184:187], v[68:71]
  ds_read_b64_tr_b16 a[34:35], v237 offset:8960
  v_mfma_f32_16x16x32_bf16 v[8:11], a[104:107], a[160:163], v[8:11]
  buffer_load_dwordx4 v241, s[16:19], s34 offen offset:1056 nt lds
  v_mfma_f32_16x16x32_bf16 v[8:11], a[136:139], a[176:179], v[8:11]
  ds_read_b64_tr_b16 a[4:5], v237 offset:32
  v_mfma_f32_16x16x32_bf16 v[40:43], a[104:107], a[164:167], v[40:43]
  ds_read_b64_tr_b16 a[6:7], v237 offset:8480
  v_mfma_f32_16x16x32_bf16 v[40:43], a[136:139], a[180:183], v[40:43]
  ds_read_b64_tr_b16 a[36:37], v237 offset:544
  v_mfma_f32_16x16x32_bf16 v[72:75], a[104:107], a[168:171], v[72:75]
  ds_read_b64_tr_b16 a[38:39], v237 offset:8992
  v_mfma_f32_16x16x32_bf16 v[72:75], a[136:139], a[184:187], v[72:75]
  ds_read_b64_tr_b16 a[8:9], v237 offset:64
  v_mfma_f32_16x16x32_bf16 v[12:15], a[108:111], a[160:163], v[12:15]
  ds_read_b64_tr_b16 a[10:11], v237 offset:8512
  v_mfma_f32_16x16x32_bf16 v[12:15], a[140:143], a[176:179], v[12:15]
  ds_read_b64_tr_b16 a[40:41], v237 offset:576
  v_mfma_f32_16x16x32_bf16 v[44:47], a[108:111], a[164:167], v[44:47]
  ds_read_b64_tr_b16 a[42:43], v237 offset:9024
  v_mfma_f32_16x16x32_bf16 v[44:47], a[140:143], a[180:183], v[44:47]
  ds_read_b64_tr_b16 a[12:13], v237 offset:96
  v_mfma_f32_16x16x32_bf16 v[76:79], a[108:111], a[168:171], v[76:79]
  buffer_load_dwordx4 v242, s[16:19], s34 offen offset:2112 nt lds
  v_mfma_f32_16x16x32_bf16 v[76:79], a[140:143], a[184:187], v[76:79]
  ds_read_b64_tr_b16 a[14:15], v237 offset:8544
  v_mfma_f32_16x16x32_bf16 v[16:19], a[112:115], a[160:163], v[16:19]
  ds_read_b64_tr_b16 a[44:45], v237 offset:608
  v_mfma_f32_16x16x32_bf16 v[16:19], a[144:147], a[176:179], v[16:19]
  ds_read_b64_tr_b16 a[46:47], v237 offset:9056
  v_mfma_f32_16x16x32_bf16 v[48:51], a[112:115], a[164:167], v[48:51]
  ds_read_b64_tr_b16 a[16:17], v237 offset:128
  v_mfma_f32_16x16x32_bf16 v[48:51], a[144:147], a[180:183], v[48:51]
  ds_read_b64_tr_b16 a[18:19], v237 offset:8576
  v_mfma_f32_16x16x32_bf16 v[80:83], a[112:115], a[168:171], v[80:83]
  ds_read_b64_tr_b16 a[48:49], v237 offset:640
  v_mfma_f32_16x16x32_bf16 v[80:83], a[144:147], a[184:187], v[80:83]
  ds_read_b64_tr_b16 a[50:51], v237 offset:9088
  v_mfma_f32_16x16x32_bf16 v[20:23], a[116:119], a[160:163], v[20:23]
  ds_read_b64_tr_b16 a[20:21], v237 offset:160
  v_mfma_f32_16x16x32_bf16 v[20:23], a[148:151], a[176:179], v[20:23]
  ds_read_b64_tr_b16 a[22:23], v237 offset:8608
  v_mfma_f32_16x16x32_bf16 v[52:55], a[116:119], a[164:167], v[52:55]
  ds_read_b64_tr_b16 a[52:53], v237 offset:672
  v_mfma_f32_16x16x32_bf16 v[52:55], a[148:151], a[180:183], v[52:55]
  buffer_load_dwordx4 v243, s[16:19], s34 offen offset:3168 nt lds
  v_mfma_f32_16x16x32_bf16 v[84:87], a[116:119], a[168:171], v[84:87]
  ds_read_b64_tr_b16 a[54:55], v237 offset:9120
  v_mfma_f32_16x16x32_bf16 v[84:87], a[148:151], a[184:187], v[84:87]
  ds_read_b64_tr_b16 a[24:25], v237 offset:192
  v_mfma_f32_16x16x32_bf16 v[24:27], a[120:123], a[160:163], v[24:27]
  ds_read_b64_tr_b16 a[26:27], v237 offset:8640
  v_mfma_f32_16x16x32_bf16 v[24:27], a[152:155], a[176:179], v[24:27]
  ds_read_b64_tr_b16 a[56:57], v237 offset:704
  v_mfma_f32_16x16x32_bf16 v[56:59], a[120:123], a[164:167], v[56:59]
  ds_read_b64_tr_b16 a[58:59], v237 offset:9152
  v_mfma_f32_16x16x32_bf16 v[56:59], a[152:155], a[180:183], v[56:59]
  ds_read_b64_tr_b16 a[28:29], v237 offset:224
  v_mfma_f32_16x16x32_bf16 v[88:91], a[120:123], a[168:171], v[88:91]
  ds_read_b64_tr_b16 a[30:31], v237 offset:8672
  v_mfma_f32_16x16x32_bf16 v[88:91], a[152:155], a[184:187], v[88:91]
  ds_read_b64_tr_b16 a[60:61], v237 offset:736
  v_mfma_f32_16x16x32_bf16 v[28:31], a[124:127], a[160:163], v[28:31]
  ds_read_b64_tr_b16 a[62:63], v237 offset:9184
  v_mfma_f32_16x16x32_bf16 v[28:31], a[156:159], a[176:179], v[28:31]
  v_mfma_f32_16x16x32_bf16 v[60:63], a[124:127], a[164:167], v[60:63]
  v_mfma_f32_16x16x32_bf16 v[60:63], a[156:159], a[180:183], v[60:63]
  v_mfma_f32_16x16x32_bf16 v[92:95], a[124:127], a[168:171], v[92:95]
  v_mfma_f32_16x16x32_bf16 v[92:95], a[156:159], a[184:187], v[92:95]
  s_waitcnt lgkmcnt(0)
  v_mfma_f32_16x16x32_bf16 v[0:3], a[0:3], a[64:67], v[0:3]
  s_waitcnt vmcnt(4)
  v_mfma_f32_16x16x32_bf16 v[0:3], a[32:35], a[80:83], v[0:3]
  s_barrier
  s_mov_b32 s34, 32768
  s_add_u32 m0, s32, 67584
  v_mfma_f32_16x16x32_bf16 v[32:35], a[0:3], a[68:71], v[32:35]
  buffer_load_dwordx4 v240, s[16:19], s34 offen offset:0 nt lds
  ds_read_b128 a[160:163], v236 offset:33792
  v_mfma_f32_16x16x32_bf16 v[32:35], a[32:35], a[84:87], v[32:35]
  ds_read_b128 a[164:167], v236 offset:38016
  v_mfma_f32_16x16x32_bf16 v[64:67], a[0:3], a[72:75], v[64:67]
  ds_read_b128 a[168:171], v236 offset:34304
  v_mfma_f32_16x16x32_bf16 v[64:67], a[32:35], a[88:91], v[64:67]
  ds_read_b128 a[176:179], v236 offset:33856
  v_mfma_f32_16x16x32_bf16 v[4:7], a[4:7], a[64:67], v[4:7]
  ds_read_b128 a[180:183], v236 offset:38080
  v_mfma_f32_16x16x32_bf16 v[4:7], a[36:39], a[80:83], v[4:7]
  buffer_load_dwordx4 v241, s[16:19], s34 offen offset:1056 nt lds
  v_mfma_f32_16x16x32_bf16 v[36:39], a[4:7], a[68:71], v[36:39]
  ds_read_b128 a[184:187], v236 offset:34368
  v_mfma_f32_16x16x32_bf16 v[36:39], a[36:39], a[84:87], v[36:39]
  ds_read_b64_tr_b16 a[96:97], v237 offset:16896
  v_mfma_f32_16x16x32_bf16 v[68:71], a[4:7], a[72:75], v[68:71]
  ds_read_b64_tr_b16 a[98:99], v237 offset:25344
  ds_read_b64_tr_b16 a[128:129], v237 offset:17408
  v_mfma_f32_16x16x32_bf16 v[68:71], a[36:39], a[88:91], v[68:71]
  ds_read_b64_tr_b16 a[130:131], v237 offset:25856
  v_mfma_f32_16x16x32_bf16 v[8:11], a[8:11], a[64:67], v[8:11]
  buffer_load_dwordx4 v242, s[16:19], s34 offen offset:2112 nt lds
  v_mfma_f32_16x16x32_bf16 v[8:11], a[40:43], a[80:83], v[8:11]
  ds_read_b64_tr_b16 a[100:101], v237 offset:16928
  v_mfma_f32_16x16x32_bf16 v[40:43], a[8:11], a[68:71], v[40:43]
  ds_read_b64_tr_b16 a[102:103], v237 offset:25376
  v_mfma_f32_16x16x32_bf16 v[40:43], a[40:43], a[84:87], v[40:43]
  ds_read_b64_tr_b16 a[132:133], v237 offset:17440
  v_mfma_f32_16x16x32_bf16 v[72:75], a[8:11], a[72:75], v[72:75]
  ds_read_b64_tr_b16 a[134:135], v237 offset:25888
  v_mfma_f32_16x16x32_bf16 v[72:75], a[40:43], a[88:91], v[72:75]
  ds_read_b64_tr_b16 a[104:105], v237 offset:16960
  v_mfma_f32_16x16x32_bf16 v[12:15], a[12:15], a[64:67], v[12:15]
  buffer_load_dwordx4 v243, s[16:19], s34 offen offset:3168 nt lds
  ds_read_b64_tr_b16 a[106:107], v237 offset:25408
  v_mfma_f32_16x16x32_bf16 v[12:15], a[44:47], a[80:83], v[12:15]
  ds_read_b64_tr_b16 a[136:137], v237 offset:17472
  v_mfma_f32_16x16x32_bf16 v[44:47], a[12:15], a[68:71], v[44:47]
  s_mov_b32 s34, 16384
  ds_read_b64_tr_b16 a[138:139], v237 offset:25920
  v_mfma_f32_16x16x32_bf16 v[44:47], a[44:47], a[84:87], v[44:47]
  s_add_u32 m0, s32, 50688
  ds_read_b64_tr_b16 a[108:109], v237 offset:16992
  v_mfma_f32_16x16x32_bf16 v[76:79], a[12:15], a[72:75], v[76:79]
  buffer_load_dwordx4 v240, s[20:23], s34 offen offset:0 nt lds
  v_mfma_f32_16x16x32_bf16 v[76:79], a[44:47], a[88:91], v[76:79]
  ds_read_b64_tr_b16 a[110:111], v237 offset:25440
  v_mfma_f32_16x16x32_bf16 v[16:19], a[16:19], a[64:67], v[16:19]
  ds_read_b64_tr_b16 a[140:141], v237 offset:17504
  v_mfma_f32_16x16x32_bf16 v[16:19], a[48:51], a[80:83], v[16:19]
  ds_read_b64_tr_b16 a[142:143], v237 offset:25952
  v_mfma_f32_16x16x32_bf16 v[48:51], a[16:19], a[68:71], v[48:51]
  ds_read_b64_tr_b16 a[112:113], v237 offset:17024
  ds_read_b64_tr_b16 a[114:115], v237 offset:25472
  v_mfma_f32_16x16x32_bf16 v[48:51], a[48:51], a[84:87], v[48:51]
  buffer_load_dwordx4 v241, s[20:23], s34 offen offset:1056 nt lds
  v_mfma_f32_16x16x32_bf16 v[80:83], a[16:19], a[72:75], v[80:83]
  ds_read_b64_tr_b16 a[144:145], v237 offset:17536
  v_mfma_f32_16x16x32_bf16 v[80:83], a[48:51], a[88:91], v[80:83]
  ds_read_b64_tr_b16 a[146:147], v237 offset:25984
  v_mfma_f32_16x16x32_bf16 v[20:23], a[20:23], a[64:67], v[20:23]
  ds_read_b64_tr_b16 a[116:117], v237 offset:17056
  v_mfma_f32_16x16x32_bf16 v[20:23], a[52:55], a[80:83], v[20:23]
  ds_read_b64_tr_b16 a[118:119], v237 offset:25504
  v_mfma_f32_16x16x32_bf16 v[52:55], a[20:23], a[68:71], v[52:55]
  ds_read_b64_tr_b16 a[148:149], v237 offset:17568
  v_mfma_f32_16x16x32_bf16 v[52:55], a[52:55], a[84:87], v[52:55]
  buffer_load_dwordx4 v242, s[20:23], s34 offen offset:2112 nt lds
  v_mfma_f32_16x16x32_bf16 v[84:87], a[20:23], a[72:75], v[84:87]
  ds_read_b64_tr_b16 a[150:151], v237 offset:26016
  ds_read_b64_tr_b16 a[120:121], v237 offset:17088
  v_mfma_f32_16x16x32_bf16 v[84:87], a[52:55], a[88:91], v[84:87]
  ds_read_b64_tr_b16 a[122:123], v237 offset:25536
  v_mfma_f32_16x16x32_bf16 v[24:27], a[24:27], a[64:67], v[24:27]
  ds_read_b64_tr_b16 a[152:153], v237 offset:17600
  v_mfma_f32_16x16x32_bf16 v[24:27], a[56:59], a[80:83], v[24:27]
  ds_read_b64_tr_b16 a[154:155], v237 offset:26048
  v_mfma_f32_16x16x32_bf16 v[56:59], a[24:27], a[68:71], v[56:59]
  buffer_load_dwordx4 v243, s[20:23], s34 offen offset:3168 nt lds
  v_mfma_f32_16x16x32_bf16 v[56:59], a[56:59], a[84:87], v[56:59]
  ds_read_b64_tr_b16 a[124:125], v237 offset:17120
  v_mfma_f32_16x16x32_bf16 v[88:91], a[24:27], a[72:75], v[88:91]
  ds_read_b64_tr_b16 a[126:127], v237 offset:25568
  v_mfma_f32_16x16x32_bf16 v[88:91], a[56:59], a[88:91], v[88:91]
  ds_read_b64_tr_b16 a[156:157], v237 offset:17632
  v_mfma_f32_16x16x32_bf16 v[28:31], a[28:31], a[64:67], v[28:31]
  ds_read_b64_tr_b16 a[158:159], v237 offset:26080
  v_mfma_f32_16x16x32_bf16 v[28:31], a[60:63], a[80:83], v[28:31]
  v_mfma_f32_16x16x32_bf16 v[60:63], a[28:31], a[68:71], v[60:63]
  v_mfma_f32_16x16x32_bf16 v[60:63], a[60:63], a[84:87], v[60:63]
  v_mfma_f32_16x16x32_bf16 v[92:95], a[28:31], a[72:75], v[92:95]
  v_mfma_f32_16x16x32_bf16 v[92:95], a[60:63], a[88:91], v[92:95]
  s_waitcnt lgkmcnt(0)
  v_mfma_f32_16x16x32_bf16 v[0:3], a[96:99], a[160:163], v[0:3]
  v_mfma_f32_16x16x32_bf16 v[0:3], a[128:131], a[176:179], v[0:3]
  v_mfma_f32_16x16x32_bf16 v[4:7], a[100:103], a[160:163], v[4:7]
  v_mfma_f32_16x16x32_bf16 v[4:7], a[132:135], a[176:179], v[4:7]
  v_mfma_f32_16x16x32_bf16 v[8:11], a[104:107], a[160:163], v[8:11]
  v_mfma_f32_16x16x32_bf16 v[8:11], a[136:139], a[176:179], v[8:11]
  v_mfma_f32_16x16x32_bf16 v[12:15], a[108:111], a[160:163], v[12:15]
  v_mfma_f32_16x16x32_bf16 v[12:15], a[140:143], a[176:179], v[12:15]
  v_mfma_f32_16x16x32_bf16 v[16:19], a[112:115], a[160:163], v[16:19]
  v_mfma_f32_16x16x32_bf16 v[16:19], a[144:147], a[176:179], v[16:19]
  v_mfma_f32_16x16x32_bf16 v[20:23], a[116:119], a[160:163], v[20:23]
  s_waitcnt vmcnt(52)
  v_mfma_f32_16x16x32_bf16 v[20:23], a[148:151], a[176:179], v[20:23]
  s_barrier
  v_mfma_f32_16x16x32_bf16 v[24:27], a[120:123], a[160:163], v[24:27]
  s_mov_b32 s34, 49152
  ds_read_b128 a[192:195], v232 offset:0
  v_mfma_f32_16x16x32_bf16 v[24:27], a[152:155], a[176:179], v[24:27]
  s_add_u32 m0, s32, 101376
  ds_read_b128 a[196:199], v232 offset:64
  v_mfma_f32_16x16x32_bf16 v[28:31], a[124:127], a[160:163], v[28:31]
  buffer_load_dwordx4 v240, s[16:19], s34 offen offset:0 nt lds
  v_mfma_f32_16x16x32_bf16 v[28:31], a[156:159], a[176:179], v[28:31]
  ds_read_b128 a[200:203], v232 offset:128
  v_mfma_f32_16x16x32_bf16 v[32:35], a[96:99], a[164:167], v[32:35]
  buffer_load_dwordx4 v241, s[16:19], s34 offen offset:1056 nt lds
  v_mfma_f32_16x16x32_bf16 v[32:35], a[128:131], a[180:183], v[32:35]
  ds_read_b128 a[204:207], v232 offset:192
  v_mul_f32 v0, s53, v0
  v_mfma_f32_16x16x32_bf16 v[36:39], a[100:103], a[164:167], v[36:39]
  ds_read_b128 a[208:211], v232 offset:512
  v_mul_f32 v1, s53, v1
  v_mul_f32 v2, s53, v2
  v_mul_f32 v3, s53, v3
  v_mfma_f32_16x16x32_bf16 v[36:39], a[132:135], a[180:183], v[36:39]
  buffer_load_dwordx4 v242, s[16:19], s34 offen offset:2112 nt lds
  v_cvt_pk_bf16_f32 v128, v0, v1
  v_mfma_f32_16x16x32_bf16 v[40:43], a[104:107], a[164:167], v[40:43]
  ds_read_b128 a[212:215], v232 offset:576
  v_cvt_pk_bf16_f32 v129, v2, v3
  v_mul_f32 v4, s53, v4
  v_mul_f32 v5, s53, v5
  v_mfma_f32_16x16x32_bf16 v[40:43], a[136:139], a[180:183], v[40:43]
  ds_read_b128 a[216:219], v232 offset:640
  v_mul_f32 v6, s53, v6
  v_mul_f32 v7, s53, v7
  v_cvt_pk_bf16_f32 v130, v4, v5
  v_mfma_f32_16x16x32_bf16 v[44:47], a[108:111], a[164:167], v[44:47]
  ds_read_b128 a[220:223], v232 offset:704
  v_cvt_pk_bf16_f32 v131, v6, v7
  v_permlane32_swap_b32 v128, v130
  v_mul_f32 v8, s53, v8
  v_mfma_f32_16x16x32_bf16 v[44:47], a[140:143], a[180:183], v[44:47]
  buffer_load_dwordx4 v243, s[16:19], s34 offen offset:3168 nt lds
  v_permlane32_swap_b32 v129, v131
  v_mfma_f32_16x16x32_bf16 v[48:51], a[112:115], a[164:167], v[48:51]
  s_lshl_b32 s35, s28, 4
  v_permlane16_swap_b32 v128, v130
  v_permlane16_swap_b32 v129, v131
  v_mul_f32 v9, s53, v9
  v_mul_f32 v10, s53, v10
  v_mfma_f32_16x16x32_bf16 v[48:51], a[144:147], a[180:183], v[48:51]
  v_mul_f32 v11, s53, v11
  v_mov_b32 v228, s35
  v_cvt_pk_bf16_f32 v132, v8, v9
  v_cvt_pk_bf16_f32 v133, v10, v11
  v_mfma_f32_16x16x32_bf16 v[52:55], a[116:119], a[164:167], v[52:55]
  v_mul_f32 v12, s53, v12
  v_mul_f32 v13, s53, v13
  v_mul_f32 v14, s53, v14
  v_mul_f32 v15, s53, v15
  v_mfma_f32_16x16x32_bf16 v[52:55], a[148:151], a[180:183], v[52:55]
  s_lshr_b32 s97, s29, 3
  global_load_dwordx4 v[224:227], v228, s[100:101] sc1
  v_cvt_pk_bf16_f32 v134, v12, v13
  v_mfma_f32_16x16x32_bf16 v[56:59], a[120:123], a[164:167], v[56:59]
  s_lshl_b32 s97, s97, 2
  v_cvt_pk_bf16_f32 v135, v14, v15
  v_permlane32_swap_b32 v132, v134
  v_mul_f32 v16, s53, v16
  v_permlane32_swap_b32 v133, v135
  v_mfma_f32_16x16x32_bf16 v[56:59], a[152:155], a[180:183], v[56:59]
  s_add_u32 s35, s35, s97
  v_permlane16_swap_b32 v132, v134
  v_permlane16_swap_b32 v133, v135
  v_mul_f32 v17, s53, v17
  v_mul_f32 v18, s53, v18
  v_mfma_f32_16x16x32_bf16 v[60:63], a[124:127], a[164:167], v[60:63]
  v_mul_f32 v19, s53, v19
  v_cvt_pk_bf16_f32 v136, v16, v17
  v_mov_b32 v228, s35
  v_cvt_pk_bf16_f32 v137, v18, v19
  v_mfma_f32_16x16x32_bf16 v[60:63], a[156:159], a[180:183], v[60:63]
  v_mul_f32 v20, s53, v20
  v_mul_f32 v21, s53, v21
  v_mul_f32 v22, s53, v22
  v_mul_f32 v23, s53, v23
  v_mfma_f32_16x16x32_bf16 v[64:67], a[96:99], a[168:171], v[64:67]
  global_load_dword v229, v228, s[100:101] sc1
  v_cvt_pk_bf16_f32 v138, v20, v21
  v_mfma_f32_16x16x32_bf16 v[64:67], a[128:131], a[184:187], v[64:67]
  v_cvt_pk_bf16_f32 v139, v22, v23
  v_permlane32_swap_b32 v136, v138
  v_mul_f32 v24, s53, v24
  v_permlane32_swap_b32 v137, v139
  v_mfma_f32_16x16x32_bf16 v[68:71], a[100:103], a[168:171], v[68:71]
  v_permlane16_swap_b32 v136, v138
  v_permlane16_swap_b32 v137, v139
  v_mul_f32 v25, s53, v25
  v_mul_f32 v26, s53, v26
  v_mfma_f32_16x16x32_bf16 v[68:71], a[132:135], a[184:187], v[68:71]
  v_mul_f32 v27, s53, v27
  v_cvt_pk_bf16_f32 v140, v24, v25
  v_cvt_pk_bf16_f32 v141, v26, v27
  v_mul_f32 v32, s53, v32
  v_mfma_f32_16x16x32_bf16 v[72:75], a[104:107], a[168:171], v[72:75]
  v_mul_f32 v28, s53, v28
  v_mul_f32 v33, s53, v33
  v_mul_f32 v29, s53, v29
  v_mul_f32 v34, s53, v34
  v_mfma_f32_16x16x32_bf16 v[72:75], a[136:139], a[184:187], v[72:75]
  v_mul_f32 v30, s53, v30
  v_mul_f32 v35, s53, v35
  v_mul_f32 v31, s53, v31
  v_cvt_pk_bf16_f32 v144, v32, v33
  v_mfma_f32_16x16x32_bf16 v[76:79], a[108:111], a[168:171], v[76:79]
  v_cvt_pk_bf16_f32 v142, v28, v29
  v_cvt_pk_bf16_f32 v145, v34, v35
  v_cvt_pk_bf16_f32 v143, v30, v31
  v_mul_f32 v36, s53, v36
  v_mfma_f32_16x16x32_bf16 v[76:79], a[140:143], a[184:187], v[76:79]
  v_permlane32_swap_b32 v140, v142
  v_mul_f32 v37, s53, v37
  v_permlane32_swap_b32 v141, v143
  v_mul_f32 v38, s53, v38
  v_mfma_f32_16x16x32_bf16 v[80:83], a[112:115], a[168:171], v[80:83]
  v_permlane16_swap_b32 v140, v142
  v_mul_f32 v39, s53, v39
  v_permlane16_swap_b32 v141, v143
  v_cvt_pk_bf16_f32 v146, v36, v37
  v_mfma_f32_16x16x32_bf16 v[80:83], a[144:147], a[184:187], v[80:83]
  v_cvt_pk_bf16_f32 v147, v38, v39
  v_permlane32_swap_b32 v144, v146
  v_mul_f32 v40, s53, v40
  v_permlane32_swap_b32 v145, v147
  v_mfma_f32_16x16x32_bf16 v[84:87], a[116:119], a[168:171], v[84:87]
  v_permlane16_swap_b32 v144, v146
  v_permlane16_swap_b32 v145, v147
  v_mul_f32 v41, s53, v41
  v_mul_f32 v42, s53, v42
  v_mfma_f32_16x16x32_bf16 v[84:87], a[148:151], a[184:187], v[84:87]
  v_mul_f32 v43, s53, v43
  v_cvt_pk_bf16_f32 v148, v40, v41
  v_cvt_pk_bf16_f32 v149, v42, v43
  v_mul_f32 v44, s53, v44
  v_mfma_f32_16x16x32_bf16 v[88:91], a[120:123], a[168:171], v[88:91]
  s_mov_b32 s34, 32768
  v_mul_f32 v45, s53, v45
  v_mul_f32 v46, s53, v46
  v_mul_f32 v47, s53, v47
  v_cvt_pk_bf16_f32 v150, v44, v45
  v_mfma_f32_16x16x32_bf16 v[88:91], a[152:155], a[184:187], v[88:91]
  s_add_u32 m0, s32, 84480
  v_cvt_pk_bf16_f32 v151, v46, v47
  v_permlane32_swap_b32 v148, v150
  v_mul_f32 v48, s53, v48
  v_permlane32_swap_b32 v149, v151
  v_mfma_f32_16x16x32_bf16 v[92:95], a[124:127], a[168:171], v[92:95]
  v_permlane16_swap_b32 v148, v150
  v_permlane16_swap_b32 v149, v151
  v_mul_f32 v49, s53, v49
  v_mul_f32 v50, s53, v50
  v_mfma_f32_16x16x32_bf16 v[92:95], a[156:159], a[184:187], v[92:95]
  s_waitcnt lgkmcnt(0)
  v_mul_f32 v51, s53, v51
  v_cvt_pk_bf16_f32 v152, v48, v49
  v_cvt_pk_bf16_f32 v153, v50, v51
  v_mul_f32 v52, s53, v52
  v_mfma_f32_16x16x32_bf16 v[0:3], a[192:195], v[128:131], 0
  v_mul_f32 v53, s53, v53
  v_mul_f32 v54, s53, v54
  v_mul_f32 v55, s53, v55
  v_cvt_pk_bf16_f32 v154, v52, v53
  v_mfma_f32_16x16x32_bf16 v[0:3], a[196:199], v[132:135], v[0:3]
  v_cvt_pk_bf16_f32 v155, v54, v55
  v_permlane32_swap_b32 v152, v154
  v_mul_f32 v56, s53, v56
  v_permlane32_swap_b32 v153, v155
  v_mfma_f32_16x16x32_bf16 v[0:3], a[200:203], v[136:139], v[0:3]
  v_permlane16_swap_b32 v152, v154
  v_permlane16_swap_b32 v153, v155
  v_mul_f32 v57, s53, v57
  v_mul_f32 v58, s53, v58
  v_mfma_f32_16x16x32_bf16 v[0:3], a[204:207], v[140:143], v[0:3]
  buffer_load_dwordx4 v240, s[20:23], s34 offen offset:0 nt lds
  v_mul_f32 v59, s53, v59
  v_mfma_f32_16x16x32_bf16 v[4:7], a[208:211], v[128:131], 0
  v_cvt_pk_bf16_f32 v156, v56, v57
  v_cvt_pk_bf16_f32 v157, v58, v59
  v_mul_f32 v64, s53, v64
  v_mul_f32 v60, s53, v60
  v_mfma_f32_16x16x32_bf16 v[4:7], a[212:215], v[132:135], v[4:7]
  v_mul_f32 v65, s53, v65
  v_mul_f32 v61, s53, v61
  v_mul_f32 v66, s53, v66
  v_mul_f32 v62, s53, v62
  v_mfma_f32_16x16x32_bf16 v[4:7], a[216:219], v[136:139], v[4:7]
  v_mul_f32 v67, s53, v67
  v_mul_f32 v63, s53, v63
  v_cvt_pk_bf16_f32 v160, v64, v65
  v_cvt_pk_bf16_f32 v158, v60, v61
  v_mfma_f32_16x16x32_bf16 v[4:7], a[220:223], v[140:143], v[4:7]
  v_cvt_pk_bf16_f32 v161, v66, v67
  v_cvt_pk_bf16_f32 v159, v62, v63
  v_mul_f32 v68, s53, v68
  v_permlane32_swap_b32 v156, v158
  v_mfma_f32_16x16x32_bf16 v[8:11], a[192:195], v[144:147], 0
  v_mul_f32 v69, s53, v69
  v_permlane32_swap_b32 v157, v159
  v_mul_f32 v70, s53, v70
  v_permlane16_swap_b32 v156, v158
  v_mfma_f32_16x16x32_bf16 v[8:11], a[196:199], v[148:151], v[8:11]
  v_mul_f32 v71, s53, v71
  v_permlane16_swap_b32 v157, v159
  v_cvt_pk_bf16_f32 v162, v68, v69
  v_cvt_pk_bf16_f32 v163, v70, v71
  v_mfma_f32_16x16x32_bf16 v[8:11], a[200:203], v[152:155], v[8:11]
  s_mov_b32 s98, 0
  v_permlane32_swap_b32 v160, v162
  v_permlane32_swap_b32 v161, v163
  v_mul_f32 v72, s53, v72
  v_permlane16_swap_b32 v160, v162
  v_mfma_f32_16x16x32_bf16 v[8:11], a[204:207], v[156:159], v[8:11]
  s_mov_b32 s47, 49152
  v_permlane16_swap_b32 v161, v163
  v_mov_b32 v233, v235
  v_mul_f32 v73, s53, v73
  v_mul_f32 v74, s53, v74
  v_mfma_f32_16x16x32_bf16 v[12:15], a[208:211], v[144:147], 0
  s_mov_b32 s46, 53248
  buffer_load_dwordx4 v241, s[20:23], s34 offen offset:1056 nt lds
  v_mul_f32 v75, s53, v75
  v_cvt_pk_bf16_f32 v164, v72, v73
  v_mfma_f32_16x16x32_bf16 v[12:15], a[212:215], v[148:151], v[12:15]
  s_mov_b32 s48, 33792
  v_cvt_pk_bf16_f32 v165, v74, v75
  v_mul_f32 v76, s53, v76
  v_mul_f32 v77, s53, v77
  v_max3_f32 v216, v0, v1, v212
  v_mov_b32 v208, 0
  v_mfma_f32_16x16x32_bf16 v[12:15], a[216:219], v[152:155], v[12:15]
  s_mov_b32 s49, 67584
  v_mul_f32 v78, s53, v78
  v_mul_f32 v79, s53, v79
  v_max3_f32 v216, v2, v3, v216
  v_cvt_pk_bf16_f32 v166, v76, v77
  v_max3_f32 v216, v4, v5, v216
  v_mfma_f32_16x16x32_bf16 v[12:15], a[220:223], v[156:159], v[12:15]
  s_mov_b32 s50, 101376
  v_cvt_pk_bf16_f32 v167, v78, v79
  v_permlane32_swap_b32 v164, v166
  v_max3_f32 v216, v6, v7, v216
  v_permlane32_swap_b32 v165, v167
  v_permlane16_swap_b32 v164, v166
  v_mov_b32 v217, v216
  v_mfma_f32_16x16x32_bf16 v[16:19], a[192:195], v[160:163], 0
  s_mov_b32 s51, 0
  ds_read_b128 a[192:195], v232 offset:8448
  v_permlane16_swap_b32 v165, v167
  v_permlane16_swap_b32 v216, v217
  v_mul_f32 v80, s53, v80
  v_mul_f32 v81, s53, v81
  v_max_f32 v216, v216, v217
  v_mfma_f32_16x16x32_bf16 v[16:19], a[196:199], v[164:167], v[16:19]
  s_mov_b32 s40, 0
  ds_read_b128 a[196:199], v232 offset:8512
  v_mul_f32 v82, s53, v82
  v_mul_f32 v83, s53, v83
  v_mov_b32 v217, v216
  v_cvt_pk_bf16_f32 v168, v80, v81
  v_cvt_pk_bf16_f32 v169, v82, v83
  v_permlane32_swap_b32 v216, v217
  v_mul_f32 v84, s53, v84
  v_mul_f32 v85, s53, v85
  v_mul_f32 v86, s53, v86
  v_mul_f32 v87, s53, v87
  v_cvt_pk_bf16_f32 v170, v84, v85
  v_cvt_pk_bf16_f32 v171, v86, v87
  s_nop 0
  v_permlane32_swap_b32 v168, v170
  s_nop 1
  v_permlane16_swap_b32 v168, v170
  v_permlane32_swap_b32 v169, v171
  s_nop 1
  v_permlane16_swap_b32 v169, v171
  s_nop 1
  v_mfma_f32_16x16x32_bf16 v[16:19], a[200:203], v[168:171], v[16:19]
  s_mov_b32 s41, 33792
  buffer_load_dwordx4 v242, s[20:23], s34 offen offset:2112 nt lds
  v_max_f32 v216, v216, v217
  v_sub_f32 v192, 0, v216
  v_mul_f32 v88, s53, v88
  v_mul_f32 v89, s53, v89
  v_mul_f32 v90, s53, v90
  v_mul_f32 v91, s53, v91
  v_cvt_pk_bf16_f32 v172, v88, v89
  v_cvt_pk_bf16_f32 v173, v90, v91
  v_mul_f32 v92, s53, v92
  v_mul_f32 v93, s53, v93
  v_mul_f32 v94, s53, v94
  v_mul_f32 v95, s53, v95
  v_cvt_pk_bf16_f32 v174, v92, v93
  v_cvt_pk_bf16_f32 v175, v94, v95
  s_nop 0
  v_permlane32_swap_b32 v172, v174
  s_nop 1
  v_permlane16_swap_b32 v172, v174
  v_permlane32_swap_b32 v173, v175
  s_nop 1
  v_permlane16_swap_b32 v173, v175
  s_nop 1
  v_mfma_f32_16x16x32_bf16 v[16:19], a[204:207], v[172:175], v[16:19]
  s_mov_b32 s42, 67584
  ds_read_b128 a[200:203], v232 offset:8576
  v_sub_f32 v193, 0, v216
  v_sub_f32 v194, 0, v216
  v_sub_f32 v195, 0, v216
  v_mfma_f32_16x16x32_bf16 v[20:23], a[208:211], v[160:163], 0
  s_mov_b32 s43, 101376
  ds_read_b128 a[204:207], v232 offset:8640
  v_sub_f32 v0, v0, v216
  v_sub_f32 v1, v1, v216
  v_sub_f32 v2, v2, v216
  v_mfma_f32_16x16x32_bf16 v[20:23], a[212:215], v[164:167], v[20:23]
  s_mov_b32 s7, 118272
  ds_read_b128 a[208:211], v232 offset:8960
  v_max3_f32 v218, v8, v9, v213
  v_mov_b32 v209, 0
  v_sub_f32 v3, v3, v216
  v_mfma_f32_16x16x32_bf16 v[20:23], a[216:219], v[168:171], v[20:23]
  ds_read_b128 a[212:215], v232 offset:9024
  v_max3_f32 v218, v10, v11, v218
  v_sub_f32 v4, v4, v216
  v_max3_f32 v218, v12, v13, v218
  v_mfma_f32_16x16x32_bf16 v[20:23], a[220:223], v[172:175], v[20:23]
  s_waitcnt lgkmcnt(2)
  ds_read_b128 a[216:219], v232 offset:9088
  v_sub_f32 v5, v5, v216
  v_max3_f32 v218, v14, v15, v218
  v_sub_f32 v6, v6, v216
  v_mov_b32 v219, v218
  v_mfma_f32_16x16x32_bf16 v[32:35], a[192:195], v[128:131], v[192:195]
  buffer_load_dwordx4 v243, s[20:23], s34 offen offset:3168 nt lds
  v_sub_f32 v7, v7, v216
  v_permlane16_swap_b32 v218, v219
  v_max_f32 v218, v218, v219
  v_mfma_f32_16x16x32_bf16 v[32:35], a[196:199], v[132:135], v[32:35]
  ds_read_b128 a[220:223], v232 offset:9152
  v_mov_b32 v219, v218
  v_max3_f32 v220, v16, v17, v214
  v_mov_b32 v210, 0
  v_permlane32_swap_b32 v218, v219
  v_mfma_f32_16x16x32_bf16 v[32:35], a[200:203], v[136:139], v[32:35]
  v_max_f32 v218, v218, v219
  v_sub_f32 v196, 0, v218
  v_sub_f32 v197, 0, v218
  v_sub_f32 v198, 0, v218
  v_mfma_f32_16x16x32_bf16 v[32:35], a[204:207], v[140:143], v[32:35]
  s_waitcnt lgkmcnt(1)
  v_sub_f32 v199, 0, v218
  v_sub_f32 v8, v8, v218
  v_sub_f32 v9, v9, v218
  v_sub_f32 v10, v10, v218
  v_mfma_f32_16x16x32_bf16 v[36:39], a[208:211], v[128:131], v[192:195]
  v_exp_f32 v0, v0
  v_exp_f32 v1, v1
  v_mfma_f32_16x16x32_bf16 v[36:39], a[212:215], v[132:135], v[36:39]
  v_sub_f32 v11, v11, v218
  v_max3_f32 v220, v18, v19, v220
  v_sub_f32 v12, v12, v218
  v_max3_f32 v220, v20, v21, v220
  v_mfma_f32_16x16x32_bf16 v[36:39], a[216:219], v[136:139], v[36:39]
  s_waitcnt lgkmcnt(0)
  v_add_f32 v208, v208, v0
  v_add_f32 v208, v208, v1
  v_cvt_pk_bf16_f32 v64, v0, v1
  v_sub_f32 v13, v13, v218
  v_exp_f32 v2, v2
  v_mfma_f32_16x16x32_bf16 v[36:39], a[220:223], v[140:143], v[36:39]
  v_max3_f32 v220, v22, v23, v220
  v_sub_f32 v14, v14, v218
  v_mov_b32 v221, v220
  v_add_f32 v208, v208, v2
  v_exp_f32 v3, v3
  v_mfma_f32_16x16x32_bf16 v[40:43], a[192:195], v[144:147], v[196:199]
  v_sub_f32 v15, v15, v218
  v_permlane16_swap_b32 v220, v221
  v_max_f32 v220, v220, v221
  v_add_f32 v208, v208, v3
  v_cvt_pk_bf16_f32 v65, v2, v3
  v_exp_f32 v4, v4
  v_mfma_f32_16x16x32_bf16 v[40:43], a[196:199], v[148:151], v[40:43]
  v_mov_b32 v221, v220
  v_add_f32 v208, v208, v4
  v_exp_f32 v5, v5
  v_permlane32_swap_b32 v220, v221
  v_mfma_f32_16x16x32_bf16 v[40:43], a[200:203], v[152:155], v[40:43]
  v_max_f32 v220, v220, v221
  v_sub_f32 v200, 0, v220
  v_add_f32 v208, v208, v5
  v_cvt_pk_bf16_f32 v66, v4, v5
  v_exp_f32 v6, v6
  v_mfma_f32_16x16x32_bf16 v[40:43], a[204:207], v[156:159], v[40:43]
  v_sub_f32 v201, 0, v220
  v_sub_f32 v202, 0, v220
  v_add_f32 v208, v208, v6
  v_sub_f32 v203, 0, v220
  v_exp_f32 v7, v7
  v_mfma_f32_16x16x32_bf16 v[44:47], a[208:211], v[144:147], v[196:199]
  v_sub_f32 v16, v16, v220
  v_add_f32 v208, v208, v7
  v_cvt_pk_bf16_f32 v67, v6, v7
  v_sub_f32 v17, v17, v220
  v_exp_f32 v8, v8
  v_mfma_f32_16x16x32_bf16 v[44:47], a[212:215], v[148:151], v[44:47]
  v_sub_f32 v18, v18, v220
  v_add_f32 v209, v209, v8
  v_exp_f32 v9, v9
  v_mfma_f32_16x16x32_bf16 v[44:47], a[216:219], v[152:155], v[44:47]
  v_sub_f32 v19, v19, v220
  v_sub_f32 v20, v20, v220
  v_add_f32 v209, v209, v9
  v_cvt_pk_bf16_f32 v68, v8, v9
  v_exp_f32 v10, v10
  v_exp_f32 v11, v11
  v_mfma_f32_16x16x32_bf16 v[44:47], a[220:223], v[156:159], v[44:47]
  v_sub_f32 v21, v21, v220
  v_sub_f32 v22, v22, v220
  v_add_f32 v209, v209, v10
  v_add_f32 v209, v209, v11
  v_cvt_pk_bf16_f32 v69, v10, v11
  v_exp_f32 v12, v12
  v_mfma_f32_16x16x32_bf16 v[48:51], a[192:195], v[160:163], v[200:203]
  v_sub_f32 v23, v23, v220
  v_add_f32 v209, v209, v12
  v_exp_f32 v13, v13
  v_mfma_f32_16x16x32_bf16 v[48:51], a[196:199], v[164:167], v[48:51]
  v_add_f32 v209, v209, v13
  v_cvt_pk_bf16_f32 v70, v12, v13
  v_exp_f32 v14, v14
  v_mfma_f32_16x16x32_bf16 v[48:51], a[200:203], v[168:171], v[48:51]
  v_add_f32 v209, v209, v14
  v_exp_f32 v15, v15
  v_mfma_f32_16x16x32_bf16 v[48:51], a[204:207], v[172:175], v[48:51]
  v_add_f32 v209, v209, v15
  v_cvt_pk_bf16_f32 v71, v14, v15
  v_exp_f32 v16, v16
  v_mfma_f32_16x16x32_bf16 v[52:55], a[208:211], v[160:163], v[200:203]
  v_add_f32 v210, v210, v16
  v_exp_f32 v17, v17
  v_add_u32 v232, 33792, v234
  v_mfma_f32_16x16x32_bf16 v[52:55], a[212:215], v[164:167], v[52:55]
  s_waitcnt vmcnt(4)
  v_add_f32 v210, v210, v17
  v_cvt_pk_bf16_f32 v72, v16, v17
  v_exp_f32 v18, v18
  v_mfma_f32_16x16x32_bf16 v[52:55], a[216:219], v[168:171], v[52:55]
  s_barrier
  ds_read_b128 a[192:195], v232 offset:0
  v_add_f32 v210, v210, v18
  v_exp_f32 v19, v19
  v_mfma_f32_16x16x32_bf16 v[52:55], a[220:223], v[172:175], v[52:55]
  s_mov_b32 s95, 53248
  ds_read_b128 a[196:199], v232 offset:64
  v_add_f32 v210, v210, v19
  v_cvt_pk_bf16_f32 v73, v18, v19
  v_exp_f32 v20, v20
  v_exp_f32 v21, v21
  v_add_f32 v210, v210, v20
  v_add_f32 v210, v210, v21
  v_cvt_pk_bf16_f32 v74, v20, v21
  v_exp_f32 v22, v22
  s_nop 0
  v_add_f32 v210, v210, v22
  v_exp_f32 v23, v23
  s_nop 0
  v_add_f32 v210, v210, v23
  v_cvt_pk_bf16_f32 v75, v22, v23
  ds_read_b128 a[200:203], v232 offset:128
  ds_read_b128 a[204:207], v232 offset:192
  ds_read_b128 a[208:211], v232 offset:512
  ds_read_b128 a[212:215], v232 offset:576
  ds_read_b128 a[216:219], v232 offset:640
  ds_read_b128 a[220:223], v232 offset:704
  s_mov_b32 m0, 0
  s_nop 0
  buffer_load_dwordx4 v240, s[16:19], s95 offen offset:0 nt lds
  buffer_load_dwordx4 v241, s[16:19], s95 offen offset:1056 nt lds
  buffer_load_dwordx4 v242, s[16:19], s95 offen offset:2112 nt lds
  buffer_load_dwordx4 v243, s[16:19], s95 offen offset:3168 nt lds
L_w3_join:
  s_add_u32 s95, s46, 4096
  s_waitcnt lgkmcnt(6)
  v_exp_f32 v32, v32
  v_mfma_f32_16x16x32_bf16 v[0:3], a[192:195], v[128:131], v[192:195]
  s_add_u32 m0, s98, 4224
  ds_read_b64_tr_b16 a[224:225], v233 offset:0
  v_add_f32 v208, v208, v32
  v_mfma_f32_16x16x32_bf16 v[0:3], a[196:199], v[132:135], v[0:3]
  buffer_load_dwordx4 v240, s[16:19], s95 offen offset:0 nt lds
  s_waitcnt lgkmcnt(2)
  v_mfma_f32_16x16x32_bf16 v[0:3], a[200:203], v[136:139], v[0:3]
  v_exp_f32 v33, v33
  v_mfma_f32_16x16x32_bf16 v[0:3], a[204:207], v[140:143], v[0:3]
  ds_read_b64_tr_b16 a[226:227], v233 offset:512
  v_and_b32 v224, v224, v225
  v_mfma_f32_16x16x32_bf16 v[4:7], a[208:211], v[128:131], v[192:195]
  ds_read_b64_tr_b16 a[228:229], v233 offset:32
  v_add_f32 v208, v208, v33
  v_mfma_f32_16x16x32_bf16 v[4:7], a[212:215], v[132:135], v[4:7]
  ds_read_b64_tr_b16 a[230:231], v233 offset:544
  v_cvt_pk_bf16_f32 v80, v32, v33
  v_mfma_f32_16x16x32_bf16 v[4:7], a[216:219], v[136:139], v[4:7]
  buffer_load_dwordx4 v241, s[16:19], s95 offen offset:1056 nt lds
  s_waitcnt lgkmcnt(3)
  v_mfma_f32_16x16x32_bf16 v[4:7], a[220:223], v[140:143], v[4:7]
  v_exp_f32 v34, v34
  v_mfma_f32_16x16x32_bf16 v[8:11], a[192:195], v[144:147], v[196:199]
  ds_read_b64_tr_b16 a[232:233], v233 offset:64
  v_and_b32 v226, v226, v227
  v_add_f32 v208, v208, v34
  v_mfma_f32_16x16x32_bf16 v[8:11], a[196:199], v[148:151], v[8:11]
  buffer_load_dwordx4 v242, s[16:19], s95 offen offset:2112 nt lds
  v_exp_f32 v35, v35
  v_mfma_f32_16x16x32_bf16 v[8:11], a[200:203], v[152:155], v[8:11]
  ds_read_b64_tr_b16 a[234:235], v233 offset:576
  v_and_b32 v224, v224, v226
  v_add_f32 v208, v208, v35
  v_cvt_pk_bf16_f32 v81, v34, v35
  v_mfma_f32_16x16x32_bf16 v[8:11], a[204:207], v[156:159], v[8:11]
  buffer_load_dwordx4 v243, s[16:19], s95 offen offset:3168 nt lds
  v_exp_f32 v36, v36
  v_mfma_f32_16x16x32_bf16 v[12:15], a[208:211], v[144:147], v[196:199]
  ds_read_b64_tr_b16 a[236:237], v233 offset:96
  v_readfirstlane_b32 s97, v224
  v_add_f32 v208, v208, v36
  v_mfma_f32_16x16x32_bf16 v[12:15], a[212:215], v[148:151], v[12:15]
  v_exp_f32 v37, v37
  v_mfma_f32_16x16x32_bf16 v[12:15], a[216:219], v[152:155], v[12:15]
  ds_read_b64_tr_b16 a[238:239], v233 offset:608
  v_readfirstlane_b32 s39, v229
  v_add_f32 v208, v208, v37
  v_cvt_pk_bf16_f32 v82, v36, v37
  v_mfma_f32_16x16x32_bf16 v[12:15], a[220:223], v[156:159], v[12:15]
  s_and_b32 s97, s97, 8
  v_exp_f32 v38, v38
  v_mfma_f32_16x16x32_bf16 v[16:19], a[192:195], v[160:163], v[200:203]
  s_getreg_b32 s55, hwreg(HW_REG_XCC_ID, 0, 4)
  ds_read_b64_tr_b16 a[240:241], v233 offset:128
  v_add_f32 v208, v208, v38
  v_mfma_f32_16x16x32_bf16 v[16:19], a[196:199], v[164:167], v[16:19]
  s_mul_i32 s54, s55, s55
  v_exp_f32 v39, v39
  v_mfma_f32_16x16x32_bf16 v[16:19], a[200:203], v[168:171], v[16:19]
  ds_read_b64_tr_b16 a[242:243], v233 offset:640
  v_add_f32 v208, v208, v39
  v_cvt_pk_bf16_f32 v83, v38, v39
  v_mfma_f32_16x16x32_bf16 v[16:19], a[204:207], v[172:175], v[16:19]
  s_lshl_b32 s54, s54, 8
  ds_read_b64_tr_b16 a[244:245], v233 offset:160
  v_exp_f32 v40, v40
  v_mfma_f32_16x16x32_bf16 v[20:23], a[208:211], v[160:163], v[200:203]
  ds_read_b64_tr_b16 a[246:247], v233 offset:672
  v_add_f32 v209, v209, v40
  v_mfma_f32_16x16x32_bf16 v[20:23], a[212:215], v[164:167], v[20:23]
  s_add_u32 s54, s54, s55
  v_exp_f32 v41, v41
  v_mfma_f32_16x16x32_bf16 v[20:23], a[216:219], v[168:171], v[20:23]
  s_add_u32 s95, s46, 8192
  ds_read_b64_tr_b16 a[248:249], v233 offset:192
  v_add_f32 v209, v209, v41
  v_cvt_pk_bf16_f32 v84, v40, v41
  v_mfma_f32_16x16x32_bf16 v[20:23], a[220:223], v[172:175], v[20:23]
  s_add_u32 m0, s98, 8448
  s_waitcnt lgkmcnt(2)
  v_exp_f32 v42, v42
  v_mfma_f32_16x16x32_bf16 a[0:3], a[224:227], v[64:67], 0
  s_lshl_b32 s54, s54, 8
  ds_read_b64_tr_b16 a[250:251], v233 offset:704
  v_add_f32 v209, v209, v42
  v_mfma_f32_16x16x32_bf16 a[32:35], a[224:227], v[68:71], 0
  s_add_u32 s54, s54, 1
  ds_read_b64_tr_b16 a[252:253], v233 offset:224
  v_exp_f32 v43, v43
  v_mfma_f32_16x16x32_bf16 a[64:67], a[224:227], v[72:75], 0
  ds_read_b64_tr_b16 a[254:255], v233 offset:736
  v_add_f32 v209, v209, v43
  v_cvt_pk_bf16_f32 v85, v42, v43
  v_mfma_f32_16x16x32_bf16 a[4:7], a[228:231], v[64:67], 0
  s_lshl_b32 s54, s54, 3
  buffer_load_dwordx4 v240, s[16:19], s95 offen offset:0 nt lds
  v_exp_f32 v44, v44
  v_mfma_f32_16x16x32_bf16 a[36:39], a[228:231], v[68:71], 0
  ds_read_b128 a[192:195], v232 offset:8448
  v_add_f32 v209, v209, v44
  v_mfma_f32_16x16x32_bf16 a[68:71], a[228:231], v[72:75], 0
  s_cmp_eq_u32 s39, s54
  s_cselect_b32 s39, 1, 0
  buffer_load_dwordx4 v241, s[16:19], s95 offen offset:1056 nt lds
  v_exp_f32 v45, v45
  v_mfma_f32_16x16x32_bf16 a[8:11], a[232:235], v[64:67], 0
  ds_read_b128 a[196:199], v232 offset:8512
  v_add_f32 v209, v209, v45
  v_cvt_pk_bf16_f32 v86, v44, v45
  v_mfma_f32_16x16x32_bf16 a[40:43], a[232:235], v[68:71], 0
  buffer_load_dwordx4 v242, s[16:19], s95 offen offset:2112 nt lds
  v_exp_f32 v46, v46
  v_mfma_f32_16x16x32_bf16 a[72:75], a[232:235], v[72:75], 0
  ds_read_b128 a[200:203], v232 offset:8576
  v_add_f32 v209, v209, v46
  v_mfma_f32_16x16x32_bf16 a[12:15], a[236:239], v[64:67], 0
  s_lshr_b32 s36, s29, 3
  buffer_load_dwordx4 v243, s[16:19], s95 offen offset:3168 nt lds
  v_exp_f32 v47, v47
  v_mfma_f32_16x16x32_bf16 a[44:47], a[236:239], v[68:71], 0
  s_add_u32 s33, s43, s32
  ds_read_b128 a[204:207], v232 offset:8640
  v_add_f32 v209, v209, v47
  v_cvt_pk_bf16_f32 v87, v46, v47
  v_mfma_f32_16x16x32_bf16 a[76:79], a[236:239], v[72:75], 0
  s_add_u32 m0, s33, 16896
  v_exp_f32 v48, v48
  v_mfma_f32_16x16x32_bf16 a[16:19], a[240:243], v[64:67], 0
  s_bfe_u32 s37, s29, 0x10002
  ds_read_b128 a[208:211], v232 offset:8960
  v_add_f32 v210, v210, v48
  v_mfma_f32_16x16x32_bf16 a[48:51], a[240:243], v[68:71], 0
  s_and_b32 s38, s29, 3
  v_exp_f32 v49, v49
  v_mfma_f32_16x16x32_bf16 a[80:83], a[240:243], v[72:75], 0
  s_waitcnt lgkmcnt(1)
  ds_read_b128 a[212:215], v232 offset:9024
  v_add_f32 v210, v210, v49
  v_cvt_pk_bf16_f32 v88, v48, v49
  v_mfma_f32_16x16x32_bf16 a[20:23], a[244:247], v[64:67], 0
  s_lshl_b32 s31, s28, 2
  buffer_load_dwordx4 v240, s[20:23], s47 offen offset:0 nt lds
  v_exp_f32 v50, v50
  v_mfma_f32_16x16x32_bf16 a[52:55], a[244:247], v[68:71], 0
  buffer_load_dwordx4 v241, s[20:23], s47 offen offset:1056 nt lds
  v_add_f32 v210, v210, v50
  v_mfma_f32_16x16x32_bf16 a[84:87], a[244:247], v[72:75], 0
  s_add_u32 s31, s31, s36
  v_exp_f32 v51, v51
  v_mfma_f32_16x16x32_bf16 a[24:27], a[248:251], v[64:67], 0
  buffer_load_dwordx4 v242, s[20:23], s47 offen offset:2112 nt lds
  v_add_f32 v210, v210, v51
  v_cvt_pk_bf16_f32 v89, v50, v51
  v_mfma_f32_16x16x32_bf16 a[56:59], a[248:251], v[68:71], 0
  s_lshl_b32 s31, s31, 7
  buffer_load_dwordx4 v243, s[20:23], s47 offen offset:3168 nt lds
  v_exp_f32 v52, v52
  v_mfma_f32_16x16x32_bf16 a[88:91], a[248:251], v[72:75], 0
  s_add_u32 s95, s46, 12288
  ds_read_b128 a[216:219], v232 offset:9088
  v_add_f32 v210, v210, v52
  v_mfma_f32_16x16x32_bf16 a[28:31], a[252:255], v[64:67], 0
  s_add_u32 s31, s31, 0x3000000
  v_exp_f32 v53, v53
  v_mfma_f32_16x16x32_bf16 a[60:63], a[252:255], v[68:71], 0
  s_add_u32 m0, s98, 12672
  ds_read_b128 a[220:223], v232 offset:9152
  v_add_f32 v210, v210, v53
  v_cvt_pk_bf16_f32 v90, v52, v53
  v_mfma_f32_16x16x32_bf16 a[92:95], a[252:255], v[72:75], 0
  s_lshl_b32 s30, s28, 3
  v_exp_f32 v54, v54
  v_mfma_f32_16x16x32_bf16 v[32:35], a[192:195], v[128:131], v[192:195]
  ds_read_b64_tr_b16 a[224:225], v233 offset:8448
  v_add_f32 v210, v210, v54
  v_mfma_f32_16x16x32_bf16 v[32:35], a[196:199], v[132:135], v[32:35]
  s_and_b32 s92, s29, 7
  v_exp_f32 v55, v55
  v_exp_f32 v0, v0
  v_mfma_f32_16x16x32_bf16 v[32:35], a[200:203], v[136:139], v[32:35]
  buffer_load_dwordx4 v240, s[16:19], s95 offen offset:0 nt lds
  v_add_f32 v210, v210, v55
  v_cvt_pk_bf16_f32 v91, v54, v55
  v_add_f32 v208, v208, v0
  v_mfma_f32_16x16x32_bf16 v[32:35], a[204:207], v[140:143], v[32:35]
  s_add_u32 s30, s30, s92
  s_waitcnt lgkmcnt(1)
  v_exp_f32 v1, v1
  v_mfma_f32_16x16x32_bf16 v[36:39], a[208:211], v[128:131], v[192:195]
  buffer_load_dwordx4 v241, s[16:19], s95 offen offset:1056 nt lds
  v_add_f32 v208, v208, v1
  v_cvt_pk_bf16_f32 v64, v0, v1
  v_mfma_f32_16x16x32_bf16 v[36:39], a[212:215], v[132:135], v[36:39]
  s_lshl_b32 s30, s30, 9
  v_exp_f32 v2, v2
  v_mfma_f32_16x16x32_bf16 v[36:39], a[216:219], v[136:139], v[36:39]
  buffer_load_dwordx4 v242, s[16:19], s95 offen offset:2112 nt lds
  v_add_f32 v208, v208, v2
  v_mfma_f32_16x16x32_bf16 v[36:39], a[220:223], v[140:143], v[36:39]
  s_add_u32 s30, s30, 0x3001000
  ds_read_b64_tr_b16 a[226:227], v233 offset:8960
  v_exp_f32 v3, v3
  v_mfma_f32_16x16x32_bf16 v[40:43], a[192:195], v[144:147], v[196:199]
  ds_read_b64_tr_b16 a[228:229], v233 offset:8480
  v_add_f32 v208, v208, v3
  v_cvt_pk_bf16_f32 v65, v2, v3
  v_mfma_f32_16x16x32_bf16 v[40:43], a[196:199], v[148:151], v[40:43]
  s_lshl_b32 s94, s92, 1
  buffer_load_dwordx4 v243, s[16:19], s95 offen offset:3168 nt lds
  v_exp_f32 v4, v4
  v_mfma_f32_16x16x32_bf16 v[40:43], a[200:203], v[152:155], v[40:43]
  ds_read_b64_tr_b16 a[230:231], v233 offset:8992
  v_add_f32 v208, v208, v4
  v_mfma_f32_16x16x32_bf16 v[40:43], a[204:207], v[156:159], v[40:43]
  s_lshl_b32 s92, s36, 20
  ds_read_b64_tr_b16 a[232:233], v233 offset:8512
  v_exp_f32 v5, v5
  v_mfma_f32_16x16x32_bf16 v[44:47], a[208:211], v[144:147], v[196:199]
  ds_read_b64_tr_b16 a[234:235], v233 offset:9024
  v_add_f32 v208, v208, v5
  v_cvt_pk_bf16_f32 v66, v4, v5
  v_mfma_f32_16x16x32_bf16 v[44:47], a[212:215], v[148:151], v[44:47]
  s_lshl_b32 s93, s38, 8
  ds_read_b64_tr_b16 a[236:237], v233 offset:8544
  v_exp_f32 v6, v6
  v_mfma_f32_16x16x32_bf16 v[44:47], a[216:219], v[152:155], v[44:47]
  ds_read_b64_tr_b16 a[238:239], v233 offset:9056
  v_add_f32 v208, v208, v6
  v_mfma_f32_16x16x32_bf16 v[44:47], a[220:223], v[156:159], v[44:47]
  s_add_u32 s92, s92, s93
  v_exp_f32 v7, v7
  v_mfma_f32_16x16x32_bf16 v[48:51], a[192:195], v[160:163], v[200:203]
  ds_read_b64_tr_b16 a[240:241], v233 offset:8576
  v_add_f32 v208, v208, v7
  v_cvt_pk_bf16_f32 v67, v6, v7
  v_mfma_f32_16x16x32_bf16 v[48:51], a[196:199], v[164:167], v[48:51]
  s_sub_u32 s93, 1048704, s93
  v_exp_f32 v8, v8
  v_mfma_f32_16x16x32_bf16 v[48:51], a[200:203], v[168:171], v[48:51]
  s_add_u32 s47, s47, 16384
  ds_read_b64_tr_b16 a[242:243], v233 offset:9088
  v_add_f32 v209, v209, v8
  v_mfma_f32_16x16x32_bf16 v[48:51], a[204:207], v[172:175], v[48:51]
  s_add_u32 s46, s46, 16384
  ds_read_b64_tr_b16 a[244:245], v233 offset:8608
  v_add_u32 v232, s49, v234
  v_exp_f32 v9, v9
  v_mfma_f32_16x16x32_bf16 v[52:55], a[208:211], v[160:163], v[200:203]
  s_add_u32 s12, s56, s92
  s_addc_u32 s13, s57, 0
  ds_read_b64_tr_b16 a[246:247], v233 offset:9120
  v_add_f32 v209, v209, v9
  v_cvt_pk_bf16_f32 v68, v8, v9
  v_mfma_f32_16x16x32_bf16 v[52:55], a[212:215], v[164:167], v[52:55]
  s_waitcnt vmcnt(30)
  v_exp_f32 v10, v10
  v_mfma_f32_16x16x32_bf16 v[52:55], a[216:219], v[168:171], v[52:55]
  s_barrier
  ds_read_b64_tr_b16 a[248:249], v233 offset:8640
  v_add_f32 v209, v209, v10
  v_mfma_f32_16x16x32_bf16 v[52:55], a[220:223], v[172:175], v[52:55]
  s_add_u32 s95, s46, 0
  s_waitcnt lgkmcnt(2)
  v_exp_f32 v11, v11
  v_mfma_f32_16x16x32_bf16 a[0:3], a[224:227], v[80:83], a[0:3]
  s_sub_u32 s12, s12, 128
  s_subb_u32 s13, s13, 0
  ds_read_b64_tr_b16 a[250:251], v233 offset:9152
  v_add_f32 v209, v209, v11
  v_cvt_pk_bf16_f32 v69, v10, v11
  v_mfma_f32_16x16x32_bf16 a[32:35], a[224:227], v[84:87], a[32:35]
  s_add_u32 m0, s48, 0
  ds_read_b64_tr_b16 a[252:253], v233 offset:8672
  v_exp_f32 v12, v12
  v_mfma_f32_16x16x32_bf16 a[64:67], a[224:227], v[88:91], a[64:67]
  ds_read_b64_tr_b16 a[254:255], v233 offset:9184
  v_add_f32 v209, v209, v12
  v_mfma_f32_16x16x32_bf16 a[4:7], a[228:231], v[80:83], a[4:7]
  s_mov_b32 s14, s93
  v_exp_f32 v13, v13
  v_mfma_f32_16x16x32_bf16 a[36:39], a[228:231], v[84:87], a[36:39]
  buffer_load_dwordx4 v240, s[16:19], s95 offen offset:0 nt lds
  v_add_f32 v209, v209, v13
  v_cvt_pk_bf16_f32 v70, v12, v13
  v_mfma_f32_16x16x32_bf16 a[68:71], a[228:231], v[88:91], a[68:71]
  s_mov_b32 s15, 0x20000
  ds_read_b128 a[192:195], v232 offset:0
  v_add_u32 v233, s41, v235
  v_exp_f32 v14, v14
  v_mfma_f32_16x16x32_bf16 a[8:11], a[232:235], v[80:83], a[8:11]
  s_mov_b32 s35, s40
  buffer_load_dwordx4 v241, s[16:19], s95 offen offset:1056 nt lds
  v_add_f32 v209, v209, v14
  v_mfma_f32_16x16x32_bf16 a[40:43], a[232:235], v[84:87], a[40:43]
  s_lshl_b32 s54, s28, 21
  ds_read_b128 a[196:199], v232 offset:64
  v_exp_f32 v15, v15
  v_mfma_f32_16x16x32_bf16 a[72:75], a[232:235], v[88:91], a[72:75]
  s_mov_b32 s40, s41
  buffer_load_dwordx4 v242, s[16:19], s95 offen offset:2112 nt lds
  v_add_f32 v209, v209, v15
  v_cvt_pk_bf16_f32 v71, v14, v15
  v_mfma_f32_16x16x32_bf16 a[12:15], a[236:239], v[80:83], a[12:15]
  s_mov_b32 s41, s42
  v_exp_f32 v16, v16
  v_mfma_f32_16x16x32_bf16 a[44:47], a[236:239], v[84:87], a[44:47]
  s_lshl_b32 s55, s29, 15
  ds_read_b128 a[200:203], v232 offset:128
  v_add_f32 v210, v210, v16
  v_mfma_f32_16x16x32_bf16 a[76:79], a[236:239], v[88:91], a[76:79]
  s_mov_b32 s42, s43
  buffer_load_dwordx4 v243, s[16:19], s95 offen offset:3168 nt lds
  v_exp_f32 v17, v17
  v_mfma_f32_16x16x32_bf16 a[16:19], a[240:243], v[80:83], a[16:19]
  s_mov_b32 s43, s7
  ds_read_b128 a[204:207], v232 offset:192
  v_add_f32 v210, v210, v17
  v_cvt_pk_bf16_f32 v72, v16, v17
  v_mfma_f32_16x16x32_bf16 a[48:51], a[240:243], v[84:87], a[48:51]
  s_add_u32 s54, s54, s55
  v_exp_f32 v18, v18
  v_mfma_f32_16x16x32_bf16 a[80:83], a[240:243], v[88:91], a[80:83]
  s_mov_b32 s7, s35
  s_waitcnt lgkmcnt(1)
  ds_read_b128 a[208:211], v232 offset:512
  v_add_f32 v210, v210, v18
  v_mfma_f32_16x16x32_bf16 a[20:23], a[244:247], v[80:83], a[20:23]
  s_add_u32 s8, s44, s54
  s_addc_u32 s9, s45, 0
  v_exp_f32 v19, v19
  v_mfma_f32_16x16x32_bf16 a[52:55], a[244:247], v[84:87], a[52:55]
  s_mov_b32 s98, s48
  ds_read_b128 a[212:215], v232 offset:576
  v_add_f32 v210, v210, v19
  v_cvt_pk_bf16_f32 v73, v18, v19
  v_mfma_f32_16x16x32_bf16 a[84:87], a[244:247], v[88:91], a[84:87]
  s_mov_b32 s48, s49
  v_exp_f32 v20, v20
  v_mfma_f32_16x16x32_bf16 a[24:27], a[248:251], v[80:83], a[24:27]
  s_mov_b32 s10, 1081344
  ds_read_b128 a[216:219], v232 offset:640
  v_add_f32 v210, v210, v20
  v_mfma_f32_16x16x32_bf16 a[56:59], a[248:251], v[84:87], a[56:59]
  s_mov_b32 s49, s50
  v_exp_f32 v21, v21
  v_mfma_f32_16x16x32_bf16 a[88:91], a[248:251], v[88:91], a[88:91]
  s_add_u32 s50, s50, 33792
  ds_read_b128 a[220:223], v232 offset:704
  v_add_f32 v210, v210, v21
  v_cvt_pk_bf16_f32 v74, v20, v21
  v_mfma_f32_16x16x32_bf16 a[28:31], a[252:255], v[80:83], a[28:31]
  s_mov_b32 s11, 0x20000
  v_exp_f32 v22, v22
  v_mfma_f32_16x16x32_bf16 a[60:63], a[252:255], v[84:87], a[60:63]
  s_cmp_eq_u32 s50, 135168
  s_cselect_b32 s50, 0, s50
  v_add_f32 v210, v210, v22
  v_mfma_f32_16x16x32_bf16 a[92:95], a[252:255], v[88:91], a[92:95]
  s_lshl_b32 s54, s37, 20
  v_exp_f32 v23, v23
  v_lshlrev_b32 v221, 7, v239
  v_add_u32 v221, s54, v221
  v_xor_b32 v220, 0x100000, v221
  v_add_u32 v222, 0x2000, v220
  v_add_u32 v223, 0x2000, v221
  v_add_f32 v210, v210, v23
  v_cvt_pk_bf16_f32 v75, v22, v23
  s_add_u32 s51, s51, 1
  s_cmp_lt_u32 s51, 12
L_w3_loop:
  s_add_u32 s95, s46, 4096
  v_exp_f32 v32, v32
  v_mfma_f32_16x16x32_bf16 v[0:3], a[192:195], v[128:131], v[192:195]
  s_add_u32 m0, s98, 4224
  ds_read_b64_tr_b16 a[224:225], v233 offset:0
  v_add_f32 v208, v208, v32
  v_mfma_f32_16x16x32_bf16 v[0:3], a[196:199], v[132:135], v[0:3]
  buffer_load_dwordx4 v240, s[16:19], s95 offen offset:0 nt lds
  s_waitcnt lgkmcnt(1)
  v_mfma_f32_16x16x32_bf16 v[0:3], a[200:203], v[136:139], v[0:3]
  v_exp_f32 v33, v33
  v_mfma_f32_16x16x32_bf16 v[0:3], a[204:207], v[140:143], v[0:3]
  ds_read_b64_tr_b16 a[226:227], v233 offset:512
  v_add_f32 v208, v208, v33
  v_mfma_f32_16x16x32_bf16 v[4:7], a[208:211], v[128:131], v[192:195]
  ds_read_b64_tr_b16 a[228:229], v233 offset:32
  v_cvt_pk_bf16_f32 v80, v32, v33
  v_mfma_f32_16x16x32_bf16 v[4:7], a[212:215], v[132:135], v[4:7]
  buffer_load_dwordx4 v241, s[16:19], s95 offen offset:1056 nt lds
  v_mfma_f32_16x16x32_bf16 v[4:7], a[216:219], v[136:139], v[4:7]
  v_exp_f32 v34, v34
  v_mfma_f32_16x16x32_bf16 v[4:7], a[220:223], v[140:143], v[4:7]
  ds_read_b64_tr_b16 a[230:231], v233 offset:544
  v_add_f32 v208, v208, v34
  v_mfma_f32_16x16x32_bf16 v[8:11], a[192:195], v[144:147], v[196:199]
  buffer_load_dwordx4 v242, s[16:19], s95 offen offset:2112 nt lds
  v_mfma_f32_16x16x32_bf16 v[8:11], a[196:199], v[148:151], v[8:11]
  v_exp_f32 v35, v35
  v_mfma_f32_16x16x32_bf16 v[8:11], a[200:203], v[152:155], v[8:11]
  ds_read_b64_tr_b16 a[232:233], v233 offset:64
  v_add_f32 v208, v208, v35
  v_cvt_pk_bf16_f32 v81, v34, v35
  v_mfma_f32_16x16x32_bf16 v[8:11], a[204:207], v[156:159], v[8:11]
  buffer_load_dwordx4 v243, s[16:19], s95 offen offset:3168 nt lds
  v_exp_f32 v36, v36
  v_mfma_f32_16x16x32_bf16 v[12:15], a[208:211], v[144:147], v[196:199]
  ds_read_b64_tr_b16 a[234:235], v233 offset:576
  v_add_f32 v208, v208, v36
  v_mfma_f32_16x16x32_bf16 v[12:15], a[212:215], v[148:151], v[12:15]
  ds_read_b64_tr_b16 a[236:237], v233 offset:96
  v_exp_f32 v37, v37
  v_mfma_f32_16x16x32_bf16 v[12:15], a[216:219], v[152:155], v[12:15]
  ds_read_b64_tr_b16 a[238:239], v233 offset:608
  v_add_f32 v208, v208, v37
  v_cvt_pk_bf16_f32 v82, v36, v37
  v_mfma_f32_16x16x32_bf16 v[12:15], a[220:223], v[156:159], v[12:15]
  v_exp_f32 v38, v38
  v_mfma_f32_16x16x32_bf16 v[16:19], a[192:195], v[160:163], v[200:203]
  ds_read_b64_tr_b16 a[240:241], v233 offset:128
  v_add_f32 v208, v208, v38
  v_mfma_f32_16x16x32_bf16 v[16:19], a[196:199], v[164:167], v[16:19]
  v_exp_f32 v39, v39
  v_mfma_f32_16x16x32_bf16 v[16:19], a[200:203], v[168:171], v[16:19]
  ds_read_b64_tr_b16 a[242:243], v233 offset:640
  v_add_f32 v208, v208, v39
  v_cvt_pk_bf16_f32 v83, v38, v39
  v_mfma_f32_16x16x32_bf16 v[16:19], a[204:207], v[172:175], v[16:19]
  ds_read_b64_tr_b16 a[244:245], v233 offset:160
  v_exp_f32 v40, v40
  v_mfma_f32_16x16x32_bf16 v[20:23], a[208:211], v[160:163], v[200:203]
  ds_read_b64_tr_b16 a[246:247], v233 offset:672
  v_add_f32 v209, v209, v40
  v_mfma_f32_16x16x32_bf16 v[20:23], a[212:215], v[164:167], v[20:23]
  s_add_u32 s95, s46, 8192
  v_exp_f32 v41, v41
  v_mfma_f32_16x16x32_bf16 v[20:23], a[216:219], v[168:171], v[20:23]
  s_add_u32 m0, s98, 8448
  ds_read_b64_tr_b16 a[248:249], v233 offset:192
  v_add_f32 v209, v209, v41
  v_cvt_pk_bf16_f32 v84, v40, v41
  v_mfma_f32_16x16x32_bf16 v[20:23], a[220:223], v[172:175], v[20:23]
  s_waitcnt lgkmcnt(3)
  v_exp_f32 v42, v42
  v_mfma_f32_16x16x32_bf16 a[0:3], a[224:227], v[64:67], a[0:3]
  ds_read_b64_tr_b16 a[250:251], v233 offset:704
  v_add_f32 v209, v209, v42
  v_mfma_f32_16x16x32_bf16 a[32:35], a[224:227], v[68:71], a[32:35]
  ds_read_b64_tr_b16 a[252:253], v233 offset:224
  v_exp_f32 v43, v43
  v_mfma_f32_16x16x32_bf16 a[64:67], a[224:227], v[72:75], a[64:67]
  ds_read_b64_tr_b16 a[254:255], v233 offset:736
  v_add_f32 v209, v209, v43
  v_cvt_pk_bf16_f32 v85, v42, v43
  v_mfma_f32_16x16x32_bf16 a[4:7], a[228:231], v[64:67], a[4:7]
  buffer_load_dwordx4 v240, s[16:19], s95 offen offset:0 nt lds
  v_exp_f32 v44, v44
  v_mfma_f32_16x16x32_bf16 a[36:39], a[228:231], v[68:71], a[36:39]
  ds_read_b128 a[192:195], v232 offset:8448
  v_add_f32 v209, v209, v44
  v_mfma_f32_16x16x32_bf16 a[68:71], a[228:231], v[72:75], a[68:71]
  buffer_load_dwordx4 v241, s[16:19], s95 offen offset:1056 nt lds
  v_exp_f32 v45, v45
  v_mfma_f32_16x16x32_bf16 a[8:11], a[232:235], v[64:67], a[8:11]
  ds_read_b128 a[196:199], v232 offset:8512
  v_add_f32 v209, v209, v45
  v_cvt_pk_bf16_f32 v86, v44, v45
  v_mfma_f32_16x16x32_bf16 a[40:43], a[232:235], v[68:71], a[40:43]
  buffer_load_dwordx4 v242, s[16:19], s95 offen offset:2112 nt lds
  v_exp_f32 v46, v46
  v_mfma_f32_16x16x32_bf16 a[72:75], a[232:235], v[72:75], a[72:75]
  ds_read_b128 a[200:203], v232 offset:8576
  v_add_f32 v209, v209, v46
  v_mfma_f32_16x16x32_bf16 a[12:15], a[236:239], v[64:67], a[12:15]
  buffer_load_dwordx4 v243, s[16:19], s95 offen offset:3168 nt lds
  v_exp_f32 v47, v47
  v_mfma_f32_16x16x32_bf16 a[44:47], a[236:239], v[68:71], a[44:47]
  s_add_u32 s33, s43, s32
  ds_read_b128 a[204:207], v232 offset:8640
  v_add_f32 v209, v209, v47
  v_cvt_pk_bf16_f32 v87, v46, v47
  v_mfma_f32_16x16x32_bf16 a[76:79], a[236:239], v[72:75], a[76:79]
  s_add_u32 m0, s33, 16896
  v_exp_f32 v48, v48
  v_mfma_f32_16x16x32_bf16 a[16:19], a[240:243], v[64:67], a[16:19]
  ds_read_b128 a[208:211], v232 offset:8960
  v_add_f32 v210, v210, v48
  v_mfma_f32_16x16x32_bf16 a[48:51], a[240:243], v[68:71], a[48:51]
  v_exp_f32 v49, v49
  v_mfma_f32_16x16x32_bf16 a[80:83], a[240:243], v[72:75], a[80:83]
  s_waitcnt lgkmcnt(2)
  ds_read_b128 a[212:215], v232 offset:9024
  v_add_f32 v210, v210, v49
  v_cvt_pk_bf16_f32 v88, v48, v49
  v_mfma_f32_16x16x32_bf16 a[20:23], a[244:247], v[64:67], a[20:23]
  buffer_load_dwordx4 v240, s[20:23], s47 offen offset:0 nt lds
  v_exp_f32 v50, v50
  v_mfma_f32_16x16x32_bf16 a[52:55], a[244:247], v[68:71], a[52:55]
  buffer_load_dwordx4 v241, s[20:23], s47 offen offset:1056 nt lds
  v_add_f32 v210, v210, v50
  v_mfma_f32_16x16x32_bf16 a[84:87], a[244:247], v[72:75], a[84:87]
  v_exp_f32 v51, v51
  v_mfma_f32_16x16x32_bf16 a[24:27], a[248:251], v[64:67], a[24:27]
  buffer_load_dwordx4 v242, s[20:23], s47 offen offset:2112 nt lds
  v_add_f32 v210, v210, v51
  v_cvt_pk_bf16_f32 v89, v50, v51
  v_mfma_f32_16x16x32_bf16 a[56:59], a[248:251], v[68:71], a[56:59]
  buffer_load_dwordx4 v243, s[20:23], s47 offen offset:3168 nt lds
  v_exp_f32 v52, v52
  v_mfma_f32_16x16x32_bf16 a[88:91], a[248:251], v[72:75], a[88:91]
  s_add_u32 s95, s46, 12288
  ds_read_b128 a[216:219], v232 offset:9088
  v_add_f32 v210, v210, v52
  v_mfma_f32_16x16x32_bf16 a[28:31], a[252:255], v[64:67], a[28:31]
  s_add_u32 m0, s98, 12672
  v_exp_f32 v53, v53
  v_mfma_f32_16x16x32_bf16 a[60:63], a[252:255], v[68:71], a[60:63]
  ds_read_b128 a[220:223], v232 offset:9152
  v_add_f32 v210, v210, v53
  v_cvt_pk_bf16_f32 v90, v52, v53
  v_mfma_f32_16x16x32_bf16 a[92:95], a[252:255], v[72:75], a[92:95]
  v_exp_f32 v54, v54
  v_mfma_f32_16x16x32_bf16 v[32:35], a[192:195], v[128:131], v[192:195]
  ds_read_b64_tr_b16 a[224:225], v233 offset:8448
  v_add_f32 v210, v210, v54
  v_mfma_f32_16x16x32_bf16 v[32:35], a[196:199], v[132:135], v[32:35]
  v_exp_f32 v55, v55
  v_exp_f32 v0, v0
  v_mfma_f32_16x16x32_bf16 v[32:35], a[200:203], v[136:139], v[32:35]
  buffer_load_dwordx4 v240, s[16:19], s95 offen offset:0 nt lds
  s_waitcnt lgkmcnt(1)
  v_add_f32 v210, v210, v55
  v_cvt_pk_bf16_f32 v91, v54, v55
  v_add_f32 v208, v208, v0
  v_mfma_f32_16x16x32_bf16 v[32:35], a[204:207], v[140:143], v[32:35]
  v_exp_f32 v1, v1
  v_mfma_f32_16x16x32_bf16 v[36:39], a[208:211], v[128:131], v[192:195]
  buffer_load_dwordx4 v241, s[16:19], s95 offen offset:1056 nt lds
  v_add_f32 v208, v208, v1
  v_cvt_pk_bf16_f32 v64, v0, v1
  v_mfma_f32_16x16x32_bf16 v[36:39], a[212:215], v[132:135], v[36:39]
  v_exp_f32 v2, v2
  v_mfma_f32_16x16x32_bf16 v[36:39], a[216:219], v[136:139], v[36:39]
  buffer_load_dwordx4 v242, s[16:19], s95 offen offset:2112 nt lds
  v_add_f32 v208, v208, v2
  v_mfma_f32_16x16x32_bf16 v[36:39], a[220:223], v[140:143], v[36:39]
  ds_read_b64_tr_b16 a[226:227], v233 offset:8960
  v_exp_f32 v3, v3
  v_mfma_f32_16x16x32_bf16 v[40:43], a[192:195], v[144:147], v[196:199]
  ds_read_b64_tr_b16 a[228:229], v233 offset:8480
  v_add_f32 v208, v208, v3
  v_cvt_pk_bf16_f32 v65, v2, v3
  v_mfma_f32_16x16x32_bf16 v[40:43], a[196:199], v[148:151], v[40:43]
  buffer_load_dwordx4 v243, s[16:19], s95 offen offset:3168 nt lds
  v_exp_f32 v4, v4
  v_mfma_f32_16x16x32_bf16 v[40:43], a[200:203], v[152:155], v[40:43]
  ds_read_b64_tr_b16 a[230:231], v233 offset:8992
  v_add_f32 v208, v208, v4
  v_mfma_f32_16x16x32_bf16 v[40:43], a[204:207], v[156:159], v[40:43]
  ds_read_b64_tr_b16 a[232:233], v233 offset:8512
  v_exp_f32 v5, v5
  v_mfma_f32_16x16x32_bf16 v[44:47], a[208:211], v[144:147], v[196:199]
  ds_read_b64_tr_b16 a[234:235], v233 offset:9024
  v_add_f32 v208, v208, v5
  v_cvt_pk_bf16_f32 v66, v4, v5
  v_mfma_f32_16x16x32_bf16 v[44:47], a[212:215], v[148:151], v[44:47]
  ds_read_b64_tr_b16 a[236:237], v233 offset:8544
  v_exp_f32 v6, v6
  v_mfma_f32_16x16x32_bf16 v[44:47], a[216:219], v[152:155], v[44:47]
  ds_read_b64_tr_b16 a[238:239], v233 offset:9056
  v_add_f32 v208, v208, v6
  v_mfma_f32_16x16x32_bf16 v[44:47], a[220:223], v[156:159], v[44:47]
  v_exp_f32 v7, v7
  v_mfma_f32_16x16x32_bf16 v[48:51], a[192:195], v[160:163], v[200:203]
  ds_read_b64_tr_b16 a[240:241], v233 offset:8576
  v_add_f32 v208, v208, v7
  v_cvt_pk_bf16_f32 v67, v6, v7
  v_mfma_f32_16x16x32_bf16 v[48:51], a[196:199], v[164:167], v[48:51]
  v_exp_f32 v8, v8
  v_mfma_f32_16x16x32_bf16 v[48:51], a[200:203], v[168:171], v[48:51]
  s_add_u32 s47, s47, 16384
  ds_read_b64_tr_b16 a[242:243], v233 offset:9088
  v_add_f32 v209, v209, v8
  v_mfma_f32_16x16x32_bf16 v[48:51], a[204:207], v[172:175], v[48:51]
  s_add_u32 s46, s46, 16384
  ds_read_b64_tr_b16 a[244:245], v233 offset:8608
  v_add_u32 v232, s49, v234
  v_exp_f32 v9, v9
  v_mfma_f32_16x16x32_bf16 v[52:55], a[208:211], v[160:163], v[200:203]
  ds_read_b64_tr_b16 a[246:247], v233 offset:9120
  v_add_f32 v209, v209, v9
  v_cvt_pk_bf16_f32 v68, v8, v9
  v_mfma_f32_16x16x32_bf16 v[52:55], a[212:215], v[164:167], v[52:55]
  s_waitcnt vmcnt(40)
  v_exp_f32 v10, v10
  v_mfma_f32_16x16x32_bf16 v[52:55], a[216:219], v[168:171], v[52:55]
  s_barrier
  ds_read_b64_tr_b16 a[248:249], v233 offset:8640
  v_add_f32 v209, v209, v10
  v_mfma_f32_16x16x32_bf16 v[52:55], a[220:223], v[172:175], v[52:55]
  s_add_u32 s95, s46, 0
  s_waitcnt lgkmcnt(2)
  v_exp_f32 v11, v11
  v_mfma_f32_16x16x32_bf16 a[0:3], a[224:227], v[80:83], a[0:3]
  s_add_u32 m0, s48, 0
  ds_read_b64_tr_b16 a[250:251], v233 offset:9152
  v_add_f32 v209, v209, v11
  v_cvt_pk_bf16_f32 v69, v10, v11
  v_mfma_f32_16x16x32_bf16 a[32:35], a[224:227], v[84:87], a[32:35]
  ds_read_b64_tr_b16 a[252:253], v233 offset:8672
  v_exp_f32 v12, v12
  v_mfma_f32_16x16x32_bf16 a[64:67], a[224:227], v[88:91], a[64:67]
  ds_read_b64_tr_b16 a[254:255], v233 offset:9184
  v_add_f32 v209, v209, v12
  v_mfma_f32_16x16x32_bf16 a[4:7], a[228:231], v[80:83], a[4:7]
  v_exp_f32 v13, v13
  v_mfma_f32_16x16x32_bf16 a[36:39], a[228:231], v[84:87], a[36:39]
  buffer_load_dwordx4 v240, s[16:19], s95 offen offset:0 nt lds
  v_add_f32 v209, v209, v13
  v_cvt_pk_bf16_f32 v70, v12, v13
  v_mfma_f32_16x16x32_bf16 a[68:71], a[228:231], v[88:91], a[68:71]
  ds_read_b128 a[192:195], v232 offset:0
  v_add_u32 v233, s41, v235
  v_exp_f32 v14, v14
  v_mfma_f32_16x16x32_bf16 a[8:11], a[232:235], v[80:83], a[8:11]
  s_mov_b32 s35, s40
  buffer_load_dwordx4 v241, s[16:19], s95 offen offset:1056 nt lds
  v_add_f32 v209, v209, v14
  v_mfma_f32_16x16x32_bf16 a[40:43], a[232:235], v[84:87], a[40:43]
  s_mov_b32 s40, s41
  ds_read_b128 a[196:199], v232 offset:64
  v_exp_f32 v15, v15
  v_mfma_f32_16x16x32_bf16 a[72:75], a[232:235], v[88:91], a[72:75]
  s_mov_b32 s41, s42
  buffer_load_dwordx4 v242, s[16:19], s95 offen offset:2112 nt lds
  v_add_f32 v209, v209, v15
  v_cvt_pk_bf16_f32 v71, v14, v15
  v_mfma_f32_16x16x32_bf16 a[12:15], a[236:239], v[80:83], a[12:15]
  s_mov_b32 s42, s43
  v_exp_f32 v16, v16
  v_mfma_f32_16x16x32_bf16 a[44:47], a[236:239], v[84:87], a[44:47]
  s_mov_b32 s43, s7
  ds_read_b128 a[200:203], v232 offset:128
  v_add_f32 v210, v210, v16
  v_mfma_f32_16x16x32_bf16 a[76:79], a[236:239], v[88:91], a[76:79]
  s_mov_b32 s7, s35
  buffer_load_dwordx4 v243, s[16:19], s95 offen offset:3168 nt lds
  v_exp_f32 v17, v17
  v_mfma_f32_16x16x32_bf16 a[16:19], a[240:243], v[80:83], a[16:19]
  ds_read_b128 a[204:207], v232 offset:192
  v_add_f32 v210, v210, v17
  v_cvt_pk_bf16_f32 v72, v16, v17
  v_mfma_f32_16x16x32_bf16 a[48:51], a[240:243], v[84:87], a[48:51]
  v_exp_f32 v18, v18
  v_mfma_f32_16x16x32_bf16 a[80:83], a[240:243], v[88:91], a[80:83]
  s_waitcnt lgkmcnt(2)
  ds_read_b128 a[208:211], v232 offset:512
  v_add_f32 v210, v210, v18
  v_mfma_f32_16x16x32_bf16 a[20:23], a[244:247], v[80:83], a[20:23]
  s_mov_b32 s98, s48
  v_exp_f32 v19, v19
  v_mfma_f32_16x16x32_bf16 a[52:55], a[244:247], v[84:87], a[52:55]
  s_mov_b32 s48, s49
  ds_read_b128 a[212:215], v232 offset:576
  v_add_f32 v210, v210, v19
  v_cvt_pk_bf16_f32 v73, v18, v19
  v_mfma_f32_16x16x32_bf16 a[84:87], a[244:247], v[88:91], a[84:87]
  s_mov_b32 s49, s50
  v_exp_f32 v20, v20
  v_mfma_f32_16x16x32_bf16 a[24:27], a[248:251], v[80:83], a[24:27]
  s_add_u32 s50, s50, 33792
  ds_read_b128 a[216:219], v232 offset:640
  v_add_f32 v210, v210, v20
  v_mfma_f32_16x16x32_bf16 a[56:59], a[248:251], v[84:87], a[56:59]
  s_cmp_eq_u32 s50, 135168
  s_cselect_b32 s50, 0, s50
  v_exp_f32 v21, v21
  v_mfma_f32_16x16x32_bf16 a[88:91], a[248:251], v[88:91], a[88:91]
  ds_read_b128 a[220:223], v232 offset:704
  v_add_f32 v210, v210, v21
  v_cvt_pk_bf16_f32 v74, v20, v21
  v_mfma_f32_16x16x32_bf16 a[28:31], a[252:255], v[80:83], a[28:31]
  s_add_u32 s51, s51, 1
  v_exp_f32 v22, v22
  v_mfma_f32_16x16x32_bf16 a[60:63], a[252:255], v[84:87], a[60:63]
  s_cmp_lt_u32 s51, 12
  v_add_f32 v210, v210, v22
  v_mfma_f32_16x16x32_bf16 a[92:95], a[252:255], v[88:91], a[92:95]
  v_exp_f32 v23, v23
  s_nop 0
  v_add_f32 v210, v210, v23
  v_cvt_pk_bf16_f32 v75, v22, v23
  s_cbranch_scc1 L_w3_loop
  s_add_u32 s93, s94, 0
  v_exp_f32 v32, v32
  v_mfma_f32_16x16x32_bf16 v[0:3], a[192:195], v[128:131], v[192:195]
  s_and_b32 s93, s93, 15
  ds_read_b64_tr_b16 a[224:225], v233 offset:0
  v_add_f32 v208, v208, v32
  v_mfma_f32_16x16x32_bf16 v[0:3], a[196:199], v[132:135], v[0:3]
  s_lshl_b32 s93, s93, 16
  s_waitcnt lgkmcnt(1)
  v_exp_f32 v33, v33
  v_mfma_f32_16x16x32_bf16 v[0:3], a[200:203], v[136:139], v[0:3]
  s_add_u32 m0, s32, 0
  ds_read_b64_tr_b16 a[226:227], v233 offset:512
  v_add_f32 v208, v208, v33
  v_mfma_f32_16x16x32_bf16 v[0:3], a[204:207], v[140:143], v[0:3]
  ds_read_b64_tr_b16 a[228:229], v233 offset:32
  v_cvt_pk_bf16_f32 v80, v32, v33
  v_mfma_f32_16x16x32_bf16 v[4:7], a[208:211], v[128:131], v[192:195]
  buffer_load_dwordx4 v252, s[12:15], s93 offen offset:0 lds
  v_mfma_f32_16x16x32_bf16 v[4:7], a[212:215], v[132:135], v[4:7]
  v_exp_f32 v34, v34
  v_mfma_f32_16x16x32_bf16 v[4:7], a[216:219], v[136:139], v[4:7]
  ds_read_b64_tr_b16 a[230:231], v233 offset:544
  v_add_f32 v208, v208, v34
  v_mfma_f32_16x16x32_bf16 v[4:7], a[220:223], v[140:143], v[4:7]
  v_exp_f32 v35, v35
  v_mfma_f32_16x16x32_bf16 v[8:11], a[192:195], v[144:147], v[196:199]
  ds_read_b64_tr_b16 a[232:233], v233 offset:64
  v_add_f32 v208, v208, v35
  v_mfma_f32_16x16x32_bf16 v[8:11], a[196:199], v[148:151], v[8:11]
  ds_read_b64_tr_b16 a[234:235], v233 offset:576
  v_cvt_pk_bf16_f32 v81, v34, v35
  v_mfma_f32_16x16x32_bf16 v[8:11], a[200:203], v[152:155], v[8:11]
  v_exp_f32 v36, v36
  v_mfma_f32_16x16x32_bf16 v[8:11], a[204:207], v[156:159], v[8:11]
  ds_read_b64_tr_b16 a[236:237], v233 offset:96
  v_add_f32 v208, v208, v36
  v_mfma_f32_16x16x32_bf16 v[12:15], a[208:211], v[144:147], v[196:199]
  v_exp_f32 v37, v37
  v_mfma_f32_16x16x32_bf16 v[12:15], a[212:215], v[148:151], v[12:15]
  ds_read_b64_tr_b16 a[238:239], v233 offset:608
  v_add_f32 v208, v208, v37
  v_mfma_f32_16x16x32_bf16 v[12:15], a[216:219], v[152:155], v[12:15]
  ds_read_b64_tr_b16 a[240:241], v233 offset:128
  v_cvt_pk_bf16_f32 v82, v36, v37
  v_mfma_f32_16x16x32_bf16 v[12:15], a[220:223], v[156:159], v[12:15]
  v_exp_f32 v38, v38
  v_mfma_f32_16x16x32_bf16 v[16:19], a[192:195], v[160:163], v[200:203]
  ds_read_b64_tr_b16 a[242:243], v233 offset:640
  v_add_f32 v208, v208, v38
  v_mfma_f32_16x16x32_bf16 v[16:19], a[196:199], v[164:167], v[16:19]
  v_exp_f32 v39, v39
  v_mfma_f32_16x16x32_bf16 v[16:19], a[200:203], v[168:171], v[16:19]
  ds_read_b64_tr_b16 a[244:245], v233 offset:160
  v_add_f32 v208, v208, v39
  v_cvt_pk_bf16_f32 v83, v38, v39
  v_mfma_f32_16x16x32_bf16 v[16:19], a[204:207], v[172:175], v[16:19]
  v_exp_f32 v40, v40
  v_mfma_f32_16x16x32_bf16 v[20:23], a[208:211], v[160:163], v[200:203]
  ds_read_b64_tr_b16 a[246:247], v233 offset:672
  v_add_f32 v209, v209, v40
  v_mfma_f32_16x16x32_bf16 v[20:23], a[212:215], v[164:167], v[20:23]
  v_exp_f32 v41, v41
  v_mfma_f32_16x16x32_bf16 v[20:23], a[216:219], v[168:171], v[20:23]
  buffer_load_dwordx4 v253, s[12:15], s93 offen offset:1056 lds
  v_add_f32 v209, v209, v41
  v_cvt_pk_bf16_f32 v84, v40, v41
  v_mfma_f32_16x16x32_bf16 v[20:23], a[220:223], v[172:175], v[20:23]
  s_mov_b32 s99, 0
  s_waitcnt lgkmcnt(1)
  ds_read_b64_tr_b16 a[248:249], v233 offset:192
  v_exp_f32 v42, v42
  v_mfma_f32_16x16x32_bf16 a[0:3], a[224:227], v[64:67], a[0:3]
  ds_read_b64_tr_b16 a[250:251], v233 offset:704
  v_add_f32 v209, v209, v42
  v_mfma_f32_16x16x32_bf16 a[32:35], a[224:227], v[68:71], a[32:35]
  ds_read_b64_tr_b16 a[252:253], v233 offset:224
  v_exp_f32 v43, v43
  v_mfma_f32_16x16x32_bf16 a[64:67], a[224:227], v[72:75], a[64:67]
  ds_read_b64_tr_b16 a[254:255], v233 offset:736
  v_add_f32 v209, v209, v43
  v_cvt_pk_bf16_f32 v85, v42, v43
  v_mfma_f32_16x16x32_bf16 a[4:7], a[228:231], v[64:67], a[4:7]
  v_exp_f32 v44, v44
  v_mfma_f32_16x16x32_bf16 a[36:39], a[228:231], v[68:71], a[36:39]
  buffer_load_dword v231, v220, s[8:11], s99 offen offset:0 sc1
  v_add_f32 v209, v209, v44
  v_mfma_f32_16x16x32_bf16 a[68:71], a[228:231], v[72:75], a[68:71]
  ds_read_b128 a[192:195], v232 offset:8448
  v_exp_f32 v45, v45
  v_mfma_f32_16x16x32_bf16 a[8:11], a[232:235], v[64:67], a[8:11]
  ds_read_b128 a[196:199], v232 offset:8512
  v_add_f32 v209, v209, v45
  v_cvt_pk_bf16_f32 v86, v44, v45
  v_mfma_f32_16x16x32_bf16 a[40:43], a[232:235], v[68:71], a[40:43]
  v_exp_f32 v46, v46
  v_mfma_f32_16x16x32_bf16 a[72:75], a[232:235], v[72:75], a[72:75]
  ds_read_b128 a[200:203], v232 offset:8576
  v_add_f32 v209, v209, v46
  v_mfma_f32_16x16x32_bf16 a[12:15], a[236:239], v[64:67], a[12:15]
  v_exp_f32 v47, v47
  v_mfma_f32_16x16x32_bf16 a[44:47], a[236:239], v[68:71], a[44:47]
  ds_read_b128 a[204:207], v232 offset:8640
  v_add_f32 v209, v209, v47
  v_cvt_pk_bf16_f32 v87, v46, v47
  v_mfma_f32_16x16x32_bf16 a[76:79], a[236:239], v[72:75], a[76:79]
  v_exp_f32 v48, v48
  v_mfma_f32_16x16x32_bf16 a[16:19], a[240:243], v[64:67], a[16:19]
  ds_read_b128 a[208:211], v232 offset:8960
  v_add_f32 v210, v210, v48
  v_mfma_f32_16x16x32_bf16 a[48:51], a[240:243], v[68:71], a[48:51]
  v_exp_f32 v49, v49
  v_mfma_f32_16x16x32_bf16 a[80:83], a[240:243], v[72:75], a[80:83]
  buffer_load_dwordx4 v254, s[12:15], s93 offen offset:2112 lds
  s_mov_b32 s95, 245760
  s_add_u32 m0, s32, 16896
  s_waitcnt lgkmcnt(1)
  v_add_f32 v210, v210, v49
  v_cvt_pk_bf16_f32 v88, v48, v49
  v_mfma_f32_16x16x32_bf16 a[20:23], a[244:247], v[64:67], a[20:23]
  buffer_load_dwordx4 v240, s[20:23], s95 offen offset:0 nt lds
  v_exp_f32 v50, v50
  v_mfma_f32_16x16x32_bf16 a[52:55], a[244:247], v[68:71], a[52:55]
  buffer_load_dwordx4 v241, s[20:23], s95 offen offset:1056 nt lds
  v_add_f32 v210, v210, v50
  v_mfma_f32_16x16x32_bf16 a[84:87], a[244:247], v[72:75], a[84:87]
  ds_read_b128 a[212:215], v232 offset:9024
  v_exp_f32 v51, v51
  v_mfma_f32_16x16x32_bf16 a[24:27], a[248:251], v[64:67], a[24:27]
  buffer_load_dwordx4 v242, s[20:23], s95 offen offset:2112 nt lds
  v_add_f32 v210, v210, v51
  v_cvt_pk_bf16_f32 v89, v50, v51
  v_mfma_f32_16x16x32_bf16 a[56:59], a[248:251], v[68:71], a[56:59]
  buffer_load_dwordx4 v243, s[20:23], s95 offen offset:3168 nt lds
  v_exp_f32 v52, v52
  v_mfma_f32_16x16x32_bf16 a[88:91], a[248:251], v[72:75], a[88:91]
  ds_read_b128 a[216:219], v232 offset:9088
  v_add_f32 v210, v210, v52
  v_mfma_f32_16x16x32_bf16 a[28:31], a[252:255], v[64:67], a[28:31]
  v_exp_f32 v53, v53
  v_mfma_f32_16x16x32_bf16 a[60:63], a[252:255], v[68:71], a[60:63]
  ds_read_b128 a[220:223], v232 offset:9152
  v_add_f32 v210, v210, v53
  v_cvt_pk_bf16_f32 v90, v52, v53
  v_mfma_f32_16x16x32_bf16 a[92:95], a[252:255], v[72:75], a[92:95]
  v_exp_f32 v54, v54
  v_mfma_f32_16x16x32_bf16 v[32:35], a[192:195], v[128:131], v[192:195]
  s_add_u32 m0, s32, 0
  ds_read_b64_tr_b16 a[224:225], v233 offset:8448
  v_add_f32 v210, v210, v54
  v_mfma_f32_16x16x32_bf16 v[32:35], a[196:199], v[132:135], v[32:35]
  v_exp_f32 v55, v55
  v_exp_f32 v0, v0
  v_mfma_f32_16x16x32_bf16 v[32:35], a[200:203], v[136:139], v[32:35]
  ds_read_b64_tr_b16 a[226:227], v233 offset:8960
  v_add_f32 v210, v210, v55
  v_cvt_pk_bf16_f32 v91, v54, v55
  v_add_f32 v208, v208, v0
  v_mfma_f32_16x16x32_bf16 v[32:35], a[204:207], v[140:143], v[32:35]
  s_waitcnt lgkmcnt(2)
  v_exp_f32 v1, v1
  v_mfma_f32_16x16x32_bf16 v[36:39], a[208:211], v[128:131], v[192:195]
  ds_read_b64_tr_b16 a[228:229], v233 offset:8480
  v_add_f32 v208, v208, v1
  v_cvt_pk_bf16_f32 v64, v0, v1
  v_mfma_f32_16x16x32_bf16 v[36:39], a[212:215], v[132:135], v[36:39]
  buffer_load_dwordx4 v255, s[12:15], s93 offen offset:3168 lds
  v_exp_f32 v2, v2
  v_mfma_f32_16x16x32_bf16 v[36:39], a[216:219], v[136:139], v[36:39]
  ds_read_b64_tr_b16 a[230:231], v233 offset:8992
  v_add_f32 v208, v208, v2
  v_mfma_f32_16x16x32_bf16 v[36:39], a[220:223], v[140:143], v[36:39]
  v_exp_f32 v3, v3
  v_mfma_f32_16x16x32_bf16 v[40:43], a[192:195], v[144:147], v[196:199]
  ds_read_b64_tr_b16 a[232:233], v233 offset:8512
  v_add_f32 v208, v208, v3
  v_cvt_pk_bf16_f32 v65, v2, v3
  v_mfma_f32_16x16x32_bf16 v[40:43], a[196:199], v[148:151], v[40:43]
  v_exp_f32 v4, v4
  v_mfma_f32_16x16x32_bf16 v[40:43], a[200:203], v[152:155], v[40:43]
  ds_read_b64_tr_b16 a[234:235], v233 offset:9024
  v_add_f32 v208, v208, v4
  v_mfma_f32_16x16x32_bf16 v[40:43], a[204:207], v[156:159], v[40:43]
  v_exp_f32 v5, v5
  v_mfma_f32_16x16x32_bf16 v[44:47], a[208:211], v[144:147], v[196:199]
  ds_read_b64_tr_b16 a[236:237], v233 offset:8544
  v_add_f32 v208, v208, v5
  v_cvt_pk_bf16_f32 v66, v4, v5
  v_mfma_f32_16x16x32_bf16 v[44:47], a[212:215], v[148:151], v[44:47]
  v_exp_f32 v6, v6
  v_mfma_f32_16x16x32_bf16 v[44:47], a[216:219], v[152:155], v[44:47]
  ds_read_b64_tr_b16 a[238:239], v233 offset:9056
  v_add_f32 v208, v208, v6
  v_mfma_f32_16x16x32_bf16 v[44:47], a[220:223], v[156:159], v[44:47]
  v_exp_f32 v7, v7
  v_mfma_f32_16x16x32_bf16 v[48:51], a[192:195], v[160:163], v[200:203]
  ds_read_b64_tr_b16 a[240:241], v233 offset:8576
  v_add_f32 v208, v208, v7
  v_cvt_pk_bf16_f32 v67, v6, v7
  v_mfma_f32_16x16x32_bf16 v[48:51], a[196:199], v[164:167], v[48:51]
  v_exp_f32 v8, v8
  v_mfma_f32_16x16x32_bf16 v[48:51], a[200:203], v[168:171], v[48:51]
  ds_read_b64_tr_b16 a[242:243], v233 offset:9088
  v_add_f32 v209, v209, v8
  v_mfma_f32_16x16x32_bf16 v[48:51], a[204:207], v[172:175], v[48:51]
  ds_read_b64_tr_b16 a[244:245], v233 offset:8608
  v_add_u32 v232, 67584, v234
  v_exp_f32 v9, v9
  v_mfma_f32_16x16x32_bf16 v[52:55], a[208:211], v[160:163], v[200:203]
  ds_read_b64_tr_b16 a[246:247], v233 offset:9120
  v_add_f32 v209, v209, v9
  v_cvt_pk_bf16_f32 v68, v8, v9
  v_mfma_f32_16x16x32_bf16 v[52:55], a[212:215], v[164:167], v[52:55]
  s_waitcnt vmcnt(33)
  v_exp_f32 v10, v10
  v_mfma_f32_16x16x32_bf16 v[52:55], a[216:219], v[168:171], v[52:55]
  s_barrier
  ds_read_b64_tr_b16 a[248:249], v233 offset:8640
  v_add_f32 v209, v209, v10
  v_mfma_f32_16x16x32_bf16 v[52:55], a[220:223], v[172:175], v[52:55]
  s_waitcnt lgkmcnt(2)
  v_exp_f32 v11, v11
  v_mfma_f32_16x16x32_bf16 a[0:3], a[224:227], v[80:83], a[0:3]
  ds_read_b64_tr_b16 a[250:251], v233 offset:9152
  v_add_f32 v209, v209, v11
  v_cvt_pk_bf16_f32 v69, v10, v11
  v_mfma_f32_16x16x32_bf16 a[32:35], a[224:227], v[84:87], a[32:35]
  s_mov_b32 s99, 0
  ds_read_b64_tr_b16 a[252:253], v233 offset:8672
  v_exp_f32 v12, v12
  v_mfma_f32_16x16x32_bf16 a[64:67], a[224:227], v[88:91], a[64:67]
  ds_read_b64_tr_b16 a[254:255], v233 offset:9184
  v_add_f32 v209, v209, v12
  v_mfma_f32_16x16x32_bf16 a[4:7], a[228:231], v[80:83], a[4:7]
  v_exp_f32 v13, v13
  v_mfma_f32_16x16x32_bf16 a[36:39], a[228:231], v[84:87], a[36:39]
  ds_read_b128 a[192:195], v232 offset:0
  v_add_f32 v209, v209, v13
  v_cvt_pk_bf16_f32 v70, v12, v13
  v_mfma_f32_16x16x32_bf16 a[68:71], a[228:231], v[88:91], a[68:71]
  buffer_load_dword v231, v221, s[8:11], s99 offen offset:0 sc1
  s_add_u32 s93, s94, 1
  s_and_b32 s93, s93, 15
  s_lshl_b32 s93, s93, 16
  s_add_u32 m0, s32, 33792
  v_add_u32 v233, 101376, v235
  v_exp_f32 v14, v14
  v_mfma_f32_16x16x32_bf16 a[8:11], a[232:235], v[80:83], a[8:11]
  buffer_load_dwordx4 v252, s[12:15], s93 offen offset:0 lds
  v_add_f32 v209, v209, v14
  v_mfma_f32_16x16x32_bf16 a[40:43], a[232:235], v[84:87], a[40:43]
  ds_read_b128 a[196:199], v232 offset:64
  v_exp_f32 v15, v15
  v_mfma_f32_16x16x32_bf16 a[72:75], a[232:235], v[88:91], a[72:75]
  ds_read_b128 a[200:203], v232 offset:128
  v_add_f32 v209, v209, v15
  v_cvt_pk_bf16_f32 v71, v14, v15
  v_mfma_f32_16x16x32_bf16 a[12:15], a[236:239], v[80:83], a[12:15]
  v_exp_f32 v16, v16
  v_mfma_f32_16x16x32_bf16 a[44:47], a[236:239], v[84:87], a[44:47]
  buffer_load_dwordx4 v253, s[12:15], s93 offen offset:1056 lds
  v_add_f32 v210, v210, v16
  v_mfma_f32_16x16x32_bf16 a[76:79], a[236:239], v[88:91], a[76:79]
  v_exp_f32 v17, v17
  v_mfma_f32_16x16x32_bf16 a[16:19], a[240:243], v[80:83], a[16:19]
  ds_read_b128 a[204:207], v232 offset:192
  v_add_f32 v210, v210, v17
  v_cvt_pk_bf16_f32 v72, v16, v17
  v_mfma_f32_16x16x32_bf16 a[48:51], a[240:243], v[84:87], a[48:51]
  v_exp_f32 v18, v18
  v_mfma_f32_16x16x32_bf16 a[80:83], a[240:243], v[88:91], a[80:83]
  s_waitcnt lgkmcnt(1)
  ds_read_b128 a[208:211], v232 offset:512
  v_add_f32 v210, v210, v18
  v_mfma_f32_16x16x32_bf16 a[20:23], a[244:247], v[80:83], a[20:23]
  buffer_load_dwordx4 v254, s[12:15], s93 offen offset:2112 lds
  v_exp_f32 v19, v19
  v_mfma_f32_16x16x32_bf16 a[52:55], a[244:247], v[84:87], a[52:55]
  ds_read_b128 a[212:215], v232 offset:576
  v_add_f32 v210, v210, v19
  v_cvt_pk_bf16_f32 v73, v18, v19
  v_mfma_f32_16x16x32_bf16 a[84:87], a[244:247], v[88:91], a[84:87]
  v_exp_f32 v20, v20
  v_mfma_f32_16x16x32_bf16 a[24:27], a[248:251], v[80:83], a[24:27]
  ds_read_b128 a[216:219], v232 offset:640
  v_add_f32 v210, v210, v20
  v_mfma_f32_16x16x32_bf16 a[56:59], a[248:251], v[84:87], a[56:59]
  buffer_load_dwordx4 v255, s[12:15], s93 offen offset:3168 lds
  v_exp_f32 v21, v21
  v_mfma_f32_16x16x32_bf16 a[88:91], a[248:251], v[88:91], a[88:91]
  ds_read_b128 a[220:223], v232 offset:704
  v_add_f32 v210, v210, v21
  v_cvt_pk_bf16_f32 v74, v20, v21
  v_mfma_f32_16x16x32_bf16 a[28:31], a[252:255], v[80:83], a[28:31]
  v_exp_f32 v22, v22
  v_mfma_f32_16x16x32_bf16 a[60:63], a[252:255], v[84:87], a[60:63]
  v_add_f32 v210, v210, v22
  v_mfma_f32_16x16x32_bf16 a[92:95], a[252:255], v[88:91], a[92:95]
  v_exp_f32 v23, v23
  s_nop 0
  v_add_f32 v210, v210, v23
  v_cvt_pk_bf16_f32 v75, v22, v23
  v_exp_f32 v32, v32
  v_mfma_f32_16x16x32_bf16 v[0:3], a[192:195], v[128:131], v[192:195]
  ds_read_b64_tr_b16 a[224:225], v233 offset:0
  v_add_f32 v208, v208, v32
  v_mfma_f32_16x16x32_bf16 v[0:3], a[196:199], v[132:135], v[0:3]
  v_exp_f32 v33, v33
  v_mfma_f32_16x16x32_bf16 v[0:3], a[200:203], v[136:139], v[0:3]
  s_add_u32 s93, s94, 2
  s_waitcnt lgkmcnt(1)
  ds_read_b64_tr_b16 a[226:227], v233 offset:512
  v_add_f32 v208, v208, v33
  v_mfma_f32_16x16x32_bf16 v[0:3], a[204:207], v[140:143], v[0:3]
  s_and_b32 s93, s93, 15
  ds_read_b64_tr_b16 a[228:229], v233 offset:32
  v_cvt_pk_bf16_f32 v80, v32, v33
  v_mfma_f32_16x16x32_bf16 v[4:7], a[208:211], v[128:131], v[192:195]
  s_lshl_b32 s93, s93, 16
  v_exp_f32 v34, v34
  v_mfma_f32_16x16x32_bf16 v[4:7], a[212:215], v[132:135], v[4:7]
  s_add_u32 m0, s32, 50688
  ds_read_b64_tr_b16 a[230:231], v233 offset:544
  v_add_f32 v208, v208, v34
  v_mfma_f32_16x16x32_bf16 v[4:7], a[216:219], v[136:139], v[4:7]
  v_exp_f32 v35, v35
  v_mfma_f32_16x16x32_bf16 v[4:7], a[220:223], v[140:143], v[4:7]
  buffer_load_dwordx4 v252, s[12:15], s93 offen offset:0 lds
  v_mfma_f32_16x16x32_bf16 v[8:11], a[192:195], v[144:147], v[196:199]
  ds_read_b64_tr_b16 a[232:233], v233 offset:64
  v_add_f32 v208, v208, v35
  v_mfma_f32_16x16x32_bf16 v[8:11], a[196:199], v[148:151], v[8:11]
  ds_read_b64_tr_b16 a[234:235], v233 offset:576
  v_cvt_pk_bf16_f32 v81, v34, v35
  v_mfma_f32_16x16x32_bf16 v[8:11], a[200:203], v[152:155], v[8:11]
  v_exp_f32 v36, v36
  v_mfma_f32_16x16x32_bf16 v[8:11], a[204:207], v[156:159], v[8:11]
  ds_read_b64_tr_b16 a[236:237], v233 offset:96
  v_add_f32 v208, v208, v36
  v_mfma_f32_16x16x32_bf16 v[12:15], a[208:211], v[144:147], v[196:199]
  v_exp_f32 v37, v37
  v_mfma_f32_16x16x32_bf16 v[12:15], a[212:215], v[148:151], v[12:15]
  ds_read_b64_tr_b16 a[238:239], v233 offset:608
  v_add_f32 v208, v208, v37
  v_mfma_f32_16x16x32_bf16 v[12:15], a[216:219], v[152:155], v[12:15]
  ds_read_b64_tr_b16 a[240:241], v233 offset:128
  v_cvt_pk_bf16_f32 v82, v36, v37
  v_mfma_f32_16x16x32_bf16 v[12:15], a[220:223], v[156:159], v[12:15]
  s_mov_b32 s99, 0
  v_exp_f32 v38, v38
  v_mfma_f32_16x16x32_bf16 v[16:19], a[192:195], v[160:163], v[200:203]
  ds_read_b64_tr_b16 a[242:243], v233 offset:640
  v_add_f32 v208, v208, v38
  v_mfma_f32_16x16x32_bf16 v[16:19], a[196:199], v[164:167], v[16:19]
  v_exp_f32 v39, v39
  v_mfma_f32_16x16x32_bf16 v[16:19], a[200:203], v[168:171], v[16:19]
  ds_read_b64_tr_b16 a[244:245], v233 offset:160
  v_add_f32 v208, v208, v39
  v_cvt_pk_bf16_f32 v83, v38, v39
  v_mfma_f32_16x16x32_bf16 v[16:19], a[204:207], v[172:175], v[16:19]
  v_exp_f32 v40, v40
  v_mfma_f32_16x16x32_bf16 v[20:23], a[208:211], v[160:163], v[200:203]
  buffer_load_dword v231, v222, s[8:11], s99 offen offset:0 sc1
  v_add_f32 v209, v209, v40
  v_mfma_f32_16x16x32_bf16 v[20:23], a[212:215], v[164:167], v[20:23]
  ds_read_b64_tr_b16 a[246:247], v233 offset:672
  v_exp_f32 v41, v41
  v_mfma_f32_16x16x32_bf16 v[20:23], a[216:219], v[168:171], v[20:23]
  ds_read_b64_tr_b16 a[248:249], v233 offset:192
  v_add_f32 v209, v209, v41
  v_cvt_pk_bf16_f32 v84, v40, v41
  v_mfma_f32_16x16x32_bf16 v[20:23], a[220:223], v[172:175], v[20:23]
  s_waitcnt lgkmcnt(2)
  v_exp_f32 v42, v42
  v_mfma_f32_16x16x32_bf16 a[0:3], a[224:227], v[64:67], a[0:3]
  buffer_load_dwordx4 v253, s[12:15], s93 offen offset:1056 lds
  v_add_f32 v209, v209, v42
  v_mfma_f32_16x16x32_bf16 a[32:35], a[224:227], v[68:71], a[32:35]
  ds_read_b64_tr_b16 a[250:251], v233 offset:704
  v_exp_f32 v43, v43
  v_mfma_f32_16x16x32_bf16 a[64:67], a[224:227], v[72:75], a[64:67]
  ds_read_b64_tr_b16 a[252:253], v233 offset:224
  v_add_f32 v209, v209, v43
  v_cvt_pk_bf16_f32 v85, v42, v43
  v_mfma_f32_16x16x32_bf16 a[4:7], a[228:231], v[64:67], a[4:7]
  ds_read_b64_tr_b16 a[254:255], v233 offset:736
  v_exp_f32 v44, v44
  v_mfma_f32_16x16x32_bf16 a[36:39], a[228:231], v[68:71], a[36:39]
  ds_read_b128 a[192:195], v232 offset:8448
  v_add_f32 v209, v209, v44
  v_mfma_f32_16x16x32_bf16 a[68:71], a[228:231], v[72:75], a[68:71]
  v_exp_f32 v45, v45
  v_mfma_f32_16x16x32_bf16 a[8:11], a[232:235], v[64:67], a[8:11]
  ds_read_b128 a[196:199], v232 offset:8512
  v_add_f32 v209, v209, v45
  v_cvt_pk_bf16_f32 v86, v44, v45
  v_mfma_f32_16x16x32_bf16 a[40:43], a[232:235], v[68:71], a[40:43]
  v_exp_f32 v46, v46
  v_mfma_f32_16x16x32_bf16 a[72:75], a[232:235], v[72:75], a[72:75]
  ds_read_b128 a[200:203], v232 offset:8576
  v_add_f32 v209, v209, v46
  v_mfma_f32_16x16x32_bf16 a[12:15], a[236:239], v[64:67], a[12:15]
  v_exp_f32 v47, v47
  v_mfma_f32_16x16x32_bf16 a[44:47], a[236:239], v[68:71], a[44:47]
  ds_read_b128 a[204:207], v232 offset:8640
  v_add_f32 v209, v209, v47
  v_cvt_pk_bf16_f32 v87, v46, v47
  v_mfma_f32_16x16x32_bf16 a[76:79], a[236:239], v[72:75], a[76:79]
  v_exp_f32 v48, v48
  v_mfma_f32_16x16x32_bf16 a[16:19], a[240:243], v[64:67], a[16:19]
  ds_read_b128 a[208:211], v232 offset:8960
  v_add_f32 v210, v210, v48
  v_mfma_f32_16x16x32_bf16 a[48:51], a[240:243], v[68:71], a[48:51]
  v_exp_f32 v49, v49
  v_mfma_f32_16x16x32_bf16 a[80:83], a[240:243], v[72:75], a[80:83]
  s_waitcnt lgkmcnt(2)
  ds_read_b128 a[212:215], v232 offset:9024
  v_add_f32 v210, v210, v49
  v_cvt_pk_bf16_f32 v88, v48, v49
  v_mfma_f32_16x16x32_bf16 a[20:23], a[244:247], v[64:67], a[20:23]
  buffer_load_dwordx4 v254, s[12:15], s93 offen offset:2112 lds
  v_exp_f32 v50, v50
  v_mfma_f32_16x16x32_bf16 a[52:55], a[244:247], v[68:71], a[52:55]
  ds_read_b128 a[216:219], v232 offset:9088
  v_add_f32 v210, v210, v50
  v_mfma_f32_16x16x32_bf16 a[84:87], a[244:247], v[72:75], a[84:87]
  v_exp_f32 v51, v51
  v_mfma_f32_16x16x32_bf16 a[24:27], a[248:251], v[64:67], a[24:27]
  ds_read_b128 a[220:223], v232 offset:9152
  v_add_f32 v210, v210, v51
  v_cvt_pk_bf16_f32 v89, v50, v51
  v_mfma_f32_16x16x32_bf16 a[56:59], a[248:251], v[68:71], a[56:59]
  v_exp_f32 v52, v52
  v_mfma_f32_16x16x32_bf16 a[88:91], a[248:251], v[72:75], a[88:91]
  v_add_f32 v210, v210, v52
  v_mfma_f32_16x16x32_bf16 a[28:31], a[252:255], v[64:67], a[28:31]
  v_exp_f32 v53, v53
  v_mfma_f32_16x16x32_bf16 a[60:63], a[252:255], v[68:71], a[60:63]
  v_add_f32 v210, v210, v53
  v_cvt_pk_bf16_f32 v90, v52, v53
  v_mfma_f32_16x16x32_bf16 a[92:95], a[252:255], v[72:75], a[92:95]
  s_mov_b32 s99, 0
  v_exp_f32 v54, v54
  v_mfma_f32_16x16x32_bf16 v[32:35], a[192:195], v[128:131], v[192:195]
  ds_read_b64_tr_b16 a[224:225], v233 offset:8448
  v_add_f32 v210, v210, v54
  v_mfma_f32_16x16x32_bf16 v[32:35], a[196:199], v[132:135], v[32:35]
  v_exp_f32 v55, v55
  v_exp_f32 v0, v0
  v_mfma_f32_16x16x32_bf16 v[32:35], a[200:203], v[136:139], v[32:35]
  s_waitcnt lgkmcnt(1)
  ds_read_b64_tr_b16 a[226:227], v233 offset:8960
  v_add_f32 v210, v210, v55
  v_cvt_pk_bf16_f32 v91, v54, v55
  v_add_f32 v208, v208, v0
  v_mfma_f32_16x16x32_bf16 v[32:35], a[204:207], v[140:143], v[32:35]
  v_exp_f32 v1, v1
  v_mfma_f32_16x16x32_bf16 v[36:39], a[208:211], v[128:131], v[192:195]
  buffer_load_dword v231, v223, s[8:11], s99 offen offset:0 sc1
  v_add_f32 v208, v208, v1
  v_cvt_pk_bf16_f32 v64, v0, v1
  v_mfma_f32_16x16x32_bf16 v[36:39], a[212:215], v[132:135], v[36:39]
  v_exp_f32 v2, v2
  v_mfma_f32_16x16x32_bf16 v[36:39], a[216:219], v[136:139], v[36:39]
  buffer_load_dwordx4 v255, s[12:15], s93 offen offset:3168 lds
  v_add_f32 v208, v208, v2
  v_mfma_f32_16x16x32_bf16 v[36:39], a[220:223], v[140:143], v[36:39]
  ds_read_b64_tr_b16 a[228:229], v233 offset:8480
  v_exp_f32 v3, v3
  v_mfma_f32_16x16x32_bf16 v[40:43], a[192:195], v[144:147], v[196:199]
  ds_read_b64_tr_b16 a[230:231], v233 offset:8992
  v_add_f32 v208, v208, v3
  v_cvt_pk_bf16_f32 v65, v2, v3
  v_mfma_f32_16x16x32_bf16 v[40:43], a[196:199], v[148:151], v[40:43]
  v_exp_f32 v4, v4
  v_mfma_f32_16x16x32_bf16 v[40:43], a[200:203], v[152:155], v[40:43]
  ds_read_b64_tr_b16 a[232:233], v233 offset:8512
  v_add_f32 v208, v208, v4
  v_mfma_f32_16x16x32_bf16 v[40:43], a[204:207], v[156:159], v[40:43]
  v_exp_f32 v5, v5
  v_mfma_f32_16x16x32_bf16 v[44:47], a[208:211], v[144:147], v[196:199]
  ds_read_b64_tr_b16 a[234:235], v233 offset:9024
  v_add_f32 v208, v208, v5
  v_cvt_pk_bf16_f32 v66, v4, v5
  v_mfma_f32_16x16x32_bf16 v[44:47], a[212:215], v[148:151], v[44:47]
  ds_read_b64_tr_b16 a[236:237], v233 offset:8544
  v_exp_f32 v6, v6
  v_mfma_f32_16x16x32_bf16 v[44:47], a[216:219], v[152:155], v[44:47]
  ds_read_b64_tr_b16 a[238:239], v233 offset:9056
  v_add_f32 v208, v208, v6
  v_mfma_f32_16x16x32_bf16 v[44:47], a[220:223], v[156:159], v[44:47]
  v_exp_f32 v7, v7
  v_mfma_f32_16x16x32_bf16 v[48:51], a[192:195], v[160:163], v[200:203]
  ds_read_b64_tr_b16 a[240:241], v233 offset:8576
  v_add_f32 v208, v208, v7
  v_cvt_pk_bf16_f32 v67, v6, v7
  v_mfma_f32_16x16x32_bf16 v[48:51], a[196:199], v[164:167], v[48:51]
  v_exp_f32 v8, v8
  v_mfma_f32_16x16x32_bf16 v[48:51], a[200:203], v[168:171], v[48:51]
  ds_read_b64_tr_b16 a[242:243], v233 offset:9088
  v_add_f32 v209, v209, v8
  v_mfma_f32_16x16x32_bf16 v[48:51], a[204:207], v[172:175], v[48:51]
  ds_read_b64_tr_b16 a[244:245], v233 offset:8608
  v_add_u32 v232, 101376, v234
  v_exp_f32 v9, v9
  v_mfma_f32_16x16x32_bf16 v[52:55], a[208:211], v[160:163], v[200:203]
  ds_read_b64_tr_b16 a[246:247], v233 offset:9120
  v_add_f32 v209, v209, v9
  v_cvt_pk_bf16_f32 v68, v8, v9
  v_mfma_f32_16x16x32_bf16 v[52:55], a[212:215], v[164:167], v[52:55]
  s_waitcnt vmcnt(24)
  v_exp_f32 v10, v10
  v_mfma_f32_16x16x32_bf16 v[52:55], a[216:219], v[168:171], v[52:55]
  s_barrier
  ds_read_b64_tr_b16 a[248:249], v233 offset:8640
  v_add_f32 v209, v209, v10
  v_mfma_f32_16x16x32_bf16 v[52:55], a[220:223], v[172:175], v[52:55]
  s_add_u32 s93, s94, 3
  s_waitcnt lgkmcnt(2)
  v_exp_f32 v11, v11
  v_mfma_f32_16x16x32_bf16 a[0:3], a[224:227], v[80:83], a[0:3]
  s_and_b32 s93, s93, 15
  ds_read_b64_tr_b16 a[250:251], v233 offset:9152
  v_add_f32 v209, v209, v11
  v_cvt_pk_bf16_f32 v69, v10, v11
  v_mfma_f32_16x16x32_bf16 a[32:35], a[224:227], v[84:87], a[32:35]
  s_lshl_b32 s93, s93, 16
  ds_read_b64_tr_b16 a[252:253], v233 offset:8672
  v_exp_f32 v12, v12
  v_mfma_f32_16x16x32_bf16 a[64:67], a[224:227], v[88:91], a[64:67]
  s_add_u32 m0, s32, 67584
  ds_read_b64_tr_b16 a[254:255], v233 offset:9184
  v_add_f32 v209, v209, v12
  v_mfma_f32_16x16x32_bf16 a[4:7], a[228:231], v[80:83], a[4:7]
  v_exp_f32 v13, v13
  v_mfma_f32_16x16x32_bf16 a[36:39], a[228:231], v[84:87], a[36:39]
  ds_read_b128 a[192:195], v232 offset:0
  v_add_f32 v209, v209, v13
  v_cvt_pk_bf16_f32 v70, v12, v13
  v_mfma_f32_16x16x32_bf16 a[68:71], a[228:231], v[88:91], a[68:71]
  ds_read_b128 a[196:199], v232 offset:64
  v_add_u32 v233, 118272, v235
  v_exp_f32 v14, v14
  v_mfma_f32_16x16x32_bf16 a[8:11], a[232:235], v[80:83], a[8:11]
  buffer_load_dwordx4 v252, s[12:15], s93 offen offset:0 lds
  v_add_f32 v209, v209, v14
  v_mfma_f32_16x16x32_bf16 a[40:43], a[232:235], v[84:87], a[40:43]
  v_exp_f32 v15, v15
  v_mfma_f32_16x16x32_bf16 a[72:75], a[232:235], v[88:91], a[72:75]
  ds_read_b128 a[200:203], v232 offset:128
  v_add_f32 v209, v209, v15
  v_cvt_pk_bf16_f32 v71, v14, v15
  v_mfma_f32_16x16x32_bf16 a[12:15], a[236:239], v[80:83], a[12:15]
  v_exp_f32 v16, v16
  v_mfma_f32_16x16x32_bf16 a[44:47], a[236:239], v[84:87], a[44:47]
  buffer_load_dwordx4 v253, s[12:15], s93 offen offset:1056 lds
  v_add_f32 v210, v210, v16
  s_mov_b32 s99, 16384
  v_mfma_f32_16x16x32_bf16 a[76:79], a[236:239], v[88:91], a[76:79]
  v_exp_f32 v17, v17
  v_mfma_f32_16x16x32_bf16 a[16:19], a[240:243], v[80:83], a[16:19]
  buffer_load_dword v231, v220, s[8:11], s99 offen offset:0 sc1
  v_add_f32 v210, v210, v17
  v_cvt_pk_bf16_f32 v72, v16, v17
  v_mfma_f32_16x16x32_bf16 a[48:51], a[240:243], v[84:87], a[48:51]
  ds_read_b128 a[204:207], v232 offset:192
  v_exp_f32 v18, v18
  v_mfma_f32_16x16x32_bf16 a[80:83], a[240:243], v[88:91], a[80:83]
  s_waitcnt lgkmcnt(1)
  ds_read_b128 a[208:211], v232 offset:512
  v_add_f32 v210, v210, v18
  v_mfma_f32_16x16x32_bf16 a[20:23], a[244:247], v[80:83], a[20:23]
  buffer_load_dwordx4 v254, s[12:15], s93 offen offset:2112 lds
  v_exp_f32 v19, v19
  v_mfma_f32_16x16x32_bf16 a[52:55], a[244:247], v[84:87], a[52:55]
  ds_read_b128 a[212:215], v232 offset:576
  v_add_f32 v210, v210, v19
  v_cvt_pk_bf16_f32 v73, v18, v19
  v_mfma_f32_16x16x32_bf16 a[84:87], a[244:247], v[88:91], a[84:87]
  v_exp_f32 v20, v20
  v_mfma_f32_16x16x32_bf16 a[24:27], a[248:251], v[80:83], a[24:27]
  ds_read_b128 a[216:219], v232 offset:640
  v_add_f32 v210, v210, v20
  v_mfma_f32_16x16x32_bf16 a[56:59], a[248:251], v[84:87], a[56:59]
  buffer_load_dwordx4 v255, s[12:15], s93 offen offset:3168 lds
  v_exp_f32 v21, v21
  v_mfma_f32_16x16x32_bf16 a[88:91], a[248:251], v[88:91], a[88:91]
  ds_read_b128 a[220:223], v232 offset:704
  v_add_f32 v210, v210, v21
  v_cvt_pk_bf16_f32 v74, v20, v21
  v_mfma_f32_16x16x32_bf16 a[28:31], a[252:255], v[80:83], a[28:31]
  v_exp_f32 v22, v22
  v_mfma_f32_16x16x32_bf16 a[60:63], a[252:255], v[84:87], a[60:63]
  v_add_f32 v210, v210, v22
  v_mfma_f32_16x16x32_bf16 a[92:95], a[252:255], v[88:91], a[92:95]
  v_exp_f32 v23, v23
  s_nop 0
  v_add_f32 v210, v210, v23
  v_cvt_pk_bf16_f32 v75, v22, v23
  v_exp_f32 v32, v32
  v_mfma_f32_16x16x32_bf16 v[0:3], a[192:195], v[128:131], v[192:195]
  ds_read_b64_tr_b16 a[224:225], v233 offset:0
  v_add_f32 v208, v208, v32
  v_mfma_f32_16x16x32_bf16 v[0:3], a[196:199], v[132:135], v[0:3]
  v_exp_f32 v33, v33
  v_mfma_f32_16x16x32_bf16 v[0:3], a[200:203], v[136:139], v[0:3]
  s_add_u32 s93, s94, 4
  s_waitcnt lgkmcnt(1)
  ds_read_b64_tr_b16 a[226:227], v233 offset:512
  v_add_f32 v208, v208, v33
  v_mfma_f32_16x16x32_bf16 v[0:3], a[204:207], v[140:143], v[0:3]
  s_and_b32 s93, s93, 15
  ds_read_b64_tr_b16 a[228:229], v233 offset:32
  v_cvt_pk_bf16_f32 v80, v32, v33
  v_mfma_f32_16x16x32_bf16 v[4:7], a[208:211], v[128:131], v[192:195]
  s_lshl_b32 s93, s93, 16
  v_exp_f32 v34, v34
  v_mfma_f32_16x16x32_bf16 v[4:7], a[212:215], v[132:135], v[4:7]
  s_add_u32 m0, s32, 84480
  ds_read_b64_tr_b16 a[230:231], v233 offset:544
  v_add_f32 v208, v208, v34
  v_mfma_f32_16x16x32_bf16 v[4:7], a[216:219], v[136:139], v[4:7]
  v_exp_f32 v35, v35
  v_mfma_f32_16x16x32_bf16 v[4:7], a[220:223], v[140:143], v[4:7]
  buffer_load_dwordx4 v252, s[12:15], s93 offen offset:0 lds
  v_mfma_f32_16x16x32_bf16 v[8:11], a[192:195], v[144:147], v[196:199]
  ds_read_b64_tr_b16 a[232:233], v233 offset:64
  v_add_f32 v208, v208, v35
  v_mfma_f32_16x16x32_bf16 v[8:11], a[196:199], v[148:151], v[8:11]
  ds_read_b64_tr_b16 a[234:235], v233 offset:576
  v_cvt_pk_bf16_f32 v81, v34, v35
  v_mfma_f32_16x16x32_bf16 v[8:11], a[200:203], v[152:155], v[8:11]
  v_exp_f32 v36, v36
  v_mfma_f32_16x16x32_bf16 v[8:11], a[204:207], v[156:159], v[8:11]
  ds_read_b64_tr_b16 a[236:237], v233 offset:96
  v_add_f32 v208, v208, v36
  v_mfma_f32_16x16x32_bf16 v[12:15], a[208:211], v[144:147], v[196:199]
  v_exp_f32 v37, v37
  v_mfma_f32_16x16x32_bf16 v[12:15], a[212:215], v[148:151], v[12:15]
  ds_read_b64_tr_b16 a[238:239], v233 offset:608
  v_add_f32 v208, v208, v37
  v_mfma_f32_16x16x32_bf16 v[12:15], a[216:219], v[152:155], v[12:15]
  ds_read_b64_tr_b16 a[240:241], v233 offset:128
  v_cvt_pk_bf16_f32 v82, v36, v37
  v_mfma_f32_16x16x32_bf16 v[12:15], a[220:223], v[156:159], v[12:15]
  s_mov_b32 s99, 16384
  v_exp_f32 v38, v38
  v_mfma_f32_16x16x32_bf16 v[16:19], a[192:195], v[160:163], v[200:203]
  ds_read_b64_tr_b16 a[242:243], v233 offset:640
  v_add_f32 v208, v208, v38
  v_mfma_f32_16x16x32_bf16 v[16:19], a[196:199], v[164:167], v[16:19]
  v_exp_f32 v39, v39
  v_mfma_f32_16x16x32_bf16 v[16:19], a[200:203], v[168:171], v[16:19]
  ds_read_b64_tr_b16 a[244:245], v233 offset:160
  v_add_f32 v208, v208, v39
  v_cvt_pk_bf16_f32 v83, v38, v39
  v_mfma_f32_16x16x32_bf16 v[16:19], a[204:207], v[172:175], v[16:19]
  v_exp_f32 v40, v40
  v_mfma_f32_16x16x32_bf16 v[20:23], a[208:211], v[160:163], v[200:203]
  buffer_load_dword v231, v221, s[8:11], s99 offen offset:0 sc1
  v_add_f32 v209, v209, v40
  v_mfma_f32_16x16x32_bf16 v[20:23], a[212:215], v[164:167], v[20:23]
  ds_read_b64_tr_b16 a[246:247], v233 offset:672
  v_exp_f32 v41, v41
  v_mfma_f32_16x16x32_bf16 v[20:23], a[216:219], v[168:171], v[20:23]
  ds_read_b64_tr_b16 a[248:249], v233 offset:192
  v_add_f32 v209, v209, v41
  v_cvt_pk_bf16_f32 v84, v40, v41
  v_mfma_f32_16x16x32_bf16 v[20:23], a[220:223], v[172:175], v[20:23]
  s_waitcnt lgkmcnt(2)
  v_exp_f32 v42, v42
  v_mfma_f32_16x16x32_bf16 a[0:3], a[224:227], v[64:67], a[0:3]
  buffer_load_dwordx4 v253, s[12:15], s93 offen offset:1056 lds
  v_add_f32 v209, v209, v42
  v_mfma_f32_16x16x32_bf16 a[32:35], a[224:227], v[68:71], a[32:35]
  ds_read_b64_tr_b16 a[250:251], v233 offset:704
  v_exp_f32 v43, v43
  v_mfma_f32_16x16x32_bf16 a[64:67], a[224:227], v[72:75], a[64:67]
  ds_read_b64_tr_b16 a[252:253], v233 offset:224
  v_add_f32 v209, v209, v43
  v_cvt_pk_bf16_f32 v85, v42, v43
  v_mfma_f32_16x16x32_bf16 a[4:7], a[228:231], v[64:67], a[4:7]
  ds_read_b64_tr_b16 a[254:255], v233 offset:736
  v_exp_f32 v44, v44
  v_mfma_f32_16x16x32_bf16 a[36:39], a[228:231], v[68:71], a[36:39]
  ds_read_b128 a[192:195], v232 offset:8448
  v_add_f32 v209, v209, v44
  v_mfma_f32_16x16x32_bf16 a[68:71], a[228:231], v[72:75], a[68:71]
  v_exp_f32 v45, v45
  v_mfma_f32_16x16x32_bf16 a[8:11], a[232:235], v[64:67], a[8:11]
  ds_read_b128 a[196:199], v232 offset:8512
  v_add_f32 v209, v209, v45
  v_cvt_pk_bf16_f32 v86, v44, v45
  v_mfma_f32_16x16x32_bf16 a[40:43], a[232:235], v[68:71], a[40:43]
  v_exp_f32 v46, v46
  v_mfma_f32_16x16x32_bf16 a[72:75], a[232:235], v[72:75], a[72:75]
  ds_read_b128 a[200:203], v232 offset:8576
  v_add_f32 v209, v209, v46
  v_mfma_f32_16x16x32_bf16 a[12:15], a[236:239], v[64:67], a[12:15]
  v_exp_f32 v47, v47
  v_mfma_f32_16x16x32_bf16 a[44:47], a[236:239], v[68:71], a[44:47]
  ds_read_b128 a[204:207], v232 offset:8640
  v_add_f32 v209, v209, v47
  v_cvt_pk_bf16_f32 v87, v46, v47
  v_mfma_f32_16x16x32_bf16 a[76:79], a[236:239], v[72:75], a[76:79]
  v_exp_f32 v48, v48
  v_mfma_f32_16x16x32_bf16 a[16:19], a[240:243], v[64:67], a[16:19]
  ds_read_b128 a[208:211], v232 offset:8960
  v_add_f32 v210, v210, v48
  v_mfma_f32_16x16x32_bf16 a[48:51], a[240:243], v[68:71], a[48:51]
  v_exp_f32 v49, v49
  v_mfma_f32_16x16x32_bf16 a[80:83], a[240:243], v[72:75], a[80:83]
  s_waitcnt lgkmcnt(2)
  ds_read_b128 a[212:215], v232 offset:9024
  v_add_f32 v210, v210, v49
  v_cvt_pk_bf16_f32 v88, v48, v49
  v_mfma_f32_16x16x32_bf16 a[20:23], a[244:247], v[64:67], a[20:23]
  buffer_load_dwordx4 v254, s[12:15], s93 offen offset:2112 lds
  v_exp_f32 v50, v50
  v_mfma_f32_16x16x32_bf16 a[52:55], a[244:247], v[68:71], a[52:55]
  ds_read_b128 a[216:219], v232 offset:9088
  v_add_f32 v210, v210, v50
  v_mfma_f32_16x16x32_bf16 a[84:87], a[244:247], v[72:75], a[84:87]
  v_exp_f32 v51, v51
  v_mfma_f32_16x16x32_bf16 a[24:27], a[248:251], v[64:67], a[24:27]
  ds_read_b128 a[220:223], v232 offset:9152
  v_add_f32 v210, v210, v51
  v_cvt_pk_bf16_f32 v89, v50, v51
  v_mfma_f32_16x16x32_bf16 a[56:59], a[248:251], v[68:71], a[56:59]
  v_exp_f32 v52, v52
  v_mfma_f32_16x16x32_bf16 a[88:91], a[248:251], v[72:75], a[88:91]
  v_add_f32 v210, v210, v52
  v_mfma_f32_16x16x32_bf16 a[28:31], a[252:255], v[64:67], a[28:31]
  v_exp_f32 v53, v53
  v_mfma_f32_16x16x32_bf16 a[60:63], a[252:255], v[68:71], a[60:63]
  v_add_f32 v210, v210, v53
  v_cvt_pk_bf16_f32 v90, v52, v53
  v_mfma_f32_16x16x32_bf16 a[92:95], a[252:255], v[72:75], a[92:95]
  s_mov_b32 s99, 16384
  v_exp_f32 v54, v54
  v_mfma_f32_16x16x32_bf16 v[32:35], a[192:195], v[128:131], v[192:195]
  ds_read_b64_tr_b16 a[224:225], v233 offset:8448
  v_add_f32 v210, v210, v54
  v_mfma_f32_16x16x32_bf16 v[32:35], a[196:199], v[132:135], v[32:35]
  v_exp_f32 v55, v55
  v_exp_f32 v0, v0
  v_mfma_f32_16x16x32_bf16 v[32:35], a[200:203], v[136:139], v[32:35]
  s_waitcnt lgkmcnt(1)
  ds_read_b64_tr_b16 a[226:227], v233 offset:8960
  v_add_f32 v210, v210, v55
  v_cvt_pk_bf16_f32 v91, v54, v55
  v_add_f32 v208, v208, v0
  v_mfma_f32_16x16x32_bf16 v[32:35], a[204:207], v[140:143], v[32:35]
  v_exp_f32 v1, v1
  v_mfma_f32_16x16x32_bf16 v[36:39], a[208:211], v[128:131], v[192:195]
  buffer_load_dword v231, v222, s[8:11], s99 offen offset:0 sc1
  v_add_f32 v208, v208, v1
  v_cvt_pk_bf16_f32 v64, v0, v1
  v_mfma_f32_16x16x32_bf16 v[36:39], a[212:215], v[132:135], v[36:39]
  v_exp_f32 v2, v2
  v_mfma_f32_16x16x32_bf16 v[36:39], a[216:219], v[136:139], v[36:39]
  buffer_load_dwordx4 v255, s[12:15], s93 offen offset:3168 lds
  v_add_f32 v208, v208, v2
  v_mfma_f32_16x16x32_bf16 v[36:39], a[220:223], v[140:143], v[36:39]
  ds_read_b64_tr_b16 a[228:229], v233 offset:8480
  v_exp_f32 v3, v3
  v_mfma_f32_16x16x32_bf16 v[40:43], a[192:195], v[144:147], v[196:199]
  ds_read_b64_tr_b16 a[230:231], v233 offset:8992
  v_add_f32 v208, v208, v3
  v_cvt_pk_bf16_f32 v65, v2, v3
  v_mfma_f32_16x16x32_bf16 v[40:43], a[196:199], v[148:151], v[40:43]
  v_exp_f32 v4, v4
  v_mfma_f32_16x16x32_bf16 v[40:43], a[200:203], v[152:155], v[40:43]
  ds_read_b64_tr_b16 a[232:233], v233 offset:8512
  v_add_f32 v208, v208, v4
  v_mfma_f32_16x16x32_bf16 v[40:43], a[204:207], v[156:159], v[40:43]
  v_exp_f32 v5, v5
  v_mfma_f32_16x16x32_bf16 v[44:47], a[208:211], v[144:147], v[196:199]
  ds_read_b64_tr_b16 a[234:235], v233 offset:9024
  v_add_f32 v208, v208, v5
  v_cvt_pk_bf16_f32 v66, v4, v5
  v_mfma_f32_16x16x32_bf16 v[44:47], a[212:215], v[148:151], v[44:47]
  ds_read_b64_tr_b16 a[236:237], v233 offset:8544
  v_exp_f32 v6, v6
  v_mfma_f32_16x16x32_bf16 v[44:47], a[216:219], v[152:155], v[44:47]
  ds_read_b64_tr_b16 a[238:239], v233 offset:9056
  v_add_f32 v208, v208, v6
  v_mfma_f32_16x16x32_bf16 v[44:47], a[220:223], v[156:159], v[44:47]
  v_exp_f32 v7, v7
  v_mfma_f32_16x16x32_bf16 v[48:51], a[192:195], v[160:163], v[200:203]
  ds_read_b64_tr_b16 a[240:241], v233 offset:8576
  v_add_f32 v208, v208, v7
  v_cvt_pk_bf16_f32 v67, v6, v7
  v_mfma_f32_16x16x32_bf16 v[48:51], a[196:199], v[164:167], v[48:51]
  v_exp_f32 v8, v8
  v_mfma_f32_16x16x32_bf16 v[48:51], a[200:203], v[168:171], v[48:51]
  ds_read_b64_tr_b16 a[242:243], v233 offset:9088
  v_add_f32 v209, v209, v8
  v_mfma_f32_16x16x32_bf16 v[48:51], a[204:207], v[172:175], v[48:51]
  ds_read_b64_tr_b16 a[244:245], v233 offset:8608
  v_exp_f32 v9, v9
  v_mfma_f32_16x16x32_bf16 v[52:55], a[208:211], v[160:163], v[200:203]
  ds_read_b64_tr_b16 a[246:247], v233 offset:9120
  v_add_f32 v209, v209, v9
  v_cvt_pk_bf16_f32 v68, v8, v9
  v_mfma_f32_16x16x32_bf16 v[52:55], a[212:215], v[164:167], v[52:55]
  s_waitcnt vmcnt(23)
  v_exp_f32 v10, v10
  v_mfma_f32_16x16x32_bf16 v[52:55], a[216:219], v[168:171], v[52:55]
  s_barrier
  ds_read_b64_tr_b16 a[248:249], v233 offset:8640
  v_add_f32 v209, v209, v10
  v_mfma_f32_16x16x32_bf16 v[52:55], a[220:223], v[172:175], v[52:55]
  s_add_u32 s93, s94, 5
  s_waitcnt lgkmcnt(2)
  v_exp_f32 v11, v11
  v_mfma_f32_16x16x32_bf16 a[0:3], a[224:227], v[80:83], a[0:3]
  s_and_b32 s93, s93, 15
  ds_read_b64_tr_b16 a[250:251], v233 offset:9152
  v_add_f32 v209, v209, v11
  v_cvt_pk_bf16_f32 v69, v10, v11
  v_mfma_f32_16x16x32_bf16 a[32:35], a[224:227], v[84:87], a[32:35]
  s_lshl_b32 s93, s93, 16
  ds_read_b64_tr_b16 a[252:253], v233 offset:8672
  v_exp_f32 v12, v12
  v_mfma_f32_16x16x32_bf16 a[64:67], a[224:227], v[88:91], a[64:67]
  s_add_u32 m0, s32, 101376
  ds_read_b64_tr_b16 a[254:255], v233 offset:9184
  v_add_f32 v209, v209, v12
  v_mfma_f32_16x16x32_bf16 a[4:7], a[228:231], v[80:83], a[4:7]
  v_exp_f32 v13, v13
  v_mfma_f32_16x16x32_bf16 a[36:39], a[228:231], v[84:87], a[36:39]
  v_add_f32 v209, v209, v13
  v_cvt_pk_bf16_f32 v70, v12, v13
  v_mfma_f32_16x16x32_bf16 a[68:71], a[228:231], v[88:91], a[68:71]
  v_add_u32 v233, 0, v235
  v_exp_f32 v14, v14
  v_mfma_f32_16x16x32_bf16 a[8:11], a[232:235], v[80:83], a[8:11]
  buffer_load_dwordx4 v252, s[12:15], s93 offen offset:0 lds
  v_add_f32 v209, v209, v14
  v_mfma_f32_16x16x32_bf16 a[40:43], a[232:235], v[84:87], a[40:43]
  v_exp_f32 v15, v15
  v_mfma_f32_16x16x32_bf16 a[72:75], a[232:235], v[88:91], a[72:75]
  ds_read_b64_tr_b16 a[192:193], v233 offset:0
  v_add_f32 v209, v209, v15
  v_cvt_pk_bf16_f32 v71, v14, v15
  v_mfma_f32_16x16x32_bf16 a[12:15], a[236:239], v[80:83], a[12:15]
  buffer_load_dwordx4 v253, s[12:15], s93 offen offset:1056 lds
  v_exp_f32 v16, v16
  v_mfma_f32_16x16x32_bf16 a[44:47], a[236:239], v[84:87], a[44:47]
  ds_read_b64_tr_b16 a[194:195], v233 offset:512
  v_add_f32 v210, v210, v16
  v_mfma_f32_16x16x32_bf16 a[76:79], a[236:239], v[88:91], a[76:79]
  ds_read_b64_tr_b16 a[196:197], v233 offset:32
  v_exp_f32 v17, v17
  v_mfma_f32_16x16x32_bf16 a[16:19], a[240:243], v[80:83], a[16:19]
  buffer_load_dwordx4 v254, s[12:15], s93 offen offset:2112 lds
  v_add_f32 v210, v210, v17
  v_cvt_pk_bf16_f32 v72, v16, v17
  v_mfma_f32_16x16x32_bf16 a[48:51], a[240:243], v[84:87], a[48:51]
  ds_read_b64_tr_b16 a[198:199], v233 offset:544
  v_exp_f32 v18, v18
  v_mfma_f32_16x16x32_bf16 a[80:83], a[240:243], v[88:91], a[80:83]
  s_waitcnt lgkmcnt(3)
  ds_read_b64_tr_b16 a[200:201], v233 offset:64
  v_add_f32 v210, v210, v18
  v_mfma_f32_16x16x32_bf16 a[20:23], a[244:247], v[80:83], a[20:23]
  buffer_load_dwordx4 v255, s[12:15], s93 offen offset:3168 lds
  s_mov_b32 s99, 16384
  v_exp_f32 v19, v19
  v_mfma_f32_16x16x32_bf16 a[52:55], a[244:247], v[84:87], a[52:55]
  buffer_load_dword v231, v223, s[8:11], s99 offen offset:0 sc1
  s_add_u32 s93, s94, 6
  s_and_b32 s93, s93, 15
  s_lshl_b32 s93, s93, 16
  s_add_u32 m0, s32, 118272
  v_add_f32 v210, v210, v19
  v_cvt_pk_bf16_f32 v73, v18, v19
  v_mfma_f32_16x16x32_bf16 a[84:87], a[244:247], v[88:91], a[84:87]
  ds_read_b64_tr_b16 a[202:203], v233 offset:576
  v_exp_f32 v20, v20
  v_mfma_f32_16x16x32_bf16 a[24:27], a[248:251], v[80:83], a[24:27]
  ds_read_b64_tr_b16 a[204:205], v233 offset:96
  v_add_f32 v210, v210, v20
  v_mfma_f32_16x16x32_bf16 a[56:59], a[248:251], v[84:87], a[56:59]
  ds_read_b64_tr_b16 a[206:207], v233 offset:608
  v_exp_f32 v21, v21
  v_mfma_f32_16x16x32_bf16 a[88:91], a[248:251], v[88:91], a[88:91]
  buffer_load_dwordx4 v252, s[12:15], s93 offen offset:0 lds
  v_add_f32 v210, v210, v21
  v_cvt_pk_bf16_f32 v74, v20, v21
  v_mfma_f32_16x16x32_bf16 a[28:31], a[252:255], v[80:83], a[28:31]
  ds_read_b64_tr_b16 a[208:209], v233 offset:128
  v_exp_f32 v22, v22
  v_mfma_f32_16x16x32_bf16 a[60:63], a[252:255], v[84:87], a[60:63]
  buffer_load_dwordx4 v253, s[12:15], s93 offen offset:1056 lds
  v_add_f32 v210, v210, v22
  v_mfma_f32_16x16x32_bf16 a[92:95], a[252:255], v[88:91], a[92:95]
  ds_read_b64_tr_b16 a[210:211], v233 offset:640
  v_exp_f32 v23, v23
  s_nop 0
  v_add_f32 v210, v210, v23
  v_cvt_pk_bf16_f32 v75, v22, v23
  ds_read_b64_tr_b16 a[212:213], v233 offset:160
  ds_read_b64_tr_b16 a[214:215], v233 offset:672
  ds_read_b64_tr_b16 a[216:217], v233 offset:192
  ds_read_b64_tr_b16 a[218:219], v233 offset:704
  ds_read_b64_tr_b16 a[220:221], v233 offset:224
  ds_read_b64_tr_b16 a[222:223], v233 offset:736
  buffer_load_dwordx4 v254, s[12:15], s93 offen offset:2112 lds
  buffer_load_dwordx4 v255, s[12:15], s93 offen offset:3168 lds
  s_waitcnt lgkmcnt(6)
  v_exp_f32 v32, v32
  v_exp_f32 v33, v33
  v_add_f32 v208, v208, v32
  v_add_f32 v208, v208, v33
  v_mfma_f32_16x16x32_bf16 a[0:3], a[192:195], v[64:67], a[0:3]
  ds_read_b64_tr_b16 a[224:225], v233 offset:8448
  v_cvt_pk_bf16_f32 v80, v32, v33
  v_exp_f32 v34, v34
  v_exp_f32 v35, v35
  v_mfma_f32_16x16x32_bf16 a[4:7], a[196:199], v[64:67], a[4:7]
  ds_read_b64_tr_b16 a[226:227], v233 offset:8960
  v_add_f32 v208, v208, v34
  v_add_f32 v208, v208, v35
  v_cvt_pk_bf16_f32 v81, v34, v35
  v_exp_f32 v36, v36
  v_mfma_f32_16x16x32_bf16 a[8:11], a[200:203], v[64:67], a[8:11]
  ds_read_b64_tr_b16 a[228:229], v233 offset:8480
  v_add_f32 v208, v208, v36
  v_exp_f32 v40, v40
  v_exp_f32 v37, v37
  v_mfma_f32_16x16x32_bf16 a[12:15], a[204:207], v[64:67], a[12:15]
  ds_read_b64_tr_b16 a[230:231], v233 offset:8992
  v_add_f32 v209, v209, v40
  v_add_f32 v208, v208, v37
  v_cvt_pk_bf16_f32 v82, v36, v37
  v_exp_f32 v41, v41
  v_mfma_f32_16x16x32_bf16 a[16:19], a[208:211], v[64:67], a[16:19]
  ds_read_b64_tr_b16 a[232:233], v233 offset:8512
  v_exp_f32 v38, v38
  v_exp_f32 v39, v39
  v_add_f32 v208, v208, v38
  s_waitcnt lgkmcnt(2)
  ds_read_b64_tr_b16 a[234:235], v233 offset:9024
  v_mfma_f32_16x16x32_bf16 a[20:23], a[212:215], v[64:67], a[20:23]
  ds_read_b64_tr_b16 a[236:237], v233 offset:8544
  v_add_f32 v209, v209, v41
  v_add_f32 v208, v208, v39
  v_cvt_pk_bf16_f32 v83, v38, v39
  v_cvt_pk_bf16_f32 v84, v40, v41
  ds_read_b64_tr_b16 a[238:239], v233 offset:9056
  v_mfma_f32_16x16x32_bf16 a[24:27], a[216:219], v[64:67], a[24:27]
  ds_read_b64_tr_b16 a[240:241], v233 offset:8576
  v_exp_f32 v42, v42
  v_exp_f32 v43, v43
  v_add_f32 v209, v209, v42
  ds_read_b64_tr_b16 a[242:243], v233 offset:9088
  v_mfma_f32_16x16x32_bf16 a[28:31], a[220:223], v[64:67], a[28:31]
  ds_read_b64_tr_b16 a[244:245], v233 offset:8608
  v_mov_b32 v224, v208
  v_add_f32 v209, v209, v43
  v_cvt_pk_bf16_f32 v85, v42, v43
  v_permlane16_swap_b32 v208, v224
  ds_read_b64_tr_b16 a[246:247], v233 offset:9120
  v_mfma_f32_16x16x32_bf16 a[0:3], a[224:227], v[80:83], a[0:3]
  ds_read_b64_tr_b16 a[248:249], v233 offset:8640
  v_add_f32 v208, v208, v224
  v_exp_f32 v44, v44
  s_waitcnt lgkmcnt(4)
  ds_read_b64_tr_b16 a[250:251], v233 offset:9152
  v_add_f32 v209, v209, v44
  v_mfma_f32_16x16x32_bf16 a[4:7], a[228:231], v[80:83], a[4:7]
  ds_read_b64_tr_b16 a[252:253], v233 offset:8672
  v_mov_b32 v224, v208
  v_exp_f32 v45, v45
  ds_read_b64_tr_b16 a[254:255], v233 offset:9184
  v_mfma_f32_16x16x32_bf16 a[8:11], a[232:235], v[80:83], a[8:11]
  v_permlane32_swap_b32 v208, v224
  v_add_f32 v209, v209, v45
  v_mfma_f32_16x16x32_bf16 a[12:15], a[236:239], v[80:83], a[12:15]
  s_waitcnt lgkmcnt(3)
  v_add_f32 v208, v208, v224
  v_cvt_pk_bf16_f32 v86, v44, v45
  v_mfma_f32_16x16x32_bf16 a[16:19], a[240:243], v[80:83], a[16:19]
  s_lshl_b32 s35, s3, 2
  v_rcp_f32 v216, v208
  v_mov_b32 v230, 152064
  v_exp_f32 v46, v46
  v_mfma_f32_16x16x32_bf16 a[20:23], a[244:247], v[80:83], a[20:23]
  s_add_u32 s35, s35, 152064
  s_waitcnt lgkmcnt(0)
  v_mov_b32 v229, s35
  v_add_f32 v209, v209, v46
  v_exp_f32 v47, v47
  v_mfma_f32_16x16x32_bf16 a[24:27], a[248:251], v[80:83], a[24:27]
  s_mov_b32 s33, 0x4b800000
  v_cmp_nge_f32 vcc, s33, v208
  v_add_f32 v209, v209, v47
  v_cvt_pk_bf16_f32 v87, v46, v47
  v_mfma_f32_16x16x32_bf16 a[28:31], a[252:255], v[80:83], a[28:31]
  s_mov_b64 s[54:55], 0
  v_mfma_f32_16x16x32_bf16 a[32:35], a[192:195], v[68:71], a[32:35]
  s_or_b64 s[54:55], s[54:55], vcc
  v_exp_f32 v48, v48
  v_mfma_f32_16x16x32_bf16 a[32:35], a[224:227], v[84:87], a[32:35]
  v_add_f32 v210, v210, v48
  v_exp_f32 v49, v49
  v_accvgpr_read_b32 v104, a0
  v_accvgpr_read_b32 v105, a1
  v_accvgpr_read_b32 v106, a2
  v_mfma_f32_16x16x32_bf16 a[36:39], a[196:199], v[68:71], a[36:39]
  v_accvgpr_read_b32 v107, a3
  v_accvgpr_read_b32 v108, a4
  v_accvgpr_read_b32 v109, a5
  v_accvgpr_read_b32 v110, a6
  v_accvgpr_read_b32 v111, a7
  v_mul_f32 v104, v216, v104
  v_mfma_f32_16x16x32_bf16 a[36:39], a[228:231], v[84:87], a[36:39]
  s_mov_b32 s34, 0
  v_mul_f32 v105, v216, v105
  v_mul_f32 v106, v216, v106
  v_mul_f32 v107, v216, v107
  v_mul_f32 v108, v216, v108
  v_mul_f32 v109, v216, v109
  v_mul_f32 v110, v216, v110
  v_mfma_f32_16x16x32_bf16 a[40:43], a[200:203], v[68:71], a[40:43]
  v_mul_f32 v111, v216, v111
  v_cvt_pk_bf16_f32 v112, v104, v105
  v_cvt_pk_bf16_f32 v113, v106, v107
  v_cvt_pk_bf16_f32 v114, v108, v109
  v_cvt_pk_bf16_f32 v115, v110, v111
  v_add_f32 v210, v210, v49
  v_mfma_f32_16x16x32_bf16 a[40:43], a[232:235], v[84:87], a[40:43]
  buffer_store_dwordx4 v[112:115], v238, s[24:27], s34 offen offset:0
  v_cvt_pk_bf16_f32 v88, v48, v49
  v_exp_f32 v50, v50
  v_mfma_f32_16x16x32_bf16 a[44:47], a[204:207], v[68:71], a[44:47]
  s_mov_b32 s34, 8192
  v_add_f32 v210, v210, v50
  v_accvgpr_read_b32 v116, a8
  v_accvgpr_read_b32 v117, a9
  v_accvgpr_read_b32 v118, a10
  v_accvgpr_read_b32 v119, a11
  v_accvgpr_read_b32 v120, a12
  v_mfma_f32_16x16x32_bf16 a[44:47], a[236:239], v[84:87], a[44:47]
  v_accvgpr_read_b32 v121, a13
  v_accvgpr_read_b32 v122, a14
  v_accvgpr_read_b32 v123, a15
  v_mul_f32 v116, v216, v116
  v_mul_f32 v117, v216, v117
  v_mul_f32 v118, v216, v118
  v_mfma_f32_16x16x32_bf16 a[48:51], a[208:211], v[68:71], a[48:51]
  v_mul_f32 v119, v216, v119
  v_mul_f32 v120, v216, v120
  v_mul_f32 v121, v216, v121
  v_mul_f32 v122, v216, v122
  v_mul_f32 v123, v216, v123
  v_cvt_pk_bf16_f32 v124, v116, v117
  v_mfma_f32_16x16x32_bf16 a[48:51], a[240:243], v[84:87], a[48:51]
  v_cvt_pk_bf16_f32 v125, v118, v119
  v_cvt_pk_bf16_f32 v126, v120, v121
  v_cvt_pk_bf16_f32 v127, v122, v123
  v_exp_f32 v51, v51
  v_mov_b32 v225, v209
  v_mfma_f32_16x16x32_bf16 a[52:55], a[212:215], v[68:71], a[52:55]
  buffer_store_dwordx4 v[124:127], v238, s[24:27], s34 offen offset:0
  v_add_f32 v210, v210, v51
  v_permlane16_swap_b32 v209, v225
  v_cvt_pk_bf16_f32 v89, v50, v51
  v_mfma_f32_16x16x32_bf16 a[52:55], a[244:247], v[84:87], a[52:55]
  s_mov_b32 s34, 16384
  v_accvgpr_read_b32 v104, a16
  v_accvgpr_read_b32 v105, a17
  v_accvgpr_read_b32 v106, a18
  v_accvgpr_read_b32 v107, a19
  v_accvgpr_read_b32 v108, a20
  v_accvgpr_read_b32 v109, a21
  v_mfma_f32_16x16x32_bf16 a[56:59], a[216:219], v[68:71], a[56:59]
  v_accvgpr_read_b32 v110, a22
  v_accvgpr_read_b32 v111, a23
  v_mul_f32 v104, v216, v104
  v_mul_f32 v105, v216, v105
  v_mul_f32 v106, v216, v106
  v_mul_f32 v107, v216, v107
  v_mul_f32 v108, v216, v108
  v_mul_f32 v109, v216, v109
  v_mul_f32 v110, v216, v110
  v_mul_f32 v111, v216, v111
  v_cvt_pk_bf16_f32 v112, v104, v105
  v_cvt_pk_bf16_f32 v113, v106, v107
  v_cvt_pk_bf16_f32 v114, v108, v109
  v_cvt_pk_bf16_f32 v115, v110, v111
  v_mfma_f32_16x16x32_bf16 a[56:59], a[248:251], v[84:87], a[56:59]
  buffer_store_dwordx4 v[112:115], v238, s[24:27], s34 offen offset:0
  v_add_f32 v209, v209, v225
  v_exp_f32 v52, v52
  v_mfma_f32_16x16x32_bf16 a[60:63], a[220:223], v[68:71], a[60:63]
  s_mov_b32 s34, 24576
  v_add_f32 v210, v210, v52
  v_mov_b32 v225, v209
  v_exp_f32 v53, v53
  v_accvgpr_read_b32 v116, a24
  v_permlane32_swap_b32 v209, v225
  v_mfma_f32_16x16x32_bf16 a[60:63], a[252:255], v[84:87], a[60:63]
  v_add_f32 v210, v210, v53
  v_accvgpr_read_b32 v117, a25
  v_accvgpr_read_b32 v118, a26
  v_accvgpr_read_b32 v119, a27
  v_accvgpr_read_b32 v120, a28
  v_accvgpr_read_b32 v121, a29
  v_accvgpr_read_b32 v122, a30
  v_accvgpr_read_b32 v123, a31
  v_mul_f32 v116, v216, v116
  v_mul_f32 v117, v216, v117
  v_mul_f32 v118, v216, v118
  v_mul_f32 v119, v216, v119
  v_mul_f32 v120, v216, v120
  v_mul_f32 v121, v216, v121
  v_mul_f32 v122, v216, v122
  v_mul_f32 v123, v216, v123
  v_cvt_pk_bf16_f32 v124, v116, v117
  v_cvt_pk_bf16_f32 v125, v118, v119
  v_cvt_pk_bf16_f32 v126, v120, v121
  v_cvt_pk_bf16_f32 v127, v122, v123
  v_mfma_f32_16x16x32_bf16 a[64:67], a[192:195], v[72:75], a[64:67]
  buffer_store_dwordx4 v[124:127], v238, s[24:27], s34 offen offset:0
  v_add_f32 v209, v209, v225
  v_cvt_pk_bf16_f32 v90, v52, v53
  v_cmp_nge_f32 vcc, s33, v209
  v_exp_f32 v54, v54
  v_exp_f32 v55, v55
  s_nop 0
  v_cvt_pk_bf16_f32 v91, v54, v55
  s_nop 1
  v_mfma_f32_16x16x32_bf16 a[64:67], a[224:227], v[88:91], a[64:67]
  s_or_b64 s[54:55], s[54:55], vcc
  v_rcp_f32 v217, v209
  v_add_f32 v210, v210, v54
  v_add_f32 v210, v210, v55
  v_accvgpr_read_b32 v0, a32
  v_accvgpr_read_b32 v1, a33
  v_mfma_f32_16x16x32_bf16 a[68:71], a[196:199], v[72:75], a[68:71]
  v_accvgpr_read_b32 v2, a34
  v_accvgpr_read_b32 v3, a35
  v_accvgpr_read_b32 v4, a36
  v_accvgpr_read_b32 v5, a37
  v_accvgpr_read_b32 v6, a38
  v_accvgpr_read_b32 v7, a39
  v_mfma_f32_16x16x32_bf16 a[68:71], a[228:231], v[88:91], a[68:71]
  s_mov_b32 s34, 0
  v_mul_f32 v0, v217, v0
  v_mul_f32 v1, v217, v1
  v_mul_f32 v2, v217, v2
  v_mul_f32 v3, v217, v3
  v_mul_f32 v4, v217, v4
  v_mul_f32 v5, v217, v5
  v_mfma_f32_16x16x32_bf16 a[72:75], a[200:203], v[72:75], a[72:75]
  v_mul_f32 v6, v217, v6
  v_mul_f32 v7, v217, v7
  v_cvt_pk_bf16_f32 v8, v0, v1
  v_cvt_pk_bf16_f32 v9, v2, v3
  v_cvt_pk_bf16_f32 v10, v4, v5
  v_cvt_pk_bf16_f32 v11, v6, v7
  v_mfma_f32_16x16x32_bf16 a[72:75], a[232:235], v[88:91], a[72:75]
  buffer_store_dwordx4 v[8:11], v238, s[24:27], s34 offen offset:1024
  v_accvgpr_read_b32 v16, a40
  v_accvgpr_read_b32 v17, a41
  v_accvgpr_read_b32 v18, a42
  v_mfma_f32_16x16x32_bf16 a[76:79], a[204:207], v[72:75], a[76:79]
  s_mov_b32 s34, 8192
  v_accvgpr_read_b32 v19, a43
  v_accvgpr_read_b32 v20, a44
  v_accvgpr_read_b32 v21, a45
  v_accvgpr_read_b32 v22, a46
  v_accvgpr_read_b32 v23, a47
  v_mul_f32 v16, v217, v16
  v_mfma_f32_16x16x32_bf16 a[76:79], a[236:239], v[88:91], a[76:79]
  v_mul_f32 v17, v217, v17
  v_mul_f32 v18, v217, v18
  v_mul_f32 v19, v217, v19
  v_mul_f32 v20, v217, v20
  v_mul_f32 v21, v217, v21
  v_mul_f32 v22, v217, v22
  v_mfma_f32_16x16x32_bf16 a[80:83], a[208:211], v[72:75], a[80:83]
  v_mul_f32 v23, v217, v23
  v_cvt_pk_bf16_f32 v24, v16, v17
  v_cvt_pk_bf16_f32 v25, v18, v19
  v_cvt_pk_bf16_f32 v26, v20, v21
  v_cvt_pk_bf16_f32 v27, v22, v23
  v_mov_b32 v226, v210
  v_mfma_f32_16x16x32_bf16 a[80:83], a[240:243], v[88:91], a[80:83]
  buffer_store_dwordx4 v[24:27], v238, s[24:27], s34 offen offset:1024
  v_permlane16_swap_b32 v210, v226
  v_accvgpr_read_b32 v0, a48
  v_accvgpr_read_b32 v1, a49
  v_mfma_f32_16x16x32_bf16 a[84:87], a[212:215], v[72:75], a[84:87]
  s_mov_b32 s34, 16384
  v_accvgpr_read_b32 v2, a50
  v_accvgpr_read_b32 v3, a51
  v_accvgpr_read_b32 v4, a52
  v_accvgpr_read_b32 v5, a53
  v_accvgpr_read_b32 v6, a54
  v_accvgpr_read_b32 v7, a55
  v_mfma_f32_16x16x32_bf16 a[84:87], a[244:247], v[88:91], a[84:87]
  v_mul_f32 v0, v217, v0
  v_mul_f32 v1, v217, v1
  v_mul_f32 v2, v217, v2
  v_mul_f32 v3, v217, v3
  v_mul_f32 v4, v217, v4
  v_mul_f32 v5, v217, v5
  v_mfma_f32_16x16x32_bf16 a[88:91], a[216:219], v[72:75], a[88:91]
  v_mul_f32 v6, v217, v6
  v_mul_f32 v7, v217, v7
  v_cvt_pk_bf16_f32 v8, v0, v1
  v_cvt_pk_bf16_f32 v9, v2, v3
  v_cvt_pk_bf16_f32 v10, v4, v5
  v_cvt_pk_bf16_f32 v11, v6, v7
  v_mfma_f32_16x16x32_bf16 a[88:91], a[248:251], v[88:91], a[88:91]
  buffer_store_dwordx4 v[8:11], v238, s[24:27], s34 offen offset:1024
  v_add_f32 v210, v210, v226
  v_mov_b32 v226, v210
  v_accvgpr_read_b32 v16, a56
  v_mfma_f32_16x16x32_bf16 a[92:95], a[220:223], v[72:75], a[92:95]
  s_mov_b32 s34, 24576
  v_permlane32_swap_b32 v210, v226
  v_accvgpr_read_b32 v17, a57
  v_accvgpr_read_b32 v18, a58
  v_accvgpr_read_b32 v19, a59
  v_accvgpr_read_b32 v20, a60
  v_accvgpr_read_b32 v21, a61
  v_mfma_f32_16x16x32_bf16 a[92:95], a[252:255], v[88:91], a[92:95]
  v_accvgpr_read_b32 v22, a62
  v_accvgpr_read_b32 v23, a63
  v_mul_f32 v16, v217, v16
  v_mul_f32 v17, v217, v17
  v_mul_f32 v18, v217, v18
  v_mul_f32 v19, v217, v19
  v_mul_f32 v20, v217, v20
  v_mul_f32 v21, v217, v21
  v_mul_f32 v22, v217, v22
  v_mul_f32 v23, v217, v23
  v_cvt_pk_bf16_f32 v24, v16, v17
  v_cvt_pk_bf16_f32 v25, v18, v19
  v_cvt_pk_bf16_f32 v26, v20, v21
  v_cvt_pk_bf16_f32 v27, v22, v23
  v_add_f32 v210, v210, v226
  v_rcp_f32 v218, v210
  v_cmp_nge_f32 vcc, s33, v210
  s_nop 0
  s_or_b64 s[54:55], s[54:55], vcc
  s_cselect_b32 s33, 1, 0
  v_mov_b32 v228, s33
  ds_write_b32 v229, v228
  buffer_store_dwordx4 v[24:27], v238, s[24:27], s34 offen offset:1024
  s_mov_b32 s34, 0
  v_accvgpr_read_b32 v0, a64
  v_accvgpr_read_b32 v1, a65
  v_accvgpr_read_b32 v2, a66
  v_accvgpr_read_b32 v3, a67
  v_accvgpr_read_b32 v4, a68
  v_accvgpr_read_b32 v5, a69
  v_accvgpr_read_b32 v6, a70
  v_accvgpr_read_b32 v7, a71
  v_mul_f32 v0, v218, v0
  v_mul_f32 v1, v218, v1
  v_mul_f32 v2, v218, v2
  v_mul_f32 v3, v218, v3
  v_mul_f32 v4, v218, v4
  v_mul_f32 v5, v218, v5
  v_mul_f32 v6, v218, v6
  v_mul_f32 v7, v218, v7
  v_cvt_pk_bf16_f32 v8, v0, v1
  v_cvt_pk_bf16_f32 v9, v2, v3
  v_cvt_pk_bf16_f32 v10, v4, v5
  v_cvt_pk_bf16_f32 v11, v6, v7
  buffer_store_dwordx4 v[8:11], v238, s[24:27], s34 offen offset:2048
  s_waitcnt lgkmcnt(0)
  s_barrier
  ds_read_b128 v[220:223], v230 offset:0
  s_mov_b32 s34, 8192
  v_accvgpr_read_b32 v16, a72
  v_accvgpr_read_b32 v17, a73
  v_accvgpr_read_b32 v18, a74
  v_accvgpr_read_b32 v19, a75
  v_accvgpr_read_b32 v20, a76
  v_accvgpr_read_b32 v21, a77
  v_accvgpr_read_b32 v22, a78
  v_accvgpr_read_b32 v23, a79
  v_mul_f32 v16, v218, v16
  v_mul_f32 v17, v218, v17
  v_mul_f32 v18, v218, v18
  v_mul_f32 v19, v218, v19
  v_mul_f32 v20, v218, v20
  v_mul_f32 v21, v218, v21
  v_mul_f32 v22, v218, v22
  v_mul_f32 v23, v218, v23
  v_cvt_pk_bf16_f32 v24, v16, v17
  v_cvt_pk_bf16_f32 v25, v18, v19
  v_cvt_pk_bf16_f32 v26, v20, v21
  v_cvt_pk_bf16_f32 v27, v22, v23
  buffer_store_dwordx4 v[24:27], v238, s[24:27], s34 offen offset:2048
  s_mov_b32 s34, 16384
  v_accvgpr_read_b32 v32, a80
  v_accvgpr_read_b32 v33, a81
  v_accvgpr_read_b32 v34, a82
  v_accvgpr_read_b32 v35, a83
  v_accvgpr_read_b32 v36, a84
  v_accvgpr_read_b32 v37, a85
  v_accvgpr_read_b32 v38, a86
  v_accvgpr_read_b32 v39, a87
  v_mul_f32 v32, v218, v32
  v_mul_f32 v33, v218, v33
  v_mul_f32 v34, v218, v34
  v_mul_f32 v35, v218, v35
  v_mul_f32 v36, v218, v36
  v_mul_f32 v37, v218, v37
  v_mul_f32 v38, v218, v38
  v_mul_f32 v39, v218, v39
  v_cvt_pk_bf16_f32 v40, v32, v33
  v_cvt_pk_bf16_f32 v41, v34, v35
  v_cvt_pk_bf16_f32 v42, v36, v37
  v_cvt_pk_bf16_f32 v43, v38, v39
  buffer_store_dwordx4 v[40:43], v238, s[24:27], s34 offen offset:2048
  s_mov_b32 s34, 24576
  v_accvgpr_read_b32 v48, a88
  v_accvgpr_read_b32 v49, a89
  v_accvgpr_read_b32 v50, a90
  v_accvgpr_read_b32 v51, a91
  v_accvgpr_read_b32 v52, a92
  v_accvgpr_read_b32 v53, a93
  v_accvgpr_read_b32 v54, a94
  v_accvgpr_read_b32 v55, a95
  v_mul_f32 v48, v218, v48
  v_mul_f32 v49, v218, v49
  v_mul_f32 v50, v218, v50
  v_mul_f32 v51, v218, v51
  v_mul_f32 v52, v218, v52
  v_mul_f32 v53, v218, v53
  v_mul_f32 v54, v218, v54
  v_mul_f32 v55, v218, v55
  v_cvt_pk_bf16_f32 v56, v48, v49
  v_cvt_pk_bf16_f32 v57, v50, v51
  v_cvt_pk_bf16_f32 v58, v52, v53
  v_cvt_pk_bf16_f32 v59, v54, v55
  buffer_store_dwordx4 v[56:59], v238, s[24:27], s34 offen offset:2048
  s_waitcnt lgkmcnt(0)
  v_or3_b32 v228, v220, v221, v222
  v_or_b32 v228, v228, v223
  s_nop 0
  v_readfirstlane_b32 s33, v228
  s_nop 0
  s_andn2_b32 s33, s33, s52
  s_cbranch_scc0 L_w3_end
  s_waitcnt vmcnt(0)
  s_barrier
  v_mov_b32 v232, v234
  s_mov_b32 s46, 0
  s_mov_b32 m0, s32
L_w3_mx:
  s_nop 0
  buffer_load_dwordx4 v240, s[16:19], s46 offen offset:0 nt lds
  buffer_load_dwordx4 v241, s[16:19], s46 offen offset:1056 nt lds
  buffer_load_dwordx4 v242, s[16:19], s46 offen offset:2112 nt lds
  buffer_load_dwordx4 v243, s[16:19], s46 offen offset:3168 nt lds
  s_waitcnt vmcnt(0)
  s_barrier
  ds_read_b128 a[192:195], v232 offset:0
  ds_read_b128 a[196:199], v232 offset:64
  ds_read_b128 a[200:203], v232 offset:128
  ds_read_b128 a[204:207], v232 offset:192
  ds_read_b128 a[208:211], v232 offset:512
  ds_read_b128 a[212:215], v232 offset:576
  ds_read_b128 a[216:219], v232 offset:640
  ds_read_b128 a[220:223], v232 offset:704
  s_waitcnt lgkmcnt(0)
  v_mfma_f32_16x16x32_bf16 v[0:3], a[192:195], v[128:131], 0
  v_mfma_f32_16x16x32_bf16 v[0:3], a[196:199], v[132:135], v[0:3]
  v_mfma_f32_16x16x32_bf16 v[0:3], a[200:203], v[136:139], v[0:3]
  v_mfma_f32_16x16x32_bf16 v[0:3], a[204:207], v[140:143], v[0:3]
  v_mfma_f32_16x16x32_bf16 v[4:7], a[208:211], v[128:131], 0
  v_mfma_f32_16x16x32_bf16 v[4:7], a[212:215], v[132:135], v[4:7]
  v_mfma_f32_16x16x32_bf16 v[4:7], a[216:219], v[136:139], v[4:7]
  v_mfma_f32_16x16x32_bf16 v[4:7], a[220:223], v[140:143], v[4:7]
  v_mfma_f32_16x16x32_bf16 v[8:11], a[192:195], v[144:147], 0
  v_mfma_f32_16x16x32_bf16 v[8:11], a[196:199], v[148:151], v[8:11]
  v_mfma_f32_16x16x32_bf16 v[8:11], a[200:203], v[152:155], v[8:11]
  v_mfma_f32_16x16x32_bf16 v[8:11], a[204:207], v[156:159], v[8:11]
  v_mfma_f32_16x16x32_bf16 v[12:15], a[208:211], v[144:147], 0
  v_mfma_f32_16x16x32_bf16 v[12:15], a[212:215], v[148:151], v[12:15]
  v_mfma_f32_16x16x32_bf16 v[12:15], a[216:219], v[152:155], v[12:15]
  v_mfma_f32_16x16x32_bf16 v[12:15], a[220:223], v[156:159], v[12:15]
  v_mfma_f32_16x16x32_bf16 v[16:19], a[192:195], v[160:163], 0
  v_mfma_f32_16x16x32_bf16 v[16:19], a[196:199], v[164:167], v[16:19]
  v_mfma_f32_16x16x32_bf16 v[16:19], a[200:203], v[168:171], v[16:19]
  v_mfma_f32_16x16x32_bf16 v[16:19], a[204:207], v[172:175], v[16:19]
  v_mfma_f32_16x16x32_bf16 v[20:23], a[208:211], v[160:163], 0
  v_mfma_f32_16x16x32_bf16 v[20:23], a[212:215], v[164:167], v[20:23]
  v_mfma_f32_16x16x32_bf16 v[20:23], a[216:219], v[168:171], v[20:23]
  v_mfma_f32_16x16x32_bf16 v[20:23], a[220:223], v[172:175], v[20:23]
  s_nop 7
  v_max3_f32 v212, v0, v1, v212
  v_max3_f32 v212, v2, v3, v212
  v_max3_f32 v212, v4, v5, v212
  v_max3_f32 v212, v6, v7, v212
  v_max3_f32 v213, v8, v9, v213
  v_max3_f32 v213, v10, v11, v213
  v_max3_f32 v213, v12, v13, v213
  v_max3_f32 v213, v14, v15, v213
  v_max3_f32 v214, v16, v17, v214
  v_max3_f32 v214, v18, v19, v214
  v_max3_f32 v214, v20, v21, v214
  v_max3_f32 v214, v22, v23, v214
  ds_read_b128 a[192:195], v232 offset:8448
  ds_read_b128 a[196:199], v232 offset:8512
  ds_read_b128 a[200:203], v232 offset:8576
  ds_read_b128 a[204:207], v232 offset:8640
  ds_read_b128 a[208:211], v232 offset:8960
  ds_read_b128 a[212:215], v232 offset:9024
  ds_read_b128 a[216:219], v232 offset:9088
  ds_read_b128 a[220:223], v232 offset:9152
  s_waitcnt lgkmcnt(0)
  v_mfma_f32_16x16x32_bf16 v[0:3], a[192:195], v[128:131], 0
  v_mfma_f32_16x16x32_bf16 v[0:3], a[196:199], v[132:135], v[0:3]
  v_mfma_f32_16x16x32_bf16 v[0:3], a[200:203], v[136:139], v[0:3]
  v_mfma_f32_16x16x32_bf16 v[0:3], a[204:207], v[140:143], v[0:3]
  v_mfma_f32_16x16x32_bf16 v[4:7], a[208:211], v[128:131], 0
  v_mfma_f32_16x16x32_bf16 v[4:7], a[212:215], v[132:135], v[4:7]
  v_mfma_f32_16x16x32_bf16 v[4:7], a[216:219], v[136:139], v[4:7]
  v_mfma_f32_16x16x32_bf16 v[4:7], a[220:223], v[140:143], v[4:7]
  v_mfma_f32_16x16x32_bf16 v[8:11], a[192:195], v[144:147], 0
  v_mfma_f32_16x16x32_bf16 v[8:11], a[196:199], v[148:151], v[8:11]
  v_mfma_f32_16x16x32_bf16 v[8:11], a[200:203], v[152:155], v[8:11]
  v_mfma_f32_16x16x32_bf16 v[8:11], a[204:207], v[156:159], v[8:11]
  v_mfma_f32_16x16x32_bf16 v[12:15], a[208:211], v[144:147], 0
  v_mfma_f32_16x16x32_bf16 v[12:15], a[212:215], v[148:151], v[12:15]
  v_mfma_f32_16x16x32_bf16 v[12:15], a[216:219], v[152:155], v[12:15]
  v_mfma_f32_16x16x32_bf16 v[12:15], a[220:223], v[156:159], v[12:15]
  v_mfma_f32_16x16x32_bf16 v[16:19], a[192:195], v[160:163], 0
  v_mfma_f32_16x16x32_bf16 v[16:19], a[196:199], v[164:167], v[16:19]
  v_mfma_f32_16x16x32_bf16 v[16:19], a[200:203], v[168:171], v[16:19]
  v_mfma_f32_16x16x32_bf16 v[16:19], a[204:207], v[172:175], v[16:19]
  v_mfma_f32_16x16x32_bf16 v[20:23], a[208:211], v[160:163], 0
  v_mfma_f32_16x16x32_bf16 v[20:23], a[212:215], v[164:167], v[20:23]
  v_mfma_f32_16x16x32_bf16 v[20:23], a[216:219], v[168:171], v[20:23]
  v_mfma_f32_16x16x32_bf16 v[20:23], a[220:223], v[172:175], v[20:23]
  s_nop 7
  v_max3_f32 v212, v0, v1, v212
  v_max3_f32 v212, v2, v3, v212
  v_max3_f32 v212, v4, v5, v212
  v_max3_f32 v212, v6, v7, v212
  v_max3_f32 v213, v8, v9, v213
  v_max3_f32 v213, v10, v11, v213
  v_max3_f32 v213, v12, v13, v213
  v_max3_f32 v213, v14, v15, v213
  v_max3_f32 v214, v16, v17, v214
  v_max3_f32 v214, v18, v19, v214
  v_max3_f32 v214, v20, v21, v214
  v_max3_f32 v214, v22, v23, v214
  s_barrier
  s_add_u32 s46, s46, 16384
  s_cmp_lt_u32 s46, 262144
  s_cbranch_scc1 L_w3_mx
  s_mov_b32 s52, 1
  s_mov_b32 s34, 0
  s_add_u32 m0, s32, 0
  s_nop 0
  buffer_load_dwordx4 v240, s[16:19], s34 offen offset:0 nt lds
  buffer_load_dwordx4 v241, s[16:19], s34 offen offset:1056 nt lds
  buffer_load_dwordx4 v242, s[16:19], s34 offen offset:2112 nt lds
  buffer_load_dwordx4 v243, s[16:19], s34 offen offset:3168 nt lds
  s_mov_b32 s34, 0
  s_add_u32 m0, s32, 16896
  s_nop 0
  buffer_load_dwordx4 v240, s[20:23], s34 offen offset:0 nt lds
  buffer_load_dwordx4 v241, s[20:23], s34 offen offset:1056 nt lds
  buffer_load_dwordx4 v242, s[20:23], s34 offen offset:2112 nt lds
  buffer_load_dwordx4 v243, s[20:23], s34 offen offset:3168 nt lds
  s_mov_b32 s34, 16384
  s_add_u32 m0, s32, 33792
  s_nop 0
  buffer_load_dwordx4 v240, s[16:19], s34 offen offset:0 nt lds
  buffer_load_dwordx4 v241, s[16:19], s34 offen offset:1056 nt lds
  buffer_load_dwordx4 v242, s[16:19], s34 offen offset:2112 nt lds
  buffer_load_dwordx4 v243, s[16:19], s34 offen offset:3168 nt lds
  s_mov_b32 s34, 32768
  s_add_u32 m0, s32, 67584
  s_nop 0
  buffer_load_dwordx4 v240, s[16:19], s34 offen offset:0 nt lds
  buffer_load_dwordx4 v241, s[16:19], s34 offen offset:1056 nt lds
  buffer_load_dwordx4 v242, s[16:19], s34 offen offset:2112 nt lds
  buffer_load_dwordx4 v243, s[16:19], s34 offen offset:3168 nt lds
  s_mov_b32 s34, 16384
  s_add_u32 m0, s32, 50688
  s_nop 0
  buffer_load_dwordx4 v240, s[20:23], s34 offen offset:0 nt lds
  buffer_load_dwordx4 v241, s[20:23], s34 offen offset:1056 nt lds
  buffer_load_dwordx4 v242, s[20:23], s34 offen offset:2112 nt lds
  buffer_load_dwordx4 v243, s[20:23], s34 offen offset:3168 nt lds
  s_lshl_b32 s35, s28, 4
  v_mov_b32 v228, s35
  global_load_dwordx4 v[224:227], v228, s[100:101] sc1
  s_lshr_b32 s97, s29, 3
  s_lshl_b32 s97, s97, 2
  s_add_u32 s35, s35, s97
  v_mov_b32 v228, s35
  global_load_dword v229, v228, s[100:101] sc1
  s_waitcnt vmcnt(0)
  s_barrier
  ds_read_b128 a[192:195], v232 offset:0
  ds_read_b128 a[196:199], v232 offset:64
  ds_read_b128 a[200:203], v232 offset:128
  ds_read_b128 a[204:207], v232 offset:192
  ds_read_b128 a[208:211], v232 offset:512
  ds_read_b128 a[212:215], v232 offset:576
  ds_read_b128 a[216:219], v232 offset:640
  ds_read_b128 a[220:223], v232 offset:704
  s_waitcnt lgkmcnt(0)
  v_mfma_f32_16x16x32_bf16 v[0:3], a[192:195], v[128:131], 0
  v_mfma_f32_16x16x32_bf16 v[0:3], a[196:199], v[132:135], v[0:3]
  v_mfma_f32_16x16x32_bf16 v[0:3], a[200:203], v[136:139], v[0:3]
  v_mfma_f32_16x16x32_bf16 v[0:3], a[204:207], v[140:143], v[0:3]
  v_mfma_f32_16x16x32_bf16 v[4:7], a[208:211], v[128:131], 0
  v_mfma_f32_16x16x32_bf16 v[4:7], a[212:215], v[132:135], v[4:7]
  v_mfma_f32_16x16x32_bf16 v[4:7], a[216:219], v[136:139], v[4:7]
  v_mov_b32 v233, v235
  v_mfma_f32_16x16x32_bf16 v[4:7], a[220:223], v[140:143], v[4:7]
  v_mfma_f32_16x16x32_bf16 v[8:11], a[192:195], v[144:147], 0
  v_mov_b32 v208, 0
  v_mfma_f32_16x16x32_bf16 v[8:11], a[196:199], v[148:151], v[8:11]
  v_max3_f32 v216, v0, v1, v212
  v_max3_f32 v216, v2, v3, v216
  v_mfma_f32_16x16x32_bf16 v[8:11], a[200:203], v[152:155], v[8:11]
  s_mov_b32 s98, 0
  v_mfma_f32_16x16x32_bf16 v[8:11], a[204:207], v[156:159], v[8:11]
  s_mov_b32 s47, 49152
  v_max3_f32 v216, v4, v5, v216
  v_max3_f32 v216, v6, v7, v216
  v_mfma_f32_16x16x32_bf16 v[12:15], a[208:211], v[144:147], 0
  s_mov_b32 s46, 53248
  v_mov_b32 v217, v216
  v_mfma_f32_16x16x32_bf16 v[12:15], a[212:215], v[148:151], v[12:15]
  s_mov_b32 s48, 33792
  v_permlane16_swap_b32 v216, v217
  v_max_f32 v216, v216, v217
  v_mfma_f32_16x16x32_bf16 v[12:15], a[216:219], v[152:155], v[12:15]
  s_mov_b32 s49, 67584
  v_mov_b32 v217, v216
  v_mfma_f32_16x16x32_bf16 v[12:15], a[220:223], v[156:159], v[12:15]
  s_mov_b32 s50, 101376
  v_permlane32_swap_b32 v216, v217
  v_max_f32 v216, v216, v217
  v_mfma_f32_16x16x32_bf16 v[16:19], a[192:195], v[160:163], 0
  s_mov_b32 s51, 0
  ds_read_b128 a[192:195], v232 offset:8448
  v_sub_f32 v192, 0, v216
  v_mfma_f32_16x16x32_bf16 v[16:19], a[196:199], v[164:167], v[16:19]
  s_mov_b32 s40, 0
  ds_read_b128 a[196:199], v232 offset:8512
  v_sub_f32 v193, 0, v216
  v_mfma_f32_16x16x32_bf16 v[16:19], a[200:203], v[168:171], v[16:19]
  s_mov_b32 s41, 33792
  ds_read_b128 a[200:203], v232 offset:8576
  v_sub_f32 v194, 0, v216
  v_mfma_f32_16x16x32_bf16 v[16:19], a[204:207], v[172:175], v[16:19]
  s_mov_b32 s42, 67584
  ds_read_b128 a[204:207], v232 offset:8640
  v_sub_f32 v195, 0, v216
  v_mfma_f32_16x16x32_bf16 v[20:23], a[208:211], v[160:163], 0
  s_mov_b32 s43, 101376
  ds_read_b128 a[208:211], v232 offset:8960
  v_sub_f32 v0, v0, v216
  v_mfma_f32_16x16x32_bf16 v[20:23], a[212:215], v[164:167], v[20:23]
  s_mov_b32 s34, 49152
  ds_read_b128 a[212:215], v232 offset:9024
  v_sub_f32 v1, v1, v216
  v_sub_f32 v2, v2, v216
  v_max3_f32 v218, v8, v9, v213
  v_mov_b32 v209, 0
  v_mfma_f32_16x16x32_bf16 v[20:23], a[216:219], v[168:171], v[20:23]
  s_add_u32 m0, s32, 101376
  ds_read_b128 a[216:219], v232 offset:9088
  v_sub_f32 v3, v3, v216
  v_max3_f32 v218, v10, v11, v218
  v_sub_f32 v4, v4, v216
  v_max3_f32 v218, v12, v13, v218
  v_mfma_f32_16x16x32_bf16 v[20:23], a[220:223], v[172:175], v[20:23]
  s_mov_b32 s7, 118272
  s_waitcnt lgkmcnt(1)
  ds_read_b128 a[220:223], v232 offset:9152
  v_sub_f32 v5, v5, v216
  v_max3_f32 v218, v14, v15, v218
  v_sub_f32 v6, v6, v216
  v_mov_b32 v219, v218
  v_mfma_f32_16x16x32_bf16 v[32:35], a[192:195], v[128:131], v[192:195]
  v_sub_f32 v7, v7, v216
  v_permlane16_swap_b32 v218, v219
  v_max_f32 v218, v218, v219
  v_mfma_f32_16x16x32_bf16 v[32:35], a[196:199], v[132:135], v[32:35]
  v_mov_b32 v219, v218
  v_max3_f32 v220, v16, v17, v214
  v_mfma_f32_16x16x32_bf16 v[32:35], a[200:203], v[136:139], v[32:35]
  v_permlane32_swap_b32 v218, v219
  v_max_f32 v218, v218, v219
  v_sub_f32 v196, 0, v218
  v_mfma_f32_16x16x32_bf16 v[32:35], a[204:207], v[140:143], v[32:35]
  v_sub_f32 v197, 0, v218
  v_sub_f32 v198, 0, v218
  v_mfma_f32_16x16x32_bf16 v[36:39], a[208:211], v[128:131], v[192:195]
  buffer_load_dwordx4 v240, s[16:19], s34 offen offset:0 nt lds
  v_sub_f32 v199, 0, v218
  v_sub_f32 v8, v8, v218
  v_mfma_f32_16x16x32_bf16 v[36:39], a[212:215], v[132:135], v[36:39]
  s_waitcnt lgkmcnt(0)
  v_sub_f32 v9, v9, v218
  v_sub_f32 v10, v10, v218
  v_mov_b32 v210, 0
  v_exp_f32 v0, v0
  v_exp_f32 v1, v1
  v_mfma_f32_16x16x32_bf16 v[36:39], a[216:219], v[136:139], v[36:39]
  v_sub_f32 v11, v11, v218
  v_max3_f32 v220, v18, v19, v220
  v_sub_f32 v12, v12, v218
  v_max3_f32 v220, v20, v21, v220
  v_add_f32 v208, v208, v0
  v_add_f32 v208, v208, v1
  v_cvt_pk_bf16_f32 v64, v0, v1
  v_exp_f32 v2, v2
  v_mfma_f32_16x16x32_bf16 v[36:39], a[220:223], v[140:143], v[36:39]
  buffer_load_dwordx4 v241, s[16:19], s34 offen offset:1056 nt lds
  v_sub_f32 v13, v13, v218
  v_max3_f32 v220, v22, v23, v220
  v_sub_f32 v14, v14, v218
  v_mov_b32 v221, v220
  v_add_f32 v208, v208, v2
  v_exp_f32 v3, v3
  v_mfma_f32_16x16x32_bf16 v[40:43], a[192:195], v[144:147], v[196:199]
  v_sub_f32 v15, v15, v218
  v_permlane16_swap_b32 v220, v221
  v_max_f32 v220, v220, v221
  v_add_f32 v208, v208, v3
  v_cvt_pk_bf16_f32 v65, v2, v3
  v_exp_f32 v4, v4
  v_mfma_f32_16x16x32_bf16 v[40:43], a[196:199], v[148:151], v[40:43]
  v_mov_b32 v221, v220
  v_add_f32 v208, v208, v4
  v_exp_f32 v5, v5
  v_permlane32_swap_b32 v220, v221
  v_mfma_f32_16x16x32_bf16 v[40:43], a[200:203], v[152:155], v[40:43]
  buffer_load_dwordx4 v242, s[16:19], s34 offen offset:2112 nt lds
  v_max_f32 v220, v220, v221
  v_sub_f32 v200, 0, v220
  v_add_f32 v208, v208, v5
  v_cvt_pk_bf16_f32 v66, v4, v5
  v_exp_f32 v6, v6
  v_mfma_f32_16x16x32_bf16 v[40:43], a[204:207], v[156:159], v[40:43]
  v_sub_f32 v201, 0, v220
  v_sub_f32 v202, 0, v220
  v_add_f32 v208, v208, v6
  v_exp_f32 v7, v7
  v_mfma_f32_16x16x32_bf16 v[44:47], a[208:211], v[144:147], v[196:199]
  v_sub_f32 v203, 0, v220
  v_sub_f32 v16, v16, v220
  v_add_f32 v208, v208, v7
  v_cvt_pk_bf16_f32 v67, v6, v7
  v_exp_f32 v8, v8
  v_mfma_f32_16x16x32_bf16 v[44:47], a[212:215], v[148:151], v[44:47]
  buffer_load_dwordx4 v243, s[16:19], s34 offen offset:3168 nt lds
  s_mov_b32 s34, 32768
  s_add_u32 m0, s32, 84480
  v_sub_f32 v17, v17, v220
  v_sub_f32 v18, v18, v220
  v_add_f32 v209, v209, v8
  v_exp_f32 v9, v9
  v_mfma_f32_16x16x32_bf16 v[44:47], a[216:219], v[152:155], v[44:47]
  v_sub_f32 v19, v19, v220
  v_sub_f32 v20, v20, v220
  v_add_f32 v209, v209, v9
  v_cvt_pk_bf16_f32 v68, v8, v9
  v_exp_f32 v10, v10
  v_exp_f32 v11, v11
  v_mfma_f32_16x16x32_bf16 v[44:47], a[220:223], v[156:159], v[44:47]
  v_sub_f32 v21, v21, v220
  v_sub_f32 v22, v22, v220
  v_add_f32 v209, v209, v10
  v_add_f32 v209, v209, v11
  v_cvt_pk_bf16_f32 v69, v10, v11
  v_exp_f32 v12, v12
  v_mfma_f32_16x16x32_bf16 v[48:51], a[192:195], v[160:163], v[200:203]
  buffer_load_dwordx4 v240, s[20:23], s34 offen offset:0 nt lds
  v_sub_f32 v23, v23, v220
  v_add_f32 v209, v209, v12
  v_exp_f32 v13, v13
  v_mfma_f32_16x16x32_bf16 v[48:51], a[196:199], v[164:167], v[48:51]
  v_add_f32 v209, v209, v13
  v_cvt_pk_bf16_f32 v70, v12, v13
  v_exp_f32 v14, v14
  v_mfma_f32_16x16x32_bf16 v[48:51], a[200:203], v[168:171], v[48:51]
  v_add_f32 v209, v209, v14
  v_exp_f32 v15, v15
  v_mfma_f32_16x16x32_bf16 v[48:51], a[204:207], v[172:175], v[48:51]
  v_add_f32 v209, v209, v15
  v_cvt_pk_bf16_f32 v71, v14, v15
  v_exp_f32 v16, v16
  v_mfma_f32_16x16x32_bf16 v[52:55], a[208:211], v[160:163], v[200:203]
  v_add_f32 v210, v210, v16
  v_add_u32 v232, 33792, v234
  v_exp_f32 v17, v17
  v_mfma_f32_16x16x32_bf16 v[52:55], a[212:215], v[164:167], v[52:55]
  buffer_load_dwordx4 v241, s[20:23], s34 offen offset:1056 nt lds
  v_add_f32 v210, v210, v17
  v_cvt_pk_bf16_f32 v72, v16, v17
  v_exp_f32 v18, v18
  v_mfma_f32_16x16x32_bf16 v[52:55], a[216:219], v[168:171], v[52:55]
  v_add_f32 v210, v210, v18
  v_exp_f32 v19, v19
  v_mfma_f32_16x16x32_bf16 v[52:55], a[220:223], v[172:175], v[52:55]
  v_add_f32 v210, v210, v19
  v_cvt_pk_bf16_f32 v73, v18, v19
  v_exp_f32 v20, v20
  v_exp_f32 v21, v21
  buffer_load_dwordx4 v242, s[20:23], s34 offen offset:2112 nt lds
  buffer_load_dwordx4 v243, s[20:23], s34 offen offset:3168 nt lds
  v_add_f32 v210, v210, v20
  v_add_f32 v210, v210, v21
  v_cvt_pk_bf16_f32 v74, v20, v21
  v_exp_f32 v22, v22
  s_nop 0
  v_add_f32 v210, v210, v22
  v_exp_f32 v23, v23
  s_nop 0
  v_add_f32 v210, v210, v23
  v_cvt_pk_bf16_f32 v75, v22, v23
  s_waitcnt vmcnt(8)
  s_barrier
  ds_read_b128 a[192:195], v232 offset:0
  ds_read_b128 a[196:199], v232 offset:64
  ds_read_b128 a[200:203], v232 offset:128
  ds_read_b128 a[204:207], v232 offset:192
  ds_read_b128 a[208:211], v232 offset:512
  ds_read_b128 a[212:215], v232 offset:576
  ds_read_b128 a[216:219], v232 offset:640
  ds_read_b128 a[220:223], v232 offset:704
  s_mov_b32 s95, 53248
  s_mov_b32 m0, 0
  s_nop 0
  buffer_load_dwordx4 v240, s[16:19], s95 offen offset:0 nt lds
  buffer_load_dwordx4 v241, s[16:19], s95 offen offset:1056 nt lds
  buffer_load_dwordx4 v242, s[16:19], s95 offen offset:2112 nt lds
  buffer_load_dwordx4 v243, s[16:19], s95 offen offset:3168 nt lds
  s_waitcnt lgkmcnt(0)
  s_branch L_w3_join
L_w3_end:
  s_branch L_p3
L_p3:
  s_lshl_b32 s33, s28, 1
  s_add_u32 s33, s33, s37
  s_lshl_b32 s34, s33, 20
  s_lshl_b32 s35, s36, 18
  s_add_u32 s34, s34, s35
  s_add_u32 s8, s44, s34
  s_addc_u32 s9, s45, 0
  s_mov_b32 s10, 262144
  s_mov_b32 s11, 0x20000
  s_lshl_b32 s34, s33, 2
  s_add_u32 s34, s34, s38
  s_lshl_b32 s34, s34, 18
  s_add_u32 s34, s34, 0x1000000
  s_add_u32 s16, s44, s34
  s_addc_u32 s17, s45, 0
  s_mov_b32 s18, 262144
  s_mov_b32 s19, 0x20000
  s_lshl_b32 s34, s37, 2
  s_add_u32 s34, s34, s36
  s_lshl_b32 s34, s34, 15
  s_lshl_b32 s35, s38, 8
  s_add_u32 s34, s34, s35
  s_mul_i32 s33, s28, 245760
  s_add_u32 s33, s33, s34
  s_sub_u32 s34, 245760, s34
  s_add_u32 s40, s58, s33
  s_addc_u32 s41, s59, 0
  s_mov_b32 s42, s34
  s_mov_b32 s43, 0x20000
  s_lshl_b32 s48, s3, 12
  v_lshlrev_b32 v108, 4, v239
  s_lshl_b32 s33, s3, 11
  v_add_u32 v104, s33, v108
  v_add_u32 v105, 0x2000, v104
  v_subrev_u32 v109, 16896, v235
  v_add_u32 v110, 50688, v109
  v_add_u32 v111, 101376, v109
  v_and_b32 v97, 15, v239
  v_lshrrev_b32 v98, 4, v239
  v_add_u32 v106, s48, v108
  s_lshl_b32 s33, s3, 11
  v_add_u32 v115, s33, v108
  s_add_u32 s33, s36, 1
  s_and_b32 s33, s33, 3
  s_lshl_b32 s34, s36, 2
  s_add_u32 s33, s33, s34
  s_lshl_b32 s49, s33, 14
  s_add_u32 s33, s36, 2
  s_and_b32 s33, s33, 3
  s_lshl_b32 s34, s36, 2
  s_add_u32 s33, s33, s34
  s_lshl_b32 s50, s33, 14
  s_add_u32 s33, s36, 3
  s_and_b32 s33, s33, 3
  s_lshl_b32 s34, s36, 2
  s_add_u32 s33, s33, s34
  s_lshl_b32 s51, s33, 14
  v_and_b32 v101, 3, v239
  v_max_u32 v101, 1, v101
  v_add_u32 v101, s36, v101
  v_and_b32 v101, 3, v101
  s_lshl_b32 s33, s36, 7
  s_add_u32 s33, s33, s30
  v_lshlrev_b32 v101, 2, v101
  v_add_u32 v114, s33, v101
  s_lshr_b32 s33, s3, 1
  s_lshl_b32 s33, s33, 14
  s_and_b32 s34, s3, 1
  s_lshl_b32 s34, s34, 7
  s_add_u32 s33, s33, s34
  v_lshlrev_b32 v101, 10, v97
  v_lshl_add_u32 v101, v98, 3, v101
  v_add_u32 v107, s33, v101
  s_mov_b32 s99, 0
L_p3_r:
  s_cmp_lg_u32 s97, 0
  s_cbranch_scc1 L_p3_rok
  s_add_u32 s99, s99, 1
  s_cmp_gt_u32 s99, 0x100000
  s_cbranch_scc1 L_p3_rok
  s_lshl_b32 s35, s28, 4
  v_mov_b32 v228, s35
  global_load_dwordx4 v[224:227], v228, s[100:101] sc1
  s_lshr_b32 s97, s29, 3
  s_lshl_b32 s97, s97, 2
  s_add_u32 s35, s35, s97
  v_mov_b32 v228, s35
  global_load_dword v229, v228, s[100:101] sc1
  s_waitcnt vmcnt(0)
  v_and_b32 v224, v224, v225
  v_and_b32 v226, v226, v227
  v_and_b32 v224, v224, v226
  s_nop 0
  v_readfirstlane_b32 s97, v224
  v_readfirstlane_b32 s39, v229
  s_and_b32 s97, s97, 8
  s_getreg_b32 s55, hwreg(HW_REG_XCC_ID, 0, 4)
  s_mul_i32 s54, s55, s55
  s_lshl_b32 s54, s54, 8
  s_add_u32 s54, s54, s55
  s_lshl_b32 s54, s54, 8
  s_add_u32 s54, s54, 1
  s_lshl_b32 s54, s54, 3
  s_cmp_eq_u32 s39, s54
  s_cselect_b32 s39, 1, 0
  s_sleep 8
  s_branch L_p3_r
L_p3_rok:
  s_and_b32 s33, s29, 7
  s_lshl_b32 s33, s33, 2
  s_add_u32 s33, s33, s31
  v_mov_b32 v96, s33
  v_mov_b32 v97, 1
  v_and_b32 v112, 7, v239
  v_lshlrev_b32 v112, 2, v112
  v_add_u32 v112, s31, v112
  s_waitcnt vmcnt(0)
  s_barrier
  s_cmp_lg_u32 s3, 0
  s_cbranch_scc1 L_p3_a
  s_cmp_eq_u32 s39, 1
  s_cbranch_scc1 L_p3_u
  buffer_wbl2 sc1
  s_waitcnt vmcnt(0)
  s_mov_b64 exec, 1
  global_store_dword v96, v97, s[44:45] sc1
  s_mov_b64 exec, -1
  s_branch L_p3_a
L_p3_u:
  s_mov_b64 exec, 1
  global_store_dword v96, v97, s[44:45]
  s_mov_b64 exec, -1
L_p3_a:
  s_lshl_b32 s33, s37, 2
  s_add_u32 s33, s33, s3
  s_cmp_eq_u32 s33, 7
  s_cbranch_scc1 L_g1
L_g2:
  s_add_u32 s92, s94, 0
  s_and_b32 s92, s92, 15
  s_lshl_b32 s92, s92, 14
  buffer_load_dwordx4 a[128:131], v104, s[8:11], s92 offen offset:0
  buffer_load_dwordx4 a[132:135], v104, s[8:11], s92 offen offset:1024
  buffer_load_dwordx4 a[136:139], v105, s[8:11], s92 offen offset:0
  buffer_load_dwordx4 a[140:143], v105, s[8:11], s92 offen offset:1024
  ds_read_b64_tr_b16 a[0:1], v109 offset:0
  ds_read_b64_tr_b16 a[2:3], v109 offset:8448
  ds_read_b64_tr_b16 a[32:33], v109 offset:512
  ds_read_b64_tr_b16 a[34:35], v109 offset:8960
  ds_read_b64_tr_b16 a[4:5], v109 offset:32
  ds_read_b64_tr_b16 a[6:7], v109 offset:8480
  ds_read_b64_tr_b16 a[36:37], v109 offset:544
  ds_read_b64_tr_b16 a[38:39], v109 offset:8992
  ds_read_b64_tr_b16 a[8:9], v109 offset:64
  ds_read_b64_tr_b16 a[10:11], v109 offset:8512
  ds_read_b64_tr_b16 a[40:41], v109 offset:576
  ds_read_b64_tr_b16 a[42:43], v109 offset:9024
  ds_read_b64_tr_b16 a[12:13], v109 offset:96
  ds_read_b64_tr_b16 a[14:15], v109 offset:8544
  ds_read_b64_tr_b16 a[44:45], v109 offset:608
  ds_read_b64_tr_b16 a[46:47], v109 offset:9056
  s_add_u32 s92, s94, 1
  s_and_b32 s92, s92, 15
  s_lshl_b32 s92, s92, 14
  buffer_load_dwordx4 a[144:147], v104, s[8:11], s92 offen offset:0
  buffer_load_dwordx4 a[148:151], v104, s[8:11], s92 offen offset:1024
  buffer_load_dwordx4 a[152:155], v105, s[8:11], s92 offen offset:0
  buffer_load_dwordx4 a[156:159], v105, s[8:11], s92 offen offset:1024
  s_waitcnt vmcnt(4)
  ds_read_b64_tr_b16 a[16:17], v109 offset:128
  s_waitcnt lgkmcnt(6)
  ds_read_b64_tr_b16 a[18:19], v109 offset:8576
  v_mfma_f32_16x16x32_bf16 v[0:3], a[0:3], a[128:131], 0
  s_add_u32 s93, s94, 7
  s_and_b32 s93, s93, 15
  s_lshl_b32 s93, s93, 16
  s_add_u32 m0, s32, 135168
  ds_read_b64_tr_b16 a[48:49], v109 offset:640
  ds_read_b64_tr_b16 a[50:51], v109 offset:9088
  v_mfma_f32_16x16x32_bf16 v[0:3], a[32:35], a[136:139], v[0:3]
  buffer_load_dwordx4 v252, s[12:15], s93 offen offset:0 lds
  ds_read_b64_tr_b16 a[20:21], v109 offset:160
  ds_read_b64_tr_b16 a[22:23], v109 offset:8608
  v_mfma_f32_16x16x32_bf16 v[32:35], a[0:3], a[132:135], 0
  ds_read_b64_tr_b16 a[52:53], v109 offset:672
  ds_read_b64_tr_b16 a[54:55], v109 offset:9120
  v_mfma_f32_16x16x32_bf16 v[32:35], a[32:35], a[140:143], v[32:35]
  ds_read_b64_tr_b16 a[24:25], v109 offset:192
  ds_read_b64_tr_b16 a[26:27], v109 offset:8640
  v_mfma_f32_16x16x32_bf16 v[4:7], a[4:7], a[128:131], 0
  ds_read_b64_tr_b16 a[56:57], v109 offset:704
  ds_read_b64_tr_b16 a[58:59], v109 offset:9152
  v_mfma_f32_16x16x32_bf16 v[4:7], a[36:39], a[136:139], v[4:7]
  buffer_load_dwordx4 v253, s[12:15], s93 offen offset:1056 lds
  ds_read_b64_tr_b16 a[28:29], v109 offset:224
  ds_read_b64_tr_b16 a[30:31], v109 offset:8672
  v_mfma_f32_16x16x32_bf16 v[36:39], a[4:7], a[132:135], 0
  ds_read_b64_tr_b16 a[60:61], v109 offset:736
  ds_read_b64_tr_b16 a[62:63], v109 offset:9184
  v_mfma_f32_16x16x32_bf16 v[36:39], a[36:39], a[140:143], v[36:39]
  v_mfma_f32_16x16x32_bf16 v[8:11], a[8:11], a[128:131], 0
  buffer_load_dwordx4 v254, s[12:15], s93 offen offset:2112 lds
  s_waitcnt lgkmcnt(8)
  v_mfma_f32_16x16x32_bf16 v[8:11], a[40:43], a[136:139], v[8:11]
  ds_read_b64_tr_b16 a[64:65], v109 offset:33792
  ds_read_b64_tr_b16 a[66:67], v109 offset:42240
  v_mfma_f32_16x16x32_bf16 v[40:43], a[8:11], a[132:135], 0
  ds_read_b64_tr_b16 a[96:97], v109 offset:34304
  ds_read_b64_tr_b16 a[98:99], v109 offset:42752
  v_mfma_f32_16x16x32_bf16 v[40:43], a[40:43], a[140:143], v[40:43]
  ds_read_b64_tr_b16 a[68:69], v109 offset:33824
  ds_read_b64_tr_b16 a[70:71], v109 offset:42272
  v_mfma_f32_16x16x32_bf16 v[12:15], a[12:15], a[128:131], 0
  buffer_load_dwordx4 v255, s[12:15], s93 offen offset:3168 lds
  v_mfma_f32_16x16x32_bf16 v[12:15], a[44:47], a[136:139], v[12:15]
  ds_read_b64_tr_b16 a[100:101], v109 offset:34336
  ds_read_b64_tr_b16 a[102:103], v109 offset:42784
  v_mfma_f32_16x16x32_bf16 v[44:47], a[12:15], a[132:135], 0
  ds_read_b64_tr_b16 a[72:73], v109 offset:33856
  ds_read_b64_tr_b16 a[74:75], v109 offset:42304
  v_mfma_f32_16x16x32_bf16 v[44:47], a[44:47], a[140:143], v[44:47]
  ds_read_b64_tr_b16 a[104:105], v109 offset:34368
  ds_read_b64_tr_b16 a[106:107], v109 offset:42816
  v_mfma_f32_16x16x32_bf16 v[16:19], a[16:19], a[128:131], 0
  global_load_dword v113, v112, s[44:45] sc1
  s_add_u32 s93, s94, 8
  s_and_b32 s93, s93, 15
  v_mfma_f32_16x16x32_bf16 v[16:19], a[48:51], a[136:139], v[16:19]
  s_lshl_b32 s93, s93, 16
  ds_read_b64_tr_b16 a[76:77], v109 offset:33888
  ds_read_b64_tr_b16 a[78:79], v109 offset:42336
  v_mfma_f32_16x16x32_bf16 v[48:51], a[16:19], a[132:135], 0
  s_add_u32 m0, s32, 16896
  ds_read_b64_tr_b16 a[108:109], v109 offset:34400
  ds_read_b64_tr_b16 a[110:111], v109 offset:42848
  v_mfma_f32_16x16x32_bf16 v[48:51], a[48:51], a[140:143], v[48:51]
  buffer_load_dwordx4 v252, s[12:15], s93 offen offset:0 lds
  v_mfma_f32_16x16x32_bf16 v[20:23], a[20:23], a[128:131], 0
  ds_read_b64_tr_b16 a[80:81], v109 offset:33920
  v_mfma_f32_16x16x32_bf16 v[20:23], a[52:55], a[136:139], v[20:23]
  ds_read_b64_tr_b16 a[82:83], v109 offset:42368
  ds_read_b64_tr_b16 a[112:113], v109 offset:34432
  v_mfma_f32_16x16x32_bf16 v[52:55], a[20:23], a[132:135], 0
  ds_read_b64_tr_b16 a[114:115], v109 offset:42880
  ds_read_b64_tr_b16 a[84:85], v109 offset:33952
  v_mfma_f32_16x16x32_bf16 v[52:55], a[52:55], a[140:143], v[52:55]
  buffer_load_dwordx4 v253, s[12:15], s93 offen offset:1056 lds
  s_waitcnt lgkmcnt(7)
  v_mfma_f32_16x16x32_bf16 v[24:27], a[24:27], a[128:131], 0
  ds_read_b64_tr_b16 a[86:87], v109 offset:42400
  ds_read_b64_tr_b16 a[116:117], v109 offset:34464
  v_mfma_f32_16x16x32_bf16 v[24:27], a[56:59], a[136:139], v[24:27]
  ds_read_b64_tr_b16 a[118:119], v109 offset:42912
  ds_read_b64_tr_b16 a[88:89], v109 offset:33984
  v_mfma_f32_16x16x32_bf16 v[56:59], a[24:27], a[132:135], 0
  buffer_load_dwordx4 v254, s[12:15], s93 offen offset:2112 lds
  v_mfma_f32_16x16x32_bf16 v[56:59], a[56:59], a[140:143], v[56:59]
  ds_read_b64_tr_b16 a[90:91], v109 offset:42432
  ds_read_b64_tr_b16 a[120:121], v109 offset:34496
  v_mfma_f32_16x16x32_bf16 v[28:31], a[28:31], a[128:131], 0
  ds_read_b64_tr_b16 a[122:123], v109 offset:42944
  ds_read_b64_tr_b16 a[92:93], v109 offset:34016
  v_mfma_f32_16x16x32_bf16 v[28:31], a[60:63], a[136:139], v[28:31]
  ds_read_b64_tr_b16 a[94:95], v109 offset:42464
  ds_read_b64_tr_b16 a[124:125], v109 offset:34528
  v_mfma_f32_16x16x32_bf16 v[60:63], a[28:31], a[132:135], 0
  buffer_load_dwordx4 v255, s[12:15], s93 offen offset:3168 lds
  v_mfma_f32_16x16x32_bf16 v[60:63], a[60:63], a[140:143], v[60:63]
  ds_read_b64_tr_b16 a[126:127], v109 offset:42976
  s_waitcnt vmcnt(4)
L_g2_pl:
  v_cmp_ne_u32 vcc, 1, v113
  s_mov_b32 s34, 0
  s_cbranch_vccz L_g2_pok
L_g2_pl2:
  s_sleep 1
  global_load_dword v113, v112, s[44:45] sc1
  s_waitcnt vmcnt(0)
  v_cmp_ne_u32 vcc, 1, v113
  s_add_u32 s34, s34, 1
  s_cbranch_vccz L_g2_pok
  s_cmp_lt_u32 s34, 0x200000
  s_cbranch_scc1 L_g2_pl2
L_g2_pok:
  s_cmp_eq_u32 s39, 1
  s_cbranch_scc1 L_g2_pgo
  buffer_inv sc1
  s_waitcnt vmcnt(0)
L_g2_pgo:
  s_waitcnt vmcnt(9)
  v_mfma_f32_16x16x32_bf16 v[0:3], a[64:67], a[144:147], v[0:3]
  s_add_u32 s92, s94, 2
  s_and_b32 s92, s92, 15
  s_lshl_b32 s92, s92, 14
  v_mfma_f32_16x16x32_bf16 v[0:3], a[96:99], a[152:155], v[0:3]
  buffer_load_dwordx4 a[160:163], v104, s[8:11], s92 offen offset:0
  v_mfma_f32_16x16x32_bf16 v[32:35], a[64:67], a[148:151], v[32:35]
  ds_read_b64_tr_b16 a[0:1], v110 offset:0
  ds_read_b64_tr_b16 a[2:3], v110 offset:8448
  v_mfma_f32_16x16x32_bf16 v[32:35], a[96:99], a[156:159], v[32:35]
  buffer_load_dwordx4 a[164:167], v104, s[8:11], s92 offen offset:1024
  v_mfma_f32_16x16x32_bf16 v[4:7], a[68:71], a[144:147], v[4:7]
  ds_read_b64_tr_b16 a[32:33], v110 offset:512
  ds_read_b64_tr_b16 a[34:35], v110 offset:8960
  v_mfma_f32_16x16x32_bf16 v[4:7], a[100:103], a[152:155], v[4:7]
  ds_read_b64_tr_b16 a[4:5], v110 offset:32
  ds_read_b64_tr_b16 a[6:7], v110 offset:8480
  v_mfma_f32_16x16x32_bf16 v[36:39], a[68:71], a[148:151], v[36:39]
  buffer_load_dwordx4 a[168:171], v105, s[8:11], s92 offen offset:0
  v_mfma_f32_16x16x32_bf16 v[36:39], a[100:103], a[156:159], v[36:39]
  ds_read_b64_tr_b16 a[36:37], v110 offset:544
  v_mfma_f32_16x16x32_bf16 v[8:11], a[72:75], a[144:147], v[8:11]
  buffer_load_dwordx4 a[172:175], v105, s[8:11], s92 offen offset:1024
  s_add_u32 s92, s94, 3
  v_mfma_f32_16x16x32_bf16 v[8:11], a[104:107], a[152:155], v[8:11]
  s_and_b32 s92, s92, 15
  ds_read_b64_tr_b16 a[38:39], v110 offset:8992
  ds_read_b64_tr_b16 a[8:9], v110 offset:64
  v_mfma_f32_16x16x32_bf16 v[40:43], a[72:75], a[148:151], v[40:43]
  s_lshl_b32 s92, s92, 14
  ds_read_b64_tr_b16 a[10:11], v110 offset:8512
  ds_read_b64_tr_b16 a[40:41], v110 offset:576
  v_mfma_f32_16x16x32_bf16 v[40:43], a[104:107], a[156:159], v[40:43]
  buffer_load_dwordx4 a[176:179], v104, s[8:11], s92 offen offset:0
  v_mfma_f32_16x16x32_bf16 v[12:15], a[76:79], a[144:147], v[12:15]
  s_waitcnt lgkmcnt(4)
  ds_read_b64_tr_b16 a[42:43], v110 offset:9024
  v_mfma_f32_16x16x32_bf16 v[12:15], a[108:111], a[152:155], v[12:15]
  buffer_load_dwordx4 a[180:183], v104, s[8:11], s92 offen offset:1024
  v_mfma_f32_16x16x32_bf16 v[44:47], a[76:79], a[148:151], v[44:47]
  ds_read_b64_tr_b16 a[12:13], v110 offset:96
  ds_read_b64_tr_b16 a[14:15], v110 offset:8544
  v_mfma_f32_16x16x32_bf16 v[44:47], a[108:111], a[156:159], v[44:47]
  ds_read_b64_tr_b16 a[44:45], v110 offset:608
  ds_read_b64_tr_b16 a[46:47], v110 offset:9056
  v_mfma_f32_16x16x32_bf16 v[16:19], a[80:83], a[144:147], v[16:19]
  buffer_load_dwordx4 a[184:187], v105, s[8:11], s92 offen offset:0
  v_mfma_f32_16x16x32_bf16 v[16:19], a[112:115], a[152:155], v[16:19]
  ds_read_b64_tr_b16 a[16:17], v110 offset:128
  v_mfma_f32_16x16x32_bf16 v[48:51], a[80:83], a[148:151], v[48:51]
  buffer_load_dwordx4 a[188:191], v105, s[8:11], s92 offen offset:1024
  s_add_u32 s92, s94, 4
  v_mfma_f32_16x16x32_bf16 v[48:51], a[112:115], a[156:159], v[48:51]
  s_and_b32 s92, s92, 15
  ds_read_b64_tr_b16 a[18:19], v110 offset:8576
  ds_read_b64_tr_b16 a[48:49], v110 offset:640
  v_mfma_f32_16x16x32_bf16 v[20:23], a[84:87], a[144:147], v[20:23]
  s_lshl_b32 s92, s92, 14
  ds_read_b64_tr_b16 a[50:51], v110 offset:9088
  ds_read_b64_tr_b16 a[20:21], v110 offset:160
  v_mfma_f32_16x16x32_bf16 v[20:23], a[116:119], a[152:155], v[20:23]
  buffer_load_dwordx4 a[192:195], v104, s[8:11], s92 offen offset:0
  v_mfma_f32_16x16x32_bf16 v[52:55], a[84:87], a[148:151], v[52:55]
  ds_read_b64_tr_b16 a[22:23], v110 offset:8608
  v_mfma_f32_16x16x32_bf16 v[52:55], a[116:119], a[156:159], v[52:55]
  buffer_load_dwordx4 a[196:199], v104, s[8:11], s92 offen offset:1024
  v_mfma_f32_16x16x32_bf16 v[24:27], a[88:91], a[144:147], v[24:27]
  ds_read_b64_tr_b16 a[52:53], v110 offset:672
  ds_read_b64_tr_b16 a[54:55], v110 offset:9120
  v_mfma_f32_16x16x32_bf16 v[24:27], a[120:123], a[152:155], v[24:27]
  ds_read_b64_tr_b16 a[24:25], v110 offset:192
  ds_read_b64_tr_b16 a[26:27], v110 offset:8640
  v_mfma_f32_16x16x32_bf16 v[56:59], a[88:91], a[148:151], v[56:59]
  buffer_load_dwordx4 a[200:203], v105, s[8:11], s92 offen offset:0
  v_mfma_f32_16x16x32_bf16 v[56:59], a[120:123], a[156:159], v[56:59]
  ds_read_b64_tr_b16 a[56:57], v110 offset:704
  v_mfma_f32_16x16x32_bf16 v[28:31], a[92:95], a[144:147], v[28:31]
  buffer_load_dwordx4 a[204:207], v105, s[8:11], s92 offen offset:1024
  v_mfma_f32_16x16x32_bf16 v[28:31], a[124:127], a[152:155], v[28:31]
  ds_read_b64_tr_b16 a[58:59], v110 offset:9152
  ds_read_b64_tr_b16 a[28:29], v110 offset:224
  v_mfma_f32_16x16x32_bf16 v[60:63], a[92:95], a[148:151], v[60:63]
  ds_read_b64_tr_b16 a[30:31], v110 offset:8672
  ds_read_b64_tr_b16 a[60:61], v110 offset:736
  v_mfma_f32_16x16x32_bf16 v[60:63], a[124:127], a[156:159], v[60:63]
  s_waitcnt vmcnt(8)
  ds_read_b64_tr_b16 a[62:63], v110 offset:9184
  v_mfma_f32_16x16x32_bf16 v[0:3], a[0:3], a[160:163], v[0:3]
  s_barrier
  s_add_u32 s92, s94, 5
  s_and_b32 s92, s92, 15
  s_lshl_b32 s92, s92, 14
  v_mfma_f32_16x16x32_bf16 v[0:3], a[32:35], a[168:171], v[0:3]
  buffer_load_dwordx4 a[208:211], v104, s[8:11], s92 offen offset:0
  v_mfma_f32_16x16x32_bf16 v[32:35], a[0:3], a[164:167], v[32:35]
  ds_read_b64_tr_b16 a[64:65], v110 offset:16896
  ds_read_b64_tr_b16 a[66:67], v110 offset:25344
  v_mfma_f32_16x16x32_bf16 v[32:35], a[32:35], a[172:175], v[32:35]
  ds_read_b64_tr_b16 a[96:97], v110 offset:17408
  ds_read_b64_tr_b16 a[98:99], v110 offset:25856
  v_mfma_f32_16x16x32_bf16 v[4:7], a[4:7], a[160:163], v[4:7]
  buffer_load_dwordx4 a[212:215], v104, s[8:11], s92 offen offset:1024
  s_waitcnt lgkmcnt(4)
  v_mfma_f32_16x16x32_bf16 v[4:7], a[36:39], a[168:171], v[4:7]
  ds_read_b64_tr_b16 a[68:69], v110 offset:16928
  v_mfma_f32_16x16x32_bf16 v[36:39], a[4:7], a[164:167], v[36:39]
  ds_read_b64_tr_b16 a[70:71], v110 offset:25376
  ds_read_b64_tr_b16 a[100:101], v110 offset:17440
  v_mfma_f32_16x16x32_bf16 v[36:39], a[36:39], a[172:175], v[36:39]
  buffer_load_dwordx4 a[216:219], v105, s[8:11], s92 offen offset:0
  v_mfma_f32_16x16x32_bf16 v[8:11], a[8:11], a[160:163], v[8:11]
  ds_read_b64_tr_b16 a[102:103], v110 offset:25888
  v_mfma_f32_16x16x32_bf16 v[8:11], a[40:43], a[168:171], v[8:11]
  ds_read_b64_tr_b16 a[72:73], v110 offset:16960
  ds_read_b64_tr_b16 a[74:75], v110 offset:25408
  v_mfma_f32_16x16x32_bf16 v[40:43], a[8:11], a[164:167], v[40:43]
  buffer_load_dwordx4 a[220:223], v105, s[8:11], s92 offen offset:1024
  s_add_u32 s92, s94, 6
  v_mfma_f32_16x16x32_bf16 v[40:43], a[40:43], a[172:175], v[40:43]
  s_and_b32 s92, s92, 15
  ds_read_b64_tr_b16 a[104:105], v110 offset:17472
  ds_read_b64_tr_b16 a[106:107], v110 offset:25920
  v_mfma_f32_16x16x32_bf16 v[12:15], a[12:15], a[160:163], v[12:15]
  s_lshl_b32 s92, s92, 14
  ds_read_b64_tr_b16 a[76:77], v110 offset:16992
  v_mfma_f32_16x16x32_bf16 v[12:15], a[44:47], a[168:171], v[12:15]
  buffer_load_dwordx4 a[224:227], v104, s[8:11], s92 offen offset:0
  v_mfma_f32_16x16x32_bf16 v[44:47], a[12:15], a[164:167], v[44:47]
  ds_read_b64_tr_b16 a[78:79], v110 offset:25440
  ds_read_b64_tr_b16 a[108:109], v110 offset:17504
  v_mfma_f32_16x16x32_bf16 v[44:47], a[44:47], a[172:175], v[44:47]
  ds_read_b64_tr_b16 a[110:111], v110 offset:25952
  v_mfma_f32_16x16x32_bf16 v[16:19], a[16:19], a[160:163], v[16:19]
  buffer_load_dwordx4 a[228:231], v104, s[8:11], s92 offen offset:1024
  v_mfma_f32_16x16x32_bf16 v[16:19], a[48:51], a[168:171], v[16:19]
  ds_read_b64_tr_b16 a[80:81], v110 offset:17024
  ds_read_b64_tr_b16 a[82:83], v110 offset:25472
  v_mfma_f32_16x16x32_bf16 v[48:51], a[16:19], a[164:167], v[48:51]
  buffer_load_dwordx4 a[232:235], v105, s[8:11], s92 offen offset:0
  v_mfma_f32_16x16x32_bf16 v[48:51], a[48:51], a[172:175], v[48:51]
  ds_read_b64_tr_b16 a[112:113], v110 offset:17536
  ds_read_b64_tr_b16 a[114:115], v110 offset:25984
  v_mfma_f32_16x16x32_bf16 v[20:23], a[20:23], a[160:163], v[20:23]
  ds_read_b64_tr_b16 a[84:85], v110 offset:17056
  v_mfma_f32_16x16x32_bf16 v[20:23], a[52:55], a[168:171], v[20:23]
  buffer_load_dwordx4 a[236:239], v105, s[8:11], s92 offen offset:1024
  s_add_u32 s93, s94, 9
  s_and_b32 s93, s93, 15
  v_mfma_f32_16x16x32_bf16 v[52:55], a[20:23], a[164:167], v[52:55]
  s_lshl_b32 s93, s93, 16
  ds_read_b64_tr_b16 a[86:87], v110 offset:25504
  ds_read_b64_tr_b16 a[116:117], v110 offset:17568
  v_mfma_f32_16x16x32_bf16 v[52:55], a[52:55], a[172:175], v[52:55]
  s_add_u32 m0, s32, 0
  ds_read_b64_tr_b16 a[118:119], v110 offset:26016
  v_mfma_f32_16x16x32_bf16 v[24:27], a[24:27], a[160:163], v[24:27]
  buffer_load_dwordx4 v252, s[12:15], s93 offen offset:0 lds
  v_mfma_f32_16x16x32_bf16 v[24:27], a[56:59], a[168:171], v[24:27]
  ds_read_b64_tr_b16 a[88:89], v110 offset:17088
  ds_read_b64_tr_b16 a[90:91], v110 offset:25536
  v_mfma_f32_16x16x32_bf16 v[56:59], a[24:27], a[164:167], v[56:59]
  ds_read_b64_tr_b16 a[120:121], v110 offset:17600
  ds_read_b64_tr_b16 a[122:123], v110 offset:26048
  v_mfma_f32_16x16x32_bf16 v[56:59], a[56:59], a[172:175], v[56:59]
  buffer_load_dwordx4 v253, s[12:15], s93 offen offset:1056 lds
  v_mfma_f32_16x16x32_bf16 v[28:31], a[28:31], a[160:163], v[28:31]
  ds_read_b64_tr_b16 a[92:93], v110 offset:17120
  v_mfma_f32_16x16x32_bf16 v[28:31], a[60:63], a[168:171], v[28:31]
  ds_read_b64_tr_b16 a[94:95], v110 offset:25568
  ds_read_b64_tr_b16 a[124:125], v110 offset:17632
  v_mfma_f32_16x16x32_bf16 v[60:63], a[28:31], a[164:167], v[60:63]
  buffer_load_dwordx4 v254, s[12:15], s93 offen offset:2112 lds
  v_mfma_f32_16x16x32_bf16 v[60:63], a[60:63], a[172:175], v[60:63]
  s_waitcnt vmcnt(15)
  s_waitcnt lgkmcnt(5)
  ds_read_b64_tr_b16 a[126:127], v110 offset:26080
  v_mfma_f32_16x16x32_bf16 v[0:3], a[64:67], a[176:179], v[0:3]
  s_add_u32 s92, s94, 7
  s_and_b32 s92, s92, 15
  v_mfma_f32_16x16x32_bf16 v[0:3], a[96:99], a[184:187], v[0:3]
  s_lshl_b32 s92, s92, 14
  ds_read_b64_tr_b16 a[0:1], v110 offset:33792
  ds_read_b64_tr_b16 a[2:3], v110 offset:42240
  v_mfma_f32_16x16x32_bf16 v[32:35], a[64:67], a[180:183], v[32:35]
  buffer_load_dwordx4 a[240:243], v104, s[8:11], s92 offen offset:0
  v_mfma_f32_16x16x32_bf16 v[32:35], a[96:99], a[188:191], v[32:35]
  ds_read_b64_tr_b16 a[32:33], v110 offset:34304
  v_mfma_f32_16x16x32_bf16 v[4:7], a[68:71], a[176:179], v[4:7]
  ds_read_b64_tr_b16 a[34:35], v110 offset:42752
  v_mfma_f32_16x16x32_bf16 v[4:7], a[100:103], a[184:187], v[4:7]
  ds_read_b64_tr_b16 a[4:5], v110 offset:33824
  ds_read_b64_tr_b16 a[6:7], v110 offset:42272
  v_mfma_f32_16x16x32_bf16 v[36:39], a[68:71], a[180:183], v[36:39]
  buffer_load_dwordx4 a[244:247], v104, s[8:11], s92 offen offset:1024
  v_mfma_f32_16x16x32_bf16 v[36:39], a[100:103], a[188:191], v[36:39]
  ds_read_b64_tr_b16 a[36:37], v110 offset:34336
  v_mfma_f32_16x16x32_bf16 v[8:11], a[72:75], a[176:179], v[8:11]
  ds_read_b64_tr_b16 a[38:39], v110 offset:42784
  v_mfma_f32_16x16x32_bf16 v[8:11], a[104:107], a[184:187], v[8:11]
  ds_read_b64_tr_b16 a[8:9], v110 offset:33856
  ds_read_b64_tr_b16 a[10:11], v110 offset:42304
  v_mfma_f32_16x16x32_bf16 v[40:43], a[72:75], a[180:183], v[40:43]
  ds_read_b64_tr_b16 a[40:41], v110 offset:34368
  v_mfma_f32_16x16x32_bf16 v[40:43], a[104:107], a[188:191], v[40:43]
  buffer_load_dwordx4 a[248:251], v105, s[8:11], s92 offen offset:0
  v_mfma_f32_16x16x32_bf16 v[12:15], a[76:79], a[176:179], v[12:15]
  ds_read_b64_tr_b16 a[42:43], v110 offset:42816
  v_mfma_f32_16x16x32_bf16 v[12:15], a[108:111], a[184:187], v[12:15]
  ds_read_b64_tr_b16 a[12:13], v110 offset:33888
  ds_read_b64_tr_b16 a[14:15], v110 offset:42336
  v_mfma_f32_16x16x32_bf16 v[44:47], a[76:79], a[180:183], v[44:47]
  ds_read_b64_tr_b16 a[44:45], v110 offset:34400
  v_mfma_f32_16x16x32_bf16 v[44:47], a[108:111], a[188:191], v[44:47]
  ds_read_b64_tr_b16 a[46:47], v110 offset:42848
  v_mfma_f32_16x16x32_bf16 v[16:19], a[80:83], a[176:179], v[16:19]
  buffer_load_dwordx4 a[252:255], v105, s[8:11], s92 offen offset:1024
  v_mfma_f32_16x16x32_bf16 v[16:19], a[112:115], a[184:187], v[16:19]
  ds_read_b64_tr_b16 a[16:17], v110 offset:33920
  ds_read_b64_tr_b16 a[18:19], v110 offset:42368
  v_mfma_f32_16x16x32_bf16 v[48:51], a[80:83], a[180:183], v[48:51]
  ds_read_b64_tr_b16 a[48:49], v110 offset:34432
  v_mfma_f32_16x16x32_bf16 v[48:51], a[112:115], a[188:191], v[48:51]
  s_add_u32 m0, s32, 0
  ds_read_b64_tr_b16 a[50:51], v110 offset:42880
  v_mfma_f32_16x16x32_bf16 v[20:23], a[84:87], a[176:179], v[20:23]
  buffer_load_dwordx4 v255, s[12:15], s93 offen offset:3168 lds
  v_mfma_f32_16x16x32_bf16 v[20:23], a[116:119], a[184:187], v[20:23]
  s_add_u32 s93, s94, 10
  ds_read_b64_tr_b16 a[20:21], v110 offset:33952
  ds_read_b64_tr_b16 a[22:23], v110 offset:42400
  v_mfma_f32_16x16x32_bf16 v[52:55], a[84:87], a[180:183], v[52:55]
  s_and_b32 s93, s93, 15
  ds_read_b64_tr_b16 a[52:53], v110 offset:34464
  v_mfma_f32_16x16x32_bf16 v[52:55], a[116:119], a[188:191], v[52:55]
  s_lshl_b32 s93, s93, 16
  ds_read_b64_tr_b16 a[54:55], v110 offset:42912
  v_mfma_f32_16x16x32_bf16 v[24:27], a[88:91], a[176:179], v[24:27]
  s_add_u32 m0, s32, 33792
  ds_read_b64_tr_b16 a[24:25], v110 offset:33984
  s_waitcnt lgkmcnt(5)
  ds_read_b64_tr_b16 a[26:27], v110 offset:42432
  v_mfma_f32_16x16x32_bf16 v[24:27], a[120:123], a[184:187], v[24:27]
  buffer_load_dwordx4 v252, s[12:15], s93 offen offset:0 lds
  v_mfma_f32_16x16x32_bf16 v[56:59], a[88:91], a[180:183], v[56:59]
  ds_read_b64_tr_b16 a[56:57], v110 offset:34496
  v_mfma_f32_16x16x32_bf16 v[56:59], a[120:123], a[188:191], v[56:59]
  ds_read_b64_tr_b16 a[58:59], v110 offset:42944
  v_mfma_f32_16x16x32_bf16 v[28:31], a[92:95], a[176:179], v[28:31]
  ds_read_b64_tr_b16 a[28:29], v110 offset:34016
  ds_read_b64_tr_b16 a[30:31], v110 offset:42464
  v_mfma_f32_16x16x32_bf16 v[28:31], a[124:127], a[184:187], v[28:31]
  buffer_load_dwordx4 v253, s[12:15], s93 offen offset:1056 lds
  v_mfma_f32_16x16x32_bf16 v[60:63], a[92:95], a[180:183], v[60:63]
  ds_read_b64_tr_b16 a[60:61], v110 offset:34528
  v_mfma_f32_16x16x32_bf16 v[60:63], a[124:127], a[188:191], v[60:63]
  s_waitcnt vmcnt(18)
  ds_read_b64_tr_b16 a[62:63], v110 offset:42976
  v_mfma_f32_16x16x32_bf16 v[0:3], a[0:3], a[192:195], v[0:3]
  s_barrier
  s_add_u32 s92, s94, 8
  s_and_b32 s92, s92, 15
  v_mfma_f32_16x16x32_bf16 v[0:3], a[32:35], a[200:203], v[0:3]
  s_lshl_b32 s92, s92, 14
  ds_read_b64_tr_b16 a[64:65], v111 offset:0
  ds_read_b64_tr_b16 a[66:67], v111 offset:8448
  v_mfma_f32_16x16x32_bf16 v[32:35], a[0:3], a[196:199], v[32:35]
  buffer_load_dwordx4 a[128:131], v104, s[8:11], s92 offen offset:0
  v_mfma_f32_16x16x32_bf16 v[32:35], a[32:35], a[204:207], v[32:35]
  ds_read_b64_tr_b16 a[96:97], v111 offset:512
  v_mfma_f32_16x16x32_bf16 v[4:7], a[4:7], a[192:195], v[4:7]
  ds_read_b64_tr_b16 a[98:99], v111 offset:8960
  v_mfma_f32_16x16x32_bf16 v[4:7], a[36:39], a[200:203], v[4:7]
  ds_read_b64_tr_b16 a[68:69], v111 offset:32
  ds_read_b64_tr_b16 a[70:71], v111 offset:8480
  v_mfma_f32_16x16x32_bf16 v[36:39], a[4:7], a[196:199], v[36:39]
  buffer_load_dwordx4 a[132:135], v104, s[8:11], s92 offen offset:1024
  v_mfma_f32_16x16x32_bf16 v[36:39], a[36:39], a[204:207], v[36:39]
  ds_read_b64_tr_b16 a[100:101], v111 offset:544
  v_mfma_f32_16x16x32_bf16 v[8:11], a[8:11], a[192:195], v[8:11]
  ds_read_b64_tr_b16 a[102:103], v111 offset:8992
  v_mfma_f32_16x16x32_bf16 v[8:11], a[40:43], a[200:203], v[8:11]
  ds_read_b64_tr_b16 a[72:73], v111 offset:64
  ds_read_b64_tr_b16 a[74:75], v111 offset:8512
  v_mfma_f32_16x16x32_bf16 v[40:43], a[8:11], a[196:199], v[40:43]
  ds_read_b64_tr_b16 a[104:105], v111 offset:576
  v_mfma_f32_16x16x32_bf16 v[40:43], a[40:43], a[204:207], v[40:43]
  buffer_load_dwordx4 a[136:139], v105, s[8:11], s92 offen offset:0
  v_mfma_f32_16x16x32_bf16 v[12:15], a[12:15], a[192:195], v[12:15]
  ds_read_b64_tr_b16 a[106:107], v111 offset:9024
  v_mfma_f32_16x16x32_bf16 v[12:15], a[44:47], a[200:203], v[12:15]
  ds_read_b64_tr_b16 a[76:77], v111 offset:96
  ds_read_b64_tr_b16 a[78:79], v111 offset:8544
  v_mfma_f32_16x16x32_bf16 v[44:47], a[12:15], a[196:199], v[44:47]
  ds_read_b64_tr_b16 a[108:109], v111 offset:608
  v_mfma_f32_16x16x32_bf16 v[44:47], a[44:47], a[204:207], v[44:47]
  ds_read_b64_tr_b16 a[110:111], v111 offset:9056
  v_mfma_f32_16x16x32_bf16 v[16:19], a[16:19], a[192:195], v[16:19]
  buffer_load_dwordx4 a[140:143], v105, s[8:11], s92 offen offset:1024
  v_mfma_f32_16x16x32_bf16 v[16:19], a[48:51], a[200:203], v[16:19]
  ds_read_b64_tr_b16 a[80:81], v111 offset:128
  ds_read_b64_tr_b16 a[82:83], v111 offset:8576
  v_mfma_f32_16x16x32_bf16 v[48:51], a[16:19], a[196:199], v[48:51]
  ds_read_b64_tr_b16 a[112:113], v111 offset:640
  v_mfma_f32_16x16x32_bf16 v[48:51], a[48:51], a[204:207], v[48:51]
  s_add_u32 m0, s32, 33792
  s_waitcnt lgkmcnt(6)
  ds_read_b64_tr_b16 a[114:115], v111 offset:9088
  v_mfma_f32_16x16x32_bf16 v[20:23], a[20:23], a[192:195], v[20:23]
  buffer_load_dwordx4 v254, s[12:15], s93 offen offset:2112 lds
  v_mfma_f32_16x16x32_bf16 v[20:23], a[52:55], a[200:203], v[20:23]
  ds_read_b64_tr_b16 a[84:85], v111 offset:160
  ds_read_b64_tr_b16 a[86:87], v111 offset:8608
  v_mfma_f32_16x16x32_bf16 v[52:55], a[20:23], a[196:199], v[52:55]
  ds_read_b64_tr_b16 a[116:117], v111 offset:672
  v_mfma_f32_16x16x32_bf16 v[52:55], a[52:55], a[204:207], v[52:55]
  ds_read_b64_tr_b16 a[118:119], v111 offset:9120
  v_mfma_f32_16x16x32_bf16 v[24:27], a[24:27], a[192:195], v[24:27]
  ds_read_b64_tr_b16 a[88:89], v111 offset:192
  ds_read_b64_tr_b16 a[90:91], v111 offset:8640
  v_mfma_f32_16x16x32_bf16 v[24:27], a[56:59], a[200:203], v[24:27]
  buffer_load_dwordx4 v255, s[12:15], s93 offen offset:3168 lds
  s_add_u32 s93, s94, 11
  v_mfma_f32_16x16x32_bf16 v[56:59], a[24:27], a[196:199], v[56:59]
  s_and_b32 s93, s93, 15
  ds_read_b64_tr_b16 a[120:121], v111 offset:704
  v_mfma_f32_16x16x32_bf16 v[56:59], a[56:59], a[204:207], v[56:59]
  s_lshl_b32 s93, s93, 16
  ds_read_b64_tr_b16 a[122:123], v111 offset:9152
  v_mfma_f32_16x16x32_bf16 v[28:31], a[28:31], a[192:195], v[28:31]
  s_add_u32 m0, s32, 50688
  ds_read_b64_tr_b16 a[92:93], v111 offset:224
  ds_read_b64_tr_b16 a[94:95], v111 offset:8672
  v_mfma_f32_16x16x32_bf16 v[28:31], a[60:63], a[200:203], v[28:31]
  buffer_load_dwordx4 v252, s[12:15], s93 offen offset:0 lds
  v_mfma_f32_16x16x32_bf16 v[60:63], a[28:31], a[196:199], v[60:63]
  ds_read_b64_tr_b16 a[124:125], v111 offset:736
  v_mfma_f32_16x16x32_bf16 v[60:63], a[60:63], a[204:207], v[60:63]
  s_waitcnt vmcnt(21)
  ds_read_b64_tr_b16 a[126:127], v111 offset:9184
  v_mfma_f32_16x16x32_bf16 v[0:3], a[64:67], a[208:211], v[0:3]
  s_add_u32 s92, s94, 9
  s_and_b32 s92, s92, 15
  v_mfma_f32_16x16x32_bf16 v[0:3], a[96:99], a[216:219], v[0:3]
  s_lshl_b32 s92, s92, 14
  ds_read_b64_tr_b16 a[0:1], v111 offset:16896
  ds_read_b64_tr_b16 a[2:3], v111 offset:25344
  v_mfma_f32_16x16x32_bf16 v[32:35], a[64:67], a[212:215], v[32:35]
  buffer_load_dwordx4 a[144:147], v104, s[8:11], s92 offen offset:0
  v_mfma_f32_16x16x32_bf16 v[32:35], a[96:99], a[220:223], v[32:35]
  ds_read_b64_tr_b16 a[32:33], v111 offset:17408
  v_mfma_f32_16x16x32_bf16 v[4:7], a[68:71], a[208:211], v[4:7]
  ds_read_b64_tr_b16 a[34:35], v111 offset:25856
  v_mfma_f32_16x16x32_bf16 v[4:7], a[100:103], a[216:219], v[4:7]
  ds_read_b64_tr_b16 a[4:5], v111 offset:16928
  ds_read_b64_tr_b16 a[6:7], v111 offset:25376
  v_mfma_f32_16x16x32_bf16 v[36:39], a[68:71], a[212:215], v[36:39]
  buffer_load_dwordx4 a[148:151], v104, s[8:11], s92 offen offset:1024
  v_mfma_f32_16x16x32_bf16 v[36:39], a[100:103], a[220:223], v[36:39]
  ds_read_b64_tr_b16 a[36:37], v111 offset:17440
  v_mfma_f32_16x16x32_bf16 v[8:11], a[72:75], a[208:211], v[8:11]
  ds_read_b64_tr_b16 a[38:39], v111 offset:25888
  v_mfma_f32_16x16x32_bf16 v[8:11], a[104:107], a[216:219], v[8:11]
  ds_read_b64_tr_b16 a[8:9], v111 offset:16960
  ds_read_b64_tr_b16 a[10:11], v111 offset:25408
  v_mfma_f32_16x16x32_bf16 v[40:43], a[72:75], a[212:215], v[40:43]
  ds_read_b64_tr_b16 a[40:41], v111 offset:17472
  v_mfma_f32_16x16x32_bf16 v[40:43], a[104:107], a[220:223], v[40:43]
  buffer_load_dwordx4 a[152:155], v105, s[8:11], s92 offen offset:0
  s_waitcnt lgkmcnt(7)
  v_mfma_f32_16x16x32_bf16 v[12:15], a[76:79], a[208:211], v[12:15]
  ds_read_b64_tr_b16 a[42:43], v111 offset:25920
  v_mfma_f32_16x16x32_bf16 v[12:15], a[108:111], a[216:219], v[12:15]
  ds_read_b64_tr_b16 a[12:13], v111 offset:16992
  ds_read_b64_tr_b16 a[14:15], v111 offset:25440
  v_mfma_f32_16x16x32_bf16 v[44:47], a[76:79], a[212:215], v[44:47]
  ds_read_b64_tr_b16 a[44:45], v111 offset:17504
  v_mfma_f32_16x16x32_bf16 v[44:47], a[108:111], a[220:223], v[44:47]
  ds_read_b64_tr_b16 a[46:47], v111 offset:25952
  v_mfma_f32_16x16x32_bf16 v[16:19], a[80:83], a[208:211], v[16:19]
  buffer_load_dwordx4 a[156:159], v105, s[8:11], s92 offen offset:1024
  v_mfma_f32_16x16x32_bf16 v[16:19], a[112:115], a[216:219], v[16:19]
  ds_read_b64_tr_b16 a[16:17], v111 offset:17024
  ds_read_b64_tr_b16 a[18:19], v111 offset:25472
  v_mfma_f32_16x16x32_bf16 v[48:51], a[80:83], a[212:215], v[48:51]
  ds_read_b64_tr_b16 a[48:49], v111 offset:17536
  v_mfma_f32_16x16x32_bf16 v[48:51], a[112:115], a[220:223], v[48:51]
  s_add_u32 m0, s32, 50688
  ds_read_b64_tr_b16 a[50:51], v111 offset:25984
  v_mfma_f32_16x16x32_bf16 v[20:23], a[84:87], a[208:211], v[20:23]
  buffer_load_dwordx4 v253, s[12:15], s93 offen offset:1056 lds
  v_mfma_f32_16x16x32_bf16 v[20:23], a[116:119], a[216:219], v[20:23]
  ds_read_b64_tr_b16 a[20:21], v111 offset:17056
  ds_read_b64_tr_b16 a[22:23], v111 offset:25504
  v_mfma_f32_16x16x32_bf16 v[52:55], a[84:87], a[212:215], v[52:55]
  ds_read_b64_tr_b16 a[52:53], v111 offset:17568
  v_mfma_f32_16x16x32_bf16 v[52:55], a[116:119], a[220:223], v[52:55]
  ds_read_b64_tr_b16 a[54:55], v111 offset:26016
  v_mfma_f32_16x16x32_bf16 v[24:27], a[88:91], a[208:211], v[24:27]
  ds_read_b64_tr_b16 a[24:25], v111 offset:17088
  ds_read_b64_tr_b16 a[26:27], v111 offset:25536
  v_mfma_f32_16x16x32_bf16 v[24:27], a[120:123], a[216:219], v[24:27]
  buffer_load_dwordx4 v254, s[12:15], s93 offen offset:2112 lds
  v_mfma_f32_16x16x32_bf16 v[56:59], a[88:91], a[212:215], v[56:59]
  ds_read_b64_tr_b16 a[56:57], v111 offset:17600
  v_mfma_f32_16x16x32_bf16 v[56:59], a[120:123], a[220:223], v[56:59]
  ds_read_b64_tr_b16 a[58:59], v111 offset:26048
  v_mfma_f32_16x16x32_bf16 v[28:31], a[92:95], a[208:211], v[28:31]
  ds_read_b64_tr_b16 a[28:29], v111 offset:17120
  ds_read_b64_tr_b16 a[30:31], v111 offset:25568
  v_mfma_f32_16x16x32_bf16 v[28:31], a[124:127], a[216:219], v[28:31]
  buffer_load_dwordx4 v255, s[12:15], s93 offen offset:3168 lds
  v_mfma_f32_16x16x32_bf16 v[60:63], a[92:95], a[212:215], v[60:63]
  ds_read_b64_tr_b16 a[60:61], v111 offset:17632
  v_mfma_f32_16x16x32_bf16 v[60:63], a[124:127], a[220:223], v[60:63]
  s_waitcnt vmcnt(24)
  ds_read_b64_tr_b16 a[62:63], v111 offset:26080
  v_mfma_f32_16x16x32_bf16 v[0:3], a[0:3], a[224:227], v[0:3]
  s_barrier
  s_add_u32 s92, s94, 10
  s_and_b32 s92, s92, 15
  v_mfma_f32_16x16x32_bf16 v[0:3], a[32:35], a[232:235], v[0:3]
  s_lshl_b32 s92, s92, 14
  ds_read_b64_tr_b16 a[64:65], v111 offset:33792
  ds_read_b64_tr_b16 a[66:67], v111 offset:42240
  v_mfma_f32_16x16x32_bf16 v[32:35], a[0:3], a[228:231], v[32:35]
  buffer_load_dwordx4 a[160:163], v104, s[8:11], s92 offen offset:0
  v_mfma_f32_16x16x32_bf16 v[32:35], a[32:35], a[236:239], v[32:35]
  s_waitcnt lgkmcnt(3)
  ds_read_b64_tr_b16 a[96:97], v111 offset:34304
  v_mfma_f32_16x16x32_bf16 v[4:7], a[4:7], a[224:227], v[4:7]
  ds_read_b64_tr_b16 a[98:99], v111 offset:42752
  v_mfma_f32_16x16x32_bf16 v[4:7], a[36:39], a[232:235], v[4:7]
  ds_read_b64_tr_b16 a[68:69], v111 offset:33824
  ds_read_b64_tr_b16 a[70:71], v111 offset:42272
  v_mfma_f32_16x16x32_bf16 v[36:39], a[4:7], a[228:231], v[36:39]
  buffer_load_dwordx4 a[164:167], v104, s[8:11], s92 offen offset:1024
  v_mfma_f32_16x16x32_bf16 v[36:39], a[36:39], a[236:239], v[36:39]
  ds_read_b64_tr_b16 a[100:101], v111 offset:34336
  v_mfma_f32_16x16x32_bf16 v[8:11], a[8:11], a[224:227], v[8:11]
  ds_read_b64_tr_b16 a[102:103], v111 offset:42784
  v_mfma_f32_16x16x32_bf16 v[8:11], a[40:43], a[232:235], v[8:11]
  ds_read_b64_tr_b16 a[72:73], v111 offset:33856
  ds_read_b64_tr_b16 a[74:75], v111 offset:42304
  v_mfma_f32_16x16x32_bf16 v[40:43], a[8:11], a[228:231], v[40:43]
  ds_read_b64_tr_b16 a[104:105], v111 offset:34368
  v_mfma_f32_16x16x32_bf16 v[40:43], a[40:43], a[236:239], v[40:43]
  buffer_load_dwordx4 a[168:171], v105, s[8:11], s92 offen offset:0
  v_mfma_f32_16x16x32_bf16 v[12:15], a[12:15], a[224:227], v[12:15]
  ds_read_b64_tr_b16 a[106:107], v111 offset:42816
  v_mfma_f32_16x16x32_bf16 v[12:15], a[44:47], a[232:235], v[12:15]
  ds_read_b64_tr_b16 a[76:77], v111 offset:33888
  ds_read_b64_tr_b16 a[78:79], v111 offset:42336
  v_mfma_f32_16x16x32_bf16 v[44:47], a[12:15], a[228:231], v[44:47]
  ds_read_b64_tr_b16 a[108:109], v111 offset:34400
  v_mfma_f32_16x16x32_bf16 v[44:47], a[44:47], a[236:239], v[44:47]
  ds_read_b64_tr_b16 a[110:111], v111 offset:42848
  v_mfma_f32_16x16x32_bf16 v[16:19], a[16:19], a[224:227], v[16:19]
  buffer_load_dwordx4 a[172:175], v105, s[8:11], s92 offen offset:1024
  s_add_u32 s93, s94, 12
  v_mfma_f32_16x16x32_bf16 v[16:19], a[48:51], a[232:235], v[16:19]
  s_and_b32 s93, s93, 15
  ds_read_b64_tr_b16 a[80:81], v111 offset:33920
  ds_read_b64_tr_b16 a[82:83], v111 offset:42368
  v_mfma_f32_16x16x32_bf16 v[48:51], a[16:19], a[228:231], v[48:51]
  s_lshl_b32 s93, s93, 16
  ds_read_b64_tr_b16 a[112:113], v111 offset:34432
  v_mfma_f32_16x16x32_bf16 v[48:51], a[48:51], a[236:239], v[48:51]
  s_add_u32 m0, s32, 67584
  ds_read_b64_tr_b16 a[114:115], v111 offset:42880
  v_mfma_f32_16x16x32_bf16 v[20:23], a[20:23], a[224:227], v[20:23]
  buffer_load_dwordx4 v252, s[12:15], s93 offen offset:0 lds
  v_mfma_f32_16x16x32_bf16 v[20:23], a[52:55], a[232:235], v[20:23]
  ds_read_b64_tr_b16 a[84:85], v111 offset:33952
  ds_read_b64_tr_b16 a[86:87], v111 offset:42400
  v_mfma_f32_16x16x32_bf16 v[52:55], a[20:23], a[228:231], v[52:55]
  ds_read_b64_tr_b16 a[116:117], v111 offset:34464
  v_mfma_f32_16x16x32_bf16 v[52:55], a[52:55], a[236:239], v[52:55]
  ds_read_b64_tr_b16 a[118:119], v111 offset:42912
  v_mfma_f32_16x16x32_bf16 v[24:27], a[24:27], a[224:227], v[24:27]
  ds_read_b64_tr_b16 a[88:89], v111 offset:33984
  ds_read_b64_tr_b16 a[90:91], v111 offset:42432
  v_mfma_f32_16x16x32_bf16 v[24:27], a[56:59], a[232:235], v[24:27]
  buffer_load_dwordx4 v253, s[12:15], s93 offen offset:1056 lds
  v_mfma_f32_16x16x32_bf16 v[56:59], a[24:27], a[228:231], v[56:59]
  ds_read_b64_tr_b16 a[120:121], v111 offset:34496
  v_mfma_f32_16x16x32_bf16 v[56:59], a[56:59], a[236:239], v[56:59]
  ds_read_b64_tr_b16 a[122:123], v111 offset:42944
  v_mfma_f32_16x16x32_bf16 v[28:31], a[28:31], a[224:227], v[28:31]
  ds_read_b64_tr_b16 a[92:93], v111 offset:34016
  s_waitcnt lgkmcnt(7)
  ds_read_b64_tr_b16 a[94:95], v111 offset:42464
  v_mfma_f32_16x16x32_bf16 v[28:31], a[60:63], a[232:235], v[28:31]
  buffer_load_dwordx4 v254, s[12:15], s93 offen offset:2112 lds
  v_mfma_f32_16x16x32_bf16 v[60:63], a[28:31], a[228:231], v[60:63]
  ds_read_b64_tr_b16 a[124:125], v111 offset:34528
  v_mfma_f32_16x16x32_bf16 v[60:63], a[60:63], a[236:239], v[60:63]
  s_waitcnt vmcnt(24)
  ds_read_b64_tr_b16 a[126:127], v111 offset:42976
  v_mfma_f32_16x16x32_bf16 v[0:3], a[64:67], a[240:243], v[0:3]
  s_add_u32 s92, s94, 11
  s_and_b32 s92, s92, 15
  v_mfma_f32_16x16x32_bf16 v[0:3], a[96:99], a[248:251], v[0:3]
  s_lshl_b32 s92, s92, 14
  ds_read_b64_tr_b16 a[0:1], v109 offset:16896
  ds_read_b64_tr_b16 a[2:3], v109 offset:25344
  v_mfma_f32_16x16x32_bf16 v[32:35], a[64:67], a[244:247], v[32:35]
  buffer_load_dwordx4 a[176:179], v104, s[8:11], s92 offen offset:0
  v_mfma_f32_16x16x32_bf16 v[32:35], a[96:99], a[252:255], v[32:35]
  ds_read_b64_tr_b16 a[32:33], v109 offset:17408
  v_mfma_f32_16x16x32_bf16 v[4:7], a[68:71], a[240:243], v[4:7]
  ds_read_b64_tr_b16 a[34:35], v109 offset:25856
  v_mfma_f32_16x16x32_bf16 v[4:7], a[100:103], a[248:251], v[4:7]
  ds_read_b64_tr_b16 a[4:5], v109 offset:16928
  ds_read_b64_tr_b16 a[6:7], v109 offset:25376
  v_mfma_f32_16x16x32_bf16 v[36:39], a[68:71], a[244:247], v[36:39]
  buffer_load_dwordx4 a[180:183], v104, s[8:11], s92 offen offset:1024
  v_mfma_f32_16x16x32_bf16 v[36:39], a[100:103], a[252:255], v[36:39]
  ds_read_b64_tr_b16 a[36:37], v109 offset:17440
  v_mfma_f32_16x16x32_bf16 v[8:11], a[72:75], a[240:243], v[8:11]
  ds_read_b64_tr_b16 a[38:39], v109 offset:25888
  v_mfma_f32_16x16x32_bf16 v[8:11], a[104:107], a[248:251], v[8:11]
  ds_read_b64_tr_b16 a[8:9], v109 offset:16960
  ds_read_b64_tr_b16 a[10:11], v109 offset:25408
  v_mfma_f32_16x16x32_bf16 v[40:43], a[72:75], a[244:247], v[40:43]
  ds_read_b64_tr_b16 a[40:41], v109 offset:17472
  v_mfma_f32_16x16x32_bf16 v[40:43], a[104:107], a[252:255], v[40:43]
  buffer_load_dwordx4 a[184:187], v105, s[8:11], s92 offen offset:0
  v_mfma_f32_16x16x32_bf16 v[12:15], a[76:79], a[240:243], v[12:15]
  ds_read_b64_tr_b16 a[42:43], v109 offset:25920
  v_mfma_f32_16x16x32_bf16 v[12:15], a[108:111], a[248:251], v[12:15]
  ds_read_b64_tr_b16 a[12:13], v109 offset:16992
  ds_read_b64_tr_b16 a[14:15], v109 offset:25440
  v_mfma_f32_16x16x32_bf16 v[44:47], a[76:79], a[244:247], v[44:47]
  ds_read_b64_tr_b16 a[44:45], v109 offset:17504
  v_mfma_f32_16x16x32_bf16 v[44:47], a[108:111], a[252:255], v[44:47]
  ds_read_b64_tr_b16 a[46:47], v109 offset:25952
  v_mfma_f32_16x16x32_bf16 v[16:19], a[80:83], a[240:243], v[16:19]
  buffer_load_dwordx4 a[188:191], v105, s[8:11], s92 offen offset:1024
  v_mfma_f32_16x16x32_bf16 v[16:19], a[112:115], a[248:251], v[16:19]
  ds_read_b64_tr_b16 a[16:17], v109 offset:17024
  ds_read_b64_tr_b16 a[18:19], v109 offset:25472
  v_mfma_f32_16x16x32_bf16 v[48:51], a[80:83], a[244:247], v[48:51]
  ds_read_b64_tr_b16 a[48:49], v109 offset:17536
  v_mfma_f32_16x16x32_bf16 v[48:51], a[112:115], a[252:255], v[48:51]
  s_add_u32 m0, s32, 67584
  ds_read_b64_tr_b16 a[50:51], v109 offset:25984
  v_mfma_f32_16x16x32_bf16 v[20:23], a[84:87], a[240:243], v[20:23]
  buffer_load_dwordx4 v255, s[12:15], s93 offen offset:3168 lds
  s_waitcnt lgkmcnt(6)
  v_mfma_f32_16x16x32_bf16 v[20:23], a[116:119], a[248:251], v[20:23]
  s_add_u32 s93, s94, 13
  ds_read_b64_tr_b16 a[20:21], v109 offset:17056
  ds_read_b64_tr_b16 a[22:23], v109 offset:25504
  v_mfma_f32_16x16x32_bf16 v[52:55], a[84:87], a[244:247], v[52:55]
  s_and_b32 s93, s93, 15
  ds_read_b64_tr_b16 a[52:53], v109 offset:17568
  v_mfma_f32_16x16x32_bf16 v[52:55], a[116:119], a[252:255], v[52:55]
  s_lshl_b32 s93, s93, 16
  ds_read_b64_tr_b16 a[54:55], v109 offset:26016
  v_mfma_f32_16x16x32_bf16 v[24:27], a[88:91], a[240:243], v[24:27]
  s_add_u32 m0, s32, 84480
  ds_read_b64_tr_b16 a[24:25], v109 offset:17088
  ds_read_b64_tr_b16 a[26:27], v109 offset:25536
  v_mfma_f32_16x16x32_bf16 v[24:27], a[120:123], a[248:251], v[24:27]
  buffer_load_dwordx4 v252, s[12:15], s93 offen offset:0 lds
  v_mfma_f32_16x16x32_bf16 v[56:59], a[88:91], a[244:247], v[56:59]
  ds_read_b64_tr_b16 a[56:57], v109 offset:17600
  v_mfma_f32_16x16x32_bf16 v[56:59], a[120:123], a[252:255], v[56:59]
  ds_read_b64_tr_b16 a[58:59], v109 offset:26048
  v_mfma_f32_16x16x32_bf16 v[28:31], a[92:95], a[240:243], v[28:31]
  ds_read_b64_tr_b16 a[28:29], v109 offset:17120
  ds_read_b64_tr_b16 a[30:31], v109 offset:25568
  v_mfma_f32_16x16x32_bf16 v[28:31], a[124:127], a[248:251], v[28:31]
  buffer_load_dwordx4 v253, s[12:15], s93 offen offset:1056 lds
  v_mfma_f32_16x16x32_bf16 v[60:63], a[92:95], a[244:247], v[60:63]
  ds_read_b64_tr_b16 a[60:61], v109 offset:17632
  v_mfma_f32_16x16x32_bf16 v[60:63], a[124:127], a[252:255], v[60:63]
  s_waitcnt vmcnt(22)
  ds_read_b64_tr_b16 a[62:63], v109 offset:26080
  v_mfma_f32_16x16x32_bf16 v[0:3], a[0:3], a[128:131], v[0:3]
  s_barrier
  s_add_u32 s92, s94, 12
  s_and_b32 s92, s92, 15
  v_mfma_f32_16x16x32_bf16 v[0:3], a[32:35], a[136:139], v[0:3]
  s_lshl_b32 s92, s92, 14
  ds_read_b64_tr_b16 a[64:65], v109 offset:0
  ds_read_b64_tr_b16 a[66:67], v109 offset:8448
  v_mfma_f32_16x16x32_bf16 v[32:35], a[0:3], a[132:135], v[32:35]
  buffer_load_dwordx4 a[192:195], v104, s[8:11], s92 offen offset:0
  v_mfma_f32_16x16x32_bf16 v[32:35], a[32:35], a[140:143], v[32:35]
  ds_read_b64_tr_b16 a[96:97], v109 offset:512
  v_mfma_f32_16x16x32_bf16 v[4:7], a[4:7], a[128:131], v[4:7]
  ds_read_b64_tr_b16 a[98:99], v109 offset:8960
  v_mfma_f32_16x16x32_bf16 v[4:7], a[36:39], a[136:139], v[4:7]
  ds_read_b64_tr_b16 a[68:69], v109 offset:32
  ds_read_b64_tr_b16 a[70:71], v109 offset:8480
  v_mfma_f32_16x16x32_bf16 v[36:39], a[4:7], a[132:135], v[36:39]
  buffer_load_dwordx4 a[196:199], v104, s[8:11], s92 offen offset:1024
  v_mfma_f32_16x16x32_bf16 v[36:39], a[36:39], a[140:143], v[36:39]
  ds_read_b64_tr_b16 a[100:101], v109 offset:544
  v_mfma_f32_16x16x32_bf16 v[8:11], a[8:11], a[128:131], v[8:11]
  ds_read_b64_tr_b16 a[102:103], v109 offset:8992
  v_mfma_f32_16x16x32_bf16 v[8:11], a[40:43], a[136:139], v[8:11]
  ds_read_b64_tr_b16 a[72:73], v109 offset:64
  ds_read_b64_tr_b16 a[74:75], v109 offset:8512
  v_mfma_f32_16x16x32_bf16 v[40:43], a[8:11], a[132:135], v[40:43]
  ds_read_b64_tr_b16 a[104:105], v109 offset:576
  v_mfma_f32_16x16x32_bf16 v[40:43], a[40:43], a[140:143], v[40:43]
  buffer_load_dwordx4 a[200:203], v105, s[8:11], s92 offen offset:0
  v_mfma_f32_16x16x32_bf16 v[12:15], a[12:15], a[128:131], v[12:15]
  s_waitcnt lgkmcnt(5)
  ds_read_b64_tr_b16 a[106:107], v109 offset:9024
  v_mfma_f32_16x16x32_bf16 v[12:15], a[44:47], a[136:139], v[12:15]
  ds_read_b64_tr_b16 a[76:77], v109 offset:96
  ds_read_b64_tr_b16 a[78:79], v109 offset:8544
  v_mfma_f32_16x16x32_bf16 v[44:47], a[12:15], a[132:135], v[44:47]
  ds_read_b64_tr_b16 a[108:109], v109 offset:608
  v_mfma_f32_16x16x32_bf16 v[44:47], a[44:47], a[140:143], v[44:47]
  ds_read_b64_tr_b16 a[110:111], v109 offset:9056
  v_mfma_f32_16x16x32_bf16 v[16:19], a[16:19], a[128:131], v[16:19]
  buffer_load_dwordx4 a[204:207], v105, s[8:11], s92 offen offset:1024
  v_mfma_f32_16x16x32_bf16 v[16:19], a[48:51], a[136:139], v[16:19]
  ds_read_b64_tr_b16 a[80:81], v109 offset:128
  ds_read_b64_tr_b16 a[82:83], v109 offset:8576
  v_mfma_f32_16x16x32_bf16 v[48:51], a[16:19], a[132:135], v[48:51]
  ds_read_b64_tr_b16 a[112:113], v109 offset:640
  v_mfma_f32_16x16x32_bf16 v[48:51], a[48:51], a[140:143], v[48:51]
  s_add_u32 m0, s32, 84480
  ds_read_b64_tr_b16 a[114:115], v109 offset:9088
  v_mfma_f32_16x16x32_bf16 v[20:23], a[20:23], a[128:131], v[20:23]
  buffer_load_dwordx4 v254, s[12:15], s93 offen offset:2112 lds
  v_mfma_f32_16x16x32_bf16 v[20:23], a[52:55], a[136:139], v[20:23]
  ds_read_b64_tr_b16 a[84:85], v109 offset:160
  ds_read_b64_tr_b16 a[86:87], v109 offset:8608
  v_mfma_f32_16x16x32_bf16 v[52:55], a[20:23], a[132:135], v[52:55]
  ds_read_b64_tr_b16 a[116:117], v109 offset:672
  v_mfma_f32_16x16x32_bf16 v[52:55], a[52:55], a[140:143], v[52:55]
  ds_read_b64_tr_b16 a[118:119], v109 offset:9120
  v_mfma_f32_16x16x32_bf16 v[24:27], a[24:27], a[128:131], v[24:27]
  ds_read_b64_tr_b16 a[88:89], v109 offset:192
  ds_read_b64_tr_b16 a[90:91], v109 offset:8640
  v_mfma_f32_16x16x32_bf16 v[24:27], a[56:59], a[136:139], v[24:27]
  buffer_load_dwordx4 v255, s[12:15], s93 offen offset:3168 lds
  s_add_u32 s93, s94, 14
  v_mfma_f32_16x16x32_bf16 v[56:59], a[24:27], a[132:135], v[56:59]
  s_and_b32 s93, s93, 15
  ds_read_b64_tr_b16 a[120:121], v109 offset:704
  v_mfma_f32_16x16x32_bf16 v[56:59], a[56:59], a[140:143], v[56:59]
  s_lshl_b32 s93, s93, 16
  ds_read_b64_tr_b16 a[122:123], v109 offset:9152
  v_mfma_f32_16x16x32_bf16 v[28:31], a[28:31], a[128:131], v[28:31]
  s_add_u32 m0, s32, 101376
  ds_read_b64_tr_b16 a[92:93], v109 offset:224
  ds_read_b64_tr_b16 a[94:95], v109 offset:8672
  v_mfma_f32_16x16x32_bf16 v[28:31], a[60:63], a[136:139], v[28:31]
  buffer_load_dwordx4 v252, s[12:15], s93 offen offset:0 lds
  v_mfma_f32_16x16x32_bf16 v[60:63], a[28:31], a[132:135], v[60:63]
  ds_read_b64_tr_b16 a[124:125], v109 offset:736
  v_mfma_f32_16x16x32_bf16 v[60:63], a[60:63], a[140:143], v[60:63]
  s_waitcnt vmcnt(24)
  ds_read_b64_tr_b16 a[126:127], v109 offset:9184
  v_mfma_f32_16x16x32_bf16 v[0:3], a[64:67], a[144:147], v[0:3]
  s_add_u32 s92, s94, 13
  s_and_b32 s92, s92, 15
  v_mfma_f32_16x16x32_bf16 v[0:3], a[96:99], a[152:155], v[0:3]
  s_lshl_b32 s92, s92, 14
  ds_read_b64_tr_b16 a[0:1], v109 offset:33792
  ds_read_b64_tr_b16 a[2:3], v109 offset:42240
  v_mfma_f32_16x16x32_bf16 v[32:35], a[64:67], a[148:151], v[32:35]
  buffer_load_dwordx4 a[208:211], v104, s[8:11], s92 offen offset:0
  v_mfma_f32_16x16x32_bf16 v[32:35], a[96:99], a[156:159], v[32:35]
  ds_read_b64_tr_b16 a[32:33], v109 offset:34304
  v_mfma_f32_16x16x32_bf16 v[4:7], a[68:71], a[144:147], v[4:7]
  s_waitcnt lgkmcnt(4)
  ds_read_b64_tr_b16 a[34:35], v109 offset:42752
  v_mfma_f32_16x16x32_bf16 v[4:7], a[100:103], a[152:155], v[4:7]
  ds_read_b64_tr_b16 a[4:5], v109 offset:33824
  ds_read_b64_tr_b16 a[6:7], v109 offset:42272
  v_mfma_f32_16x16x32_bf16 v[36:39], a[68:71], a[148:151], v[36:39]
  buffer_load_dwordx4 a[212:215], v104, s[8:11], s92 offen offset:1024
  v_mfma_f32_16x16x32_bf16 v[36:39], a[100:103], a[156:159], v[36:39]
  ds_read_b64_tr_b16 a[36:37], v109 offset:34336
  v_mfma_f32_16x16x32_bf16 v[8:11], a[72:75], a[144:147], v[8:11]
  ds_read_b64_tr_b16 a[38:39], v109 offset:42784
  v_mfma_f32_16x16x32_bf16 v[8:11], a[104:107], a[152:155], v[8:11]
  ds_read_b64_tr_b16 a[8:9], v109 offset:33856
  ds_read_b64_tr_b16 a[10:11], v109 offset:42304
  v_mfma_f32_16x16x32_bf16 v[40:43], a[72:75], a[148:151], v[40:43]
  ds_read_b64_tr_b16 a[40:41], v109 offset:34368
  v_mfma_f32_16x16x32_bf16 v[40:43], a[104:107], a[156:159], v[40:43]
  buffer_load_dwordx4 a[216:219], v105, s[8:11], s92 offen offset:0
  v_mfma_f32_16x16x32_bf16 v[12:15], a[76:79], a[144:147], v[12:15]
  ds_read_b64_tr_b16 a[42:43], v109 offset:42816
  v_mfma_f32_16x16x32_bf16 v[12:15], a[108:111], a[152:155], v[12:15]
  ds_read_b64_tr_b16 a[12:13], v109 offset:33888
  ds_read_b64_tr_b16 a[14:15], v109 offset:42336
  v_mfma_f32_16x16x32_bf16 v[44:47], a[76:79], a[148:151], v[44:47]
  ds_read_b64_tr_b16 a[44:45], v109 offset:34400
  v_mfma_f32_16x16x32_bf16 v[44:47], a[108:111], a[156:159], v[44:47]
  ds_read_b64_tr_b16 a[46:47], v109 offset:42848
  v_mfma_f32_16x16x32_bf16 v[16:19], a[80:83], a[144:147], v[16:19]
  buffer_load_dwordx4 a[220:223], v105, s[8:11], s92 offen offset:1024
  v_mfma_f32_16x16x32_bf16 v[16:19], a[112:115], a[152:155], v[16:19]
  ds_read_b64_tr_b16 a[16:17], v109 offset:33920
  ds_read_b64_tr_b16 a[18:19], v109 offset:42368
  v_mfma_f32_16x16x32_bf16 v[48:51], a[80:83], a[148:151], v[48:51]
  ds_read_b64_tr_b16 a[48:49], v109 offset:34432
  v_mfma_f32_16x16x32_bf16 v[48:51], a[112:115], a[156:159], v[48:51]
  s_add_u32 m0, s32, 101376
  ds_read_b64_tr_b16 a[50:51], v109 offset:42880
  v_mfma_f32_16x16x32_bf16 v[20:23], a[84:87], a[144:147], v[20:23]
  buffer_load_dwordx4 v253, s[12:15], s93 offen offset:1056 lds
  v_mfma_f32_16x16x32_bf16 v[20:23], a[116:119], a[152:155], v[20:23]
  ds_read_b64_tr_b16 a[20:21], v109 offset:33952
  ds_read_b64_tr_b16 a[22:23], v109 offset:42400
  v_mfma_f32_16x16x32_bf16 v[52:55], a[84:87], a[148:151], v[52:55]
  ds_read_b64_tr_b16 a[52:53], v109 offset:34464
  v_mfma_f32_16x16x32_bf16 v[52:55], a[116:119], a[156:159], v[52:55]
  ds_read_b64_tr_b16 a[54:55], v109 offset:42912
  v_mfma_f32_16x16x32_bf16 v[24:27], a[88:91], a[144:147], v[24:27]
  ds_read_b64_tr_b16 a[24:25], v109 offset:33984
  ds_read_b64_tr_b16 a[26:27], v109 offset:42432
  v_mfma_f32_16x16x32_bf16 v[24:27], a[120:123], a[152:155], v[24:27]
  buffer_load_dwordx4 v254, s[12:15], s93 offen offset:2112 lds
  v_mfma_f32_16x16x32_bf16 v[56:59], a[88:91], a[148:151], v[56:59]
  ds_read_b64_tr_b16 a[56:57], v109 offset:34496
  v_mfma_f32_16x16x32_bf16 v[56:59], a[120:123], a[156:159], v[56:59]
  ds_read_b64_tr_b16 a[58:59], v109 offset:42944
  v_mfma_f32_16x16x32_bf16 v[28:31], a[92:95], a[144:147], v[28:31]
  ds_read_b64_tr_b16 a[28:29], v109 offset:34016
  s_waitcnt lgkmcnt(7)
  ds_read_b64_tr_b16 a[30:31], v109 offset:42464
  v_mfma_f32_16x16x32_bf16 v[28:31], a[124:127], a[152:155], v[28:31]
  buffer_load_dwordx4 v255, s[12:15], s93 offen offset:3168 lds
  v_mfma_f32_16x16x32_bf16 v[60:63], a[92:95], a[148:151], v[60:63]
  ds_read_b64_tr_b16 a[60:61], v109 offset:34528
  v_mfma_f32_16x16x32_bf16 v[60:63], a[124:127], a[156:159], v[60:63]
  s_waitcnt vmcnt(16)
  ds_read_b64_tr_b16 a[62:63], v109 offset:42976
  v_mfma_f32_16x16x32_bf16 v[0:3], a[0:3], a[160:163], v[0:3]
  s_barrier
  s_add_u32 s92, s94, 14
  s_and_b32 s92, s92, 15
  v_mfma_f32_16x16x32_bf16 v[0:3], a[32:35], a[168:171], v[0:3]
  s_lshl_b32 s92, s92, 14
  ds_read_b64_tr_b16 a[64:65], v110 offset:0
  ds_read_b64_tr_b16 a[66:67], v110 offset:8448
  v_mfma_f32_16x16x32_bf16 v[32:35], a[0:3], a[164:167], v[32:35]
  buffer_load_dwordx4 a[224:227], v104, s[8:11], s92 offen offset:0
  v_mfma_f32_16x16x32_bf16 v[32:35], a[32:35], a[172:175], v[32:35]
  ds_read_b64_tr_b16 a[96:97], v110 offset:512
  v_mfma_f32_16x16x32_bf16 v[4:7], a[4:7], a[160:163], v[4:7]
  ds_read_b64_tr_b16 a[98:99], v110 offset:8960
  v_mfma_f32_16x16x32_bf16 v[4:7], a[36:39], a[168:171], v[4:7]
  ds_read_b64_tr_b16 a[68:69], v110 offset:32
  ds_read_b64_tr_b16 a[70:71], v110 offset:8480
  v_mfma_f32_16x16x32_bf16 v[36:39], a[4:7], a[164:167], v[36:39]
  buffer_load_dwordx4 a[228:231], v104, s[8:11], s92 offen offset:1024
  v_mfma_f32_16x16x32_bf16 v[36:39], a[36:39], a[172:175], v[36:39]
  ds_read_b64_tr_b16 a[100:101], v110 offset:544
  v_mfma_f32_16x16x32_bf16 v[8:11], a[8:11], a[160:163], v[8:11]
  ds_read_b64_tr_b16 a[102:103], v110 offset:8992
  v_mfma_f32_16x16x32_bf16 v[8:11], a[40:43], a[168:171], v[8:11]
  ds_read_b64_tr_b16 a[72:73], v110 offset:64
  ds_read_b64_tr_b16 a[74:75], v110 offset:8512
  v_mfma_f32_16x16x32_bf16 v[40:43], a[8:11], a[164:167], v[40:43]
  ds_read_b64_tr_b16 a[104:105], v110 offset:576
  v_mfma_f32_16x16x32_bf16 v[40:43], a[40:43], a[172:175], v[40:43]
  buffer_load_dwordx4 a[232:235], v105, s[8:11], s92 offen offset:0
  v_mfma_f32_16x16x32_bf16 v[12:15], a[12:15], a[160:163], v[12:15]
  ds_read_b64_tr_b16 a[106:107], v110 offset:9024
  v_mfma_f32_16x16x32_bf16 v[12:15], a[44:47], a[168:171], v[12:15]
  ds_read_b64_tr_b16 a[76:77], v110 offset:96
  ds_read_b64_tr_b16 a[78:79], v110 offset:8544
  v_mfma_f32_16x16x32_bf16 v[44:47], a[12:15], a[164:167], v[44:47]
  ds_read_b64_tr_b16 a[108:109], v110 offset:608
  v_mfma_f32_16x16x32_bf16 v[44:47], a[44:47], a[172:175], v[44:47]
  ds_read_b64_tr_b16 a[110:111], v110 offset:9056
  v_mfma_f32_16x16x32_bf16 v[16:19], a[16:19], a[160:163], v[16:19]
  buffer_load_dwordx4 a[236:239], v105, s[8:11], s92 offen offset:1024
  s_add_u32 s93, s94, 15
  v_mfma_f32_16x16x32_bf16 v[16:19], a[48:51], a[168:171], v[16:19]
  s_and_b32 s93, s93, 15
  ds_read_b64_tr_b16 a[80:81], v110 offset:128
  ds_read_b64_tr_b16 a[82:83], v110 offset:8576
  v_mfma_f32_16x16x32_bf16 v[48:51], a[16:19], a[164:167], v[48:51]
  s_lshl_b32 s93, s93, 16
  ds_read_b64_tr_b16 a[112:113], v110 offset:640
  v_mfma_f32_16x16x32_bf16 v[48:51], a[48:51], a[172:175], v[48:51]
  s_add_u32 m0, s32, 118272
  ds_read_b64_tr_b16 a[114:115], v110 offset:9088
  v_mfma_f32_16x16x32_bf16 v[20:23], a[20:23], a[160:163], v[20:23]
  buffer_load_dwordx4 v252, s[12:15], s93 offen offset:0 lds
  s_waitcnt lgkmcnt(4)
  v_mfma_f32_16x16x32_bf16 v[20:23], a[52:55], a[168:171], v[20:23]
  ds_read_b64_tr_b16 a[84:85], v110 offset:160
  ds_read_b64_tr_b16 a[86:87], v110 offset:8608
  v_mfma_f32_16x16x32_bf16 v[52:55], a[20:23], a[164:167], v[52:55]
  ds_read_b64_tr_b16 a[116:117], v110 offset:672
  v_mfma_f32_16x16x32_bf16 v[52:55], a[52:55], a[172:175], v[52:55]
  ds_read_b64_tr_b16 a[118:119], v110 offset:9120
  v_mfma_f32_16x16x32_bf16 v[24:27], a[24:27], a[160:163], v[24:27]
  ds_read_b64_tr_b16 a[88:89], v110 offset:192
  ds_read_b64_tr_b16 a[90:91], v110 offset:8640
  v_mfma_f32_16x16x32_bf16 v[24:27], a[56:59], a[168:171], v[24:27]
  buffer_load_dwordx4 v253, s[12:15], s93 offen offset:1056 lds
  v_mfma_f32_16x16x32_bf16 v[56:59], a[24:27], a[164:167], v[56:59]
  ds_read_b64_tr_b16 a[120:121], v110 offset:704
  v_mfma_f32_16x16x32_bf16 v[56:59], a[56:59], a[172:175], v[56:59]
  ds_read_b64_tr_b16 a[122:123], v110 offset:9152
  v_mfma_f32_16x16x32_bf16 v[28:31], a[28:31], a[160:163], v[28:31]
  ds_read_b64_tr_b16 a[92:93], v110 offset:224
  ds_read_b64_tr_b16 a[94:95], v110 offset:8672
  v_mfma_f32_16x16x32_bf16 v[28:31], a[60:63], a[168:171], v[28:31]
  buffer_load_dwordx4 v254, s[12:15], s93 offen offset:2112 lds
  v_mfma_f32_16x16x32_bf16 v[60:63], a[28:31], a[164:167], v[60:63]
  ds_read_b64_tr_b16 a[124:125], v110 offset:736
  v_mfma_f32_16x16x32_bf16 v[60:63], a[60:63], a[172:175], v[60:63]
  s_waitcnt vmcnt(23)
  ds_read_b64_tr_b16 a[126:127], v110 offset:9184
  v_mfma_f32_16x16x32_bf16 v[0:3], a[64:67], a[176:179], v[0:3]
  s_add_u32 s92, s94, 15
  v_mfma_f32_16x16x32_bf16 v[0:3], a[96:99], a[184:187], v[0:3]
  s_and_b32 s92, s92, 15
  ds_read_b64_tr_b16 a[0:1], v110 offset:16896
  ds_read_b64_tr_b16 a[2:3], v110 offset:25344
  v_mfma_f32_16x16x32_bf16 v[32:35], a[64:67], a[180:183], v[32:35]
  s_lshl_b32 s92, s92, 14
  ds_read_b64_tr_b16 a[32:33], v110 offset:17408
  v_mfma_f32_16x16x32_bf16 v[32:35], a[96:99], a[188:191], v[32:35]
  buffer_load_dwordx4 a[240:243], v104, s[8:11], s92 offen offset:0
  v_mfma_f32_16x16x32_bf16 v[4:7], a[68:71], a[176:179], v[4:7]
  ds_read_b64_tr_b16 a[34:35], v110 offset:25856
  v_mfma_f32_16x16x32_bf16 v[4:7], a[100:103], a[184:187], v[4:7]
  ds_read_b64_tr_b16 a[4:5], v110 offset:16928
  v_mfma_f32_16x16x32_bf16 v[36:39], a[68:71], a[180:183], v[36:39]
  ds_read_b64_tr_b16 a[6:7], v110 offset:25376
  ds_read_b64_tr_b16 a[36:37], v110 offset:17440
  v_mfma_f32_16x16x32_bf16 v[36:39], a[100:103], a[188:191], v[36:39]
  ds_read_b64_tr_b16 a[38:39], v110 offset:25888
  v_mfma_f32_16x16x32_bf16 v[8:11], a[72:75], a[176:179], v[8:11]
  ds_read_b64_tr_b16 a[8:9], v110 offset:16960
  v_mfma_f32_16x16x32_bf16 v[8:11], a[104:107], a[184:187], v[8:11]
  buffer_load_dwordx4 a[244:247], v104, s[8:11], s92 offen offset:1024
  v_mfma_f32_16x16x32_bf16 v[40:43], a[72:75], a[180:183], v[40:43]
  ds_read_b64_tr_b16 a[10:11], v110 offset:25408
  v_mfma_f32_16x16x32_bf16 v[40:43], a[104:107], a[188:191], v[40:43]
  ds_read_b64_tr_b16 a[40:41], v110 offset:17472
  ds_read_b64_tr_b16 a[42:43], v110 offset:25920
  v_mfma_f32_16x16x32_bf16 v[12:15], a[76:79], a[176:179], v[12:15]
  ds_read_b64_tr_b16 a[12:13], v110 offset:16992
  v_mfma_f32_16x16x32_bf16 v[12:15], a[108:111], a[184:187], v[12:15]
  ds_read_b64_tr_b16 a[14:15], v110 offset:25440
  v_mfma_f32_16x16x32_bf16 v[44:47], a[76:79], a[180:183], v[44:47]
  ds_read_b64_tr_b16 a[44:45], v110 offset:17504
  v_mfma_f32_16x16x32_bf16 v[44:47], a[108:111], a[188:191], v[44:47]
  s_waitcnt lgkmcnt(6)
  ds_read_b64_tr_b16 a[46:47], v110 offset:25952
  v_mfma_f32_16x16x32_bf16 v[16:19], a[80:83], a[176:179], v[16:19]
  buffer_load_dwordx4 a[248:251], v105, s[8:11], s92 offen offset:0
  v_mfma_f32_16x16x32_bf16 v[16:19], a[112:115], a[184:187], v[16:19]
  ds_read_b64_tr_b16 a[16:17], v110 offset:17024
  ds_read_b64_tr_b16 a[18:19], v110 offset:25472
  v_mfma_f32_16x16x32_bf16 v[48:51], a[80:83], a[180:183], v[48:51]
  ds_read_b64_tr_b16 a[48:49], v110 offset:17536
  v_mfma_f32_16x16x32_bf16 v[48:51], a[112:115], a[188:191], v[48:51]
  ds_read_b64_tr_b16 a[50:51], v110 offset:25984
  v_mfma_f32_16x16x32_bf16 v[20:23], a[84:87], a[176:179], v[20:23]
  ds_read_b64_tr_b16 a[20:21], v110 offset:17056
  v_mfma_f32_16x16x32_bf16 v[20:23], a[116:119], a[184:187], v[20:23]
  ds_read_b64_tr_b16 a[22:23], v110 offset:25504
  ds_read_b64_tr_b16 a[52:53], v110 offset:17568
  v_mfma_f32_16x16x32_bf16 v[52:55], a[84:87], a[180:183], v[52:55]
  buffer_load_dwordx4 a[252:255], v105, s[8:11], s92 offen offset:1024
  v_mfma_f32_16x16x32_bf16 v[52:55], a[116:119], a[188:191], v[52:55]
  ds_read_b64_tr_b16 a[54:55], v110 offset:26016
  v_mfma_f32_16x16x32_bf16 v[24:27], a[88:91], a[176:179], v[24:27]
  ds_read_b64_tr_b16 a[24:25], v110 offset:17088
  v_mfma_f32_16x16x32_bf16 v[24:27], a[120:123], a[184:187], v[24:27]
  ds_read_b64_tr_b16 a[26:27], v110 offset:25536
  v_mfma_f32_16x16x32_bf16 v[56:59], a[88:91], a[180:183], v[56:59]
  ds_read_b64_tr_b16 a[56:57], v110 offset:17600
  ds_read_b64_tr_b16 a[58:59], v110 offset:26048
  v_mfma_f32_16x16x32_bf16 v[56:59], a[120:123], a[188:191], v[56:59]
  s_add_u32 m0, s32, 118272
  ds_read_b64_tr_b16 a[28:29], v110 offset:17120
  v_mfma_f32_16x16x32_bf16 v[28:31], a[92:95], a[176:179], v[28:31]
  buffer_load_dwordx4 v255, s[12:15], s93 offen offset:3168 lds
  v_mfma_f32_16x16x32_bf16 v[28:31], a[124:127], a[184:187], v[28:31]
  ds_read_b64_tr_b16 a[30:31], v110 offset:25568
  v_mfma_f32_16x16x32_bf16 v[60:63], a[92:95], a[180:183], v[60:63]
  ds_read_b64_tr_b16 a[60:61], v110 offset:17632
  v_mfma_f32_16x16x32_bf16 v[60:63], a[124:127], a[188:191], v[60:63]
  s_waitcnt vmcnt(12)
  ds_read_b64_tr_b16 a[62:63], v110 offset:26080
  v_mfma_f32_16x16x32_bf16 v[0:3], a[0:3], a[192:195], v[0:3]
  s_barrier
  v_mfma_f32_16x16x32_bf16 v[0:3], a[32:35], a[200:203], v[0:3]
  ds_read_b64_tr_b16 a[64:65], v110 offset:33792
  ds_read_b64_tr_b16 a[66:67], v110 offset:42240
  v_mfma_f32_16x16x32_bf16 v[32:35], a[0:3], a[196:199], v[32:35]
  ds_read_b64_tr_b16 a[96:97], v110 offset:34304
  v_mfma_f32_16x16x32_bf16 v[32:35], a[32:35], a[204:207], v[32:35]
  ds_read_b64_tr_b16 a[98:99], v110 offset:42752
  v_mfma_f32_16x16x32_bf16 v[4:7], a[4:7], a[192:195], v[4:7]
  ds_read_b64_tr_b16 a[68:69], v110 offset:33824
  v_mfma_f32_16x16x32_bf16 v[4:7], a[36:39], a[200:203], v[4:7]
  ds_read_b64_tr_b16 a[70:71], v110 offset:42272
  v_mfma_f32_16x16x32_bf16 v[36:39], a[4:7], a[196:199], v[36:39]
  ds_read_b64_tr_b16 a[100:101], v110 offset:34336
  v_mfma_f32_16x16x32_bf16 v[36:39], a[36:39], a[204:207], v[36:39]
  s_waitcnt lgkmcnt(7)
  ds_read_b64_tr_b16 a[102:103], v110 offset:42784
  v_mfma_f32_16x16x32_bf16 v[8:11], a[8:11], a[192:195], v[8:11]
  ds_read_b64_tr_b16 a[72:73], v110 offset:33856
  v_mfma_f32_16x16x32_bf16 v[8:11], a[40:43], a[200:203], v[8:11]
  ds_read_b64_tr_b16 a[74:75], v110 offset:42304
  v_mfma_f32_16x16x32_bf16 v[40:43], a[8:11], a[196:199], v[40:43]
  ds_read_b64_tr_b16 a[104:105], v110 offset:34368
  v_mfma_f32_16x16x32_bf16 v[40:43], a[40:43], a[204:207], v[40:43]
  ds_read_b64_tr_b16 a[106:107], v110 offset:42816
  v_mfma_f32_16x16x32_bf16 v[12:15], a[12:15], a[192:195], v[12:15]
  ds_read_b64_tr_b16 a[76:77], v110 offset:33888
  v_mfma_f32_16x16x32_bf16 v[12:15], a[44:47], a[200:203], v[12:15]
  ds_read_b64_tr_b16 a[78:79], v110 offset:42336
  v_mfma_f32_16x16x32_bf16 v[44:47], a[12:15], a[196:199], v[44:47]
  ds_read_b64_tr_b16 a[108:109], v110 offset:34400
  v_mfma_f32_16x16x32_bf16 v[44:47], a[44:47], a[204:207], v[44:47]
  ds_read_b64_tr_b16 a[110:111], v110 offset:42848
  v_mfma_f32_16x16x32_bf16 v[16:19], a[16:19], a[192:195], v[16:19]
  ds_read_b64_tr_b16 a[80:81], v110 offset:33920
  v_mfma_f32_16x16x32_bf16 v[16:19], a[48:51], a[200:203], v[16:19]
  ds_read_b64_tr_b16 a[82:83], v110 offset:42368
  v_mfma_f32_16x16x32_bf16 v[48:51], a[16:19], a[196:199], v[48:51]
  ds_read_b64_tr_b16 a[112:113], v110 offset:34432
  v_mfma_f32_16x16x32_bf16 v[48:51], a[48:51], a[204:207], v[48:51]
  ds_read_b64_tr_b16 a[114:115], v110 offset:42880
  v_mfma_f32_16x16x32_bf16 v[20:23], a[20:23], a[192:195], v[20:23]
  ds_read_b64_tr_b16 a[84:85], v110 offset:33952
  v_mfma_f32_16x16x32_bf16 v[20:23], a[52:55], a[200:203], v[20:23]
  ds_read_b64_tr_b16 a[86:87], v110 offset:42400
  v_mfma_f32_16x16x32_bf16 v[52:55], a[20:23], a[196:199], v[52:55]
  ds_read_b64_tr_b16 a[116:117], v110 offset:34464
  v_mfma_f32_16x16x32_bf16 v[52:55], a[52:55], a[204:207], v[52:55]
  ds_read_b64_tr_b16 a[118:119], v110 offset:42912
  v_mfma_f32_16x16x32_bf16 v[24:27], a[24:27], a[192:195], v[24:27]
  ds_read_b64_tr_b16 a[88:89], v110 offset:33984
  v_mfma_f32_16x16x32_bf16 v[24:27], a[56:59], a[200:203], v[24:27]
  ds_read_b64_tr_b16 a[90:91], v110 offset:42432
  v_mfma_f32_16x16x32_bf16 v[56:59], a[24:27], a[196:199], v[56:59]
  ds_read_b64_tr_b16 a[120:121], v110 offset:34496
  v_mfma_f32_16x16x32_bf16 v[56:59], a[56:59], a[204:207], v[56:59]
  ds_read_b64_tr_b16 a[122:123], v110 offset:42944
  v_mfma_f32_16x16x32_bf16 v[28:31], a[28:31], a[192:195], v[28:31]
  ds_read_b64_tr_b16 a[92:93], v110 offset:34016
  v_mfma_f32_16x16x32_bf16 v[28:31], a[60:63], a[200:203], v[28:31]
  ds_read_b64_tr_b16 a[94:95], v110 offset:42464
  v_mfma_f32_16x16x32_bf16 v[60:63], a[28:31], a[196:199], v[60:63]
  ds_read_b64_tr_b16 a[124:125], v110 offset:34528
  v_mfma_f32_16x16x32_bf16 v[60:63], a[60:63], a[204:207], v[60:63]
  s_waitcnt vmcnt(12)
  s_waitcnt lgkmcnt(6)
  ds_read_b64_tr_b16 a[126:127], v110 offset:42976
  v_mfma_f32_16x16x32_bf16 v[0:3], a[64:67], a[208:211], v[0:3]
  v_mfma_f32_16x16x32_bf16 v[0:3], a[96:99], a[216:219], v[0:3]
  ds_read_b64_tr_b16 a[0:1], v111 offset:0
  ds_read_b64_tr_b16 a[2:3], v111 offset:8448
  v_mfma_f32_16x16x32_bf16 v[32:35], a[64:67], a[212:215], v[32:35]
  ds_read_b64_tr_b16 a[32:33], v111 offset:512
  v_mfma_f32_16x16x32_bf16 v[32:35], a[96:99], a[220:223], v[32:35]
  ds_read_b64_tr_b16 a[34:35], v111 offset:8960
  v_mfma_f32_16x16x32_bf16 v[4:7], a[68:71], a[208:211], v[4:7]
  ds_read_b64_tr_b16 a[4:5], v111 offset:32
  v_mfma_f32_16x16x32_bf16 v[4:7], a[100:103], a[216:219], v[4:7]
  ds_read_b64_tr_b16 a[6:7], v111 offset:8480
  v_mfma_f32_16x16x32_bf16 v[36:39], a[68:71], a[212:215], v[36:39]
  ds_read_b64_tr_b16 a[36:37], v111 offset:544
  v_mfma_f32_16x16x32_bf16 v[36:39], a[100:103], a[220:223], v[36:39]
  ds_read_b64_tr_b16 a[38:39], v111 offset:8992
  v_mfma_f32_16x16x32_bf16 v[8:11], a[72:75], a[208:211], v[8:11]
  ds_read_b64_tr_b16 a[8:9], v111 offset:64
  v_mfma_f32_16x16x32_bf16 v[8:11], a[104:107], a[216:219], v[8:11]
  ds_read_b64_tr_b16 a[10:11], v111 offset:8512
  v_mfma_f32_16x16x32_bf16 v[40:43], a[72:75], a[212:215], v[40:43]
  ds_read_b64_tr_b16 a[40:41], v111 offset:576
  v_mfma_f32_16x16x32_bf16 v[40:43], a[104:107], a[220:223], v[40:43]
  ds_read_b64_tr_b16 a[42:43], v111 offset:9024
  v_mfma_f32_16x16x32_bf16 v[12:15], a[76:79], a[208:211], v[12:15]
  ds_read_b64_tr_b16 a[12:13], v111 offset:96
  v_mfma_f32_16x16x32_bf16 v[12:15], a[108:111], a[216:219], v[12:15]
  ds_read_b64_tr_b16 a[14:15], v111 offset:8544
  v_mfma_f32_16x16x32_bf16 v[44:47], a[76:79], a[212:215], v[44:47]
  ds_read_b64_tr_b16 a[44:45], v111 offset:608
  v_mfma_f32_16x16x32_bf16 v[44:47], a[108:111], a[220:223], v[44:47]
  ds_read_b64_tr_b16 a[46:47], v111 offset:9056
  v_mfma_f32_16x16x32_bf16 v[16:19], a[80:83], a[208:211], v[16:19]
  ds_read_b64_tr_b16 a[16:17], v111 offset:128
  v_mfma_f32_16x16x32_bf16 v[16:19], a[112:115], a[216:219], v[16:19]
  ds_read_b64_tr_b16 a[18:19], v111 offset:8576
  v_mfma_f32_16x16x32_bf16 v[48:51], a[80:83], a[212:215], v[48:51]
  ds_read_b64_tr_b16 a[48:49], v111 offset:640
  v_mfma_f32_16x16x32_bf16 v[48:51], a[112:115], a[220:223], v[48:51]
  ds_read_b64_tr_b16 a[50:51], v111 offset:9088
  v_mfma_f32_16x16x32_bf16 v[20:23], a[84:87], a[208:211], v[20:23]
  ds_read_b64_tr_b16 a[20:21], v111 offset:160
  v_mfma_f32_16x16x32_bf16 v[20:23], a[116:119], a[216:219], v[20:23]
  ds_read_b64_tr_b16 a[22:23], v111 offset:8608
  v_mfma_f32_16x16x32_bf16 v[52:55], a[84:87], a[212:215], v[52:55]
  ds_read_b64_tr_b16 a[52:53], v111 offset:672
  v_mfma_f32_16x16x32_bf16 v[52:55], a[116:119], a[220:223], v[52:55]
  s_waitcnt lgkmcnt(7)
  ds_read_b64_tr_b16 a[54:55], v111 offset:9120
  v_mfma_f32_16x16x32_bf16 v[24:27], a[88:91], a[208:211], v[24:27]
  ds_read_b64_tr_b16 a[24:25], v111 offset:192
  v_mfma_f32_16x16x32_bf16 v[24:27], a[120:123], a[216:219], v[24:27]
  ds_read_b64_tr_b16 a[26:27], v111 offset:8640
  v_mfma_f32_16x16x32_bf16 v[56:59], a[88:91], a[212:215], v[56:59]
  ds_read_b64_tr_b16 a[56:57], v111 offset:704
  v_mfma_f32_16x16x32_bf16 v[56:59], a[120:123], a[220:223], v[56:59]
  ds_read_b64_tr_b16 a[58:59], v111 offset:9152
  v_mfma_f32_16x16x32_bf16 v[28:31], a[92:95], a[208:211], v[28:31]
  ds_read_b64_tr_b16 a[28:29], v111 offset:224
  v_mfma_f32_16x16x32_bf16 v[28:31], a[124:127], a[216:219], v[28:31]
  ds_read_b64_tr_b16 a[30:31], v111 offset:8672
  v_mfma_f32_16x16x32_bf16 v[60:63], a[92:95], a[212:215], v[60:63]
  ds_read_b64_tr_b16 a[60:61], v111 offset:736
  v_mfma_f32_16x16x32_bf16 v[60:63], a[124:127], a[220:223], v[60:63]
  s_waitcnt vmcnt(0)
  ds_read_b64_tr_b16 a[62:63], v111 offset:9184
  v_mfma_f32_16x16x32_bf16 v[0:3], a[0:3], a[224:227], v[0:3]
  s_barrier
  v_mfma_f32_16x16x32_bf16 v[0:3], a[32:35], a[232:235], v[0:3]
  ds_read_b64_tr_b16 a[64:65], v111 offset:16896
  ds_read_b64_tr_b16 a[66:67], v111 offset:25344
  v_mfma_f32_16x16x32_bf16 v[32:35], a[0:3], a[228:231], v[32:35]
  ds_read_b64_tr_b16 a[96:97], v111 offset:17408
  v_mfma_f32_16x16x32_bf16 v[32:35], a[32:35], a[236:239], v[32:35]
  ds_read_b64_tr_b16 a[98:99], v111 offset:25856
  v_mfma_f32_16x16x32_bf16 v[4:7], a[4:7], a[224:227], v[4:7]
  ds_read_b64_tr_b16 a[68:69], v111 offset:16928
  v_mfma_f32_16x16x32_bf16 v[4:7], a[36:39], a[232:235], v[4:7]
  ds_read_b64_tr_b16 a[70:71], v111 offset:25376
  v_mfma_f32_16x16x32_bf16 v[36:39], a[4:7], a[228:231], v[36:39]
  ds_read_b64_tr_b16 a[100:101], v111 offset:17440
  v_mfma_f32_16x16x32_bf16 v[36:39], a[36:39], a[236:239], v[36:39]
  ds_read_b64_tr_b16 a[102:103], v111 offset:25888
  v_mfma_f32_16x16x32_bf16 v[8:11], a[8:11], a[224:227], v[8:11]
  ds_read_b64_tr_b16 a[72:73], v111 offset:16960
  v_mfma_f32_16x16x32_bf16 v[8:11], a[40:43], a[232:235], v[8:11]
  ds_read_b64_tr_b16 a[74:75], v111 offset:25408
  v_mfma_f32_16x16x32_bf16 v[40:43], a[8:11], a[228:231], v[40:43]
  ds_read_b64_tr_b16 a[104:105], v111 offset:17472
  v_mfma_f32_16x16x32_bf16 v[40:43], a[40:43], a[236:239], v[40:43]
  ds_read_b64_tr_b16 a[106:107], v111 offset:25920
  v_mfma_f32_16x16x32_bf16 v[12:15], a[12:15], a[224:227], v[12:15]
  ds_read_b64_tr_b16 a[76:77], v111 offset:16992
  v_mfma_f32_16x16x32_bf16 v[12:15], a[44:47], a[232:235], v[12:15]
  ds_read_b64_tr_b16 a[78:79], v111 offset:25440
  v_mfma_f32_16x16x32_bf16 v[44:47], a[12:15], a[228:231], v[44:47]
  ds_read_b64_tr_b16 a[108:109], v111 offset:17504
  v_mfma_f32_16x16x32_bf16 v[44:47], a[44:47], a[236:239], v[44:47]
  s_waitcnt lgkmcnt(7)
  ds_read_b64_tr_b16 a[110:111], v111 offset:25952
  v_mfma_f32_16x16x32_bf16 v[16:19], a[16:19], a[224:227], v[16:19]
  ds_read_b64_tr_b16 a[80:81], v111 offset:17024
  v_mfma_f32_16x16x32_bf16 v[16:19], a[48:51], a[232:235], v[16:19]
  ds_read_b64_tr_b16 a[82:83], v111 offset:25472
  v_mfma_f32_16x16x32_bf16 v[48:51], a[16:19], a[228:231], v[48:51]
  ds_read_b64_tr_b16 a[112:113], v111 offset:17536
  v_mfma_f32_16x16x32_bf16 v[48:51], a[48:51], a[236:239], v[48:51]
  ds_read_b64_tr_b16 a[114:115], v111 offset:25984
  v_mfma_f32_16x16x32_bf16 v[20:23], a[20:23], a[224:227], v[20:23]
  ds_read_b64_tr_b16 a[84:85], v111 offset:17056
  v_mfma_f32_16x16x32_bf16 v[20:23], a[52:55], a[232:235], v[20:23]
  ds_read_b64_tr_b16 a[86:87], v111 offset:25504
  v_mfma_f32_16x16x32_bf16 v[52:55], a[20:23], a[228:231], v[52:55]
  ds_read_b64_tr_b16 a[116:117], v111 offset:17568
  v_mfma_f32_16x16x32_bf16 v[52:55], a[52:55], a[236:239], v[52:55]
  ds_read_b64_tr_b16 a[118:119], v111 offset:26016
  v_mfma_f32_16x16x32_bf16 v[24:27], a[24:27], a[224:227], v[24:27]
  ds_read_b64_tr_b16 a[88:89], v111 offset:17088
  v_mfma_f32_16x16x32_bf16 v[24:27], a[56:59], a[232:235], v[24:27]
  ds_read_b64_tr_b16 a[90:91], v111 offset:25536
  v_mfma_f32_16x16x32_bf16 v[56:59], a[24:27], a[228:231], v[56:59]
  ds_read_b64_tr_b16 a[120:121], v111 offset:17600
  v_mfma_f32_16x16x32_bf16 v[56:59], a[56:59], a[236:239], v[56:59]
  ds_read_b64_tr_b16 a[122:123], v111 offset:26048
  v_mfma_f32_16x16x32_bf16 v[28:31], a[28:31], a[224:227], v[28:31]
  ds_read_b64_tr_b16 a[92:93], v111 offset:17120
  v_mfma_f32_16x16x32_bf16 v[28:31], a[60:63], a[232:235], v[28:31]
  ds_read_b64_tr_b16 a[94:95], v111 offset:25568
  v_mfma_f32_16x16x32_bf16 v[60:63], a[28:31], a[228:231], v[60:63]
  ds_read_b64_tr_b16 a[124:125], v111 offset:17632
  v_mfma_f32_16x16x32_bf16 v[60:63], a[60:63], a[236:239], v[60:63]
  ds_read_b64_tr_b16 a[126:127], v111 offset:26080
  s_lshl_b32 s33, s3, 2
  s_add_u32 s33, s33, s36
  s_lshl_b32 s33, s33, 14
  s_add_u32 s35, s33, 4096
  s_cmp_eq_u32 s3, s36
  s_cbranch_scc1 L_g2_own
  s_waitcnt vmcnt(1)
  v_mfma_f32_16x16x32_bf16 v[0:3], a[64:67], a[240:243], v[0:3]
  v_mfma_f32_16x16x32_bf16 v[0:3], a[96:99], a[248:251], v[0:3]
  v_mfma_f32_16x16x32_bf16 v[32:35], a[64:67], a[244:247], v[32:35]
  v_mfma_f32_16x16x32_bf16 v[32:35], a[96:99], a[252:255], v[32:35]
  v_mfma_f32_16x16x32_bf16 v[4:7], a[68:71], a[240:243], v[4:7]
  v_mfma_f32_16x16x32_bf16 v[4:7], a[100:103], a[248:251], v[4:7]
  v_mfma_f32_16x16x32_bf16 v[36:39], a[68:71], a[244:247], v[36:39]
  v_mfma_f32_16x16x32_bf16 v[36:39], a[100:103], a[252:255], v[36:39]
  s_waitcnt lgkmcnt(3)
  v_mfma_f32_16x16x32_bf16 v[8:11], a[72:75], a[240:243], v[8:11]
  v_mfma_f32_16x16x32_bf16 v[8:11], a[104:107], a[248:251], v[8:11]
  v_cvt_pk_bf16_f32 v64, v0, v1
  v_cvt_pk_bf16_f32 v65, v2, v3
  v_cvt_pk_bf16_f32 v80, v32, v33
  v_cvt_pk_bf16_f32 v81, v34, v35
  v_mfma_f32_16x16x32_bf16 v[40:43], a[72:75], a[244:247], v[40:43]
  v_cvt_pk_bf16_f32 v66, v4, v5
  v_cvt_pk_bf16_f32 v67, v6, v7
  v_mfma_f32_16x16x32_bf16 v[40:43], a[104:107], a[252:255], v[40:43]
  buffer_store_dwordx4 v[64:67], v108, s[16:19], s33 offen offset:0 sc1
  v_mfma_f32_16x16x32_bf16 v[12:15], a[76:79], a[240:243], v[12:15]
  v_cvt_pk_bf16_f32 v82, v36, v37
  v_cvt_pk_bf16_f32 v83, v38, v39
  v_mfma_f32_16x16x32_bf16 v[12:15], a[108:111], a[248:251], v[12:15]
  buffer_store_dwordx4 v[80:83], v108, s[16:19], s35 offen offset:0 sc1
  v_mfma_f32_16x16x32_bf16 v[44:47], a[76:79], a[244:247], v[44:47]
  v_cvt_pk_bf16_f32 v68, v8, v9
  v_cvt_pk_bf16_f32 v69, v10, v11
  v_mfma_f32_16x16x32_bf16 v[44:47], a[108:111], a[252:255], v[44:47]
  v_mfma_f32_16x16x32_bf16 v[16:19], a[80:83], a[240:243], v[16:19]
  v_cvt_pk_bf16_f32 v84, v40, v41
  v_cvt_pk_bf16_f32 v85, v42, v43
  v_mfma_f32_16x16x32_bf16 v[16:19], a[112:115], a[248:251], v[16:19]
  v_mfma_f32_16x16x32_bf16 v[48:51], a[80:83], a[244:247], v[48:51]
  v_cvt_pk_bf16_f32 v70, v12, v13
  v_cvt_pk_bf16_f32 v71, v14, v15
  v_mfma_f32_16x16x32_bf16 v[48:51], a[112:115], a[252:255], v[48:51]
  buffer_store_dwordx4 v[68:71], v108, s[16:19], s33 offen offset:1024 sc1
  v_mfma_f32_16x16x32_bf16 v[20:23], a[84:87], a[240:243], v[20:23]
  v_cvt_pk_bf16_f32 v86, v44, v45
  v_cvt_pk_bf16_f32 v87, v46, v47
  v_mfma_f32_16x16x32_bf16 v[20:23], a[116:119], a[248:251], v[20:23]
  buffer_store_dwordx4 v[84:87], v108, s[16:19], s35 offen offset:1024 sc1
  v_mfma_f32_16x16x32_bf16 v[52:55], a[84:87], a[244:247], v[52:55]
  v_cvt_pk_bf16_f32 v72, v16, v17
  v_cvt_pk_bf16_f32 v73, v18, v19
  v_mfma_f32_16x16x32_bf16 v[52:55], a[116:119], a[252:255], v[52:55]
  v_mfma_f32_16x16x32_bf16 v[24:27], a[88:91], a[240:243], v[24:27]
  v_cvt_pk_bf16_f32 v88, v48, v49
  v_cvt_pk_bf16_f32 v89, v50, v51
  v_mfma_f32_16x16x32_bf16 v[24:27], a[120:123], a[248:251], v[24:27]
  v_mfma_f32_16x16x32_bf16 v[56:59], a[88:91], a[244:247], v[56:59]
  v_cvt_pk_bf16_f32 v74, v20, v21
  v_cvt_pk_bf16_f32 v75, v22, v23
  v_mfma_f32_16x16x32_bf16 v[56:59], a[120:123], a[252:255], v[56:59]
  buffer_store_dwordx4 v[72:75], v108, s[16:19], s33 offen offset:2048 sc1
  s_waitcnt lgkmcnt(0)
  v_mfma_f32_16x16x32_bf16 v[28:31], a[92:95], a[240:243], v[28:31]
  v_cvt_pk_bf16_f32 v90, v52, v53
  v_cvt_pk_bf16_f32 v91, v54, v55
  v_mfma_f32_16x16x32_bf16 v[28:31], a[124:127], a[248:251], v[28:31]
  buffer_store_dwordx4 v[88:91], v108, s[16:19], s35 offen offset:2048 sc1
  v_mfma_f32_16x16x32_bf16 v[60:63], a[92:95], a[244:247], v[60:63]
  v_cvt_pk_bf16_f32 v76, v24, v25
  v_cvt_pk_bf16_f32 v77, v26, v27
  v_mfma_f32_16x16x32_bf16 v[60:63], a[124:127], a[252:255], v[60:63]
  v_cvt_pk_bf16_f32 v92, v56, v57
  v_cvt_pk_bf16_f32 v93, v58, v59
  s_nop 0
  v_cvt_pk_bf16_f32 v78, v28, v29
  v_cvt_pk_bf16_f32 v79, v30, v31
  buffer_store_dwordx4 v[76:79], v108, s[16:19], s33 offen offset:3072 sc1
  s_nop 1
  v_cvt_pk_bf16_f32 v94, v60, v61
  v_cvt_pk_bf16_f32 v95, v62, v63
  buffer_store_dwordx4 v[92:95], v108, s[16:19], s35 offen offset:3072 sc1
  s_barrier
  s_branch L_fin_s
L_g2_own:
  s_waitcnt vmcnt(1)
  v_mfma_f32_16x16x32_bf16 v[0:3], a[64:67], a[240:243], v[0:3]
  v_mfma_f32_16x16x32_bf16 v[0:3], a[96:99], a[248:251], v[0:3]
  v_mfma_f32_16x16x32_bf16 v[32:35], a[64:67], a[244:247], v[32:35]
  v_mfma_f32_16x16x32_bf16 v[32:35], a[96:99], a[252:255], v[32:35]
  v_mfma_f32_16x16x32_bf16 v[4:7], a[68:71], a[240:243], v[4:7]
  v_mfma_f32_16x16x32_bf16 v[4:7], a[100:103], a[248:251], v[4:7]
  v_mfma_f32_16x16x32_bf16 v[36:39], a[68:71], a[244:247], v[36:39]
  v_mfma_f32_16x16x32_bf16 v[36:39], a[100:103], a[252:255], v[36:39]
  s_waitcnt lgkmcnt(3)
  v_mfma_f32_16x16x32_bf16 v[8:11], a[72:75], a[240:243], v[8:11]
  v_mfma_f32_16x16x32_bf16 v[8:11], a[104:107], a[248:251], v[8:11]
  ds_write_b128 v108, v[0:3] offset:0
  v_mfma_f32_16x16x32_bf16 v[40:43], a[72:75], a[244:247], v[40:43]
  ds_write_b128 v108, v[32:35] offset:8192
  v_mfma_f32_16x16x32_bf16 v[40:43], a[104:107], a[252:255], v[40:43]
  ds_write_b128 v108, v[4:7] offset:1024
  v_mfma_f32_16x16x32_bf16 v[12:15], a[76:79], a[240:243], v[12:15]
  ds_write_b128 v108, v[36:39] offset:9216
  v_mfma_f32_16x16x32_bf16 v[12:15], a[108:111], a[248:251], v[12:15]
  v_mfma_f32_16x16x32_bf16 v[44:47], a[76:79], a[244:247], v[44:47]
  ds_write_b128 v108, v[8:11] offset:2048
  v_mfma_f32_16x16x32_bf16 v[44:47], a[108:111], a[252:255], v[44:47]
  v_mfma_f32_16x16x32_bf16 v[16:19], a[80:83], a[240:243], v[16:19]
  ds_write_b128 v108, v[40:43] offset:10240
  v_mfma_f32_16x16x32_bf16 v[16:19], a[112:115], a[248:251], v[16:19]
  v_mfma_f32_16x16x32_bf16 v[48:51], a[80:83], a[244:247], v[48:51]
  v_mfma_f32_16x16x32_bf16 v[48:51], a[112:115], a[252:255], v[48:51]
  ds_write_b128 v108, v[12:15] offset:3072
  v_mfma_f32_16x16x32_bf16 v[20:23], a[84:87], a[240:243], v[20:23]
  v_mfma_f32_16x16x32_bf16 v[20:23], a[116:119], a[248:251], v[20:23]
  ds_write_b128 v108, v[44:47] offset:11264
  v_mfma_f32_16x16x32_bf16 v[52:55], a[84:87], a[244:247], v[52:55]
  v_mfma_f32_16x16x32_bf16 v[52:55], a[116:119], a[252:255], v[52:55]
  ds_write_b128 v108, v[16:19] offset:4096
  v_mfma_f32_16x16x32_bf16 v[24:27], a[88:91], a[240:243], v[24:27]
  ds_write_b128 v108, v[48:51] offset:12288
  v_mfma_f32_16x16x32_bf16 v[24:27], a[120:123], a[248:251], v[24:27]
  v_mfma_f32_16x16x32_bf16 v[56:59], a[88:91], a[244:247], v[56:59]
  ds_write_b128 v108, v[20:23] offset:5120
  v_mfma_f32_16x16x32_bf16 v[56:59], a[120:123], a[252:255], v[56:59]
  s_waitcnt lgkmcnt(5)
  v_mfma_f32_16x16x32_bf16 v[28:31], a[92:95], a[240:243], v[28:31]
  ds_write_b128 v108, v[52:55] offset:13312
  v_mfma_f32_16x16x32_bf16 v[28:31], a[124:127], a[248:251], v[28:31]
  v_mfma_f32_16x16x32_bf16 v[60:63], a[92:95], a[244:247], v[60:63]
  v_mfma_f32_16x16x32_bf16 v[60:63], a[124:127], a[252:255], v[60:63]
  ds_write_b128 v108, v[24:27] offset:6144
  s_nop 0
  ds_write_b128 v108, v[56:59] offset:14336
  s_nop 2
  ds_write_b128 v108, v[28:31] offset:7168
  s_nop 0
  ds_write_b128 v108, v[60:63] offset:15360
  s_waitcnt lgkmcnt(0)
  s_barrier
  s_branch L_fin
L_g1:
  s_add_u32 s92, s94, 0
  s_and_b32 s92, s92, 15
  s_lshl_b32 s92, s92, 14
  buffer_load_dwordx4 a[128:131], v104, s[8:11], s92 offen offset:0
  buffer_load_dwordx4 a[136:139], v105, s[8:11], s92 offen offset:0
  ds_read_b64_tr_b16 a[0:1], v109 offset:0
  ds_read_b64_tr_b16 a[2:3], v109 offset:8448
  ds_read_b64_tr_b16 a[32:33], v109 offset:512
  ds_read_b64_tr_b16 a[34:35], v109 offset:8960
  ds_read_b64_tr_b16 a[4:5], v109 offset:32
  ds_read_b64_tr_b16 a[6:7], v109 offset:8480
  ds_read_b64_tr_b16 a[36:37], v109 offset:544
  ds_read_b64_tr_b16 a[38:39], v109 offset:8992
  ds_read_b64_tr_b16 a[8:9], v109 offset:64
  ds_read_b64_tr_b16 a[10:11], v109 offset:8512
  ds_read_b64_tr_b16 a[40:41], v109 offset:576
  ds_read_b64_tr_b16 a[42:43], v109 offset:9024
  ds_read_b64_tr_b16 a[12:13], v109 offset:96
  ds_read_b64_tr_b16 a[14:15], v109 offset:8544
  ds_read_b64_tr_b16 a[44:45], v109 offset:608
  ds_read_b64_tr_b16 a[46:47], v109 offset:9056
  s_add_u32 s92, s94, 1
  s_and_b32 s92, s92, 15
  s_lshl_b32 s92, s92, 14
  buffer_load_dwordx4 a[144:147], v104, s[8:11], s92 offen offset:0
  buffer_load_dwordx4 a[152:155], v105, s[8:11], s92 offen offset:0
  s_waitcnt vmcnt(2)
  ds_read_b64_tr_b16 a[16:17], v109 offset:128
  s_waitcnt lgkmcnt(8)
  ds_read_b64_tr_b16 a[18:19], v109 offset:8576
  v_mfma_f32_16x16x32_bf16 v[0:3], a[0:3], a[128:131], 0
  s_add_u32 s93, s94, 7
  s_and_b32 s93, s93, 15
  s_lshl_b32 s93, s93, 16
  s_add_u32 m0, s32, 135168
  ds_read_b64_tr_b16 a[48:49], v109 offset:640
  buffer_load_dwordx4 v252, s[12:15], s93 offen offset:0 lds
  ds_read_b64_tr_b16 a[50:51], v109 offset:9088
  v_mfma_f32_16x16x32_bf16 v[0:3], a[32:35], a[136:139], v[0:3]
  ds_read_b64_tr_b16 a[20:21], v109 offset:160
  ds_read_b64_tr_b16 a[22:23], v109 offset:8608
  v_mfma_f32_16x16x32_bf16 v[4:7], a[4:7], a[128:131], 0
  buffer_load_dwordx4 v253, s[12:15], s93 offen offset:1056 lds
  ds_read_b64_tr_b16 a[52:53], v109 offset:672
  ds_read_b64_tr_b16 a[54:55], v109 offset:9120
  v_mfma_f32_16x16x32_bf16 v[4:7], a[36:39], a[136:139], v[4:7]
  ds_read_b64_tr_b16 a[24:25], v109 offset:192
  s_waitcnt lgkmcnt(7)
  ds_read_b64_tr_b16 a[26:27], v109 offset:8640
  v_mfma_f32_16x16x32_bf16 v[8:11], a[8:11], a[128:131], 0
  buffer_load_dwordx4 v254, s[12:15], s93 offen offset:2112 lds
  ds_read_b64_tr_b16 a[56:57], v109 offset:704
  ds_read_b64_tr_b16 a[58:59], v109 offset:9152
  v_mfma_f32_16x16x32_bf16 v[8:11], a[40:43], a[136:139], v[8:11]
  ds_read_b64_tr_b16 a[28:29], v109 offset:224
  ds_read_b64_tr_b16 a[30:31], v109 offset:8672
  v_mfma_f32_16x16x32_bf16 v[12:15], a[12:15], a[128:131], 0
  buffer_load_dwordx4 v255, s[12:15], s93 offen offset:3168 lds
  ds_read_b64_tr_b16 a[60:61], v109 offset:736
  ds_read_b64_tr_b16 a[62:63], v109 offset:9184
  ds_read_b64_tr_b16 a[64:65], v109 offset:33792
  ds_read_b64_tr_b16 a[66:67], v109 offset:42240
  ds_read_b64_tr_b16 a[96:97], v109 offset:34304
  ds_read_b64_tr_b16 a[98:99], v109 offset:42752
  ds_read_b64_tr_b16 a[68:69], v109 offset:33824
  ds_read_b64_tr_b16 a[70:71], v109 offset:42272
  ds_read_b64_tr_b16 a[100:101], v109 offset:34336
  v_mfma_f32_16x16x32_bf16 v[12:15], a[44:47], a[136:139], v[12:15]
  ds_read_b64_tr_b16 a[102:103], v109 offset:42784
  ds_read_b64_tr_b16 a[72:73], v109 offset:33856
  ds_read_b64_tr_b16 a[74:75], v109 offset:42304
  ds_read_b64_tr_b16 a[104:105], v109 offset:34368
  ds_read_b64_tr_b16 a[106:107], v109 offset:42816
  ds_read_b64_tr_b16 a[76:77], v109 offset:33888
  v_mfma_f32_16x16x32_bf16 v[16:19], a[16:19], a[128:131], 0
  global_load_dword v113, v112, s[44:45] sc1
  s_add_u32 s93, s94, 8
  s_and_b32 s93, s93, 15
  s_lshl_b32 s93, s93, 16
  s_add_u32 m0, s32, 16896
  s_waitcnt lgkmcnt(8)
  v_mfma_f32_16x16x32_bf16 v[16:19], a[48:51], a[136:139], v[16:19]
  buffer_load_dwordx4 v252, s[12:15], s93 offen offset:0 lds
  v_mfma_f32_16x16x32_bf16 v[20:23], a[20:23], a[128:131], 0
  ds_read_b64_tr_b16 a[78:79], v109 offset:42336
  ds_read_b64_tr_b16 a[108:109], v109 offset:34400
  ds_read_b64_tr_b16 a[110:111], v109 offset:42848
  ds_read_b64_tr_b16 a[80:81], v109 offset:33920
  ds_read_b64_tr_b16 a[82:83], v109 offset:42368
  ds_read_b64_tr_b16 a[112:113], v109 offset:34432
  ds_read_b64_tr_b16 a[114:115], v109 offset:42880
  v_mfma_f32_16x16x32_bf16 v[20:23], a[52:55], a[136:139], v[20:23]
  buffer_load_dwordx4 v253, s[12:15], s93 offen offset:1056 lds
  v_mfma_f32_16x16x32_bf16 v[24:27], a[24:27], a[128:131], 0
  ds_read_b64_tr_b16 a[84:85], v109 offset:33952
  ds_read_b64_tr_b16 a[86:87], v109 offset:42400
  ds_read_b64_tr_b16 a[116:117], v109 offset:34464
  ds_read_b64_tr_b16 a[118:119], v109 offset:42912
  ds_read_b64_tr_b16 a[88:89], v109 offset:33984
  ds_read_b64_tr_b16 a[90:91], v109 offset:42432
  v_mfma_f32_16x16x32_bf16 v[24:27], a[56:59], a[136:139], v[24:27]
  buffer_load_dwordx4 v254, s[12:15], s93 offen offset:2112 lds
  v_mfma_f32_16x16x32_bf16 v[28:31], a[28:31], a[128:131], 0
  ds_read_b64_tr_b16 a[120:121], v109 offset:34496
  ds_read_b64_tr_b16 a[122:123], v109 offset:42944
  ds_read_b64_tr_b16 a[92:93], v109 offset:34016
  ds_read_b64_tr_b16 a[94:95], v109 offset:42464
  ds_read_b64_tr_b16 a[124:125], v109 offset:34528
  ds_read_b64_tr_b16 a[126:127], v109 offset:42976
  v_mfma_f32_16x16x32_bf16 v[28:31], a[60:63], a[136:139], v[28:31]
  buffer_load_dwordx4 v255, s[12:15], s93 offen offset:3168 lds
  s_waitcnt vmcnt(4)
L_g1_pl:
  v_cmp_ne_u32 vcc, 1, v113
  s_mov_b32 s34, 0
  s_cbranch_vccz L_g1_pok
L_g1_pl2:
  s_sleep 1
  global_load_dword v113, v112, s[44:45] sc1
  s_waitcnt vmcnt(0)
  v_cmp_ne_u32 vcc, 1, v113
  s_add_u32 s34, s34, 1
  s_cbranch_vccz L_g1_pok
  s_cmp_lt_u32 s34, 0x200000
  s_cbranch_scc1 L_g1_pl2
L_g1_pok:
  s_cmp_eq_u32 s39, 1
  s_cbranch_scc1 L_g1_pgo
  buffer_inv sc1
  s_waitcnt vmcnt(0)
L_g1_pgo:
  s_waitcnt vmcnt(9)
  v_mfma_f32_16x16x32_bf16 v[0:3], a[64:67], a[144:147], v[0:3]
  s_add_u32 s92, s94, 2
  s_and_b32 s92, s92, 15
  s_lshl_b32 s92, s92, 14
  v_mfma_f32_16x16x32_bf16 v[0:3], a[96:99], a[152:155], v[0:3]
  buffer_load_dwordx4 a[160:163], v104, s[8:11], s92 offen offset:0
  s_waitcnt lgkmcnt(6)
  v_mfma_f32_16x16x32_bf16 v[4:7], a[68:71], a[144:147], v[4:7]
  ds_read_b64_tr_b16 a[0:1], v110 offset:0
  ds_read_b64_tr_b16 a[2:3], v110 offset:8448
  ds_read_b64_tr_b16 a[32:33], v110 offset:512
  ds_read_b64_tr_b16 a[34:35], v110 offset:8960
  v_mfma_f32_16x16x32_bf16 v[4:7], a[100:103], a[152:155], v[4:7]
  buffer_load_dwordx4 a[168:171], v105, s[8:11], s92 offen offset:0
  s_add_u32 s92, s94, 3
  s_and_b32 s92, s92, 15
  v_mfma_f32_16x16x32_bf16 v[8:11], a[72:75], a[144:147], v[8:11]
  s_lshl_b32 s92, s92, 14
  ds_read_b64_tr_b16 a[4:5], v110 offset:32
  ds_read_b64_tr_b16 a[6:7], v110 offset:8480
  ds_read_b64_tr_b16 a[36:37], v110 offset:544
  ds_read_b64_tr_b16 a[38:39], v110 offset:8992
  v_mfma_f32_16x16x32_bf16 v[8:11], a[104:107], a[152:155], v[8:11]
  buffer_load_dwordx4 a[176:179], v104, s[8:11], s92 offen offset:0
  v_mfma_f32_16x16x32_bf16 v[12:15], a[76:79], a[144:147], v[12:15]
  ds_read_b64_tr_b16 a[8:9], v110 offset:64
  ds_read_b64_tr_b16 a[10:11], v110 offset:8512
  ds_read_b64_tr_b16 a[40:41], v110 offset:576
  v_mfma_f32_16x16x32_bf16 v[12:15], a[108:111], a[152:155], v[12:15]
  ds_read_b64_tr_b16 a[42:43], v110 offset:9024
  ds_read_b64_tr_b16 a[12:13], v110 offset:96
  ds_read_b64_tr_b16 a[14:15], v110 offset:8544
  ds_read_b64_tr_b16 a[44:45], v110 offset:608
  v_mfma_f32_16x16x32_bf16 v[16:19], a[80:83], a[144:147], v[16:19]
  buffer_load_dwordx4 a[184:187], v105, s[8:11], s92 offen offset:0
  s_add_u32 s92, s94, 4
  s_and_b32 s92, s92, 15
  v_mfma_f32_16x16x32_bf16 v[16:19], a[112:115], a[152:155], v[16:19]
  s_lshl_b32 s92, s92, 14
  ds_read_b64_tr_b16 a[46:47], v110 offset:9056
  ds_read_b64_tr_b16 a[16:17], v110 offset:128
  ds_read_b64_tr_b16 a[18:19], v110 offset:8576
  v_mfma_f32_16x16x32_bf16 v[20:23], a[84:87], a[144:147], v[20:23]
  buffer_load_dwordx4 a[192:195], v104, s[8:11], s92 offen offset:0
  v_mfma_f32_16x16x32_bf16 v[20:23], a[116:119], a[152:155], v[20:23]
  ds_read_b64_tr_b16 a[48:49], v110 offset:640
  ds_read_b64_tr_b16 a[50:51], v110 offset:9088
  ds_read_b64_tr_b16 a[20:21], v110 offset:160
  ds_read_b64_tr_b16 a[22:23], v110 offset:8608
  v_mfma_f32_16x16x32_bf16 v[24:27], a[88:91], a[144:147], v[24:27]
  buffer_load_dwordx4 a[200:203], v105, s[8:11], s92 offen offset:0
  s_waitcnt lgkmcnt(7)
  v_mfma_f32_16x16x32_bf16 v[24:27], a[120:123], a[152:155], v[24:27]
  ds_read_b64_tr_b16 a[52:53], v110 offset:672
  ds_read_b64_tr_b16 a[54:55], v110 offset:9120
  ds_read_b64_tr_b16 a[24:25], v110 offset:192
  v_mfma_f32_16x16x32_bf16 v[28:31], a[92:95], a[144:147], v[28:31]
  ds_read_b64_tr_b16 a[26:27], v110 offset:8640
  ds_read_b64_tr_b16 a[56:57], v110 offset:704
  ds_read_b64_tr_b16 a[58:59], v110 offset:9152
  ds_read_b64_tr_b16 a[28:29], v110 offset:224
  v_mfma_f32_16x16x32_bf16 v[28:31], a[124:127], a[152:155], v[28:31]
  s_waitcnt vmcnt(4)
  ds_read_b64_tr_b16 a[30:31], v110 offset:8672
  ds_read_b64_tr_b16 a[60:61], v110 offset:736
  ds_read_b64_tr_b16 a[62:63], v110 offset:9184
  v_mfma_f32_16x16x32_bf16 v[0:3], a[0:3], a[160:163], v[0:3]
  s_barrier
  s_add_u32 s92, s94, 5
  s_and_b32 s92, s92, 15
  s_lshl_b32 s92, s92, 14
  v_mfma_f32_16x16x32_bf16 v[0:3], a[32:35], a[168:171], v[0:3]
  buffer_load_dwordx4 a[208:211], v104, s[8:11], s92 offen offset:0
  v_mfma_f32_16x16x32_bf16 v[4:7], a[4:7], a[160:163], v[4:7]
  ds_read_b64_tr_b16 a[64:65], v110 offset:16896
  ds_read_b64_tr_b16 a[66:67], v110 offset:25344
  ds_read_b64_tr_b16 a[96:97], v110 offset:17408
  ds_read_b64_tr_b16 a[98:99], v110 offset:25856
  v_mfma_f32_16x16x32_bf16 v[4:7], a[36:39], a[168:171], v[4:7]
  buffer_load_dwordx4 a[216:219], v105, s[8:11], s92 offen offset:0
  s_add_u32 s92, s94, 6
  s_and_b32 s92, s92, 15
  v_mfma_f32_16x16x32_bf16 v[8:11], a[8:11], a[160:163], v[8:11]
  s_lshl_b32 s92, s92, 14
  ds_read_b64_tr_b16 a[68:69], v110 offset:16928
  ds_read_b64_tr_b16 a[70:71], v110 offset:25376
  ds_read_b64_tr_b16 a[100:101], v110 offset:17440
  ds_read_b64_tr_b16 a[102:103], v110 offset:25888
  v_mfma_f32_16x16x32_bf16 v[8:11], a[40:43], a[168:171], v[8:11]
  buffer_load_dwordx4 a[224:227], v104, s[8:11], s92 offen offset:0
  v_mfma_f32_16x16x32_bf16 v[12:15], a[12:15], a[160:163], v[12:15]
  ds_read_b64_tr_b16 a[72:73], v110 offset:16960
  ds_read_b64_tr_b16 a[74:75], v110 offset:25408
  ds_read_b64_tr_b16 a[104:105], v110 offset:17472
  s_waitcnt lgkmcnt(7)
  ds_read_b64_tr_b16 a[106:107], v110 offset:25920
  v_mfma_f32_16x16x32_bf16 v[12:15], a[44:47], a[168:171], v[12:15]
  ds_read_b64_tr_b16 a[76:77], v110 offset:16992
  ds_read_b64_tr_b16 a[78:79], v110 offset:25440
  ds_read_b64_tr_b16 a[108:109], v110 offset:17504
  ds_read_b64_tr_b16 a[110:111], v110 offset:25952
  v_mfma_f32_16x16x32_bf16 v[16:19], a[16:19], a[160:163], v[16:19]
  buffer_load_dwordx4 a[232:235], v105, s[8:11], s92 offen offset:0
  s_add_u32 s93, s94, 9
  s_and_b32 s93, s93, 15
  s_lshl_b32 s93, s93, 16
  v_mfma_f32_16x16x32_bf16 v[16:19], a[48:51], a[168:171], v[16:19]
  s_add_u32 m0, s32, 0
  ds_read_b64_tr_b16 a[80:81], v110 offset:17024
  ds_read_b64_tr_b16 a[82:83], v110 offset:25472
  ds_read_b64_tr_b16 a[112:113], v110 offset:17536
  ds_read_b64_tr_b16 a[114:115], v110 offset:25984
  v_mfma_f32_16x16x32_bf16 v[20:23], a[20:23], a[160:163], v[20:23]
  buffer_load_dwordx4 v252, s[12:15], s93 offen offset:0 lds
  v_mfma_f32_16x16x32_bf16 v[20:23], a[52:55], a[168:171], v[20:23]
  ds_read_b64_tr_b16 a[84:85], v110 offset:17056
  ds_read_b64_tr_b16 a[86:87], v110 offset:25504
  ds_read_b64_tr_b16 a[116:117], v110 offset:17568
  ds_read_b64_tr_b16 a[118:119], v110 offset:26016
  v_mfma_f32_16x16x32_bf16 v[24:27], a[24:27], a[160:163], v[24:27]
  buffer_load_dwordx4 v253, s[12:15], s93 offen offset:1056 lds
  v_mfma_f32_16x16x32_bf16 v[24:27], a[56:59], a[168:171], v[24:27]
  ds_read_b64_tr_b16 a[88:89], v110 offset:17088
  ds_read_b64_tr_b16 a[90:91], v110 offset:25536
  ds_read_b64_tr_b16 a[120:121], v110 offset:17600
  ds_read_b64_tr_b16 a[122:123], v110 offset:26048
  v_mfma_f32_16x16x32_bf16 v[28:31], a[28:31], a[160:163], v[28:31]
  buffer_load_dwordx4 v254, s[12:15], s93 offen offset:2112 lds
  v_mfma_f32_16x16x32_bf16 v[28:31], a[60:63], a[168:171], v[28:31]
  s_waitcnt vmcnt(9)
  ds_read_b64_tr_b16 a[92:93], v110 offset:17120
  ds_read_b64_tr_b16 a[94:95], v110 offset:25568
  ds_read_b64_tr_b16 a[124:125], v110 offset:17632
  ds_read_b64_tr_b16 a[126:127], v110 offset:26080
  v_mfma_f32_16x16x32_bf16 v[0:3], a[64:67], a[176:179], v[0:3]
  s_add_u32 s92, s94, 7
  s_and_b32 s92, s92, 15
  s_lshl_b32 s92, s92, 14
  v_mfma_f32_16x16x32_bf16 v[0:3], a[96:99], a[184:187], v[0:3]
  buffer_load_dwordx4 a[240:243], v104, s[8:11], s92 offen offset:0
  s_waitcnt lgkmcnt(5)
  v_mfma_f32_16x16x32_bf16 v[4:7], a[68:71], a[176:179], v[4:7]
  ds_read_b64_tr_b16 a[0:1], v110 offset:33792
  ds_read_b64_tr_b16 a[2:3], v110 offset:42240
  ds_read_b64_tr_b16 a[32:33], v110 offset:34304
  ds_read_b64_tr_b16 a[34:35], v110 offset:42752
  v_mfma_f32_16x16x32_bf16 v[4:7], a[100:103], a[184:187], v[4:7]
  ds_read_b64_tr_b16 a[4:5], v110 offset:33824
  ds_read_b64_tr_b16 a[6:7], v110 offset:42272
  ds_read_b64_tr_b16 a[36:37], v110 offset:34336
  v_mfma_f32_16x16x32_bf16 v[8:11], a[72:75], a[176:179], v[8:11]
  buffer_load_dwordx4 a[248:251], v105, s[8:11], s92 offen offset:0
  v_mfma_f32_16x16x32_bf16 v[8:11], a[104:107], a[184:187], v[8:11]
  ds_read_b64_tr_b16 a[38:39], v110 offset:42784
  ds_read_b64_tr_b16 a[8:9], v110 offset:33856
  ds_read_b64_tr_b16 a[10:11], v110 offset:42304
  v_mfma_f32_16x16x32_bf16 v[12:15], a[76:79], a[176:179], v[12:15]
  ds_read_b64_tr_b16 a[40:41], v110 offset:34368
  ds_read_b64_tr_b16 a[42:43], v110 offset:42816
  ds_read_b64_tr_b16 a[12:13], v110 offset:33888
  v_mfma_f32_16x16x32_bf16 v[12:15], a[108:111], a[184:187], v[12:15]
  s_add_u32 m0, s32, 0
  ds_read_b64_tr_b16 a[14:15], v110 offset:42336
  ds_read_b64_tr_b16 a[44:45], v110 offset:34400
  ds_read_b64_tr_b16 a[46:47], v110 offset:42848
  v_mfma_f32_16x16x32_bf16 v[16:19], a[80:83], a[176:179], v[16:19]
  buffer_load_dwordx4 v255, s[12:15], s93 offen offset:3168 lds
  s_add_u32 s93, s94, 10
  s_and_b32 s93, s93, 15
  v_mfma_f32_16x16x32_bf16 v[16:19], a[112:115], a[184:187], v[16:19]
  s_lshl_b32 s93, s93, 16
  ds_read_b64_tr_b16 a[16:17], v110 offset:33920
  ds_read_b64_tr_b16 a[18:19], v110 offset:42368
  ds_read_b64_tr_b16 a[48:49], v110 offset:34432
  ds_read_b64_tr_b16 a[50:51], v110 offset:42880
  v_mfma_f32_16x16x32_bf16 v[20:23], a[84:87], a[176:179], v[20:23]
  s_add_u32 m0, s32, 33792
  ds_read_b64_tr_b16 a[20:21], v110 offset:33952
  ds_read_b64_tr_b16 a[22:23], v110 offset:42400
  ds_read_b64_tr_b16 a[52:53], v110 offset:34464
  v_mfma_f32_16x16x32_bf16 v[20:23], a[116:119], a[184:187], v[20:23]
  buffer_load_dwordx4 v252, s[12:15], s93 offen offset:0 lds
  v_mfma_f32_16x16x32_bf16 v[24:27], a[88:91], a[176:179], v[24:27]
  ds_read_b64_tr_b16 a[54:55], v110 offset:42912
  ds_read_b64_tr_b16 a[24:25], v110 offset:33984
  s_waitcnt lgkmcnt(9)
  ds_read_b64_tr_b16 a[26:27], v110 offset:42432
  v_mfma_f32_16x16x32_bf16 v[24:27], a[120:123], a[184:187], v[24:27]
  ds_read_b64_tr_b16 a[56:57], v110 offset:34496
  ds_read_b64_tr_b16 a[58:59], v110 offset:42944
  ds_read_b64_tr_b16 a[28:29], v110 offset:34016
  v_mfma_f32_16x16x32_bf16 v[28:31], a[92:95], a[176:179], v[28:31]
  buffer_load_dwordx4 v253, s[12:15], s93 offen offset:1056 lds
  v_mfma_f32_16x16x32_bf16 v[28:31], a[124:127], a[184:187], v[28:31]
  s_waitcnt vmcnt(12)
  ds_read_b64_tr_b16 a[30:31], v110 offset:42464
  ds_read_b64_tr_b16 a[60:61], v110 offset:34528
  ds_read_b64_tr_b16 a[62:63], v110 offset:42976
  v_mfma_f32_16x16x32_bf16 v[0:3], a[0:3], a[192:195], v[0:3]
  s_barrier
  s_add_u32 s92, s94, 8
  s_and_b32 s92, s92, 15
  s_lshl_b32 s92, s92, 14
  v_mfma_f32_16x16x32_bf16 v[0:3], a[32:35], a[200:203], v[0:3]
  buffer_load_dwordx4 a[128:131], v104, s[8:11], s92 offen offset:0
  v_mfma_f32_16x16x32_bf16 v[4:7], a[4:7], a[192:195], v[4:7]
  ds_read_b64_tr_b16 a[64:65], v111 offset:0
  ds_read_b64_tr_b16 a[66:67], v111 offset:8448
  ds_read_b64_tr_b16 a[96:97], v111 offset:512
  ds_read_b64_tr_b16 a[98:99], v111 offset:8960
  v_mfma_f32_16x16x32_bf16 v[4:7], a[36:39], a[200:203], v[4:7]
  ds_read_b64_tr_b16 a[68:69], v111 offset:32
  ds_read_b64_tr_b16 a[70:71], v111 offset:8480
  ds_read_b64_tr_b16 a[100:101], v111 offset:544
  v_mfma_f32_16x16x32_bf16 v[8:11], a[8:11], a[192:195], v[8:11]
  buffer_load_dwordx4 a[136:139], v105, s[8:11], s92 offen offset:0
  v_mfma_f32_16x16x32_bf16 v[8:11], a[40:43], a[200:203], v[8:11]
  ds_read_b64_tr_b16 a[102:103], v111 offset:8992
  ds_read_b64_tr_b16 a[72:73], v111 offset:64
  ds_read_b64_tr_b16 a[74:75], v111 offset:8512
  v_mfma_f32_16x16x32_bf16 v[12:15], a[12:15], a[192:195], v[12:15]
  ds_read_b64_tr_b16 a[104:105], v111 offset:576
  ds_read_b64_tr_b16 a[106:107], v111 offset:9024
  ds_read_b64_tr_b16 a[76:77], v111 offset:96
  v_mfma_f32_16x16x32_bf16 v[12:15], a[44:47], a[200:203], v[12:15]
  s_add_u32 m0, s32, 33792
  ds_read_b64_tr_b16 a[78:79], v111 offset:8544
  ds_read_b64_tr_b16 a[108:109], v111 offset:608
  s_waitcnt lgkmcnt(8)
  ds_read_b64_tr_b16 a[110:111], v111 offset:9056
  v_mfma_f32_16x16x32_bf16 v[16:19], a[16:19], a[192:195], v[16:19]
  buffer_load_dwordx4 v254, s[12:15], s93 offen offset:2112 lds
  v_mfma_f32_16x16x32_bf16 v[16:19], a[48:51], a[200:203], v[16:19]
  ds_read_b64_tr_b16 a[80:81], v111 offset:128
  ds_read_b64_tr_b16 a[82:83], v111 offset:8576
  ds_read_b64_tr_b16 a[112:113], v111 offset:640
  ds_read_b64_tr_b16 a[114:115], v111 offset:9088
  v_mfma_f32_16x16x32_bf16 v[20:23], a[20:23], a[192:195], v[20:23]
  ds_read_b64_tr_b16 a[84:85], v111 offset:160
  ds_read_b64_tr_b16 a[86:87], v111 offset:8608
  ds_read_b64_tr_b16 a[116:117], v111 offset:672
  v_mfma_f32_16x16x32_bf16 v[20:23], a[52:55], a[200:203], v[20:23]
  buffer_load_dwordx4 v255, s[12:15], s93 offen offset:3168 lds
  s_add_u32 s93, s94, 11
  s_and_b32 s93, s93, 15
  v_mfma_f32_16x16x32_bf16 v[24:27], a[24:27], a[192:195], v[24:27]
  s_lshl_b32 s93, s93, 16
  ds_read_b64_tr_b16 a[118:119], v111 offset:9120
  ds_read_b64_tr_b16 a[88:89], v111 offset:192
  ds_read_b64_tr_b16 a[90:91], v111 offset:8640
  v_mfma_f32_16x16x32_bf16 v[24:27], a[56:59], a[200:203], v[24:27]
  s_add_u32 m0, s32, 50688
  ds_read_b64_tr_b16 a[120:121], v111 offset:704
  ds_read_b64_tr_b16 a[122:123], v111 offset:9152
  ds_read_b64_tr_b16 a[92:93], v111 offset:224
  v_mfma_f32_16x16x32_bf16 v[28:31], a[28:31], a[192:195], v[28:31]
  buffer_load_dwordx4 v252, s[12:15], s93 offen offset:0 lds
  v_mfma_f32_16x16x32_bf16 v[28:31], a[60:63], a[200:203], v[28:31]
  s_waitcnt vmcnt(15)
  ds_read_b64_tr_b16 a[94:95], v111 offset:8672
  ds_read_b64_tr_b16 a[124:125], v111 offset:736
  ds_read_b64_tr_b16 a[126:127], v111 offset:9184
  v_mfma_f32_16x16x32_bf16 v[0:3], a[64:67], a[208:211], v[0:3]
  s_add_u32 s92, s94, 9
  s_and_b32 s92, s92, 15
  s_lshl_b32 s92, s92, 14
  v_mfma_f32_16x16x32_bf16 v[0:3], a[96:99], a[216:219], v[0:3]
  buffer_load_dwordx4 a[144:147], v104, s[8:11], s92 offen offset:0
  v_mfma_f32_16x16x32_bf16 v[4:7], a[68:71], a[208:211], v[4:7]
  ds_read_b64_tr_b16 a[0:1], v111 offset:16896
  ds_read_b64_tr_b16 a[2:3], v111 offset:25344
  ds_read_b64_tr_b16 a[32:33], v111 offset:17408
  s_waitcnt lgkmcnt(6)
  ds_read_b64_tr_b16 a[34:35], v111 offset:25856
  v_mfma_f32_16x16x32_bf16 v[4:7], a[100:103], a[216:219], v[4:7]
  ds_read_b64_tr_b16 a[4:5], v111 offset:16928
  ds_read_b64_tr_b16 a[6:7], v111 offset:25376
  ds_read_b64_tr_b16 a[36:37], v111 offset:17440
  v_mfma_f32_16x16x32_bf16 v[8:11], a[72:75], a[208:211], v[8:11]
  buffer_load_dwordx4 a[152:155], v105, s[8:11], s92 offen offset:0
  v_mfma_f32_16x16x32_bf16 v[8:11], a[104:107], a[216:219], v[8:11]
  ds_read_b64_tr_b16 a[38:39], v111 offset:25888
  ds_read_b64_tr_b16 a[8:9], v111 offset:16960
  ds_read_b64_tr_b16 a[10:11], v111 offset:25408
  v_mfma_f32_16x16x32_bf16 v[12:15], a[76:79], a[208:211], v[12:15]
  ds_read_b64_tr_b16 a[40:41], v111 offset:17472
  ds_read_b64_tr_b16 a[42:43], v111 offset:25920
  ds_read_b64_tr_b16 a[12:13], v111 offset:16992
  v_mfma_f32_16x16x32_bf16 v[12:15], a[108:111], a[216:219], v[12:15]
  s_add_u32 m0, s32, 50688
  ds_read_b64_tr_b16 a[14:15], v111 offset:25440
  ds_read_b64_tr_b16 a[44:45], v111 offset:17504
  ds_read_b64_tr_b16 a[46:47], v111 offset:25952
  v_mfma_f32_16x16x32_bf16 v[16:19], a[80:83], a[208:211], v[16:19]
  buffer_load_dwordx4 v253, s[12:15], s93 offen offset:1056 lds
  v_mfma_f32_16x16x32_bf16 v[16:19], a[112:115], a[216:219], v[16:19]
  ds_read_b64_tr_b16 a[16:17], v111 offset:17024
  ds_read_b64_tr_b16 a[18:19], v111 offset:25472
  ds_read_b64_tr_b16 a[48:49], v111 offset:17536
  ds_read_b64_tr_b16 a[50:51], v111 offset:25984
  v_mfma_f32_16x16x32_bf16 v[20:23], a[84:87], a[208:211], v[20:23]
  ds_read_b64_tr_b16 a[20:21], v111 offset:17056
  ds_read_b64_tr_b16 a[22:23], v111 offset:25504
  ds_read_b64_tr_b16 a[52:53], v111 offset:17568
  v_mfma_f32_16x16x32_bf16 v[20:23], a[116:119], a[216:219], v[20:23]
  buffer_load_dwordx4 v254, s[12:15], s93 offen offset:2112 lds
  v_mfma_f32_16x16x32_bf16 v[24:27], a[88:91], a[208:211], v[24:27]
  ds_read_b64_tr_b16 a[54:55], v111 offset:26016
  ds_read_b64_tr_b16 a[24:25], v111 offset:17088
  ds_read_b64_tr_b16 a[26:27], v111 offset:25536
  v_mfma_f32_16x16x32_bf16 v[24:27], a[120:123], a[216:219], v[24:27]
  ds_read_b64_tr_b16 a[56:57], v111 offset:17600
  ds_read_b64_tr_b16 a[58:59], v111 offset:26048
  s_waitcnt lgkmcnt(9)
  ds_read_b64_tr_b16 a[28:29], v111 offset:17120
  v_mfma_f32_16x16x32_bf16 v[28:31], a[92:95], a[208:211], v[28:31]
  buffer_load_dwordx4 v255, s[12:15], s93 offen offset:3168 lds
  v_mfma_f32_16x16x32_bf16 v[28:31], a[124:127], a[216:219], v[28:31]
  s_waitcnt vmcnt(18)
  ds_read_b64_tr_b16 a[30:31], v111 offset:25568
  ds_read_b64_tr_b16 a[60:61], v111 offset:17632
  ds_read_b64_tr_b16 a[62:63], v111 offset:26080
  v_mfma_f32_16x16x32_bf16 v[0:3], a[0:3], a[224:227], v[0:3]
  s_barrier
  s_add_u32 s92, s94, 10
  s_and_b32 s92, s92, 15
  s_lshl_b32 s92, s92, 14
  v_mfma_f32_16x16x32_bf16 v[0:3], a[32:35], a[232:235], v[0:3]
  buffer_load_dwordx4 a[160:163], v104, s[8:11], s92 offen offset:0
  v_mfma_f32_16x16x32_bf16 v[4:7], a[4:7], a[224:227], v[4:7]
  ds_read_b64_tr_b16 a[64:65], v111 offset:33792
  ds_read_b64_tr_b16 a[66:67], v111 offset:42240
  ds_read_b64_tr_b16 a[96:97], v111 offset:34304
  ds_read_b64_tr_b16 a[98:99], v111 offset:42752
  v_mfma_f32_16x16x32_bf16 v[4:7], a[36:39], a[232:235], v[4:7]
  ds_read_b64_tr_b16 a[68:69], v111 offset:33824
  ds_read_b64_tr_b16 a[70:71], v111 offset:42272
  ds_read_b64_tr_b16 a[100:101], v111 offset:34336
  v_mfma_f32_16x16x32_bf16 v[8:11], a[8:11], a[224:227], v[8:11]
  buffer_load_dwordx4 a[168:171], v105, s[8:11], s92 offen offset:0
  s_add_u32 s93, s94, 12
  v_mfma_f32_16x16x32_bf16 v[8:11], a[40:43], a[232:235], v[8:11]
  s_and_b32 s93, s93, 15
  ds_read_b64_tr_b16 a[102:103], v111 offset:42784
  ds_read_b64_tr_b16 a[72:73], v111 offset:33856
  ds_read_b64_tr_b16 a[74:75], v111 offset:42304
  v_mfma_f32_16x16x32_bf16 v[12:15], a[12:15], a[224:227], v[12:15]
  s_lshl_b32 s93, s93, 16
  ds_read_b64_tr_b16 a[104:105], v111 offset:34368
  ds_read_b64_tr_b16 a[106:107], v111 offset:42816
  ds_read_b64_tr_b16 a[76:77], v111 offset:33888
  v_mfma_f32_16x16x32_bf16 v[12:15], a[44:47], a[232:235], v[12:15]
  s_add_u32 m0, s32, 67584
  ds_read_b64_tr_b16 a[78:79], v111 offset:42336
  ds_read_b64_tr_b16 a[108:109], v111 offset:34400
  ds_read_b64_tr_b16 a[110:111], v111 offset:42848
  v_mfma_f32_16x16x32_bf16 v[16:19], a[16:19], a[224:227], v[16:19]
  buffer_load_dwordx4 v252, s[12:15], s93 offen offset:0 lds
  s_waitcnt lgkmcnt(9)
  v_mfma_f32_16x16x32_bf16 v[16:19], a[48:51], a[232:235], v[16:19]
  ds_read_b64_tr_b16 a[80:81], v111 offset:33920
  ds_read_b64_tr_b16 a[82:83], v111 offset:42368
  ds_read_b64_tr_b16 a[112:113], v111 offset:34432
  ds_read_b64_tr_b16 a[114:115], v111 offset:42880
  v_mfma_f32_16x16x32_bf16 v[20:23], a[20:23], a[224:227], v[20:23]
  ds_read_b64_tr_b16 a[84:85], v111 offset:33952
  ds_read_b64_tr_b16 a[86:87], v111 offset:42400
  ds_read_b64_tr_b16 a[116:117], v111 offset:34464
  v_mfma_f32_16x16x32_bf16 v[20:23], a[52:55], a[232:235], v[20:23]
  buffer_load_dwordx4 v253, s[12:15], s93 offen offset:1056 lds
  v_mfma_f32_16x16x32_bf16 v[24:27], a[24:27], a[224:227], v[24:27]
  ds_read_b64_tr_b16 a[118:119], v111 offset:42912
  ds_read_b64_tr_b16 a[88:89], v111 offset:33984
  ds_read_b64_tr_b16 a[90:91], v111 offset:42432
  v_mfma_f32_16x16x32_bf16 v[24:27], a[56:59], a[232:235], v[24:27]
  ds_read_b64_tr_b16 a[120:121], v111 offset:34496
  ds_read_b64_tr_b16 a[122:123], v111 offset:42944
  ds_read_b64_tr_b16 a[92:93], v111 offset:34016
  v_mfma_f32_16x16x32_bf16 v[28:31], a[28:31], a[224:227], v[28:31]
  buffer_load_dwordx4 v254, s[12:15], s93 offen offset:2112 lds
  v_mfma_f32_16x16x32_bf16 v[28:31], a[60:63], a[232:235], v[28:31]
  s_waitcnt vmcnt(18)
  ds_read_b64_tr_b16 a[94:95], v111 offset:42464
  ds_read_b64_tr_b16 a[124:125], v111 offset:34528
  ds_read_b64_tr_b16 a[126:127], v111 offset:42976
  v_mfma_f32_16x16x32_bf16 v[0:3], a[64:67], a[240:243], v[0:3]
  s_add_u32 s92, s94, 11
  s_and_b32 s92, s92, 15
  s_lshl_b32 s92, s92, 14
  v_mfma_f32_16x16x32_bf16 v[0:3], a[96:99], a[248:251], v[0:3]
  buffer_load_dwordx4 a[176:179], v104, s[8:11], s92 offen offset:0
  v_mfma_f32_16x16x32_bf16 v[4:7], a[68:71], a[240:243], v[4:7]
  ds_read_b64_tr_b16 a[0:1], v109 offset:16896
  ds_read_b64_tr_b16 a[2:3], v109 offset:25344
  ds_read_b64_tr_b16 a[32:33], v109 offset:17408
  s_waitcnt lgkmcnt(6)
  ds_read_b64_tr_b16 a[34:35], v109 offset:25856
  v_mfma_f32_16x16x32_bf16 v[4:7], a[100:103], a[248:251], v[4:7]
  ds_read_b64_tr_b16 a[4:5], v109 offset:16928
  ds_read_b64_tr_b16 a[6:7], v109 offset:25376
  ds_read_b64_tr_b16 a[36:37], v109 offset:17440
  v_mfma_f32_16x16x32_bf16 v[8:11], a[72:75], a[240:243], v[8:11]
  buffer_load_dwordx4 a[184:187], v105, s[8:11], s92 offen offset:0
  v_mfma_f32_16x16x32_bf16 v[8:11], a[104:107], a[248:251], v[8:11]
  ds_read_b64_tr_b16 a[38:39], v109 offset:25888
  ds_read_b64_tr_b16 a[8:9], v109 offset:16960
  ds_read_b64_tr_b16 a[10:11], v109 offset:25408
  v_mfma_f32_16x16x32_bf16 v[12:15], a[76:79], a[240:243], v[12:15]
  ds_read_b64_tr_b16 a[40:41], v109 offset:17472
  ds_read_b64_tr_b16 a[42:43], v109 offset:25920
  ds_read_b64_tr_b16 a[12:13], v109 offset:16992
  v_mfma_f32_16x16x32_bf16 v[12:15], a[108:111], a[248:251], v[12:15]
  s_add_u32 m0, s32, 67584
  ds_read_b64_tr_b16 a[14:15], v109 offset:25440
  ds_read_b64_tr_b16 a[44:45], v109 offset:17504
  ds_read_b64_tr_b16 a[46:47], v109 offset:25952
  v_mfma_f32_16x16x32_bf16 v[16:19], a[80:83], a[240:243], v[16:19]
  buffer_load_dwordx4 v255, s[12:15], s93 offen offset:3168 lds
  s_add_u32 s93, s94, 13
  s_and_b32 s93, s93, 15
  v_mfma_f32_16x16x32_bf16 v[16:19], a[112:115], a[248:251], v[16:19]
  s_lshl_b32 s93, s93, 16
  ds_read_b64_tr_b16 a[16:17], v109 offset:17024
  ds_read_b64_tr_b16 a[18:19], v109 offset:25472
  ds_read_b64_tr_b16 a[48:49], v109 offset:17536
  ds_read_b64_tr_b16 a[50:51], v109 offset:25984
  v_mfma_f32_16x16x32_bf16 v[20:23], a[84:87], a[240:243], v[20:23]
  s_add_u32 m0, s32, 84480
  ds_read_b64_tr_b16 a[20:21], v109 offset:17056
  ds_read_b64_tr_b16 a[22:23], v109 offset:25504
  ds_read_b64_tr_b16 a[52:53], v109 offset:17568
  v_mfma_f32_16x16x32_bf16 v[20:23], a[116:119], a[248:251], v[20:23]
  buffer_load_dwordx4 v252, s[12:15], s93 offen offset:0 lds
  v_mfma_f32_16x16x32_bf16 v[24:27], a[88:91], a[240:243], v[24:27]
  ds_read_b64_tr_b16 a[54:55], v109 offset:26016
  ds_read_b64_tr_b16 a[24:25], v109 offset:17088
  ds_read_b64_tr_b16 a[26:27], v109 offset:25536
  v_mfma_f32_16x16x32_bf16 v[24:27], a[120:123], a[248:251], v[24:27]
  ds_read_b64_tr_b16 a[56:57], v109 offset:17600
  ds_read_b64_tr_b16 a[58:59], v109 offset:26048
  s_waitcnt lgkmcnt(8)
  ds_read_b64_tr_b16 a[28:29], v109 offset:17120
  v_mfma_f32_16x16x32_bf16 v[28:31], a[92:95], a[240:243], v[28:31]
  buffer_load_dwordx4 v253, s[12:15], s93 offen offset:1056 lds
  v_mfma_f32_16x16x32_bf16 v[28:31], a[124:127], a[248:251], v[28:31]
  s_waitcnt vmcnt(16)
  ds_read_b64_tr_b16 a[30:31], v109 offset:25568
  ds_read_b64_tr_b16 a[60:61], v109 offset:17632
  ds_read_b64_tr_b16 a[62:63], v109 offset:26080
  v_mfma_f32_16x16x32_bf16 v[0:3], a[0:3], a[128:131], v[0:3]
  s_barrier
  s_add_u32 s92, s94, 12
  s_and_b32 s92, s92, 15
  s_lshl_b32 s92, s92, 14
  v_mfma_f32_16x16x32_bf16 v[0:3], a[32:35], a[136:139], v[0:3]
  buffer_load_dwordx4 a[192:195], v104, s[8:11], s92 offen offset:0
  v_mfma_f32_16x16x32_bf16 v[4:7], a[4:7], a[128:131], v[4:7]
  ds_read_b64_tr_b16 a[64:65], v109 offset:0
  ds_read_b64_tr_b16 a[66:67], v109 offset:8448
  ds_read_b64_tr_b16 a[96:97], v109 offset:512
  ds_read_b64_tr_b16 a[98:99], v109 offset:8960
  v_mfma_f32_16x16x32_bf16 v[4:7], a[36:39], a[136:139], v[4:7]
  ds_read_b64_tr_b16 a[68:69], v109 offset:32
  ds_read_b64_tr_b16 a[70:71], v109 offset:8480
  ds_read_b64_tr_b16 a[100:101], v109 offset:544
  v_mfma_f32_16x16x32_bf16 v[8:11], a[8:11], a[128:131], v[8:11]
  buffer_load_dwordx4 a[200:203], v105, s[8:11], s92 offen offset:0
  v_mfma_f32_16x16x32_bf16 v[8:11], a[40:43], a[136:139], v[8:11]
  ds_read_b64_tr_b16 a[102:103], v109 offset:8992
  ds_read_b64_tr_b16 a[72:73], v109 offset:64
  ds_read_b64_tr_b16 a[74:75], v109 offset:8512
  v_mfma_f32_16x16x32_bf16 v[12:15], a[12:15], a[128:131], v[12:15]
  ds_read_b64_tr_b16 a[104:105], v109 offset:576
  ds_read_b64_tr_b16 a[106:107], v109 offset:9024
  ds_read_b64_tr_b16 a[76:77], v109 offset:96
  v_mfma_f32_16x16x32_bf16 v[12:15], a[44:47], a[136:139], v[12:15]
  s_add_u32 m0, s32, 84480
  ds_read_b64_tr_b16 a[78:79], v109 offset:8544
  ds_read_b64_tr_b16 a[108:109], v109 offset:608
  ds_read_b64_tr_b16 a[110:111], v109 offset:9056
  v_mfma_f32_16x16x32_bf16 v[16:19], a[16:19], a[128:131], v[16:19]
  buffer_load_dwordx4 v254, s[12:15], s93 offen offset:2112 lds
  v_mfma_f32_16x16x32_bf16 v[16:19], a[48:51], a[136:139], v[16:19]
  ds_read_b64_tr_b16 a[80:81], v109 offset:128
  ds_read_b64_tr_b16 a[82:83], v109 offset:8576
  ds_read_b64_tr_b16 a[112:113], v109 offset:640
  s_waitcnt lgkmcnt(9)
  ds_read_b64_tr_b16 a[114:115], v109 offset:9088
  v_mfma_f32_16x16x32_bf16 v[20:23], a[20:23], a[128:131], v[20:23]
  ds_read_b64_tr_b16 a[84:85], v109 offset:160
  ds_read_b64_tr_b16 a[86:87], v109 offset:8608
  ds_read_b64_tr_b16 a[116:117], v109 offset:672
  v_mfma_f32_16x16x32_bf16 v[20:23], a[52:55], a[136:139], v[20:23]
  buffer_load_dwordx4 v255, s[12:15], s93 offen offset:3168 lds
  s_add_u32 s93, s94, 14
  s_and_b32 s93, s93, 15
  v_mfma_f32_16x16x32_bf16 v[24:27], a[24:27], a[128:131], v[24:27]
  s_lshl_b32 s93, s93, 16
  ds_read_b64_tr_b16 a[118:119], v109 offset:9120
  ds_read_b64_tr_b16 a[88:89], v109 offset:192
  ds_read_b64_tr_b16 a[90:91], v109 offset:8640
  v_mfma_f32_16x16x32_bf16 v[24:27], a[56:59], a[136:139], v[24:27]
  s_add_u32 m0, s32, 101376
  ds_read_b64_tr_b16 a[120:121], v109 offset:704
  ds_read_b64_tr_b16 a[122:123], v109 offset:9152
  ds_read_b64_tr_b16 a[92:93], v109 offset:224
  v_mfma_f32_16x16x32_bf16 v[28:31], a[28:31], a[128:131], v[28:31]
  buffer_load_dwordx4 v252, s[12:15], s93 offen offset:0 lds
  v_mfma_f32_16x16x32_bf16 v[28:31], a[60:63], a[136:139], v[28:31]
  s_waitcnt vmcnt(18)
  ds_read_b64_tr_b16 a[94:95], v109 offset:8672
  ds_read_b64_tr_b16 a[124:125], v109 offset:736
  ds_read_b64_tr_b16 a[126:127], v109 offset:9184
  v_mfma_f32_16x16x32_bf16 v[0:3], a[64:67], a[144:147], v[0:3]
  s_add_u32 s92, s94, 13
  s_and_b32 s92, s92, 15
  s_lshl_b32 s92, s92, 14
  v_mfma_f32_16x16x32_bf16 v[0:3], a[96:99], a[152:155], v[0:3]
  buffer_load_dwordx4 a[208:211], v104, s[8:11], s92 offen offset:0
  v_mfma_f32_16x16x32_bf16 v[4:7], a[68:71], a[144:147], v[4:7]
  ds_read_b64_tr_b16 a[0:1], v109 offset:33792
  ds_read_b64_tr_b16 a[2:3], v109 offset:42240
  ds_read_b64_tr_b16 a[32:33], v109 offset:34304
  ds_read_b64_tr_b16 a[34:35], v109 offset:42752
  v_mfma_f32_16x16x32_bf16 v[4:7], a[100:103], a[152:155], v[4:7]
  ds_read_b64_tr_b16 a[4:5], v109 offset:33824
  ds_read_b64_tr_b16 a[6:7], v109 offset:42272
  ds_read_b64_tr_b16 a[36:37], v109 offset:34336
  v_mfma_f32_16x16x32_bf16 v[8:11], a[72:75], a[144:147], v[8:11]
  buffer_load_dwordx4 a[216:219], v105, s[8:11], s92 offen offset:0
  s_waitcnt lgkmcnt(7)
  v_mfma_f32_16x16x32_bf16 v[8:11], a[104:107], a[152:155], v[8:11]
  ds_read_b64_tr_b16 a[38:39], v109 offset:42784
  ds_read_b64_tr_b16 a[8:9], v109 offset:33856
  ds_read_b64_tr_b16 a[10:11], v109 offset:42304
  v_mfma_f32_16x16x32_bf16 v[12:15], a[76:79], a[144:147], v[12:15]
  ds_read_b64_tr_b16 a[40:41], v109 offset:34368
  ds_read_b64_tr_b16 a[42:43], v109 offset:42816
  ds_read_b64_tr_b16 a[12:13], v109 offset:33888
  v_mfma_f32_16x16x32_bf16 v[12:15], a[108:111], a[152:155], v[12:15]
  s_add_u32 m0, s32, 101376
  ds_read_b64_tr_b16 a[14:15], v109 offset:42336
  ds_read_b64_tr_b16 a[44:45], v109 offset:34400
  ds_read_b64_tr_b16 a[46:47], v109 offset:42848
  v_mfma_f32_16x16x32_bf16 v[16:19], a[80:83], a[144:147], v[16:19]
  buffer_load_dwordx4 v253, s[12:15], s93 offen offset:1056 lds
  v_mfma_f32_16x16x32_bf16 v[16:19], a[112:115], a[152:155], v[16:19]
  ds_read_b64_tr_b16 a[16:17], v109 offset:33920
  ds_read_b64_tr_b16 a[18:19], v109 offset:42368
  ds_read_b64_tr_b16 a[48:49], v109 offset:34432
  ds_read_b64_tr_b16 a[50:51], v109 offset:42880
  v_mfma_f32_16x16x32_bf16 v[20:23], a[84:87], a[144:147], v[20:23]
  ds_read_b64_tr_b16 a[20:21], v109 offset:33952
  ds_read_b64_tr_b16 a[22:23], v109 offset:42400
  ds_read_b64_tr_b16 a[52:53], v109 offset:34464
  v_mfma_f32_16x16x32_bf16 v[20:23], a[116:119], a[152:155], v[20:23]
  buffer_load_dwordx4 v254, s[12:15], s93 offen offset:2112 lds
  v_mfma_f32_16x16x32_bf16 v[24:27], a[88:91], a[144:147], v[24:27]
  ds_read_b64_tr_b16 a[54:55], v109 offset:42912
  ds_read_b64_tr_b16 a[24:25], v109 offset:33984
  ds_read_b64_tr_b16 a[26:27], v109 offset:42432
  v_mfma_f32_16x16x32_bf16 v[24:27], a[120:123], a[152:155], v[24:27]
  ds_read_b64_tr_b16 a[56:57], v109 offset:34496
  ds_read_b64_tr_b16 a[58:59], v109 offset:42944
  ds_read_b64_tr_b16 a[28:29], v109 offset:34016
  v_mfma_f32_16x16x32_bf16 v[28:31], a[92:95], a[144:147], v[28:31]
  buffer_load_dwordx4 v255, s[12:15], s93 offen offset:3168 lds
  v_mfma_f32_16x16x32_bf16 v[28:31], a[124:127], a[152:155], v[28:31]
  s_waitcnt vmcnt(12)
  ds_read_b64_tr_b16 a[30:31], v109 offset:42464
  ds_read_b64_tr_b16 a[60:61], v109 offset:34528
  s_waitcnt lgkmcnt(8)
  ds_read_b64_tr_b16 a[62:63], v109 offset:42976
  v_mfma_f32_16x16x32_bf16 v[0:3], a[0:3], a[160:163], v[0:3]
  s_barrier
  s_add_u32 s92, s94, 14
  s_and_b32 s92, s92, 15
  s_lshl_b32 s92, s92, 14
  v_mfma_f32_16x16x32_bf16 v[0:3], a[32:35], a[168:171], v[0:3]
  buffer_load_dwordx4 a[224:227], v104, s[8:11], s92 offen offset:0
  v_mfma_f32_16x16x32_bf16 v[4:7], a[4:7], a[160:163], v[4:7]
  ds_read_b64_tr_b16 a[64:65], v110 offset:0
  ds_read_b64_tr_b16 a[66:67], v110 offset:8448
  ds_read_b64_tr_b16 a[96:97], v110 offset:512
  ds_read_b64_tr_b16 a[98:99], v110 offset:8960
  v_mfma_f32_16x16x32_bf16 v[4:7], a[36:39], a[168:171], v[4:7]
  ds_read_b64_tr_b16 a[68:69], v110 offset:32
  ds_read_b64_tr_b16 a[70:71], v110 offset:8480
  ds_read_b64_tr_b16 a[100:101], v110 offset:544
  v_mfma_f32_16x16x32_bf16 v[8:11], a[8:11], a[160:163], v[8:11]
  buffer_load_dwordx4 a[232:235], v105, s[8:11], s92 offen offset:0
  s_add_u32 s93, s94, 15
  v_mfma_f32_16x16x32_bf16 v[8:11], a[40:43], a[168:171], v[8:11]
  s_and_b32 s93, s93, 15
  ds_read_b64_tr_b16 a[102:103], v110 offset:8992
  ds_read_b64_tr_b16 a[72:73], v110 offset:64
  ds_read_b64_tr_b16 a[74:75], v110 offset:8512
  v_mfma_f32_16x16x32_bf16 v[12:15], a[12:15], a[160:163], v[12:15]
  s_lshl_b32 s93, s93, 16
  ds_read_b64_tr_b16 a[104:105], v110 offset:576
  ds_read_b64_tr_b16 a[106:107], v110 offset:9024
  ds_read_b64_tr_b16 a[76:77], v110 offset:96
  v_mfma_f32_16x16x32_bf16 v[12:15], a[44:47], a[168:171], v[12:15]
  s_add_u32 m0, s32, 118272
  ds_read_b64_tr_b16 a[78:79], v110 offset:8544
  ds_read_b64_tr_b16 a[108:109], v110 offset:608
  ds_read_b64_tr_b16 a[110:111], v110 offset:9056
  v_mfma_f32_16x16x32_bf16 v[16:19], a[16:19], a[160:163], v[16:19]
  buffer_load_dwordx4 v252, s[12:15], s93 offen offset:0 lds
  v_mfma_f32_16x16x32_bf16 v[16:19], a[48:51], a[168:171], v[16:19]
  ds_read_b64_tr_b16 a[80:81], v110 offset:128
  ds_read_b64_tr_b16 a[82:83], v110 offset:8576
  ds_read_b64_tr_b16 a[112:113], v110 offset:640
  ds_read_b64_tr_b16 a[114:115], v110 offset:9088
  v_mfma_f32_16x16x32_bf16 v[20:23], a[20:23], a[160:163], v[20:23]
  ds_read_b64_tr_b16 a[84:85], v110 offset:160
  ds_read_b64_tr_b16 a[86:87], v110 offset:8608
  s_waitcnt lgkmcnt(9)
  ds_read_b64_tr_b16 a[116:117], v110 offset:672
  v_mfma_f32_16x16x32_bf16 v[20:23], a[52:55], a[168:171], v[20:23]
  buffer_load_dwordx4 v253, s[12:15], s93 offen offset:1056 lds
  v_mfma_f32_16x16x32_bf16 v[24:27], a[24:27], a[160:163], v[24:27]
  ds_read_b64_tr_b16 a[118:119], v110 offset:9120
  ds_read_b64_tr_b16 a[88:89], v110 offset:192
  ds_read_b64_tr_b16 a[90:91], v110 offset:8640
  v_mfma_f32_16x16x32_bf16 v[24:27], a[56:59], a[168:171], v[24:27]
  ds_read_b64_tr_b16 a[120:121], v110 offset:704
  ds_read_b64_tr_b16 a[122:123], v110 offset:9152
  ds_read_b64_tr_b16 a[92:93], v110 offset:224
  v_mfma_f32_16x16x32_bf16 v[28:31], a[28:31], a[160:163], v[28:31]
  buffer_load_dwordx4 v254, s[12:15], s93 offen offset:2112 lds
  v_mfma_f32_16x16x32_bf16 v[28:31], a[60:63], a[168:171], v[28:31]
  s_waitcnt vmcnt(17)
  ds_read_b64_tr_b16 a[94:95], v110 offset:8672
  ds_read_b64_tr_b16 a[124:125], v110 offset:736
  ds_read_b64_tr_b16 a[126:127], v110 offset:9184
  v_mfma_f32_16x16x32_bf16 v[0:3], a[64:67], a[176:179], v[0:3]
  s_add_u32 s92, s94, 15
  s_and_b32 s92, s92, 15
  v_mfma_f32_16x16x32_bf16 v[0:3], a[96:99], a[184:187], v[0:3]
  s_lshl_b32 s92, s92, 14
  ds_read_b64_tr_b16 a[0:1], v110 offset:16896
  ds_read_b64_tr_b16 a[2:3], v110 offset:25344
  ds_read_b64_tr_b16 a[32:33], v110 offset:17408
  v_mfma_f32_16x16x32_bf16 v[4:7], a[68:71], a[176:179], v[4:7]
  buffer_load_dwordx4 a[240:243], v104, s[8:11], s92 offen offset:0
  v_mfma_f32_16x16x32_bf16 v[4:7], a[100:103], a[184:187], v[4:7]
  ds_read_b64_tr_b16 a[34:35], v110 offset:25856
  ds_read_b64_tr_b16 a[4:5], v110 offset:16928
  ds_read_b64_tr_b16 a[6:7], v110 offset:25376
  v_mfma_f32_16x16x32_bf16 v[8:11], a[72:75], a[176:179], v[8:11]
  ds_read_b64_tr_b16 a[36:37], v110 offset:17440
  ds_read_b64_tr_b16 a[38:39], v110 offset:25888
  v_mfma_f32_16x16x32_bf16 v[8:11], a[104:107], a[184:187], v[8:11]
  ds_read_b64_tr_b16 a[8:9], v110 offset:16960
  ds_read_b64_tr_b16 a[10:11], v110 offset:25408
  s_waitcnt lgkmcnt(9)
  ds_read_b64_tr_b16 a[40:41], v110 offset:17472
  v_mfma_f32_16x16x32_bf16 v[12:15], a[76:79], a[176:179], v[12:15]
  ds_read_b64_tr_b16 a[42:43], v110 offset:25920
  ds_read_b64_tr_b16 a[12:13], v110 offset:16992
  ds_read_b64_tr_b16 a[14:15], v110 offset:25440
  v_mfma_f32_16x16x32_bf16 v[12:15], a[108:111], a[184:187], v[12:15]
  ds_read_b64_tr_b16 a[44:45], v110 offset:17504
  ds_read_b64_tr_b16 a[46:47], v110 offset:25952
  v_mfma_f32_16x16x32_bf16 v[16:19], a[80:83], a[176:179], v[16:19]
  buffer_load_dwordx4 a[248:251], v105, s[8:11], s92 offen offset:0
  v_mfma_f32_16x16x32_bf16 v[16:19], a[112:115], a[184:187], v[16:19]
  ds_read_b64_tr_b16 a[16:17], v110 offset:17024
  ds_read_b64_tr_b16 a[18:19], v110 offset:25472
  ds_read_b64_tr_b16 a[48:49], v110 offset:17536
  v_mfma_f32_16x16x32_bf16 v[20:23], a[84:87], a[176:179], v[20:23]
  ds_read_b64_tr_b16 a[50:51], v110 offset:25984
  ds_read_b64_tr_b16 a[20:21], v110 offset:17056
  ds_read_b64_tr_b16 a[22:23], v110 offset:25504
  v_mfma_f32_16x16x32_bf16 v[20:23], a[116:119], a[184:187], v[20:23]
  ds_read_b64_tr_b16 a[52:53], v110 offset:17568
  ds_read_b64_tr_b16 a[54:55], v110 offset:26016
  v_mfma_f32_16x16x32_bf16 v[24:27], a[88:91], a[176:179], v[24:27]
  s_add_u32 m0, s32, 118272
  ds_read_b64_tr_b16 a[24:25], v110 offset:17088
  ds_read_b64_tr_b16 a[26:27], v110 offset:25536
  ds_read_b64_tr_b16 a[56:57], v110 offset:17600
  v_mfma_f32_16x16x32_bf16 v[24:27], a[120:123], a[184:187], v[24:27]
  buffer_load_dwordx4 v255, s[12:15], s93 offen offset:3168 lds
  v_mfma_f32_16x16x32_bf16 v[28:31], a[92:95], a[176:179], v[28:31]
  ds_read_b64_tr_b16 a[58:59], v110 offset:26048
  ds_read_b64_tr_b16 a[28:29], v110 offset:17120
  ds_read_b64_tr_b16 a[30:31], v110 offset:25568
  v_mfma_f32_16x16x32_bf16 v[28:31], a[124:127], a[184:187], v[28:31]
  s_waitcnt vmcnt(8)
  ds_read_b64_tr_b16 a[60:61], v110 offset:17632
  s_waitcnt lgkmcnt(7)
  ds_read_b64_tr_b16 a[62:63], v110 offset:26080
  v_mfma_f32_16x16x32_bf16 v[0:3], a[0:3], a[192:195], v[0:3]
  s_barrier
  v_mfma_f32_16x16x32_bf16 v[0:3], a[32:35], a[200:203], v[0:3]
  ds_read_b64_tr_b16 a[64:65], v110 offset:33792
  ds_read_b64_tr_b16 a[66:67], v110 offset:42240
  ds_read_b64_tr_b16 a[96:97], v110 offset:34304
  v_mfma_f32_16x16x32_bf16 v[4:7], a[4:7], a[192:195], v[4:7]
  ds_read_b64_tr_b16 a[98:99], v110 offset:42752
  ds_read_b64_tr_b16 a[68:69], v110 offset:33824
  v_mfma_f32_16x16x32_bf16 v[4:7], a[36:39], a[200:203], v[4:7]
  ds_read_b64_tr_b16 a[70:71], v110 offset:42272
  ds_read_b64_tr_b16 a[100:101], v110 offset:34336
  v_mfma_f32_16x16x32_bf16 v[8:11], a[8:11], a[192:195], v[8:11]
  ds_read_b64_tr_b16 a[102:103], v110 offset:42784
  ds_read_b64_tr_b16 a[72:73], v110 offset:33856
  v_mfma_f32_16x16x32_bf16 v[8:11], a[40:43], a[200:203], v[8:11]
  ds_read_b64_tr_b16 a[74:75], v110 offset:42304
  ds_read_b64_tr_b16 a[104:105], v110 offset:34368
  v_mfma_f32_16x16x32_bf16 v[12:15], a[12:15], a[192:195], v[12:15]
  ds_read_b64_tr_b16 a[106:107], v110 offset:42816
  ds_read_b64_tr_b16 a[76:77], v110 offset:33888
  v_mfma_f32_16x16x32_bf16 v[12:15], a[44:47], a[200:203], v[12:15]
  ds_read_b64_tr_b16 a[78:79], v110 offset:42336
  ds_read_b64_tr_b16 a[108:109], v110 offset:34400
  v_mfma_f32_16x16x32_bf16 v[16:19], a[16:19], a[192:195], v[16:19]
  ds_read_b64_tr_b16 a[110:111], v110 offset:42848
  ds_read_b64_tr_b16 a[80:81], v110 offset:33920
  ds_read_b64_tr_b16 a[82:83], v110 offset:42368
  v_mfma_f32_16x16x32_bf16 v[16:19], a[48:51], a[200:203], v[16:19]
  ds_read_b64_tr_b16 a[112:113], v110 offset:34432
  ds_read_b64_tr_b16 a[114:115], v110 offset:42880
  v_mfma_f32_16x16x32_bf16 v[20:23], a[20:23], a[192:195], v[20:23]
  ds_read_b64_tr_b16 a[84:85], v110 offset:33952
  ds_read_b64_tr_b16 a[86:87], v110 offset:42400
  v_mfma_f32_16x16x32_bf16 v[20:23], a[52:55], a[200:203], v[20:23]
  ds_read_b64_tr_b16 a[116:117], v110 offset:34464
  s_waitcnt lgkmcnt(10)
  ds_read_b64_tr_b16 a[118:119], v110 offset:42912
  v_mfma_f32_16x16x32_bf16 v[24:27], a[24:27], a[192:195], v[24:27]
  ds_read_b64_tr_b16 a[88:89], v110 offset:33984
  ds_read_b64_tr_b16 a[90:91], v110 offset:42432
  v_mfma_f32_16x16x32_bf16 v[24:27], a[56:59], a[200:203], v[24:27]
  ds_read_b64_tr_b16 a[120:121], v110 offset:34496
  ds_read_b64_tr_b16 a[122:123], v110 offset:42944
  v_mfma_f32_16x16x32_bf16 v[28:31], a[28:31], a[192:195], v[28:31]
  ds_read_b64_tr_b16 a[92:93], v110 offset:34016
  ds_read_b64_tr_b16 a[94:95], v110 offset:42464
  v_mfma_f32_16x16x32_bf16 v[28:31], a[60:63], a[200:203], v[28:31]
  s_waitcnt vmcnt(8)
  ds_read_b64_tr_b16 a[124:125], v110 offset:34528
  ds_read_b64_tr_b16 a[126:127], v110 offset:42976
  v_mfma_f32_16x16x32_bf16 v[0:3], a[64:67], a[208:211], v[0:3]
  v_mfma_f32_16x16x32_bf16 v[0:3], a[96:99], a[216:219], v[0:3]
  ds_read_b64_tr_b16 a[0:1], v111 offset:0
  ds_read_b64_tr_b16 a[2:3], v111 offset:8448
  ds_read_b64_tr_b16 a[32:33], v111 offset:512
  v_mfma_f32_16x16x32_bf16 v[4:7], a[68:71], a[208:211], v[4:7]
  ds_read_b64_tr_b16 a[34:35], v111 offset:8960
  ds_read_b64_tr_b16 a[4:5], v111 offset:32
  v_mfma_f32_16x16x32_bf16 v[4:7], a[100:103], a[216:219], v[4:7]
  ds_read_b64_tr_b16 a[6:7], v111 offset:8480
  ds_read_b64_tr_b16 a[36:37], v111 offset:544
  v_mfma_f32_16x16x32_bf16 v[8:11], a[72:75], a[208:211], v[8:11]
  ds_read_b64_tr_b16 a[38:39], v111 offset:8992
  ds_read_b64_tr_b16 a[8:9], v111 offset:64
  v_mfma_f32_16x16x32_bf16 v[8:11], a[104:107], a[216:219], v[8:11]
  ds_read_b64_tr_b16 a[10:11], v111 offset:8512
  s_waitcnt lgkmcnt(10)
  ds_read_b64_tr_b16 a[40:41], v111 offset:576
  v_mfma_f32_16x16x32_bf16 v[12:15], a[76:79], a[208:211], v[12:15]
  ds_read_b64_tr_b16 a[42:43], v111 offset:9024
  ds_read_b64_tr_b16 a[12:13], v111 offset:96
  v_mfma_f32_16x16x32_bf16 v[12:15], a[108:111], a[216:219], v[12:15]
  ds_read_b64_tr_b16 a[14:15], v111 offset:8544
  ds_read_b64_tr_b16 a[44:45], v111 offset:608
  v_mfma_f32_16x16x32_bf16 v[16:19], a[80:83], a[208:211], v[16:19]
  ds_read_b64_tr_b16 a[46:47], v111 offset:9056
  ds_read_b64_tr_b16 a[16:17], v111 offset:128
  ds_read_b64_tr_b16 a[18:19], v111 offset:8576
  v_mfma_f32_16x16x32_bf16 v[16:19], a[112:115], a[216:219], v[16:19]
  ds_read_b64_tr_b16 a[48:49], v111 offset:640
  ds_read_b64_tr_b16 a[50:51], v111 offset:9088
  v_mfma_f32_16x16x32_bf16 v[20:23], a[84:87], a[208:211], v[20:23]
  ds_read_b64_tr_b16 a[20:21], v111 offset:160
  ds_read_b64_tr_b16 a[22:23], v111 offset:8608
  v_mfma_f32_16x16x32_bf16 v[20:23], a[116:119], a[216:219], v[20:23]
  ds_read_b64_tr_b16 a[52:53], v111 offset:672
  ds_read_b64_tr_b16 a[54:55], v111 offset:9120
  v_mfma_f32_16x16x32_bf16 v[24:27], a[88:91], a[208:211], v[24:27]
  ds_read_b64_tr_b16 a[24:25], v111 offset:192
  ds_read_b64_tr_b16 a[26:27], v111 offset:8640
  v_mfma_f32_16x16x32_bf16 v[24:27], a[120:123], a[216:219], v[24:27]
  ds_read_b64_tr_b16 a[56:57], v111 offset:704
  ds_read_b64_tr_b16 a[58:59], v111 offset:9152
  v_mfma_f32_16x16x32_bf16 v[28:31], a[92:95], a[208:211], v[28:31]
  ds_read_b64_tr_b16 a[28:29], v111 offset:224
  ds_read_b64_tr_b16 a[30:31], v111 offset:8672
  v_mfma_f32_16x16x32_bf16 v[28:31], a[124:127], a[216:219], v[28:31]
  s_waitcnt vmcnt(0)
  ds_read_b64_tr_b16 a[60:61], v111 offset:736
  s_waitcnt lgkmcnt(9)
  ds_read_b64_tr_b16 a[62:63], v111 offset:9184
  v_mfma_f32_16x16x32_bf16 v[0:3], a[0:3], a[224:227], v[0:3]
  s_barrier
  v_mfma_f32_16x16x32_bf16 v[0:3], a[32:35], a[232:235], v[0:3]
  ds_read_b64_tr_b16 a[64:65], v111 offset:16896
  ds_read_b64_tr_b16 a[66:67], v111 offset:25344
  ds_read_b64_tr_b16 a[96:97], v111 offset:17408
  v_mfma_f32_16x16x32_bf16 v[4:7], a[4:7], a[224:227], v[4:7]
  ds_read_b64_tr_b16 a[98:99], v111 offset:25856
  ds_read_b64_tr_b16 a[68:69], v111 offset:16928
  v_mfma_f32_16x16x32_bf16 v[4:7], a[36:39], a[232:235], v[4:7]
  ds_read_b64_tr_b16 a[70:71], v111 offset:25376
  ds_read_b64_tr_b16 a[100:101], v111 offset:17440
  v_mfma_f32_16x16x32_bf16 v[8:11], a[8:11], a[224:227], v[8:11]
  ds_read_b64_tr_b16 a[102:103], v111 offset:25888
  ds_read_b64_tr_b16 a[72:73], v111 offset:16960
  v_mfma_f32_16x16x32_bf16 v[8:11], a[40:43], a[232:235], v[8:11]
  ds_read_b64_tr_b16 a[74:75], v111 offset:25408
  ds_read_b64_tr_b16 a[104:105], v111 offset:17472
  v_mfma_f32_16x16x32_bf16 v[12:15], a[12:15], a[224:227], v[12:15]
  ds_read_b64_tr_b16 a[106:107], v111 offset:25920
  ds_read_b64_tr_b16 a[76:77], v111 offset:16992
  v_mfma_f32_16x16x32_bf16 v[12:15], a[44:47], a[232:235], v[12:15]
  ds_read_b64_tr_b16 a[78:79], v111 offset:25440
  ds_read_b64_tr_b16 a[108:109], v111 offset:17504
  v_mfma_f32_16x16x32_bf16 v[16:19], a[16:19], a[224:227], v[16:19]
  ds_read_b64_tr_b16 a[110:111], v111 offset:25952
  ds_read_b64_tr_b16 a[80:81], v111 offset:17024
  ds_read_b64_tr_b16 a[82:83], v111 offset:25472
  v_mfma_f32_16x16x32_bf16 v[16:19], a[48:51], a[232:235], v[16:19]
  ds_read_b64_tr_b16 a[112:113], v111 offset:17536
  ds_read_b64_tr_b16 a[114:115], v111 offset:25984
  v_mfma_f32_16x16x32_bf16 v[20:23], a[20:23], a[224:227], v[20:23]
  ds_read_b64_tr_b16 a[84:85], v111 offset:17056
  s_waitcnt lgkmcnt(10)
  ds_read_b64_tr_b16 a[86:87], v111 offset:25504
  v_mfma_f32_16x16x32_bf16 v[20:23], a[52:55], a[232:235], v[20:23]
  ds_read_b64_tr_b16 a[116:117], v111 offset:17568
  ds_read_b64_tr_b16 a[118:119], v111 offset:26016
  v_mfma_f32_16x16x32_bf16 v[24:27], a[24:27], a[224:227], v[24:27]
  ds_read_b64_tr_b16 a[88:89], v111 offset:17088
  ds_read_b64_tr_b16 a[90:91], v111 offset:25536
  v_mfma_f32_16x16x32_bf16 v[24:27], a[56:59], a[232:235], v[24:27]
  ds_read_b64_tr_b16 a[120:121], v111 offset:17600
  ds_read_b64_tr_b16 a[122:123], v111 offset:26048
  v_mfma_f32_16x16x32_bf16 v[28:31], a[28:31], a[224:227], v[28:31]
  ds_read_b64_tr_b16 a[92:93], v111 offset:17120
  ds_read_b64_tr_b16 a[94:95], v111 offset:25568
  v_mfma_f32_16x16x32_bf16 v[28:31], a[60:63], a[232:235], v[28:31]
  ds_read_b64_tr_b16 a[124:125], v111 offset:17632
  ds_read_b64_tr_b16 a[126:127], v111 offset:26080
  s_lshl_b32 s33, s3, 2
  s_add_u32 s33, s33, s36
  s_lshl_b32 s33, s33, 14
  s_add_u32 s35, s33, 4096
  s_cmp_eq_u32 s3, s36
  s_cbranch_scc1 L_g1_own
  s_waitcnt vmcnt(1)
  v_mfma_f32_16x16x32_bf16 v[0:3], a[64:67], a[240:243], v[0:3]
  v_mfma_f32_16x16x32_bf16 v[0:3], a[96:99], a[248:251], v[0:3]
  v_mfma_f32_16x16x32_bf16 v[4:7], a[68:71], a[240:243], v[4:7]
  v_mfma_f32_16x16x32_bf16 v[4:7], a[100:103], a[248:251], v[4:7]
  v_mfma_f32_16x16x32_bf16 v[8:11], a[72:75], a[240:243], v[8:11]
  s_waitcnt lgkmcnt(6)
  v_mfma_f32_16x16x32_bf16 v[8:11], a[104:107], a[248:251], v[8:11]
  v_mfma_f32_16x16x32_bf16 v[12:15], a[76:79], a[240:243], v[12:15]
  v_mfma_f32_16x16x32_bf16 v[12:15], a[108:111], a[248:251], v[12:15]
  v_mfma_f32_16x16x32_bf16 v[16:19], a[80:83], a[240:243], v[16:19]
  v_mfma_f32_16x16x32_bf16 v[16:19], a[112:115], a[248:251], v[16:19]
  v_cvt_pk_bf16_f32 v64, v0, v1
  v_cvt_pk_bf16_f32 v65, v2, v3
  v_cvt_pk_bf16_f32 v66, v4, v5
  v_cvt_pk_bf16_f32 v67, v6, v7
  buffer_store_dwordx4 v[64:67], v108, s[16:19], s33 offen offset:0 sc1
  v_mfma_f32_16x16x32_bf16 v[20:23], a[84:87], a[240:243], v[20:23]
  v_cvt_pk_bf16_f32 v68, v8, v9
  v_cvt_pk_bf16_f32 v69, v10, v11
  v_mfma_f32_16x16x32_bf16 v[20:23], a[116:119], a[248:251], v[20:23]
  v_mfma_f32_16x16x32_bf16 v[24:27], a[88:91], a[240:243], v[24:27]
  s_waitcnt lgkmcnt(0)
  v_cvt_pk_bf16_f32 v70, v12, v13
  v_cvt_pk_bf16_f32 v71, v14, v15
  v_mfma_f32_16x16x32_bf16 v[24:27], a[120:123], a[248:251], v[24:27]
  buffer_store_dwordx4 v[68:71], v108, s[16:19], s33 offen offset:1024 sc1
  v_mfma_f32_16x16x32_bf16 v[28:31], a[92:95], a[240:243], v[28:31]
  v_cvt_pk_bf16_f32 v72, v16, v17
  v_cvt_pk_bf16_f32 v73, v18, v19
  v_mfma_f32_16x16x32_bf16 v[28:31], a[124:127], a[248:251], v[28:31]
  v_cvt_pk_bf16_f32 v74, v20, v21
  v_cvt_pk_bf16_f32 v75, v22, v23
  buffer_store_dwordx4 v[72:75], v108, s[16:19], s33 offen offset:2048 sc1
  v_cvt_pk_bf16_f32 v76, v24, v25
  v_cvt_pk_bf16_f32 v77, v26, v27
  s_nop 2
  v_cvt_pk_bf16_f32 v78, v28, v29
  v_cvt_pk_bf16_f32 v79, v30, v31
  buffer_store_dwordx4 v[76:79], v108, s[16:19], s33 offen offset:3072 sc1
  s_barrier
  s_branch L_fin_s
L_g1_own:
  s_waitcnt vmcnt(1)
  v_mfma_f32_16x16x32_bf16 v[0:3], a[64:67], a[240:243], v[0:3]
  v_mfma_f32_16x16x32_bf16 v[0:3], a[96:99], a[248:251], v[0:3]
  v_mfma_f32_16x16x32_bf16 v[4:7], a[68:71], a[240:243], v[4:7]
  v_mfma_f32_16x16x32_bf16 v[4:7], a[100:103], a[248:251], v[4:7]
  v_mfma_f32_16x16x32_bf16 v[8:11], a[72:75], a[240:243], v[8:11]
  s_waitcnt lgkmcnt(6)
  v_mfma_f32_16x16x32_bf16 v[8:11], a[104:107], a[248:251], v[8:11]
  v_mfma_f32_16x16x32_bf16 v[12:15], a[76:79], a[240:243], v[12:15]
  v_mfma_f32_16x16x32_bf16 v[12:15], a[108:111], a[248:251], v[12:15]
  v_mfma_f32_16x16x32_bf16 v[16:19], a[80:83], a[240:243], v[16:19]
  v_mfma_f32_16x16x32_bf16 v[16:19], a[112:115], a[248:251], v[16:19]
  ds_write_b128 v108, v[0:3] offset:0
  v_mfma_f32_16x16x32_bf16 v[20:23], a[84:87], a[240:243], v[20:23]
  ds_write_b128 v108, v[4:7] offset:1024
  v_mfma_f32_16x16x32_bf16 v[20:23], a[116:119], a[248:251], v[20:23]
  ds_write_b128 v108, v[8:11] offset:2048
  v_mfma_f32_16x16x32_bf16 v[24:27], a[88:91], a[240:243], v[24:27]
  ds_write_b128 v108, v[12:15] offset:3072
  s_waitcnt lgkmcnt(4)
  v_mfma_f32_16x16x32_bf16 v[24:27], a[120:123], a[248:251], v[24:27]
  v_mfma_f32_16x16x32_bf16 v[28:31], a[92:95], a[240:243], v[28:31]
  ds_write_b128 v108, v[16:19] offset:4096
  v_mfma_f32_16x16x32_bf16 v[28:31], a[124:127], a[248:251], v[28:31]
  ds_write_b128 v108, v[20:23] offset:5120
  s_nop 3
  ds_write_b128 v108, v[24:27] offset:6144
  s_nop 1
  ds_write_b128 v108, v[28:31] offset:7168
  s_waitcnt lgkmcnt(0)
  s_barrier
  s_branch L_fin
L_fin_s:
  s_lshl_b32 s33, s3, 5
  s_add_u32 s33, s33, s36
  s_lshl_b32 s33, s33, 2
  s_add_u32 s33, s33, s30
  v_mov_b32 v96, s33
  v_mov_b32 v97, 1
  s_waitcnt vmcnt(0)
  s_mov_b64 exec, 1
  global_store_dword v96, v97, s[44:45] sc1
  s_mov_b64 exec, -1
L_fin:
  ds_read_b128 v[0:3], v106 offset:0
  ds_read_b128 v[4:7], v106 offset:1024
  ds_read_b128 v[8:11], v106 offset:2048
  ds_read_b128 v[12:15], v106 offset:3072
  s_mov_b32 s34, 0
L_fin_p:
  global_load_dword v97, v114, s[44:45] sc1
  s_waitcnt vmcnt(0)
  v_cmp_ne_u32 vcc, 1, v97
  s_add_u32 s34, s34, 1
  s_cbranch_vccz L_fin_ok
  s_sleep 1
  s_cmp_lt_u32 s34, 0x200000
  s_cbranch_scc1 L_fin_p
L_fin_ok:
  buffer_load_dwordx4 v[24:27], v115, s[16:19], s49 offen offset:0 sc1
  buffer_load_dwordx4 v[28:31], v115, s[16:19], s49 offen offset:1024 sc1
  buffer_load_dwordx4 v[32:35], v115, s[16:19], s50 offen offset:0 sc1
  buffer_load_dwordx4 v[36:39], v115, s[16:19], s50 offen offset:1024 sc1
  buffer_load_dwordx4 v[40:43], v115, s[16:19], s51 offen offset:0 sc1
  buffer_load_dwordx4 v[44:47], v115, s[16:19], s51 offen offset:1024 sc1
  s_waitcnt vmcnt(4)
  v_lshlrev_b32 v64, 16, v24
  v_and_b32 v72, 0xffff0000, v24
  v_lshlrev_b32 v65, 16, v25
  v_and_b32 v73, 0xffff0000, v25
  v_lshlrev_b32 v66, 16, v26
  v_and_b32 v74, 0xffff0000, v26
  v_lshlrev_b32 v67, 16, v27
  v_and_b32 v75, 0xffff0000, v27
  v_lshlrev_b32 v68, 16, v28
  v_and_b32 v76, 0xffff0000, v28
  v_lshlrev_b32 v69, 16, v29
  v_and_b32 v77, 0xffff0000, v29
  v_lshlrev_b32 v70, 16, v30
  v_and_b32 v78, 0xffff0000, v30
  v_lshlrev_b32 v71, 16, v31
  v_and_b32 v79, 0xffff0000, v31
  s_waitcnt lgkmcnt(0)
  v_add_f32 v0, v0, v64
  v_add_f32 v1, v1, v72
  v_add_f32 v2, v2, v65
  v_add_f32 v3, v3, v73
  v_add_f32 v4, v4, v66
  v_add_f32 v5, v5, v74
  v_add_f32 v6, v6, v67
  v_add_f32 v7, v7, v75
  v_add_f32 v8, v8, v68
  v_add_f32 v9, v9, v76
  v_add_f32 v10, v10, v69
  v_add_f32 v11, v11, v77
  v_add_f32 v12, v12, v70
  v_add_f32 v13, v13, v78
  v_add_f32 v14, v14, v71
  v_add_f32 v15, v15, v79
  s_waitcnt vmcnt(2)
  v_lshlrev_b32 v64, 16, v32
  v_and_b32 v72, 0xffff0000, v32
  v_lshlrev_b32 v65, 16, v33
  v_and_b32 v73, 0xffff0000, v33
  v_lshlrev_b32 v66, 16, v34
  v_and_b32 v74, 0xffff0000, v34
  v_lshlrev_b32 v67, 16, v35
  v_and_b32 v75, 0xffff0000, v35
  v_lshlrev_b32 v68, 16, v36
  v_and_b32 v76, 0xffff0000, v36
  v_lshlrev_b32 v69, 16, v37
  v_and_b32 v77, 0xffff0000, v37
  v_lshlrev_b32 v70, 16, v38
  v_and_b32 v78, 0xffff0000, v38
  v_lshlrev_b32 v71, 16, v39
  v_and_b32 v79, 0xffff0000, v39
  v_add_f32 v0, v0, v64
  v_add_f32 v1, v1, v72
  v_add_f32 v2, v2, v65
  v_add_f32 v3, v3, v73
  v_add_f32 v4, v4, v66
  v_add_f32 v5, v5, v74
  v_add_f32 v6, v6, v67
  v_add_f32 v7, v7, v75
  v_add_f32 v8, v8, v68
  v_add_f32 v9, v9, v76
  v_add_f32 v10, v10, v69
  v_add_f32 v11, v11, v77
  v_add_f32 v12, v12, v70
  v_add_f32 v13, v13, v78
  v_add_f32 v14, v14, v71
  v_add_f32 v15, v15, v79
  s_waitcnt vmcnt(0)
  v_lshlrev_b32 v64, 16, v40
  v_and_b32 v72, 0xffff0000, v40
  v_lshlrev_b32 v65, 16, v41
  v_and_b32 v73, 0xffff0000, v41
  v_lshlrev_b32 v66, 16, v42
  v_and_b32 v74, 0xffff0000, v42
  v_lshlrev_b32 v67, 16, v43
  v_and_b32 v75, 0xffff0000, v43
  v_lshlrev_b32 v68, 16, v44
  v_and_b32 v76, 0xffff0000, v44
  v_lshlrev_b32 v69, 16, v45
  v_and_b32 v77, 0xffff0000, v45
  v_lshlrev_b32 v70, 16, v46
  v_and_b32 v78, 0xffff0000, v46
  v_lshlrev_b32 v71, 16, v47
  v_and_b32 v79, 0xffff0000, v47
  v_add_f32 v0, v0, v64
  v_add_f32 v1, v1, v72
  v_add_f32 v2, v2, v65
  v_add_f32 v3, v3, v73
  v_add_f32 v4, v4, v66
  v_add_f32 v5, v5, v74
  v_add_f32 v6, v6, v67
  v_add_f32 v7, v7, v75
  v_add_f32 v8, v8, v68
  v_add_f32 v9, v9, v76
  v_add_f32 v10, v10, v69
  v_add_f32 v11, v11, v77
  v_add_f32 v12, v12, v70
  v_add_f32 v13, v13, v78
  v_add_f32 v14, v14, v71
  v_add_f32 v15, v15, v79
  v_cvt_pk_bf16_f32 v16, v0, v1
  v_cvt_pk_bf16_f32 v17, v2, v3
  v_cvt_pk_bf16_f32 v18, v4, v5
  v_cvt_pk_bf16_f32 v19, v6, v7
  v_cvt_pk_bf16_f32 v20, v8, v9
  v_cvt_pk_bf16_f32 v21, v10, v11
  v_cvt_pk_bf16_f32 v22, v12, v13
  v_cvt_pk_bf16_f32 v23, v14, v15
  buffer_store_dwordx2 v[16:17], v107, s[40:43], 0 offen offset:0
  buffer_store_dwordx2 v[18:19], v107, s[40:43], 0 offen offset:32
  buffer_store_dwordx2 v[20:21], v107, s[40:43], 0 offen offset:64
  buffer_store_dwordx2 v[22:23], v107, s[40:43], 0 offen offset:96
  s_endpgm
L_k1_done:
  s_endpgm
.section .rodata,"a"
.p2align 6
.amdhsa_kernel standalone__mha_block_cached__near_ridge_kernel
  .amdhsa_next_free_vgpr 512
  .amdhsa_next_free_sgpr 102
  .amdhsa_accum_offset 256
  .amdhsa_group_segment_fixed_size 0
  .amdhsa_kernarg_size 64
  .amdhsa_user_sgpr_count 2
  .amdhsa_user_sgpr_kernarg_segment_ptr 1
  .amdhsa_system_sgpr_workgroup_id_x 1
.end_amdhsa_kernel
```
